```python
import torch

def _softmax(x, axis=-1):
    return torch.softmax(x, dim=axis)
def _gelu(x):
    return torch.nn.functional.gelu(x, approximate="tanh")
def _silu(x):
    return torch.nn.functional.silu(x)
def _sigmoid(x):
    return torch.sigmoid(x)
def _layernorm(x, axis=-1, eps=1e-5):
    m = x.mean(dim=axis, keepdim=True)
    v = x.var(dim=axis, keepdim=True, unbiased=False)
    return (x - m) / torch.sqrt(v + eps)
def _scatter_add(tgt, idx, src, axis=0):
    return tgt.clone().index_add_(axis, idx, src)
def _segment_sum(src, seg, n):
    out = torch.zeros((n,) + src.shape[1:], dtype=src.dtype)
    return out.index_add_(0, seg, src)
def _pad(x, pw):
    flat = tuple(v for pair in reversed(pw) for v in pair)
    return torch.nn.functional.pad(x, flat)

kernel_name = 'parallel_sum__softmax_full_mha__dense_activation_relu__prompt'

def setup_inputs():

    _w = (lambda a: (lambda t: t.to(torch.bfloat16) if t.is_floating_point() else t)(torch.as_tensor(a)))
    def _A_setup():
        B, S, D = 1, 2048, 576
        return {
            "x": _w((lambda *s: torch.randn(*s, dtype=torch.bfloat16) * 0.05)(B, S, D)),
            "wqkv": _w((lambda *s: torch.randn(*s, dtype=torch.bfloat16) * 0.2)(D, 3 * D)),
            "wo": _w((lambda *s: torch.randn(*s, dtype=torch.bfloat16) * 0.1)(D, D)),
        }
    _A_in = _A_setup()

    def _B_setup():
        B, S, D, Dff = 1, 2048, 576, 4608
        return {
            "x": _w((lambda *s: torch.randn(*s, dtype=torch.bfloat16) * 0.05)(B, S, D)),
            "w1": _w((lambda *s: torch.randn(*s, dtype=torch.bfloat16) * 0.1)(D, Dff)),
            "w2": _w((lambda *s: torch.randn(*s, dtype=torch.bfloat16) * 0.1)(Dff, D)),
        }
    _B_in = _B_setup()

    return {
        "A_x": _A_in["x"],
        "A_wqkv": _A_in["wqkv"],
        "A_wo": _A_in["wo"],
        "B_x": _B_in["x"],
        "B_w1": _B_in["w1"],
        "B_w2": _B_in["w2"],
    }

def reference(A_x, A_wqkv, A_wo, B_x, B_w1, B_w2):
    def _A_ref(x, wqkv, wo):
        B, S, D = x.shape
        H = 32; Dh = D // H
        qkv = (lambda x, *d: x.permute(*d))((x @ wqkv).reshape(B, S, 3, H, Dh), 2, 0, 3, 1, 4)
        q, k, v = qkv[0], qkv[1], qkv[2]
        scale = Dh ** -0.5
        scores = torch.einsum("bhqd,bhkd->bhqk", q, k) * scale
        p = _softmax(scores, axis=-1)
        o = torch.einsum("bhqk,bhkd->bhqd", p, v)
        return (lambda x, *d: x.permute(*d))(o, 0, 2, 1, 3).reshape(B, S, D) @ wo

    def _B_ref(x, w1, w2):
        h = torch.einsum("bsd,df->bsf", x, w1)
        zero = torch.zeros_like(h)
        h = torch.maximum(h, zero)
        return torch.einsum("bsf,fd->bsd", h, w2)

    x = A_x
    xn = _layernorm(x, axis=-1)
    return x + _A_ref(xn, A_wqkv, A_wo) + _B_ref(xn, B_w1, B_w2)
```

```asm
; @launch grid=(256,1,1) block=(256,1,1) lds=163840
.amdgcn_target "amdgcn-amd-amdhsa--gfx950"
.text
.globl parallel_sum__softmax_full_mha__dense_activation_relu__prompt_kernel
.p2align 8
.type parallel_sum__softmax_full_mha__dense_activation_relu__prompt_kernel,@function
parallel_sum__softmax_full_mha__dense_activation_relu__prompt_kernel:
    s_cmp_ge_u32 s2, 256
    s_cbranch_scc1 parallel_sum__softmax_full_mha__dense_activation_relu__prompt_kernel_end
    v_and_b32 v255, 63, v0
    v_lshrrev_b32 v1, 6, v0
    s_nop 0
    v_readfirstlane_b32 s40, v1
    s_load_dwordx2 s[38:39], s[0:1], 56
    s_load_dwordx2 s[60:61], s[0:1], 16
    s_getpc_b64 s[62:63]
parallel_sum__softmax_full_mha__dense_activation_relu__prompt_kernel_pc:
    s_lshr_b32 s3, s2, 3
    s_and_b32 s3, s3, 3
    s_lshl_b32 s3, s3, 2
    s_add_u32 s3, s3, s40
    s_lshl_b32 s3, s3, 13
    v_lshlrev_b32 v241, 7, v255
    v_add_u32 v241, s3, v241
    v_min_u32 v242, parallel_sum__softmax_full_mha__dense_activation_relu__prompt_kernel_codeend-parallel_sum__softmax_full_mha__dense_activation_relu__prompt_kernel_pc-4, v241
    global_load_dword v243, v242, s[62:63]
    s_or_b32 s3, s2, s40
    s_cmp_lg_u32 s3, 0
    s_cbranch_scc1 parallel_sum__softmax_full_mha__dense_activation_relu__prompt_kernel_notag0
    s_memrealtime s[64:65]
    s_waitcnt lgkmcnt(0)
    s_or_b32 s64, s64, 1
    v_mov_b32 v2, s64
    v_mov_b32 v3, 0
    s_mov_b64 exec, 1
    global_store_dword v3, v2, s[38:39] sc1
    s_mov_b64 exec, -1
parallel_sum__softmax_full_mha__dense_activation_relu__prompt_kernel_notag0:
    s_load_dwordx4 s[4:7], s[0:1], 0
    s_load_dwordx4 s[32:35], s[0:1], 32
    s_load_dwordx2 s[36:37], s[0:1], 64
    s_and_b32 s56, s2, 7
    s_lshr_b32 s57, s2, 3
    s_and_b32 s41, s56, 1
    s_and_b32 s58, s57, 7
    s_lshl_b32 s58, s58, 1
    s_add_u32 s41, s41, s58
    s_lshr_b32 s42, s56, 1
    s_lshr_b32 s58, s57, 3
    s_lshl_b32 s58, s58, 2
    s_add_u32 s42, s42, s58
    v_lshrrev_b32 v224, 3, v255
    v_lshrrev_b32 v225, 1, v224
    v_and_b32 v226, 7, v255
    v_xor_b32 v226, v226, v225
    v_mul_u32_u24 v224, 1152, v224
    v_lshl_add_u32 v227, v226, 4, v224
    v_xor_b32 v226, 4, v226
    v_lshl_add_u32 v228, v226, 4, v224
    s_lshl_b32 s56, s41, 2
    s_add_u32 s56, s56, s40
    s_mul_i32 s56, s56, 36864
    s_mul_i32 s57, s40, 36864
    s_waitcnt lgkmcnt(0)
    s_mov_b32 s12, s4
    s_mov_b32 s13, s5
    s_mov_b32 s14, 2359296
    s_mov_b32 s15, 0x20000
    s_mov_b32 s68, 9
parallel_sum__softmax_full_mha__dense_activation_relu__prompt_kernel_xloop:
    s_add_u32 m0, s57, 0
    s_add_u32 s3, s56, 0
    buffer_load_dwordx4 v227, s[12:15], s3 offen  lds
    s_add_u32 m0, s57, 9216
    s_add_u32 s3, s56, 9216
    buffer_load_dwordx4 v228, s[12:15], s3 offen  lds
    s_add_u32 m0, s57, 18432
    s_add_u32 s3, s56, 18432
    buffer_load_dwordx4 v227, s[12:15], s3 offen  lds
    s_add_u32 m0, s57, 27648
    s_add_u32 s3, s56, 27648
    buffer_load_dwordx4 v228, s[12:15], s3 offen  lds
    s_add_u32 s57, s57, 1024
    s_add_u32 s56, s56, 128
    s_sub_u32 s68, s68, 1
    s_cmp_lg_u32 s68, 0
    s_cbranch_scc1 parallel_sum__softmax_full_mha__dense_activation_relu__prompt_kernel_xloop
    s_mov_b32 s16, s6
    s_mov_b32 s17, s7
    s_mov_b32 s18, 1990656
    s_mov_b32 s19, 0x20000
    s_mov_b32 s20, s32
    s_mov_b32 s21, s33
    s_mov_b32 s22, 5308416
    s_mov_b32 s23, 0x20000
    s_mov_b32 s24, s34
    s_mov_b32 s25, s35
    s_mov_b32 s26, 5308416
    s_mov_b32 s27, 0x20000
    s_mov_b32 s8, s36
    s_mov_b32 s9, s37
    s_mov_b32 s10, 47969280
    s_mov_b32 s11, 0x20000
    s_mov_b32 s28, s60
    s_mov_b32 s29, s61
    s_mov_b32 s30, 663552
    s_mov_b32 s31, 0x20000
    v_lshlrev_b32 v254, 4, v255
    v_lshrrev_b32 v224, 5, v255
    v_bfe_u32 v225, v255, 4, 1
    v_bfe_u32 v226, v255, 2, 2
    v_and_b32 v227, 3, v255
    v_lshlrev_b32 v228, 5, v225
    v_lshl_add_u32 v228, v227, 3, v228
    v_lshrrev_b32 v229, 1, v226
    v_lshlrev_b32 v229, 6, v229
    v_xor_b32 v229, v228, v229
    v_lshl_add_u32 v230, v224, 3, v226
    v_lshl_add_u32 v208, v230, 7, v229
    v_lshl_add_u32 v210, v230, 6, v228
    v_lshl_add_u32 v230, v224, 2, v226
    v_lshl_add_u32 v209, v230, 7, v229
    v_lshrrev_b32 v224, 3, v255
    v_bfe_u32 v225, v255, 4, 1
    v_lshlrev_b32 v225, 2, v225
    v_and_b32 v226, 7, v255
    v_xor_b32 v226, v226, v225
    v_lshlrev_b32 v226, 4, v226
    s_mov_b32 s56, 3456
    v_mad_u32_u24 v216, v224, s56, v226
    s_mov_b32 s56, 9216
    v_mad_u32_u24 v217, v224, s56, v226
    s_mov_b32 s56, 1152
    v_mad_u32_u24 v219, v224, s56, v226
    v_lshrrev_b32 v224, 2, v255
    v_and_b32 v226, 3, v255
    v_lshlrev_b32 v226, 4, v226
    s_mov_b32 s56, 9216
    v_mad_u32_u24 v218, v224, s56, v226
    v_lshlrev_b32 v254, 4, v255
    s_mul_i32 s43, s40, 9216
    s_mul_i32 s44, s40, 248832
    s_mul_i32 s45, s40, 663552
    s_mul_i32 s46, s40, 1327104
    s_and_b32 s56, s42, 1
    s_lshl_b32 s57, s56, 5
    s_mul_i32 s58, s42, 288
    s_add_u32 s58, s58, s57
    s_mul_i32 s57, s40, 72
    s_add_u32 s58, s58, s57
    s_mul_i32 s47, s58, 1152
    s_cmp_eq_u32 s40, 3
    s_cselect_b32 s57, s56, 0
    s_mul_i32 s57, s57, 331776
    s_sub_u32 s48, s47, s57
    s_mul_i32 s58, s42, 576
    s_lshl_b32 s57, s56, 6
    s_add_u32 s51, s58, s57
    s_cmp_eq_u32 s56, 0
    s_cselect_b32 s57, 512, 0
    s_add_u32 s52, s58, s57
    s_lshl_b32 s49, s42, 7
    s_add_u32 s57, s42, 16
    s_cmp_lt_u32 s42, 11
    s_cselect_b32 s57, s57, s42
    s_lshl_b32 s50, s57, 7
    s_cmp_lt_u32 s42, 9
    s_cselect_b32 s53, 0x3eae1a93, 1.0
    s_mov_b32 s54, 1.0
    s_sub_u32 s57, s42, 2
    s_cmp_lt_u32 s57, 9
    s_cselect_b32 s100, 1, 0
    s_mov_b32 s96, s8
    s_mov_b32 s97, s9
    s_cmp_lt_u32 s42, 11
    s_cselect_b32 s98, s10, 0
    s_mov_b32 s99, 0x20000
    s_lshl_b32 s57, s41, 2
    s_add_u32 s57, s57, s40
    s_lshl_b32 s57, s57, 4
    s_add_u32 s57, s57, s42
    s_lshl_b32 s55, s57, 10
    s_add_u32 s55, s55, 9437184
    v_and_b32 v224, 31, v255
    v_lshrrev_b32 v225, 5, v255
    v_lshlrev_b32 v192, 14, v225
    v_lshl_add_u32 v192, v224, 3, v192
    s_lshl_b32 s59, s41, 2
    s_add_u32 s59, s59, s40
    s_cmp_lt_u32 s42, 9
    s_cselect_b32 s56, 0, 9
    s_cselect_b32 s57, 0, 2359296
    s_sub_u32 s56, s42, s56
    s_lshl_b32 s56, s56, 18
    s_add_u32 s56, s56, s57
    s_lshl_b32 s58, s59, 8
    s_add_u32 s60, s56, s58
    s_add_u32 s56, s42, 7
    s_cmp_lt_u32 s42, 2
    s_cselect_b32 s56, s56, 0
    s_lshl_b32 s56, s56, 18
    s_add_u32 s56, s56, s58
    s_add_u32 s61, s56, 2359296
    s_sub_u32 s56, s42, 2
    s_lshl_b32 s56, s56, 6
    s_and_b32 s56, s56, 0x3ff
    s_mul_i32 s57, s59, 1152
    s_add_u32 s57, s57, 4718592
    s_mov_b32 s58, 73728
    s_add_u32 s101, s56, 0
    v_add_u32 v226, s101, v224
    v_mul_u32_u24 v227, 3641, v226
    v_lshrrev_b32 v227, 16, v227
    v_mul_u32_u24 v228, 18, v227
    v_sub_u32 v226, v226, v228
    v_mul_lo_u32 v227, v227, s58
    v_lshl_add_u32 v227, v226, 4, v227
    v_mul_u32_u24 v228, 288, v225
    v_add3_u32 v200, v227, v228, s57
    s_add_u32 s101, s56, 32
    v_add_u32 v226, s101, v224
    v_mul_u32_u24 v227, 3641, v226
    v_lshrrev_b32 v227, 16, v227
    v_mul_u32_u24 v228, 18, v227
    v_sub_u32 v226, v226, v228
    v_mul_lo_u32 v227, v227, s58
    v_lshl_add_u32 v227, v226, 4, v227
    v_mul_u32_u24 v228, 288, v225
    v_add3_u32 v201, v227, v228, s57
    s_lshr_b32 s71, s40, 1
    s_lshl_b32 s69, s42, 1
    s_add_u32 s69, s69, s71
    s_and_b32 s76, s40, 1
    s_lshl_b32 s76, s76, 1
    s_lshl_b32 s70, s41, 2
    s_add_u32 s70, s70, s76
    s_cmp_lg_u32 s2, 0
    s_cbranch_scc1 parallel_sum__softmax_full_mha__dense_activation_relu__prompt_kernel_notag
    v_mov_b32 v4, 0x3f803f80
    v_mov_b32 v5, v4
    v_mov_b32 v6, v4
    v_mov_b32 v7, v4
    s_lshl_b32 s3, s40, 10
    s_add_u32 s3, s3, 47961088
    buffer_store_dwordx4 v[4:7], v254, s[8:11], s3 offen sc1
    s_add_u32 s6, s3, 4096
    v_mov_b32 v8, 0
    v_mov_b32 v9, 0
    v_mov_b32 v10, 0
    v_mov_b32 v11, 0
    buffer_store_dwordx4 v[8:11], v254, s[8:11], s6 offen sc1
parallel_sum__softmax_full_mha__dense_activation_relu__prompt_kernel_notag:
    s_mul_i32 s34, s2, 3
    s_add_u32 s34, s34, s40
    s_cmp_lt_u32 s40, 3
    s_cselect_b32 s56, s34, 720
    s_min_u32 s34, s56, 720
    s_cmp_eq_u32 s34, 720
    s_cbranch_scc1 parallel_sum__softmax_full_mha__dense_activation_relu__prompt_kernel_wof_skip
    s_mul_i32 s56, s34, 7282
    s_lshr_b32 s56, s56, 16
    s_mul_i32 s57, s56, 9
    s_sub_u32 s36, s34, s57
    s_and_b32 s57, s56, 3
    s_lshr_b32 s56, s56, 2
    s_mul_i32 s58, s56, 52
    s_lshr_b32 s58, s58, 8
    s_mul_i32 s59, s58, 5
    s_sub_u32 s56, s56, s59
    s_mul_i32 s58, s58, 288
    s_lshl_b32 s56, s56, 6
    s_add_u32 s56, s56, s58
    s_lshl_b32 s57, s57, 3
    v_lshrrev_b32 v224, 2, v255
    v_and_b32 v225, 3, v255
    s_cmp_eq_u32 s36, 8
    s_cbranch_scc1 parallel_sum__softmax_full_mha__dense_activation_relu__prompt_kernel_wof_rem
    s_add_u32 s57, s57, s36
    s_mul_i32 s57, s57, 18
    v_add_u32 v224, s57, v224
    s_branch parallel_sum__softmax_full_mha__dense_activation_relu__prompt_kernel_wof_go
parallel_sum__softmax_full_mha__dense_activation_relu__prompt_kernel_wof_rem:
    v_lshrrev_b32 v226, 1, v224
    v_add_u32 v226, s57, v226
    v_mul_u32_u24 v226, 18, v226
    v_and_b32 v224, 1, v224
    v_add3_u32 v224, v224, v226, 16
parallel_sum__softmax_full_mha__dense_activation_relu__prompt_kernel_wof_go:
    v_mul_u32_u24 v224, 1152, v224
    v_lshl_add_u32 v224, v225, 4, v224
    s_lshl_b32 s58, s40, 10
    s_add_u32 m0, s58, 147456
    s_nop 0
    buffer_load_dwordx4 v224, s[28:31], s56 offen lds
parallel_sum__softmax_full_mha__dense_activation_relu__prompt_kernel_wof_skip:
    v_mul_u32_u24 v237, 52429, v255
    v_lshrrev_b32 v237, 18, v237
    v_mul_u32_u24 v238, 5, v237
    v_sub_u32 v238, v255, v238
    v_min_u32 v237, 8, v237
    v_mul_u32_u24 v237, 9216, v237
    v_lshl_add_u32 v237, v238, 7, v237
    s_mul_i32 s57, s41, 36
    s_mul_i32 s58, s40, 9
    s_add_u32 s57, s57, s58
    s_mul_i32 s57, s57, 9216
    s_mul_i32 s58, s42, 576
    s_and_b32 s58, s58, 0xffffff80
    s_add_u32 s57, s57, s58
    buffer_load_dword v239, v237, s[20:23], s57 offen
    v_mov_b32 v244, -1
    v_mov_b32 v245, -1
    v_mov_b32 v246, -1
    v_mov_b32 v247, -1
    s_lshl_b32 s56, s70, 15
    s_lshl_b32 s57, s69, 10
    s_add_u32 s56, s56, s57
    s_add_u32 s56, s56, 7077888
    buffer_store_dwordx4 v[244:247], v254, s[8:11], s56 offen sc1
    s_add_u32 s56, s56, 32768
    buffer_store_dwordx4 v[244:247], v254, s[8:11], s56 offen sc1
    s_lshl_b32 s56, s70, 12
    s_lshr_b32 s57, s69, 2
    s_lshl_b32 s57, s57, 9
    s_add_u32 s56, s56, s57
    s_and_b32 s57, s69, 3
    s_lshl_b32 s57, s57, 2
    s_add_u32 s56, s56, s57
    s_add_u32 s56, s56, 9175040
    v_and_b32 v248, 31, v255
    v_lshlrev_b32 v248, 4, v248
    s_mov_b32 exec_hi, 0
    buffer_store_dword v244, v248, s[8:11], s56 offen sc1
    s_add_u32 s56, s56, 4096
    buffer_store_dword v244, v248, s[8:11], s56 offen sc1
    s_mov_b32 exec_hi, -1
    v_and_b32 v224, 31, v255
    v_lshrrev_b32 v225, 5, v255
    v_lshrrev_b32 v226, 3, v224
    v_mul_u32_u24 v226, 9216, v226
    v_and_b32 v227, 7, v224
    v_lshl_add_u32 v226, v227, 7, v226
    s_mul_i32 s57, s40, 36864
    v_add_u32 v226, s57, v226
    v_lshrrev_b32 v227, 1, v224
    v_and_b32 v227, 7, v227
    v_add_u32 v224, 0, v225
    v_xor_b32 v224, v224, v227
    v_lshl_add_u32 v228, v224, 4, v226
    v_add_u32 v224, 2, v225
    v_xor_b32 v224, v224, v227
    v_lshl_add_u32 v229, v224, 4, v226
    v_add_u32 v224, 4, v225
    v_xor_b32 v224, v224, v227
    v_lshl_add_u32 v230, v224, 4, v226
    v_add_u32 v224, 6, v225
    v_xor_b32 v224, v224, v227
    v_lshl_add_u32 v231, v224, 4, v226
    v_mov_b32 v144, 0
    v_mov_b32 v145, 0
    v_mov_b32 v146, 0
    v_mov_b32 v147, 0
    v_mov_b32 v148, 0
    v_mov_b32 v149, 0
    v_mov_b32 v150, 0
    v_mov_b32 v151, 0
    s_mov_b32 s59, 0x3f803f80
    s_waitcnt vmcnt(37)
    ds_read_b128 v[0:3], v228 offset:0
    ds_read_b128 v[4:7], v229 offset:0
    ds_read_b128 v[8:11], v230 offset:0
    ds_read_b128 v[12:15], v231 offset:0
    s_waitcnt vmcnt(33)
    ds_read_b128 v[16:19], v228 offset:1024
    ds_read_b128 v[20:23], v229 offset:1024
    ds_read_b128 v[24:27], v230 offset:1024
    ds_read_b128 v[28:31], v231 offset:1024
    s_waitcnt lgkmcnt(4)
    v_dot2c_f32_bf16 v144, s59, v0
    v_dot2c_f32_bf16 v148, v0, v0
    v_dot2c_f32_bf16 v145, s59, v1
    v_dot2c_f32_bf16 v149, v1, v1
    v_dot2c_f32_bf16 v146, s59, v2
    v_dot2c_f32_bf16 v150, v2, v2
    v_dot2c_f32_bf16 v147, s59, v3
    v_dot2c_f32_bf16 v151, v3, v3
    v_dot2c_f32_bf16 v144, s59, v4
    v_dot2c_f32_bf16 v148, v4, v4
    v_dot2c_f32_bf16 v145, s59, v5
    v_dot2c_f32_bf16 v149, v5, v5
    v_dot2c_f32_bf16 v146, s59, v6
    v_dot2c_f32_bf16 v150, v6, v6
    v_dot2c_f32_bf16 v147, s59, v7
    v_dot2c_f32_bf16 v151, v7, v7
    v_dot2c_f32_bf16 v144, s59, v8
    v_dot2c_f32_bf16 v148, v8, v8
    v_dot2c_f32_bf16 v145, s59, v9
    v_dot2c_f32_bf16 v149, v9, v9
    v_dot2c_f32_bf16 v146, s59, v10
    v_dot2c_f32_bf16 v150, v10, v10
    v_dot2c_f32_bf16 v147, s59, v11
    v_dot2c_f32_bf16 v151, v11, v11
    v_dot2c_f32_bf16 v144, s59, v12
    v_dot2c_f32_bf16 v148, v12, v12
    v_dot2c_f32_bf16 v145, s59, v13
    v_dot2c_f32_bf16 v149, v13, v13
    v_dot2c_f32_bf16 v146, s59, v14
    v_dot2c_f32_bf16 v150, v14, v14
    v_dot2c_f32_bf16 v147, s59, v15
    v_dot2c_f32_bf16 v151, v15, v15
    s_waitcnt vmcnt(29)
    ds_read_b128 v[32:35], v228 offset:2048
    ds_read_b128 v[36:39], v229 offset:2048
    ds_read_b128 v[40:43], v230 offset:2048
    ds_read_b128 v[44:47], v231 offset:2048
    s_waitcnt lgkmcnt(4)
    v_dot2c_f32_bf16 v144, s59, v16
    v_dot2c_f32_bf16 v148, v16, v16
    v_dot2c_f32_bf16 v145, s59, v17
    v_dot2c_f32_bf16 v149, v17, v17
    v_dot2c_f32_bf16 v146, s59, v18
    v_dot2c_f32_bf16 v150, v18, v18
    v_dot2c_f32_bf16 v147, s59, v19
    v_dot2c_f32_bf16 v151, v19, v19
    v_dot2c_f32_bf16 v144, s59, v20
    v_dot2c_f32_bf16 v148, v20, v20
    v_dot2c_f32_bf16 v145, s59, v21
    v_dot2c_f32_bf16 v149, v21, v21
    v_dot2c_f32_bf16 v146, s59, v22
    v_dot2c_f32_bf16 v150, v22, v22
    v_dot2c_f32_bf16 v147, s59, v23
    v_dot2c_f32_bf16 v151, v23, v23
    v_dot2c_f32_bf16 v144, s59, v24
    v_dot2c_f32_bf16 v148, v24, v24
    v_dot2c_f32_bf16 v145, s59, v25
    v_dot2c_f32_bf16 v149, v25, v25
    v_dot2c_f32_bf16 v146, s59, v26
    v_dot2c_f32_bf16 v150, v26, v26
    v_dot2c_f32_bf16 v147, s59, v27
    v_dot2c_f32_bf16 v151, v27, v27
    v_dot2c_f32_bf16 v144, s59, v28
    v_dot2c_f32_bf16 v148, v28, v28
    v_dot2c_f32_bf16 v145, s59, v29
    v_dot2c_f32_bf16 v149, v29, v29
    v_dot2c_f32_bf16 v146, s59, v30
    v_dot2c_f32_bf16 v150, v30, v30
    v_dot2c_f32_bf16 v147, s59, v31
    v_dot2c_f32_bf16 v151, v31, v31
    s_waitcnt vmcnt(25)
    ds_read_b128 v[48:51], v228 offset:3072
    ds_read_b128 v[52:55], v229 offset:3072
    ds_read_b128 v[56:59], v230 offset:3072
    ds_read_b128 v[60:63], v231 offset:3072
    s_waitcnt lgkmcnt(4)
    v_dot2c_f32_bf16 v144, s59, v32
    v_dot2c_f32_bf16 v148, v32, v32
    v_dot2c_f32_bf16 v145, s59, v33
    v_dot2c_f32_bf16 v149, v33, v33
    v_dot2c_f32_bf16 v146, s59, v34
    v_dot2c_f32_bf16 v150, v34, v34
    v_dot2c_f32_bf16 v147, s59, v35
    v_dot2c_f32_bf16 v151, v35, v35
    v_dot2c_f32_bf16 v144, s59, v36
    v_dot2c_f32_bf16 v148, v36, v36
    v_dot2c_f32_bf16 v145, s59, v37
    v_dot2c_f32_bf16 v149, v37, v37
    v_dot2c_f32_bf16 v146, s59, v38
    v_dot2c_f32_bf16 v150, v38, v38
    v_dot2c_f32_bf16 v147, s59, v39
    v_dot2c_f32_bf16 v151, v39, v39
    v_dot2c_f32_bf16 v144, s59, v40
    v_dot2c_f32_bf16 v148, v40, v40
    v_dot2c_f32_bf16 v145, s59, v41
    v_dot2c_f32_bf16 v149, v41, v41
    v_dot2c_f32_bf16 v146, s59, v42
    v_dot2c_f32_bf16 v150, v42, v42
    v_dot2c_f32_bf16 v147, s59, v43
    v_dot2c_f32_bf16 v151, v43, v43
    v_dot2c_f32_bf16 v144, s59, v44
    v_dot2c_f32_bf16 v148, v44, v44
    v_dot2c_f32_bf16 v145, s59, v45
    v_dot2c_f32_bf16 v149, v45, v45
    v_dot2c_f32_bf16 v146, s59, v46
    v_dot2c_f32_bf16 v150, v46, v46
    v_dot2c_f32_bf16 v147, s59, v47
    v_dot2c_f32_bf16 v151, v47, v47
    s_waitcnt vmcnt(21)
    ds_read_b128 v[64:67], v228 offset:4096
    ds_read_b128 v[68:71], v229 offset:4096
    ds_read_b128 v[72:75], v230 offset:4096
    ds_read_b128 v[76:79], v231 offset:4096
    s_waitcnt lgkmcnt(4)
    v_dot2c_f32_bf16 v144, s59, v48
    v_dot2c_f32_bf16 v148, v48, v48
    v_dot2c_f32_bf16 v145, s59, v49
    v_dot2c_f32_bf16 v149, v49, v49
    v_dot2c_f32_bf16 v146, s59, v50
    v_dot2c_f32_bf16 v150, v50, v50
    v_dot2c_f32_bf16 v147, s59, v51
    v_dot2c_f32_bf16 v151, v51, v51
    v_dot2c_f32_bf16 v144, s59, v52
    v_dot2c_f32_bf16 v148, v52, v52
    v_dot2c_f32_bf16 v145, s59, v53
    v_dot2c_f32_bf16 v149, v53, v53
    v_dot2c_f32_bf16 v146, s59, v54
    v_dot2c_f32_bf16 v150, v54, v54
    v_dot2c_f32_bf16 v147, s59, v55
    v_dot2c_f32_bf16 v151, v55, v55
    v_dot2c_f32_bf16 v144, s59, v56
    v_dot2c_f32_bf16 v148, v56, v56
    v_dot2c_f32_bf16 v145, s59, v57
    v_dot2c_f32_bf16 v149, v57, v57
    v_dot2c_f32_bf16 v146, s59, v58
    v_dot2c_f32_bf16 v150, v58, v58
    v_dot2c_f32_bf16 v147, s59, v59
    v_dot2c_f32_bf16 v151, v59, v59
    v_dot2c_f32_bf16 v144, s59, v60
    v_dot2c_f32_bf16 v148, v60, v60
    v_dot2c_f32_bf16 v145, s59, v61
    v_dot2c_f32_bf16 v149, v61, v61
    v_dot2c_f32_bf16 v146, s59, v62
    v_dot2c_f32_bf16 v150, v62, v62
    v_dot2c_f32_bf16 v147, s59, v63
    v_dot2c_f32_bf16 v151, v63, v63
    s_waitcnt vmcnt(17)
    ds_read_b128 v[80:83], v228 offset:5120
    ds_read_b128 v[84:87], v229 offset:5120
    ds_read_b128 v[88:91], v230 offset:5120
    ds_read_b128 v[92:95], v231 offset:5120
    s_waitcnt lgkmcnt(4)
    v_dot2c_f32_bf16 v144, s59, v64
    v_dot2c_f32_bf16 v148, v64, v64
    v_dot2c_f32_bf16 v145, s59, v65
    v_dot2c_f32_bf16 v149, v65, v65
    v_dot2c_f32_bf16 v146, s59, v66
    v_dot2c_f32_bf16 v150, v66, v66
    v_dot2c_f32_bf16 v147, s59, v67
    v_dot2c_f32_bf16 v151, v67, v67
    v_dot2c_f32_bf16 v144, s59, v68
    v_dot2c_f32_bf16 v148, v68, v68
    v_dot2c_f32_bf16 v145, s59, v69
    v_dot2c_f32_bf16 v149, v69, v69
    v_dot2c_f32_bf16 v146, s59, v70
    v_dot2c_f32_bf16 v150, v70, v70
    v_dot2c_f32_bf16 v147, s59, v71
    v_dot2c_f32_bf16 v151, v71, v71
    v_dot2c_f32_bf16 v144, s59, v72
    v_dot2c_f32_bf16 v148, v72, v72
    v_dot2c_f32_bf16 v145, s59, v73
    v_dot2c_f32_bf16 v149, v73, v73
    v_dot2c_f32_bf16 v146, s59, v74
    v_dot2c_f32_bf16 v150, v74, v74
    v_dot2c_f32_bf16 v147, s59, v75
    v_dot2c_f32_bf16 v151, v75, v75
    v_dot2c_f32_bf16 v144, s59, v76
    v_dot2c_f32_bf16 v148, v76, v76
    v_dot2c_f32_bf16 v145, s59, v77
    v_dot2c_f32_bf16 v149, v77, v77
    v_dot2c_f32_bf16 v146, s59, v78
    v_dot2c_f32_bf16 v150, v78, v78
    v_dot2c_f32_bf16 v147, s59, v79
    v_dot2c_f32_bf16 v151, v79, v79
    s_waitcnt vmcnt(13)
    ds_read_b128 v[96:99], v228 offset:6144
    ds_read_b128 v[100:103], v229 offset:6144
    ds_read_b128 v[104:107], v230 offset:6144
    ds_read_b128 v[108:111], v231 offset:6144
    s_waitcnt lgkmcnt(4)
    v_dot2c_f32_bf16 v144, s59, v80
    v_dot2c_f32_bf16 v148, v80, v80
    v_dot2c_f32_bf16 v145, s59, v81
    v_dot2c_f32_bf16 v149, v81, v81
    v_dot2c_f32_bf16 v146, s59, v82
    v_dot2c_f32_bf16 v150, v82, v82
    v_dot2c_f32_bf16 v147, s59, v83
    v_dot2c_f32_bf16 v151, v83, v83
    v_dot2c_f32_bf16 v144, s59, v84
    v_dot2c_f32_bf16 v148, v84, v84
    v_dot2c_f32_bf16 v145, s59, v85
    v_dot2c_f32_bf16 v149, v85, v85
    v_dot2c_f32_bf16 v146, s59, v86
    v_dot2c_f32_bf16 v150, v86, v86
    v_dot2c_f32_bf16 v147, s59, v87
    v_dot2c_f32_bf16 v151, v87, v87
    v_dot2c_f32_bf16 v144, s59, v88
    v_dot2c_f32_bf16 v148, v88, v88
    v_dot2c_f32_bf16 v145, s59, v89
    v_dot2c_f32_bf16 v149, v89, v89
    v_dot2c_f32_bf16 v146, s59, v90
    v_dot2c_f32_bf16 v150, v90, v90
    v_dot2c_f32_bf16 v147, s59, v91
    v_dot2c_f32_bf16 v151, v91, v91
    v_dot2c_f32_bf16 v144, s59, v92
    v_dot2c_f32_bf16 v148, v92, v92
    v_dot2c_f32_bf16 v145, s59, v93
    v_dot2c_f32_bf16 v149, v93, v93
    v_dot2c_f32_bf16 v146, s59, v94
    v_dot2c_f32_bf16 v150, v94, v94
    v_dot2c_f32_bf16 v147, s59, v95
    v_dot2c_f32_bf16 v151, v95, v95
    s_waitcnt vmcnt(9)
    ds_read_b128 v[112:115], v228 offset:7168
    ds_read_b128 v[116:119], v229 offset:7168
    ds_read_b128 v[120:123], v230 offset:7168
    ds_read_b128 v[124:127], v231 offset:7168
    s_waitcnt lgkmcnt(4)
    v_dot2c_f32_bf16 v144, s59, v96
    v_dot2c_f32_bf16 v148, v96, v96
    v_dot2c_f32_bf16 v145, s59, v97
    v_dot2c_f32_bf16 v149, v97, v97
    v_dot2c_f32_bf16 v146, s59, v98
    v_dot2c_f32_bf16 v150, v98, v98
    v_dot2c_f32_bf16 v147, s59, v99
    v_dot2c_f32_bf16 v151, v99, v99
    v_dot2c_f32_bf16 v144, s59, v100
    v_dot2c_f32_bf16 v148, v100, v100
    v_dot2c_f32_bf16 v145, s59, v101
    v_dot2c_f32_bf16 v149, v101, v101
    v_dot2c_f32_bf16 v146, s59, v102
    v_dot2c_f32_bf16 v150, v102, v102
    v_dot2c_f32_bf16 v147, s59, v103
    v_dot2c_f32_bf16 v151, v103, v103
    v_dot2c_f32_bf16 v144, s59, v104
    v_dot2c_f32_bf16 v148, v104, v104
    v_dot2c_f32_bf16 v145, s59, v105
    v_dot2c_f32_bf16 v149, v105, v105
    v_dot2c_f32_bf16 v146, s59, v106
    v_dot2c_f32_bf16 v150, v106, v106
    v_dot2c_f32_bf16 v147, s59, v107
    v_dot2c_f32_bf16 v151, v107, v107
    v_dot2c_f32_bf16 v144, s59, v108
    v_dot2c_f32_bf16 v148, v108, v108
    v_dot2c_f32_bf16 v145, s59, v109
    v_dot2c_f32_bf16 v149, v109, v109
    v_dot2c_f32_bf16 v146, s59, v110
    v_dot2c_f32_bf16 v150, v110, v110
    v_dot2c_f32_bf16 v147, s59, v111
    v_dot2c_f32_bf16 v151, v111, v111
    s_waitcnt vmcnt(5)
    ds_read_b128 v[128:131], v228 offset:8192
    ds_read_b128 v[132:135], v229 offset:8192
    ds_read_b128 v[136:139], v230 offset:8192
    ds_read_b128 v[140:143], v231 offset:8192
    s_waitcnt lgkmcnt(4)
    v_dot2c_f32_bf16 v144, s59, v112
    v_dot2c_f32_bf16 v148, v112, v112
    v_dot2c_f32_bf16 v145, s59, v113
    v_dot2c_f32_bf16 v149, v113, v113
    v_dot2c_f32_bf16 v146, s59, v114
    v_dot2c_f32_bf16 v150, v114, v114
    v_dot2c_f32_bf16 v147, s59, v115
    v_dot2c_f32_bf16 v151, v115, v115
    v_dot2c_f32_bf16 v144, s59, v116
    v_dot2c_f32_bf16 v148, v116, v116
    v_dot2c_f32_bf16 v145, s59, v117
    v_dot2c_f32_bf16 v149, v117, v117
    v_dot2c_f32_bf16 v146, s59, v118
    v_dot2c_f32_bf16 v150, v118, v118
    v_dot2c_f32_bf16 v147, s59, v119
    v_dot2c_f32_bf16 v151, v119, v119
    v_dot2c_f32_bf16 v144, s59, v120
    v_dot2c_f32_bf16 v148, v120, v120
    v_dot2c_f32_bf16 v145, s59, v121
    v_dot2c_f32_bf16 v149, v121, v121
    v_dot2c_f32_bf16 v146, s59, v122
    v_dot2c_f32_bf16 v150, v122, v122
    v_dot2c_f32_bf16 v147, s59, v123
    v_dot2c_f32_bf16 v151, v123, v123
    v_dot2c_f32_bf16 v144, s59, v124
    v_dot2c_f32_bf16 v148, v124, v124
    v_dot2c_f32_bf16 v145, s59, v125
    v_dot2c_f32_bf16 v149, v125, v125
    v_dot2c_f32_bf16 v146, s59, v126
    v_dot2c_f32_bf16 v150, v126, v126
    v_dot2c_f32_bf16 v147, s59, v127
    v_dot2c_f32_bf16 v151, v127, v127
    s_waitcnt lgkmcnt(0)
    v_dot2c_f32_bf16 v144, s59, v128
    v_dot2c_f32_bf16 v148, v128, v128
    v_dot2c_f32_bf16 v145, s59, v129
    v_dot2c_f32_bf16 v149, v129, v129
    v_dot2c_f32_bf16 v146, s59, v130
    v_dot2c_f32_bf16 v150, v130, v130
    v_dot2c_f32_bf16 v147, s59, v131
    v_dot2c_f32_bf16 v151, v131, v131
    v_dot2c_f32_bf16 v144, s59, v132
    v_dot2c_f32_bf16 v148, v132, v132
    v_dot2c_f32_bf16 v145, s59, v133
    v_dot2c_f32_bf16 v149, v133, v133
    v_dot2c_f32_bf16 v146, s59, v134
    v_dot2c_f32_bf16 v150, v134, v134
    v_dot2c_f32_bf16 v147, s59, v135
    v_dot2c_f32_bf16 v151, v135, v135
    v_dot2c_f32_bf16 v144, s59, v136
    v_dot2c_f32_bf16 v148, v136, v136
    v_dot2c_f32_bf16 v145, s59, v137
    v_dot2c_f32_bf16 v149, v137, v137
    v_dot2c_f32_bf16 v146, s59, v138
    v_dot2c_f32_bf16 v150, v138, v138
    v_dot2c_f32_bf16 v147, s59, v139
    v_dot2c_f32_bf16 v151, v139, v139
    v_dot2c_f32_bf16 v144, s59, v140
    v_dot2c_f32_bf16 v148, v140, v140
    v_dot2c_f32_bf16 v145, s59, v141
    v_dot2c_f32_bf16 v149, v141, v141
    v_dot2c_f32_bf16 v146, s59, v142
    v_dot2c_f32_bf16 v150, v142, v142
    v_dot2c_f32_bf16 v147, s59, v143
    v_dot2c_f32_bf16 v151, v143, v143
    s_cmp_eq_u32 s34, 720
    s_cbranch_scc1 parallel_sum__softmax_full_mha__dense_activation_relu__prompt_kernel_wof2_skip
    v_lshrrev_b32 v224, 5, v255
    v_bfe_u32 v225, v255, 4, 1
    v_bfe_u32 v226, v255, 2, 2
    v_and_b32 v227, 3, v255
    v_lshlrev_b32 v225, 5, v225
    v_lshl_add_u32 v225, v227, 3, v225
    s_cmp_eq_u32 s36, 8
    s_cselect_b32 s56, 3, 2
    s_cselect_b32 s37, 8, 9
    s_lshl_b32 s37, 1, s37
    v_lshlrev_b32 v224, s56, v224
    v_add_u32 v224, v224, v226
    v_lshl_add_u32 v220, v224, 6, v225
    s_lshl_b32 s56, s40, 10
    s_add_u32 s56, s56, 147456
    v_add_u32 v220, s56, v220
    v_add_u32 v224, s37, v220
    ds_read_b64_tr_b16 v[176:177], v220
    ds_read_b64_tr_b16 v[178:179], v224
    s_waitcnt lgkmcnt(0)
    s_lshl_b32 s56, s34, 10
    s_add_u32 s56, s56, 47185920
    buffer_store_dwordx4 v[176:179], v254, s[8:11], s56 offen sc1
parallel_sum__softmax_full_mha__dense_activation_relu__prompt_kernel_wof2_skip:
    v_mov_b32 v231, 0
    global_load_dword v232, v231, s[38:39] sc1
    s_waitcnt lgkmcnt(0)
    s_barrier
    s_mov_b32 s28, s16
    s_mov_b32 s29, s17
    s_cmp_lt_u32 s42, 11
    s_cselect_b32 s30, s18, 0
    s_mov_b32 s31, 0x20000
    v_add_u32 v220, s49, v216
    s_add_u32 m0, s43, 0
    s_add_u32 s101, s44, 0
    buffer_load_dwordx4 v220, s[16:19], s101 offen  lds
    s_add_u32 m0, s43, 1024
    s_add_u32 s101, s44, 27648
    buffer_load_dwordx4 v220, s[16:19], s101 offen  lds
    s_add_u32 m0, s43, 2048
    s_add_u32 s101, s44, 55296
    buffer_load_dwordx4 v220, s[16:19], s101 offen  lds
    s_add_u32 m0, s43, 3072
    s_add_u32 s101, s44, 82944
    buffer_load_dwordx4 v220, s[16:19], s101 offen  lds
    s_add_u32 m0, s43, 4096
    s_add_u32 s101, s44, 110592
    buffer_load_dwordx4 v220, s[16:19], s101 offen  lds
    s_add_u32 m0, s43, 5120
    s_add_u32 s101, s44, 138240
    buffer_load_dwordx4 v220, s[16:19], s101 offen  lds
    s_add_u32 m0, s43, 6144
    s_add_u32 s101, s44, 165888
    buffer_load_dwordx4 v220, s[16:19], s101 offen  lds
    s_add_u32 m0, s43, 7168
    s_add_u32 s101, s44, 193536
    buffer_load_dwordx4 v220, s[16:19], s101 offen  lds
    s_add_u32 m0, s43, 8192
    s_add_u32 s101, s44, 221184
    buffer_load_dwordx4 v220, s[16:19], s101 offen  lds
    s_nop 2
    v_add_f32 v144, v144, v145
    v_add_f32 v146, v146, v147
    v_add_f32 v148, v148, v149
    v_add_f32 v150, v150, v151
    v_add_f32 v144, v144, v146
    v_add_f32 v148, v148, v150
    v_mov_b32 v224, v144
    v_mov_b32 v225, v144
    s_nop 1
    v_permlane32_swap_b32 v224, v225
    s_nop 1
    v_add_f32 v144, v224, v225
    v_mov_b32 v224, v148
    v_mov_b32 v225, v148
    s_nop 1
    v_permlane32_swap_b32 v224, v225
    s_nop 1
    v_add_f32 v148, v224, v225
    v_mul_f32 v144, 0x3ae38e39, v144
    v_mul_f32 v148, 0x3ae38e39, v148
    v_fma_f32 v148, -v144, v144, v148
    v_max_f32 v148, 0, v148
    v_add_f32 v148, 0x3727c5ac, v148
    v_rsq_f32 v230, v148
    s_nop 0
    v_mul_f32 v231, v144, v230
    v_sub_f32 v231, 0, v231
    s_mov_b32 s56, 0xffff0000
    v_lshlrev_b32 v224, 16, v0
    v_and_b32 v225, s56, v0
    v_pk_fma_f32 v[224:225], v[224:225], v[230:231], v[230:231] op_sel:[0,0,1] op_sel_hi:[1,0,1]
    v_lshlrev_b32 v226, 16, v1
    v_and_b32 v227, s56, v1
    v_cvt_pk_bf16_f32 v0, v224, v225
    v_pk_fma_f32 v[226:227], v[226:227], v[230:231], v[230:231] op_sel:[0,0,1] op_sel_hi:[1,0,1]
    v_lshlrev_b32 v224, 16, v2
    v_and_b32 v225, s56, v2
    v_cvt_pk_bf16_f32 v1, v226, v227
    v_pk_fma_f32 v[224:225], v[224:225], v[230:231], v[230:231] op_sel:[0,0,1] op_sel_hi:[1,0,1]
    v_add_u32 v220, s49, v216
    v_lshlrev_b32 v226, 16, v3
    v_and_b32 v227, s56, v3
    v_cvt_pk_bf16_f32 v2, v224, v225
    v_pk_fma_f32 v[226:227], v[226:227], v[230:231], v[230:231] op_sel:[0,0,1] op_sel_hi:[1,0,1]
    v_lshlrev_b32 v224, 16, v4
    v_and_b32 v225, s56, v4
    v_cvt_pk_bf16_f32 v3, v226, v227
    v_pk_fma_f32 v[224:225], v[224:225], v[230:231], v[230:231] op_sel:[0,0,1] op_sel_hi:[1,0,1]
    v_lshlrev_b32 v226, 16, v5
    v_and_b32 v227, s56, v5
    v_cvt_pk_bf16_f32 v4, v224, v225
    v_pk_fma_f32 v[226:227], v[226:227], v[230:231], v[230:231] op_sel:[0,0,1] op_sel_hi:[1,0,1]
    v_lshlrev_b32 v224, 16, v6
    v_and_b32 v225, s56, v6
    v_cvt_pk_bf16_f32 v5, v226, v227
    v_pk_fma_f32 v[224:225], v[224:225], v[230:231], v[230:231] op_sel:[0,0,1] op_sel_hi:[1,0,1]
    v_lshlrev_b32 v226, 16, v7
    v_and_b32 v227, s56, v7
    v_cvt_pk_bf16_f32 v6, v224, v225
    v_pk_fma_f32 v[226:227], v[226:227], v[230:231], v[230:231] op_sel:[0,0,1] op_sel_hi:[1,0,1]
    v_lshlrev_b32 v224, 16, v8
    v_and_b32 v225, s56, v8
    v_cvt_pk_bf16_f32 v7, v226, v227
    v_pk_fma_f32 v[224:225], v[224:225], v[230:231], v[230:231] op_sel:[0,0,1] op_sel_hi:[1,0,1]
    v_lshlrev_b32 v226, 16, v9
    v_and_b32 v227, s56, v9
    v_cvt_pk_bf16_f32 v8, v224, v225
    s_add_u32 m0, s43, 36864
    s_add_u32 s101, s44, 995328
    buffer_load_dwordx4 v220, s[16:19], s101 offen  lds
    v_pk_fma_f32 v[226:227], v[226:227], v[230:231], v[230:231] op_sel:[0,0,1] op_sel_hi:[1,0,1]
    v_lshlrev_b32 v224, 16, v10
    v_and_b32 v225, s56, v10
    v_cvt_pk_bf16_f32 v9, v226, v227
    v_pk_fma_f32 v[224:225], v[224:225], v[230:231], v[230:231] op_sel:[0,0,1] op_sel_hi:[1,0,1]
    v_lshlrev_b32 v226, 16, v11
    v_and_b32 v227, s56, v11
    v_cvt_pk_bf16_f32 v10, v224, v225
    v_pk_fma_f32 v[226:227], v[226:227], v[230:231], v[230:231] op_sel:[0,0,1] op_sel_hi:[1,0,1]
    v_lshlrev_b32 v224, 16, v12
    v_and_b32 v225, s56, v12
    v_cvt_pk_bf16_f32 v11, v226, v227
    v_pk_fma_f32 v[224:225], v[224:225], v[230:231], v[230:231] op_sel:[0,0,1] op_sel_hi:[1,0,1]
    v_lshlrev_b32 v226, 16, v13
    v_and_b32 v227, s56, v13
    v_cvt_pk_bf16_f32 v12, v224, v225
    v_pk_fma_f32 v[226:227], v[226:227], v[230:231], v[230:231] op_sel:[0,0,1] op_sel_hi:[1,0,1]
    v_lshlrev_b32 v224, 16, v14
    v_and_b32 v225, s56, v14
    v_cvt_pk_bf16_f32 v13, v226, v227
    v_pk_fma_f32 v[224:225], v[224:225], v[230:231], v[230:231] op_sel:[0,0,1] op_sel_hi:[1,0,1]
    v_lshlrev_b32 v226, 16, v15
    v_and_b32 v227, s56, v15
    v_cvt_pk_bf16_f32 v14, v224, v225
    v_pk_fma_f32 v[226:227], v[226:227], v[230:231], v[230:231] op_sel:[0,0,1] op_sel_hi:[1,0,1]
    v_lshlrev_b32 v224, 16, v16
    v_and_b32 v225, s56, v16
    s_add_u32 m0, s43, 37888
    s_add_u32 s101, s44, 1022976
    buffer_load_dwordx4 v220, s[16:19], s101 offen  lds
    v_cvt_pk_bf16_f32 v15, v226, v227
    v_pk_fma_f32 v[224:225], v[224:225], v[230:231], v[230:231] op_sel:[0,0,1] op_sel_hi:[1,0,1]
    v_lshlrev_b32 v226, 16, v17
    v_and_b32 v227, s56, v17
    v_cvt_pk_bf16_f32 v16, v224, v225
    v_pk_fma_f32 v[226:227], v[226:227], v[230:231], v[230:231] op_sel:[0,0,1] op_sel_hi:[1,0,1]
    v_lshlrev_b32 v224, 16, v18
    v_and_b32 v225, s56, v18
    v_cvt_pk_bf16_f32 v17, v226, v227
    v_pk_fma_f32 v[224:225], v[224:225], v[230:231], v[230:231] op_sel:[0,0,1] op_sel_hi:[1,0,1]
    v_lshlrev_b32 v226, 16, v19
    v_and_b32 v227, s56, v19
    v_cvt_pk_bf16_f32 v18, v224, v225
    v_pk_fma_f32 v[226:227], v[226:227], v[230:231], v[230:231] op_sel:[0,0,1] op_sel_hi:[1,0,1]
    v_lshlrev_b32 v224, 16, v20
    v_and_b32 v225, s56, v20
    v_cvt_pk_bf16_f32 v19, v226, v227
    v_pk_fma_f32 v[224:225], v[224:225], v[230:231], v[230:231] op_sel:[0,0,1] op_sel_hi:[1,0,1]
    v_lshlrev_b32 v226, 16, v21
    v_and_b32 v227, s56, v21
    v_cvt_pk_bf16_f32 v20, v224, v225
    v_pk_fma_f32 v[226:227], v[226:227], v[230:231], v[230:231] op_sel:[0,0,1] op_sel_hi:[1,0,1]
    v_lshlrev_b32 v224, 16, v22
    v_and_b32 v225, s56, v22
    v_cvt_pk_bf16_f32 v21, v226, v227
    v_pk_fma_f32 v[224:225], v[224:225], v[230:231], v[230:231] op_sel:[0,0,1] op_sel_hi:[1,0,1]
    v_lshlrev_b32 v226, 16, v23
    s_add_u32 m0, s43, 38912
    s_add_u32 s101, s44, 1050624
    buffer_load_dwordx4 v220, s[16:19], s101 offen  lds
    v_and_b32 v227, s56, v23
    v_cvt_pk_bf16_f32 v22, v224, v225
    v_pk_fma_f32 v[226:227], v[226:227], v[230:231], v[230:231] op_sel:[0,0,1] op_sel_hi:[1,0,1]
    v_lshlrev_b32 v224, 16, v24
    v_and_b32 v225, s56, v24
    v_cvt_pk_bf16_f32 v23, v226, v227
    v_pk_fma_f32 v[224:225], v[224:225], v[230:231], v[230:231] op_sel:[0,0,1] op_sel_hi:[1,0,1]
    v_lshlrev_b32 v226, 16, v25
    v_and_b32 v227, s56, v25
    v_cvt_pk_bf16_f32 v24, v224, v225
    v_pk_fma_f32 v[226:227], v[226:227], v[230:231], v[230:231] op_sel:[0,0,1] op_sel_hi:[1,0,1]
    v_lshlrev_b32 v224, 16, v26
    v_and_b32 v225, s56, v26
    v_cvt_pk_bf16_f32 v25, v226, v227
    v_pk_fma_f32 v[224:225], v[224:225], v[230:231], v[230:231] op_sel:[0,0,1] op_sel_hi:[1,0,1]
    v_lshlrev_b32 v226, 16, v27
    v_and_b32 v227, s56, v27
    v_cvt_pk_bf16_f32 v26, v224, v225
    v_pk_fma_f32 v[226:227], v[226:227], v[230:231], v[230:231] op_sel:[0,0,1] op_sel_hi:[1,0,1]
    v_lshlrev_b32 v224, 16, v28
    v_and_b32 v225, s56, v28
    v_cvt_pk_bf16_f32 v27, v226, v227
    v_pk_fma_f32 v[224:225], v[224:225], v[230:231], v[230:231] op_sel:[0,0,1] op_sel_hi:[1,0,1]
    v_lshlrev_b32 v226, 16, v29
    v_and_b32 v227, s56, v29
    v_cvt_pk_bf16_f32 v28, v224, v225
    v_pk_fma_f32 v[226:227], v[226:227], v[230:231], v[230:231] op_sel:[0,0,1] op_sel_hi:[1,0,1]
    s_add_u32 m0, s43, 39936
    s_add_u32 s101, s44, 1078272
    buffer_load_dwordx4 v220, s[16:19], s101 offen  lds
    v_lshlrev_b32 v224, 16, v30
    v_and_b32 v225, s56, v30
    v_cvt_pk_bf16_f32 v29, v226, v227
    v_pk_fma_f32 v[224:225], v[224:225], v[230:231], v[230:231] op_sel:[0,0,1] op_sel_hi:[1,0,1]
    v_lshlrev_b32 v226, 16, v31
    v_and_b32 v227, s56, v31
    v_cvt_pk_bf16_f32 v30, v224, v225
    v_pk_fma_f32 v[226:227], v[226:227], v[230:231], v[230:231] op_sel:[0,0,1] op_sel_hi:[1,0,1]
    v_lshlrev_b32 v224, 16, v32
    v_and_b32 v225, s56, v32
    v_cvt_pk_bf16_f32 v31, v226, v227
    v_pk_fma_f32 v[224:225], v[224:225], v[230:231], v[230:231] op_sel:[0,0,1] op_sel_hi:[1,0,1]
    v_lshlrev_b32 v226, 16, v33
    v_and_b32 v227, s56, v33
    v_cvt_pk_bf16_f32 v32, v224, v225
    v_pk_fma_f32 v[226:227], v[226:227], v[230:231], v[230:231] op_sel:[0,0,1] op_sel_hi:[1,0,1]
    v_lshlrev_b32 v224, 16, v34
    v_and_b32 v225, s56, v34
    v_cvt_pk_bf16_f32 v33, v226, v227
    v_pk_fma_f32 v[224:225], v[224:225], v[230:231], v[230:231] op_sel:[0,0,1] op_sel_hi:[1,0,1]
    v_lshlrev_b32 v226, 16, v35
    v_and_b32 v227, s56, v35
    v_cvt_pk_bf16_f32 v34, v224, v225
    v_pk_fma_f32 v[226:227], v[226:227], v[230:231], v[230:231] op_sel:[0,0,1] op_sel_hi:[1,0,1]
    v_lshlrev_b32 v224, 16, v36
    v_and_b32 v225, s56, v36
    v_cvt_pk_bf16_f32 v35, v226, v227
    s_add_u32 m0, s43, 40960
    s_add_u32 s101, s44, 1105920
    buffer_load_dwordx4 v220, s[16:19], s101 offen  lds
    v_pk_fma_f32 v[224:225], v[224:225], v[230:231], v[230:231] op_sel:[0,0,1] op_sel_hi:[1,0,1]
    v_lshlrev_b32 v226, 16, v37
    v_and_b32 v227, s56, v37
    v_cvt_pk_bf16_f32 v36, v224, v225
    v_pk_fma_f32 v[226:227], v[226:227], v[230:231], v[230:231] op_sel:[0,0,1] op_sel_hi:[1,0,1]
    v_lshlrev_b32 v224, 16, v38
    v_and_b32 v225, s56, v38
    v_cvt_pk_bf16_f32 v37, v226, v227
    v_pk_fma_f32 v[224:225], v[224:225], v[230:231], v[230:231] op_sel:[0,0,1] op_sel_hi:[1,0,1]
    v_lshlrev_b32 v226, 16, v39
    v_and_b32 v227, s56, v39
    v_cvt_pk_bf16_f32 v38, v224, v225
    v_pk_fma_f32 v[226:227], v[226:227], v[230:231], v[230:231] op_sel:[0,0,1] op_sel_hi:[1,0,1]
    v_lshlrev_b32 v224, 16, v40
    v_and_b32 v225, s56, v40
    v_cvt_pk_bf16_f32 v39, v226, v227
    v_pk_fma_f32 v[224:225], v[224:225], v[230:231], v[230:231] op_sel:[0,0,1] op_sel_hi:[1,0,1]
    v_lshlrev_b32 v226, 16, v41
    v_and_b32 v227, s56, v41
    v_cvt_pk_bf16_f32 v40, v224, v225
    v_pk_fma_f32 v[226:227], v[226:227], v[230:231], v[230:231] op_sel:[0,0,1] op_sel_hi:[1,0,1]
    v_lshlrev_b32 v224, 16, v42
    v_and_b32 v225, s56, v42
    v_cvt_pk_bf16_f32 v41, v226, v227
    v_pk_fma_f32 v[224:225], v[224:225], v[230:231], v[230:231] op_sel:[0,0,1] op_sel_hi:[1,0,1]
    v_lshlrev_b32 v226, 16, v43
    v_and_b32 v227, s56, v43
    s_add_u32 m0, s43, 41984
    s_add_u32 s101, s44, 1133568
    buffer_load_dwordx4 v220, s[16:19], s101 offen  lds
    v_cvt_pk_bf16_f32 v42, v224, v225
    v_pk_fma_f32 v[226:227], v[226:227], v[230:231], v[230:231] op_sel:[0,0,1] op_sel_hi:[1,0,1]
    v_lshlrev_b32 v224, 16, v44
    v_and_b32 v225, s56, v44
    v_cvt_pk_bf16_f32 v43, v226, v227
    v_pk_fma_f32 v[224:225], v[224:225], v[230:231], v[230:231] op_sel:[0,0,1] op_sel_hi:[1,0,1]
    v_lshlrev_b32 v226, 16, v45
    v_and_b32 v227, s56, v45
    v_cvt_pk_bf16_f32 v44, v224, v225
    v_pk_fma_f32 v[226:227], v[226:227], v[230:231], v[230:231] op_sel:[0,0,1] op_sel_hi:[1,0,1]
    v_lshlrev_b32 v224, 16, v46
    v_and_b32 v225, s56, v46
    v_cvt_pk_bf16_f32 v45, v226, v227
    v_pk_fma_f32 v[224:225], v[224:225], v[230:231], v[230:231] op_sel:[0,0,1] op_sel_hi:[1,0,1]
    v_lshlrev_b32 v226, 16, v47
    v_and_b32 v227, s56, v47
    v_cvt_pk_bf16_f32 v46, v224, v225
    v_pk_fma_f32 v[226:227], v[226:227], v[230:231], v[230:231] op_sel:[0,0,1] op_sel_hi:[1,0,1]
    v_lshlrev_b32 v224, 16, v48
    v_and_b32 v225, s56, v48
    v_cvt_pk_bf16_f32 v47, v226, v227
    v_pk_fma_f32 v[224:225], v[224:225], v[230:231], v[230:231] op_sel:[0,0,1] op_sel_hi:[1,0,1]
    v_lshlrev_b32 v226, 16, v49
    v_and_b32 v227, s56, v49
    v_cvt_pk_bf16_f32 v48, v224, v225
    v_pk_fma_f32 v[226:227], v[226:227], v[230:231], v[230:231] op_sel:[0,0,1] op_sel_hi:[1,0,1]
    v_lshlrev_b32 v224, 16, v50
    s_add_u32 m0, s43, 43008
    s_add_u32 s101, s44, 1161216
    buffer_load_dwordx4 v220, s[16:19], s101 offen  lds
    v_and_b32 v225, s56, v50
    v_cvt_pk_bf16_f32 v49, v226, v227
    v_pk_fma_f32 v[224:225], v[224:225], v[230:231], v[230:231] op_sel:[0,0,1] op_sel_hi:[1,0,1]
    v_lshlrev_b32 v226, 16, v51
    v_and_b32 v227, s56, v51
    v_cvt_pk_bf16_f32 v50, v224, v225
    v_pk_fma_f32 v[226:227], v[226:227], v[230:231], v[230:231] op_sel:[0,0,1] op_sel_hi:[1,0,1]
    v_lshlrev_b32 v224, 16, v52
    v_and_b32 v225, s56, v52
    v_cvt_pk_bf16_f32 v51, v226, v227
    v_pk_fma_f32 v[224:225], v[224:225], v[230:231], v[230:231] op_sel:[0,0,1] op_sel_hi:[1,0,1]
    v_lshlrev_b32 v226, 16, v53
    v_and_b32 v227, s56, v53
    v_cvt_pk_bf16_f32 v52, v224, v225
    v_pk_fma_f32 v[226:227], v[226:227], v[230:231], v[230:231] op_sel:[0,0,1] op_sel_hi:[1,0,1]
    v_lshlrev_b32 v224, 16, v54
    v_and_b32 v225, s56, v54
    v_cvt_pk_bf16_f32 v53, v226, v227
    v_pk_fma_f32 v[224:225], v[224:225], v[230:231], v[230:231] op_sel:[0,0,1] op_sel_hi:[1,0,1]
    v_lshlrev_b32 v226, 16, v55
    v_and_b32 v227, s56, v55
    v_cvt_pk_bf16_f32 v54, v224, v225
    v_pk_fma_f32 v[226:227], v[226:227], v[230:231], v[230:231] op_sel:[0,0,1] op_sel_hi:[1,0,1]
    v_lshlrev_b32 v224, 16, v56
    v_and_b32 v225, s56, v56
    v_cvt_pk_bf16_f32 v55, v226, v227
    v_pk_fma_f32 v[224:225], v[224:225], v[230:231], v[230:231] op_sel:[0,0,1] op_sel_hi:[1,0,1]
    s_add_u32 m0, s43, 44032
    s_add_u32 s101, s44, 1188864
    buffer_load_dwordx4 v220, s[16:19], s101 offen  lds
    v_lshlrev_b32 v226, 16, v57
    v_and_b32 v227, s56, v57
    v_cvt_pk_bf16_f32 v56, v224, v225
    v_pk_fma_f32 v[226:227], v[226:227], v[230:231], v[230:231] op_sel:[0,0,1] op_sel_hi:[1,0,1]
    v_lshlrev_b32 v224, 16, v58
    v_and_b32 v225, s56, v58
    v_cvt_pk_bf16_f32 v57, v226, v227
    v_pk_fma_f32 v[224:225], v[224:225], v[230:231], v[230:231] op_sel:[0,0,1] op_sel_hi:[1,0,1]
    v_lshlrev_b32 v226, 16, v59
    v_and_b32 v227, s56, v59
    v_cvt_pk_bf16_f32 v58, v224, v225
    v_pk_fma_f32 v[226:227], v[226:227], v[230:231], v[230:231] op_sel:[0,0,1] op_sel_hi:[1,0,1]
    v_lshlrev_b32 v224, 16, v60
    v_and_b32 v225, s56, v60
    v_cvt_pk_bf16_f32 v59, v226, v227
    v_pk_fma_f32 v[224:225], v[224:225], v[230:231], v[230:231] op_sel:[0,0,1] op_sel_hi:[1,0,1]
    v_lshlrev_b32 v226, 16, v61
    v_and_b32 v227, s56, v61
    v_cvt_pk_bf16_f32 v60, v224, v225
    v_pk_fma_f32 v[226:227], v[226:227], v[230:231], v[230:231] op_sel:[0,0,1] op_sel_hi:[1,0,1]
    v_lshlrev_b32 v224, 16, v62
    v_and_b32 v225, s56, v62
    v_cvt_pk_bf16_f32 v61, v226, v227
    v_pk_fma_f32 v[224:225], v[224:225], v[230:231], v[230:231] op_sel:[0,0,1] op_sel_hi:[1,0,1]
    v_lshlrev_b32 v226, 16, v63
    v_and_b32 v227, s56, v63
    v_cvt_pk_bf16_f32 v62, v224, v225
    s_add_u32 m0, s43, 45056
    s_add_u32 s101, s44, 1216512
    buffer_load_dwordx4 v220, s[16:19], s101 offen  lds
    v_pk_fma_f32 v[226:227], v[226:227], v[230:231], v[230:231] op_sel:[0,0,1] op_sel_hi:[1,0,1]
    v_lshlrev_b32 v224, 16, v64
    v_and_b32 v225, s56, v64
    v_cvt_pk_bf16_f32 v63, v226, v227
    v_pk_fma_f32 v[224:225], v[224:225], v[230:231], v[230:231] op_sel:[0,0,1] op_sel_hi:[1,0,1]
    v_lshlrev_b32 v226, 16, v65
    v_and_b32 v227, s56, v65
    v_cvt_pk_bf16_f32 v64, v224, v225
    v_pk_fma_f32 v[226:227], v[226:227], v[230:231], v[230:231] op_sel:[0,0,1] op_sel_hi:[1,0,1]
    v_lshlrev_b32 v224, 16, v66
    v_and_b32 v225, s56, v66
    v_cvt_pk_bf16_f32 v65, v226, v227
    v_pk_fma_f32 v[224:225], v[224:225], v[230:231], v[230:231] op_sel:[0,0,1] op_sel_hi:[1,0,1]
    v_lshlrev_b32 v226, 16, v67
    v_and_b32 v227, s56, v67
    v_cvt_pk_bf16_f32 v66, v224, v225
    v_pk_fma_f32 v[226:227], v[226:227], v[230:231], v[230:231] op_sel:[0,0,1] op_sel_hi:[1,0,1]
    v_lshlrev_b32 v224, 16, v68
    v_and_b32 v225, s56, v68
    v_cvt_pk_bf16_f32 v67, v226, v227
    v_pk_fma_f32 v[224:225], v[224:225], v[230:231], v[230:231] op_sel:[0,0,1] op_sel_hi:[1,0,1]
    v_lshlrev_b32 v226, 16, v69
    v_and_b32 v227, s56, v69
    v_cvt_pk_bf16_f32 v68, v224, v225
    v_pk_fma_f32 v[226:227], v[226:227], v[230:231], v[230:231] op_sel:[0,0,1] op_sel_hi:[1,0,1]
    v_lshlrev_b32 v224, 16, v70
    v_and_b32 v225, s56, v70
    v_add_u32 v220, s50, v216
    v_cvt_pk_bf16_f32 v69, v226, v227
    v_pk_fma_f32 v[224:225], v[224:225], v[230:231], v[230:231] op_sel:[0,0,1] op_sel_hi:[1,0,1]
    v_lshlrev_b32 v226, 16, v71
    v_and_b32 v227, s56, v71
    v_cvt_pk_bf16_f32 v70, v224, v225
    v_pk_fma_f32 v[226:227], v[226:227], v[230:231], v[230:231] op_sel:[0,0,1] op_sel_hi:[1,0,1]
    v_lshlrev_b32 v224, 16, v72
    v_and_b32 v225, s56, v72
    v_cvt_pk_bf16_f32 v71, v226, v227
    v_pk_fma_f32 v[224:225], v[224:225], v[230:231], v[230:231] op_sel:[0,0,1] op_sel_hi:[1,0,1]
    v_lshlrev_b32 v226, 16, v73
    v_and_b32 v227, s56, v73
    v_cvt_pk_bf16_f32 v72, v224, v225
    v_pk_fma_f32 v[226:227], v[226:227], v[230:231], v[230:231] op_sel:[0,0,1] op_sel_hi:[1,0,1]
    v_lshlrev_b32 v224, 16, v74
    v_and_b32 v225, s56, v74
    v_cvt_pk_bf16_f32 v73, v226, v227
    v_pk_fma_f32 v[224:225], v[224:225], v[230:231], v[230:231] op_sel:[0,0,1] op_sel_hi:[1,0,1]
    v_lshlrev_b32 v226, 16, v75
    v_and_b32 v227, s56, v75
    v_cvt_pk_bf16_f32 v74, v224, v225
    v_pk_fma_f32 v[226:227], v[226:227], v[230:231], v[230:231] op_sel:[0,0,1] op_sel_hi:[1,0,1]
    v_lshlrev_b32 v224, 16, v76
    v_and_b32 v225, s56, v76
    v_cvt_pk_bf16_f32 v75, v226, v227
    v_pk_fma_f32 v[224:225], v[224:225], v[230:231], v[230:231] op_sel:[0,0,1] op_sel_hi:[1,0,1]
    v_lshlrev_b32 v226, 16, v77
    s_add_u32 m0, s43, 73728
    s_add_u32 s101, s44, 0
    buffer_load_dwordx4 v220, s[28:31], s101 offen  lds
    v_and_b32 v227, s56, v77
    v_cvt_pk_bf16_f32 v76, v224, v225
    v_pk_fma_f32 v[226:227], v[226:227], v[230:231], v[230:231] op_sel:[0,0,1] op_sel_hi:[1,0,1]
    v_lshlrev_b32 v224, 16, v78
    v_and_b32 v225, s56, v78
    v_cvt_pk_bf16_f32 v77, v226, v227
    v_pk_fma_f32 v[224:225], v[224:225], v[230:231], v[230:231] op_sel:[0,0,1] op_sel_hi:[1,0,1]
    v_lshlrev_b32 v226, 16, v79
    v_and_b32 v227, s56, v79
    v_cvt_pk_bf16_f32 v78, v224, v225
    v_pk_fma_f32 v[226:227], v[226:227], v[230:231], v[230:231] op_sel:[0,0,1] op_sel_hi:[1,0,1]
    v_lshlrev_b32 v224, 16, v80
    v_and_b32 v225, s56, v80
    v_cvt_pk_bf16_f32 v79, v226, v227
    v_pk_fma_f32 v[224:225], v[224:225], v[230:231], v[230:231] op_sel:[0,0,1] op_sel_hi:[1,0,1]
    v_lshlrev_b32 v226, 16, v81
    v_and_b32 v227, s56, v81
    v_cvt_pk_bf16_f32 v80, v224, v225
    v_pk_fma_f32 v[226:227], v[226:227], v[230:231], v[230:231] op_sel:[0,0,1] op_sel_hi:[1,0,1]
    v_lshlrev_b32 v224, 16, v82
    v_and_b32 v225, s56, v82
    v_cvt_pk_bf16_f32 v81, v226, v227
    v_pk_fma_f32 v[224:225], v[224:225], v[230:231], v[230:231] op_sel:[0,0,1] op_sel_hi:[1,0,1]
    v_lshlrev_b32 v226, 16, v83
    v_and_b32 v227, s56, v83
    v_cvt_pk_bf16_f32 v82, v224, v225
    v_pk_fma_f32 v[226:227], v[226:227], v[230:231], v[230:231] op_sel:[0,0,1] op_sel_hi:[1,0,1]
    s_add_u32 m0, s43, 74752
    s_add_u32 s101, s44, 27648
    buffer_load_dwordx4 v220, s[28:31], s101 offen  lds
    v_lshlrev_b32 v224, 16, v84
    v_and_b32 v225, s56, v84
    v_cvt_pk_bf16_f32 v83, v226, v227
    v_pk_fma_f32 v[224:225], v[224:225], v[230:231], v[230:231] op_sel:[0,0,1] op_sel_hi:[1,0,1]
    v_lshlrev_b32 v226, 16, v85
    v_and_b32 v227, s56, v85
    v_cvt_pk_bf16_f32 v84, v224, v225
    v_pk_fma_f32 v[226:227], v[226:227], v[230:231], v[230:231] op_sel:[0,0,1] op_sel_hi:[1,0,1]
    v_lshlrev_b32 v224, 16, v86
    v_and_b32 v225, s56, v86
    v_cvt_pk_bf16_f32 v85, v226, v227
    v_pk_fma_f32 v[224:225], v[224:225], v[230:231], v[230:231] op_sel:[0,0,1] op_sel_hi:[1,0,1]
    v_lshlrev_b32 v226, 16, v87
    v_and_b32 v227, s56, v87
    v_cvt_pk_bf16_f32 v86, v224, v225
    v_pk_fma_f32 v[226:227], v[226:227], v[230:231], v[230:231] op_sel:[0,0,1] op_sel_hi:[1,0,1]
    v_lshlrev_b32 v224, 16, v88
    v_and_b32 v225, s56, v88
    v_cvt_pk_bf16_f32 v87, v226, v227
    v_pk_fma_f32 v[224:225], v[224:225], v[230:231], v[230:231] op_sel:[0,0,1] op_sel_hi:[1,0,1]
    v_lshlrev_b32 v226, 16, v89
    v_and_b32 v227, s56, v89
    v_cvt_pk_bf16_f32 v88, v224, v225
    v_pk_fma_f32 v[226:227], v[226:227], v[230:231], v[230:231] op_sel:[0,0,1] op_sel_hi:[1,0,1]
    v_lshlrev_b32 v224, 16, v90
    v_and_b32 v225, s56, v90
    v_cvt_pk_bf16_f32 v89, v226, v227
    s_add_u32 m0, s43, 75776
    s_add_u32 s101, s44, 55296
    buffer_load_dwordx4 v220, s[28:31], s101 offen  lds
    v_pk_fma_f32 v[224:225], v[224:225], v[230:231], v[230:231] op_sel:[0,0,1] op_sel_hi:[1,0,1]
    v_lshlrev_b32 v226, 16, v91
    v_and_b32 v227, s56, v91
    v_cvt_pk_bf16_f32 v90, v224, v225
    v_pk_fma_f32 v[226:227], v[226:227], v[230:231], v[230:231] op_sel:[0,0,1] op_sel_hi:[1,0,1]
    v_lshlrev_b32 v224, 16, v92
    v_and_b32 v225, s56, v92
    v_cvt_pk_bf16_f32 v91, v226, v227
    v_pk_fma_f32 v[224:225], v[224:225], v[230:231], v[230:231] op_sel:[0,0,1] op_sel_hi:[1,0,1]
    v_lshlrev_b32 v226, 16, v93
    v_and_b32 v227, s56, v93
    v_cvt_pk_bf16_f32 v92, v224, v225
    v_pk_fma_f32 v[226:227], v[226:227], v[230:231], v[230:231] op_sel:[0,0,1] op_sel_hi:[1,0,1]
    v_lshlrev_b32 v224, 16, v94
    v_and_b32 v225, s56, v94
    v_cvt_pk_bf16_f32 v93, v226, v227
    v_pk_fma_f32 v[224:225], v[224:225], v[230:231], v[230:231] op_sel:[0,0,1] op_sel_hi:[1,0,1]
    v_lshlrev_b32 v226, 16, v95
    v_and_b32 v227, s56, v95
    v_cvt_pk_bf16_f32 v94, v224, v225
    v_pk_fma_f32 v[226:227], v[226:227], v[230:231], v[230:231] op_sel:[0,0,1] op_sel_hi:[1,0,1]
    v_lshlrev_b32 v224, 16, v96
    v_and_b32 v225, s56, v96
    v_cvt_pk_bf16_f32 v95, v226, v227
    v_pk_fma_f32 v[224:225], v[224:225], v[230:231], v[230:231] op_sel:[0,0,1] op_sel_hi:[1,0,1]
    v_lshlrev_b32 v226, 16, v97
    v_and_b32 v227, s56, v97
    s_add_u32 m0, s43, 76800
    s_add_u32 s101, s44, 82944
    buffer_load_dwordx4 v220, s[28:31], s101 offen  lds
    v_cvt_pk_bf16_f32 v96, v224, v225
    v_pk_fma_f32 v[226:227], v[226:227], v[230:231], v[230:231] op_sel:[0,0,1] op_sel_hi:[1,0,1]
    v_lshlrev_b32 v224, 16, v98
    v_and_b32 v225, s56, v98
    v_cvt_pk_bf16_f32 v97, v226, v227
    v_pk_fma_f32 v[224:225], v[224:225], v[230:231], v[230:231] op_sel:[0,0,1] op_sel_hi:[1,0,1]
    v_lshlrev_b32 v226, 16, v99
    v_and_b32 v227, s56, v99
    v_cvt_pk_bf16_f32 v98, v224, v225
    v_pk_fma_f32 v[226:227], v[226:227], v[230:231], v[230:231] op_sel:[0,0,1] op_sel_hi:[1,0,1]
    v_lshlrev_b32 v224, 16, v100
    v_and_b32 v225, s56, v100
    v_cvt_pk_bf16_f32 v99, v226, v227
    v_pk_fma_f32 v[224:225], v[224:225], v[230:231], v[230:231] op_sel:[0,0,1] op_sel_hi:[1,0,1]
    v_lshlrev_b32 v226, 16, v101
    v_and_b32 v227, s56, v101
    v_cvt_pk_bf16_f32 v100, v224, v225
    v_pk_fma_f32 v[226:227], v[226:227], v[230:231], v[230:231] op_sel:[0,0,1] op_sel_hi:[1,0,1]
    v_lshlrev_b32 v224, 16, v102
    v_and_b32 v225, s56, v102
    v_cvt_pk_bf16_f32 v101, v226, v227
    v_pk_fma_f32 v[224:225], v[224:225], v[230:231], v[230:231] op_sel:[0,0,1] op_sel_hi:[1,0,1]
    v_lshlrev_b32 v226, 16, v103
    v_and_b32 v227, s56, v103
    v_cvt_pk_bf16_f32 v102, v224, v225
    v_pk_fma_f32 v[226:227], v[226:227], v[230:231], v[230:231] op_sel:[0,0,1] op_sel_hi:[1,0,1]
    v_lshlrev_b32 v224, 16, v104
    s_add_u32 m0, s43, 77824
    s_add_u32 s101, s44, 110592
    buffer_load_dwordx4 v220, s[28:31], s101 offen  lds
    v_and_b32 v225, s56, v104
    v_cvt_pk_bf16_f32 v103, v226, v227
    v_pk_fma_f32 v[224:225], v[224:225], v[230:231], v[230:231] op_sel:[0,0,1] op_sel_hi:[1,0,1]
    v_lshlrev_b32 v226, 16, v105
    v_and_b32 v227, s56, v105
    v_cvt_pk_bf16_f32 v104, v224, v225
    v_pk_fma_f32 v[226:227], v[226:227], v[230:231], v[230:231] op_sel:[0,0,1] op_sel_hi:[1,0,1]
    v_lshlrev_b32 v224, 16, v106
    v_and_b32 v225, s56, v106
    v_cvt_pk_bf16_f32 v105, v226, v227
    v_pk_fma_f32 v[224:225], v[224:225], v[230:231], v[230:231] op_sel:[0,0,1] op_sel_hi:[1,0,1]
    v_lshlrev_b32 v226, 16, v107
    v_and_b32 v227, s56, v107
    v_cvt_pk_bf16_f32 v106, v224, v225
    v_pk_fma_f32 v[226:227], v[226:227], v[230:231], v[230:231] op_sel:[0,0,1] op_sel_hi:[1,0,1]
    v_lshlrev_b32 v224, 16, v108
    v_and_b32 v225, s56, v108
    v_cvt_pk_bf16_f32 v107, v226, v227
    v_pk_fma_f32 v[224:225], v[224:225], v[230:231], v[230:231] op_sel:[0,0,1] op_sel_hi:[1,0,1]
    v_lshlrev_b32 v226, 16, v109
    v_and_b32 v227, s56, v109
    v_cvt_pk_bf16_f32 v108, v224, v225
    v_pk_fma_f32 v[226:227], v[226:227], v[230:231], v[230:231] op_sel:[0,0,1] op_sel_hi:[1,0,1]
    v_lshlrev_b32 v224, 16, v110
    v_and_b32 v225, s56, v110
    v_cvt_pk_bf16_f32 v109, v226, v227
    v_pk_fma_f32 v[224:225], v[224:225], v[230:231], v[230:231] op_sel:[0,0,1] op_sel_hi:[1,0,1]
    s_add_u32 m0, s43, 78848
    s_add_u32 s101, s44, 138240
    buffer_load_dwordx4 v220, s[28:31], s101 offen  lds
    v_lshlrev_b32 v226, 16, v111
    v_and_b32 v227, s56, v111
    v_cvt_pk_bf16_f32 v110, v224, v225
    v_pk_fma_f32 v[226:227], v[226:227], v[230:231], v[230:231] op_sel:[0,0,1] op_sel_hi:[1,0,1]
    v_lshlrev_b32 v224, 16, v112
    v_and_b32 v225, s56, v112
    v_cvt_pk_bf16_f32 v111, v226, v227
    v_pk_fma_f32 v[224:225], v[224:225], v[230:231], v[230:231] op_sel:[0,0,1] op_sel_hi:[1,0,1]
    v_lshlrev_b32 v226, 16, v113
    v_and_b32 v227, s56, v113
    v_cvt_pk_bf16_f32 v112, v224, v225
    v_pk_fma_f32 v[226:227], v[226:227], v[230:231], v[230:231] op_sel:[0,0,1] op_sel_hi:[1,0,1]
    v_lshlrev_b32 v224, 16, v114
    v_and_b32 v225, s56, v114
    v_cvt_pk_bf16_f32 v113, v226, v227
    v_pk_fma_f32 v[224:225], v[224:225], v[230:231], v[230:231] op_sel:[0,0,1] op_sel_hi:[1,0,1]
    v_lshlrev_b32 v226, 16, v115
    v_and_b32 v227, s56, v115
    v_cvt_pk_bf16_f32 v114, v224, v225
    v_pk_fma_f32 v[226:227], v[226:227], v[230:231], v[230:231] op_sel:[0,0,1] op_sel_hi:[1,0,1]
    v_lshlrev_b32 v224, 16, v116
    v_and_b32 v225, s56, v116
    v_cvt_pk_bf16_f32 v115, v226, v227
    v_pk_fma_f32 v[224:225], v[224:225], v[230:231], v[230:231] op_sel:[0,0,1] op_sel_hi:[1,0,1]
    v_lshlrev_b32 v226, 16, v117
    v_and_b32 v227, s56, v117
    v_cvt_pk_bf16_f32 v116, v224, v225
    s_add_u32 m0, s43, 79872
    s_add_u32 s101, s44, 165888
    buffer_load_dwordx4 v220, s[28:31], s101 offen  lds
    v_pk_fma_f32 v[226:227], v[226:227], v[230:231], v[230:231] op_sel:[0,0,1] op_sel_hi:[1,0,1]
    v_lshlrev_b32 v224, 16, v118
    v_and_b32 v225, s56, v118
    v_cvt_pk_bf16_f32 v117, v226, v227
    v_pk_fma_f32 v[224:225], v[224:225], v[230:231], v[230:231] op_sel:[0,0,1] op_sel_hi:[1,0,1]
    v_lshlrev_b32 v226, 16, v119
    v_and_b32 v227, s56, v119
    v_cvt_pk_bf16_f32 v118, v224, v225
    v_pk_fma_f32 v[226:227], v[226:227], v[230:231], v[230:231] op_sel:[0,0,1] op_sel_hi:[1,0,1]
    v_lshlrev_b32 v224, 16, v120
    v_and_b32 v225, s56, v120
    v_cvt_pk_bf16_f32 v119, v226, v227
    v_pk_fma_f32 v[224:225], v[224:225], v[230:231], v[230:231] op_sel:[0,0,1] op_sel_hi:[1,0,1]
    v_lshlrev_b32 v226, 16, v121
    v_and_b32 v227, s56, v121
    v_cvt_pk_bf16_f32 v120, v224, v225
    v_pk_fma_f32 v[226:227], v[226:227], v[230:231], v[230:231] op_sel:[0,0,1] op_sel_hi:[1,0,1]
    v_lshlrev_b32 v224, 16, v122
    v_and_b32 v225, s56, v122
    v_cvt_pk_bf16_f32 v121, v226, v227
    v_pk_fma_f32 v[224:225], v[224:225], v[230:231], v[230:231] op_sel:[0,0,1] op_sel_hi:[1,0,1]
    v_lshlrev_b32 v226, 16, v123
    v_and_b32 v227, s56, v123
    v_cvt_pk_bf16_f32 v122, v224, v225
    v_pk_fma_f32 v[226:227], v[226:227], v[230:231], v[230:231] op_sel:[0,0,1] op_sel_hi:[1,0,1]
    v_lshlrev_b32 v224, 16, v124
    v_and_b32 v225, s56, v124
    s_add_u32 m0, s43, 80896
    s_add_u32 s101, s44, 193536
    buffer_load_dwordx4 v220, s[28:31], s101 offen  lds
    v_cvt_pk_bf16_f32 v123, v226, v227
    v_pk_fma_f32 v[224:225], v[224:225], v[230:231], v[230:231] op_sel:[0,0,1] op_sel_hi:[1,0,1]
    v_lshlrev_b32 v226, 16, v125
    v_and_b32 v227, s56, v125
    v_cvt_pk_bf16_f32 v124, v224, v225
    v_pk_fma_f32 v[226:227], v[226:227], v[230:231], v[230:231] op_sel:[0,0,1] op_sel_hi:[1,0,1]
    v_lshlrev_b32 v224, 16, v126
    v_and_b32 v225, s56, v126
    v_cvt_pk_bf16_f32 v125, v226, v227
    v_pk_fma_f32 v[224:225], v[224:225], v[230:231], v[230:231] op_sel:[0,0,1] op_sel_hi:[1,0,1]
    v_lshlrev_b32 v226, 16, v127
    v_and_b32 v227, s56, v127
    v_cvt_pk_bf16_f32 v126, v224, v225
    v_pk_fma_f32 v[226:227], v[226:227], v[230:231], v[230:231] op_sel:[0,0,1] op_sel_hi:[1,0,1]
    v_lshlrev_b32 v224, 16, v128
    v_and_b32 v225, s56, v128
    v_cvt_pk_bf16_f32 v127, v226, v227
    v_pk_fma_f32 v[224:225], v[224:225], v[230:231], v[230:231] op_sel:[0,0,1] op_sel_hi:[1,0,1]
    v_lshlrev_b32 v226, 16, v129
    v_and_b32 v227, s56, v129
    v_cvt_pk_bf16_f32 v128, v224, v225
    v_pk_fma_f32 v[226:227], v[226:227], v[230:231], v[230:231] op_sel:[0,0,1] op_sel_hi:[1,0,1]
    v_lshlrev_b32 v224, 16, v130
    v_and_b32 v225, s56, v130
    v_cvt_pk_bf16_f32 v129, v226, v227
    v_pk_fma_f32 v[224:225], v[224:225], v[230:231], v[230:231] op_sel:[0,0,1] op_sel_hi:[1,0,1]
    v_lshlrev_b32 v226, 16, v131
    s_add_u32 m0, s43, 81920
    s_add_u32 s101, s44, 221184
    buffer_load_dwordx4 v220, s[28:31], s101 offen  lds
    v_and_b32 v227, s56, v131
    v_cvt_pk_bf16_f32 v130, v224, v225
    v_pk_fma_f32 v[226:227], v[226:227], v[230:231], v[230:231] op_sel:[0,0,1] op_sel_hi:[1,0,1]
    v_lshlrev_b32 v224, 16, v132
    v_and_b32 v225, s56, v132
    v_cvt_pk_bf16_f32 v131, v226, v227
    v_pk_fma_f32 v[224:225], v[224:225], v[230:231], v[230:231] op_sel:[0,0,1] op_sel_hi:[1,0,1]
    v_lshlrev_b32 v226, 16, v133
    v_and_b32 v227, s56, v133
    v_cvt_pk_bf16_f32 v132, v224, v225
    v_pk_fma_f32 v[226:227], v[226:227], v[230:231], v[230:231] op_sel:[0,0,1] op_sel_hi:[1,0,1]
    v_lshlrev_b32 v224, 16, v134
    v_and_b32 v225, s56, v134
    v_cvt_pk_bf16_f32 v133, v226, v227
    v_pk_fma_f32 v[224:225], v[224:225], v[230:231], v[230:231] op_sel:[0,0,1] op_sel_hi:[1,0,1]
    v_lshlrev_b32 v226, 16, v135
    v_and_b32 v227, s56, v135
    v_cvt_pk_bf16_f32 v134, v224, v225
    v_pk_fma_f32 v[226:227], v[226:227], v[230:231], v[230:231] op_sel:[0,0,1] op_sel_hi:[1,0,1]
    v_lshlrev_b32 v224, 16, v136
    v_and_b32 v225, s56, v136
    v_cvt_pk_bf16_f32 v135, v226, v227
    v_pk_fma_f32 v[224:225], v[224:225], v[230:231], v[230:231] op_sel:[0,0,1] op_sel_hi:[1,0,1]
    v_lshlrev_b32 v226, 16, v137
    v_and_b32 v227, s56, v137
    v_cvt_pk_bf16_f32 v136, v224, v225
    v_pk_fma_f32 v[226:227], v[226:227], v[230:231], v[230:231] op_sel:[0,0,1] op_sel_hi:[1,0,1]
    v_lshlrev_b32 v224, 16, v138
    v_and_b32 v225, s56, v138
    v_cvt_pk_bf16_f32 v137, v226, v227
    v_pk_fma_f32 v[224:225], v[224:225], v[230:231], v[230:231] op_sel:[0,0,1] op_sel_hi:[1,0,1]
    v_lshlrev_b32 v226, 16, v139
    v_and_b32 v227, s56, v139
    v_cvt_pk_bf16_f32 v138, v224, v225
    v_pk_fma_f32 v[226:227], v[226:227], v[230:231], v[230:231] op_sel:[0,0,1] op_sel_hi:[1,0,1]
    v_lshlrev_b32 v224, 16, v140
    v_and_b32 v225, s56, v140
    v_cvt_pk_bf16_f32 v139, v226, v227
    v_pk_fma_f32 v[224:225], v[224:225], v[230:231], v[230:231] op_sel:[0,0,1] op_sel_hi:[1,0,1]
    v_lshlrev_b32 v226, 16, v141
    v_and_b32 v227, s56, v141
    v_cvt_pk_bf16_f32 v140, v224, v225
    v_pk_fma_f32 v[226:227], v[226:227], v[230:231], v[230:231] op_sel:[0,0,1] op_sel_hi:[1,0,1]
    v_lshlrev_b32 v224, 16, v142
    v_and_b32 v225, s56, v142
    v_cvt_pk_bf16_f32 v141, v226, v227
    v_pk_fma_f32 v[224:225], v[224:225], v[230:231], v[230:231] op_sel:[0,0,1] op_sel_hi:[1,0,1]
    v_lshlrev_b32 v226, 16, v143
    v_and_b32 v227, s56, v143
    v_cvt_pk_bf16_f32 v142, v224, v225
    v_pk_fma_f32 v[226:227], v[226:227], v[230:231], v[230:231] op_sel:[0,0,1] op_sel_hi:[1,0,1]
    v_cvt_pk_bf16_f32 v143, v226, v227
    s_mul_i32 s57, s42, 288
    s_mul_i32 s58, s41, 18
    s_add_u32 s57, s57, s58
    s_mul_i32 s57, s57, 1152
    s_mul_i32 s58, s40, 5248
    s_add_u32 s57, s57, s58
    v_min_u32 v238, 40, v255
    v_lshlrev_b32 v238, 7, v238
    buffer_load_dword v239, v238, s[24:27], s57 offen
    s_waitcnt vmcnt(19)
    s_barrier
    v_readfirstlane_b32 s78, v232
    s_nop 0
    s_cmp_lg_u32 s78, 0
    s_cbranch_scc0 parallel_sum__softmax_full_mha__dense_activation_relu__prompt_kernel_spin_n
parallel_sum__softmax_full_mha__dense_activation_relu__prompt_kernel_spin_n_ret:
    v_mov_b32 v232, s78
    s_and_b32 s56, s42, 3
    s_lshl_b32 s32, s41, 2
    s_add_u32 s32, s32, s56
    s_lshr_b32 s33, s42, 2
    s_mul_i32 s56, s33, 20
    s_add_u32 s56, s56, s40
    s_mul_i32 s56, s56, 9216
    s_add_u32 s34, s56, 47185920
    v_add_u32 v212, 0, v208
    v_xor_b32 v213, 64, v212
    ds_read_b64_tr_b16 a[0:1], v212 offset:0
    ds_read_b64_tr_b16 a[2:3], v212 offset:512
    ds_read_b64_tr_b16 a[4:5], v212 offset:2048
    ds_read_b64_tr_b16 a[6:7], v212 offset:2560
    ds_read_b64_tr_b16 a[8:9], v212 offset:4096
    ds_read_b64_tr_b16 a[10:11], v212 offset:4608
    ds_read_b64_tr_b16 a[12:13], v212 offset:6144
    ds_read_b64_tr_b16 a[14:15], v212 offset:6656
    s_waitcnt lgkmcnt(4)
    ds_read_b64_tr_b16 a[16:17], v212 offset:8192
    ds_read_b64_tr_b16 a[18:19], v212 offset:8704
    v_mfma_f32_32x32x16_bf16 v[144:159], a[0:3], v[0:3], 0
    ds_read_b64_tr_b16 a[20:21], v212 offset:10240
    ds_read_b64_tr_b16 a[22:23], v212 offset:10752
    v_mfma_f32_32x32x16_bf16 v[144:159], a[4:7], v[4:7], v[144:159]
    s_waitcnt lgkmcnt(4)
    ds_read_b64_tr_b16 a[0:1], v212 offset:12288
    ds_read_b64_tr_b16 a[2:3], v212 offset:12800
    v_mfma_f32_32x32x16_bf16 v[144:159], a[8:11], v[8:11], v[144:159]
    ds_read_b64_tr_b16 a[4:5], v212 offset:14336
    ds_read_b64_tr_b16 a[6:7], v212 offset:14848
    v_mfma_f32_32x32x16_bf16 v[144:159], a[12:15], v[12:15], v[144:159]
    s_waitcnt lgkmcnt(4)
    ds_read_b64_tr_b16 a[8:9], v212 offset:16384
    ds_read_b64_tr_b16 a[10:11], v212 offset:16896
    v_mfma_f32_32x32x16_bf16 v[144:159], a[16:19], v[16:19], v[144:159]
    ds_read_b64_tr_b16 a[12:13], v212 offset:18432
    ds_read_b64_tr_b16 a[14:15], v212 offset:18944
    v_mfma_f32_32x32x16_bf16 v[144:159], a[20:23], v[20:23], v[144:159]
    s_waitcnt lgkmcnt(4)
    ds_read_b64_tr_b16 a[16:17], v212 offset:20480
    ds_read_b64_tr_b16 a[18:19], v212 offset:20992
    v_mfma_f32_32x32x16_bf16 v[144:159], a[0:3], v[24:27], v[144:159]
    ds_read_b64_tr_b16 a[20:21], v212 offset:22528
    ds_read_b64_tr_b16 a[22:23], v212 offset:23040
    v_mfma_f32_32x32x16_bf16 v[144:159], a[4:7], v[28:31], v[144:159]
    s_waitcnt lgkmcnt(4)
    ds_read_b64_tr_b16 a[0:1], v212 offset:24576
    ds_read_b64_tr_b16 a[2:3], v212 offset:25088
    v_mfma_f32_32x32x16_bf16 v[144:159], a[8:11], v[32:35], v[144:159]
    ds_read_b64_tr_b16 a[4:5], v212 offset:26624
    ds_read_b64_tr_b16 a[6:7], v212 offset:27136
    v_mfma_f32_32x32x16_bf16 v[144:159], a[12:15], v[36:39], v[144:159]
    s_waitcnt lgkmcnt(4)
    ds_read_b64_tr_b16 a[8:9], v212 offset:28672
    ds_read_b64_tr_b16 a[10:11], v212 offset:29184
    v_mfma_f32_32x32x16_bf16 v[144:159], a[16:19], v[40:43], v[144:159]
    ds_read_b64_tr_b16 a[12:13], v212 offset:30720
    ds_read_b64_tr_b16 a[14:15], v212 offset:31232
    v_mfma_f32_32x32x16_bf16 v[144:159], a[20:23], v[44:47], v[144:159]
    s_waitcnt lgkmcnt(4)
    ds_read_b64_tr_b16 a[16:17], v212 offset:32768
    ds_read_b64_tr_b16 a[18:19], v212 offset:33280
    v_mfma_f32_32x32x16_bf16 v[144:159], a[0:3], v[48:51], v[144:159]
    ds_read_b64_tr_b16 a[20:21], v212 offset:34816
    ds_read_b64_tr_b16 a[22:23], v212 offset:35328
    v_mfma_f32_32x32x16_bf16 v[144:159], a[4:7], v[52:55], v[144:159]
    s_waitcnt lgkmcnt(4)
    ds_read_b64_tr_b16 a[0:1], v213 offset:0
    ds_read_b64_tr_b16 a[2:3], v213 offset:512
    v_mfma_f32_32x32x16_bf16 v[144:159], a[8:11], v[56:59], v[144:159]
    ds_read_b64_tr_b16 a[4:5], v213 offset:2048
    ds_read_b64_tr_b16 a[6:7], v213 offset:2560
    v_mfma_f32_32x32x16_bf16 v[144:159], a[12:15], v[60:63], v[144:159]
    s_waitcnt lgkmcnt(4)
    ds_read_b64_tr_b16 a[8:9], v213 offset:4096
    ds_read_b64_tr_b16 a[10:11], v213 offset:4608
    v_mfma_f32_32x32x16_bf16 v[144:159], a[16:19], v[64:67], v[144:159]
    ds_read_b64_tr_b16 a[12:13], v213 offset:6144
    ds_read_b64_tr_b16 a[14:15], v213 offset:6656
    v_mfma_f32_32x32x16_bf16 v[144:159], a[20:23], v[68:71], v[144:159]
    s_waitcnt lgkmcnt(4)
    ds_read_b64_tr_b16 a[16:17], v213 offset:8192
    ds_read_b64_tr_b16 a[18:19], v213 offset:8704
    v_mfma_f32_32x32x16_bf16 v[160:175], a[0:3], v[0:3], 0
    ds_read_b64_tr_b16 a[20:21], v213 offset:10240
    ds_read_b64_tr_b16 a[22:23], v213 offset:10752
    v_mfma_f32_32x32x16_bf16 v[160:175], a[4:7], v[4:7], v[160:175]
    s_waitcnt lgkmcnt(4)
    ds_read_b64_tr_b16 a[0:1], v213 offset:12288
    ds_read_b64_tr_b16 a[2:3], v213 offset:12800
    v_mfma_f32_32x32x16_bf16 v[160:175], a[8:11], v[8:11], v[160:175]
    v_add_u32 v214, 36864, v208
    ds_read_b64_tr_b16 a[4:5], v213 offset:14336
    ds_read_b64_tr_b16 a[6:7], v213 offset:14848
    v_mfma_f32_32x32x16_bf16 v[160:175], a[12:15], v[12:15], v[160:175]
    v_xor_b32 v215, 64, v214
    s_waitcnt lgkmcnt(4)
    ds_read_b64_tr_b16 a[8:9], v213 offset:16384
    ds_read_b64_tr_b16 a[10:11], v213 offset:16896
    v_mfma_f32_32x32x16_bf16 v[160:175], a[16:19], v[16:19], v[160:175]
    ds_read_b64_tr_b16 a[12:13], v213 offset:18432
    ds_read_b64_tr_b16 a[14:15], v213 offset:18944
    v_mfma_f32_32x32x16_bf16 v[160:175], a[20:23], v[20:23], v[160:175]
    s_waitcnt lgkmcnt(4)
    ds_read_b64_tr_b16 a[16:17], v213 offset:20480
    ds_read_b64_tr_b16 a[18:19], v213 offset:20992
    v_mfma_f32_32x32x16_bf16 v[160:175], a[0:3], v[24:27], v[160:175]
    ds_read_b64_tr_b16 a[20:21], v213 offset:22528
    ds_read_b64_tr_b16 a[22:23], v213 offset:23040
    v_mfma_f32_32x32x16_bf16 v[160:175], a[4:7], v[28:31], v[160:175]
    s_waitcnt lgkmcnt(4)
    ds_read_b64_tr_b16 a[0:1], v213 offset:24576
    ds_read_b64_tr_b16 a[2:3], v213 offset:25088
    v_mfma_f32_32x32x16_bf16 v[160:175], a[8:11], v[32:35], v[160:175]
    ds_read_b64_tr_b16 a[4:5], v213 offset:26624
    ds_read_b64_tr_b16 a[6:7], v213 offset:27136
    v_mfma_f32_32x32x16_bf16 v[160:175], a[12:15], v[36:39], v[160:175]
    s_waitcnt lgkmcnt(4)
    ds_read_b64_tr_b16 a[8:9], v213 offset:28672
    ds_read_b64_tr_b16 a[10:11], v213 offset:29184
    v_mfma_f32_32x32x16_bf16 v[160:175], a[16:19], v[40:43], v[160:175]
    ds_read_b64_tr_b16 a[12:13], v213 offset:30720
    ds_read_b64_tr_b16 a[14:15], v213 offset:31232
    v_mfma_f32_32x32x16_bf16 v[160:175], a[20:23], v[44:47], v[160:175]
    s_waitcnt lgkmcnt(4)
    ds_read_b64_tr_b16 a[16:17], v213 offset:32768
    ds_read_b64_tr_b16 a[18:19], v213 offset:33280
    v_mfma_f32_32x32x16_bf16 v[160:175], a[0:3], v[48:51], v[160:175]
    s_waitcnt vmcnt(10)
    s_barrier
    v_add_u32 v220, s50, v216
    ds_read_b64_tr_b16 a[20:21], v213 offset:34816
    ds_read_b64_tr_b16 a[22:23], v213 offset:35328
    v_mfma_f32_32x32x16_bf16 v[160:175], a[4:7], v[52:55], v[160:175]
    s_add_u32 m0, s43, 110592
    s_add_u32 s101, s44, 995328
    buffer_load_dwordx4 v220, s[28:31], s101 offen  lds
    s_waitcnt lgkmcnt(4)
    ds_read_b64_tr_b16 a[0:1], v214 offset:0
    ds_read_b64_tr_b16 a[2:3], v214 offset:512
    v_mfma_f32_32x32x16_bf16 v[160:175], a[8:11], v[56:59], v[160:175]
    ds_read_b64_tr_b16 a[4:5], v214 offset:2048
    ds_read_b64_tr_b16 a[6:7], v214 offset:2560
    v_mfma_f32_32x32x16_bf16 v[160:175], a[12:15], v[60:63], v[160:175]
    s_waitcnt lgkmcnt(4)
    ds_read_b64_tr_b16 a[8:9], v214 offset:4096
    ds_read_b64_tr_b16 a[10:11], v214 offset:4608
    v_mfma_f32_32x32x16_bf16 v[160:175], a[16:19], v[64:67], v[160:175]
    s_add_u32 m0, s43, 111616
    s_add_u32 s101, s44, 1022976
    buffer_load_dwordx4 v220, s[28:31], s101 offen  lds
    ds_read_b64_tr_b16 a[12:13], v214 offset:6144
    ds_read_b64_tr_b16 a[14:15], v214 offset:6656
    v_mfma_f32_32x32x16_bf16 v[160:175], a[20:23], v[68:71], v[160:175]
    s_waitcnt lgkmcnt(4)
    ds_read_b64_tr_b16 a[16:17], v214 offset:8192
    ds_read_b64_tr_b16 a[18:19], v214 offset:8704
    v_mfma_f32_32x32x16_bf16 v[144:159], a[0:3], v[72:75], v[144:159]
    ds_read_b64_tr_b16 a[20:21], v214 offset:10240
    ds_read_b64_tr_b16 a[22:23], v214 offset:10752
    v_mfma_f32_32x32x16_bf16 v[144:159], a[4:7], v[76:79], v[144:159]
    s_waitcnt lgkmcnt(4)
    ds_read_b64_tr_b16 a[0:1], v214 offset:12288
    ds_read_b64_tr_b16 a[2:3], v214 offset:12800
    v_mfma_f32_32x32x16_bf16 v[144:159], a[8:11], v[80:83], v[144:159]
    s_add_u32 m0, s43, 112640
    s_add_u32 s101, s44, 1050624
    buffer_load_dwordx4 v220, s[28:31], s101 offen  lds
    ds_read_b64_tr_b16 a[4:5], v214 offset:14336
    ds_read_b64_tr_b16 a[6:7], v214 offset:14848
    v_mfma_f32_32x32x16_bf16 v[144:159], a[12:15], v[84:87], v[144:159]
    s_waitcnt lgkmcnt(4)
    ds_read_b64_tr_b16 a[8:9], v214 offset:16384
    ds_read_b64_tr_b16 a[10:11], v214 offset:16896
    v_mfma_f32_32x32x16_bf16 v[144:159], a[16:19], v[88:91], v[144:159]
    ds_read_b64_tr_b16 a[12:13], v214 offset:18432
    ds_read_b64_tr_b16 a[14:15], v214 offset:18944
    v_mfma_f32_32x32x16_bf16 v[144:159], a[20:23], v[92:95], v[144:159]
    s_waitcnt lgkmcnt(4)
    ds_read_b64_tr_b16 a[16:17], v214 offset:20480
    ds_read_b64_tr_b16 a[18:19], v214 offset:20992
    v_mfma_f32_32x32x16_bf16 v[144:159], a[0:3], v[96:99], v[144:159]
    s_add_u32 m0, s43, 113664
    s_add_u32 s101, s44, 1078272
    buffer_load_dwordx4 v220, s[28:31], s101 offen  lds
    ds_read_b64_tr_b16 a[20:21], v214 offset:22528
    ds_read_b64_tr_b16 a[22:23], v214 offset:23040
    v_mfma_f32_32x32x16_bf16 v[144:159], a[4:7], v[100:103], v[144:159]
    s_waitcnt lgkmcnt(4)
    ds_read_b64_tr_b16 a[0:1], v214 offset:24576
    ds_read_b64_tr_b16 a[2:3], v214 offset:25088
    v_mfma_f32_32x32x16_bf16 v[144:159], a[8:11], v[104:107], v[144:159]
    ds_read_b64_tr_b16 a[4:5], v214 offset:26624
    ds_read_b64_tr_b16 a[6:7], v214 offset:27136
    v_mfma_f32_32x32x16_bf16 v[144:159], a[12:15], v[108:111], v[144:159]
    s_waitcnt lgkmcnt(4)
    ds_read_b64_tr_b16 a[8:9], v214 offset:28672
    ds_read_b64_tr_b16 a[10:11], v214 offset:29184
    v_mfma_f32_32x32x16_bf16 v[144:159], a[16:19], v[112:115], v[144:159]
    s_add_u32 m0, s43, 114688
    s_add_u32 s101, s44, 1105920
    buffer_load_dwordx4 v220, s[28:31], s101 offen  lds
    ds_read_b64_tr_b16 a[12:13], v214 offset:30720
    ds_read_b64_tr_b16 a[14:15], v214 offset:31232
    v_mfma_f32_32x32x16_bf16 v[144:159], a[20:23], v[116:119], v[144:159]
    s_waitcnt lgkmcnt(4)
    ds_read_b64_tr_b16 a[16:17], v214 offset:32768
    ds_read_b64_tr_b16 a[18:19], v214 offset:33280
    v_mfma_f32_32x32x16_bf16 v[144:159], a[0:3], v[120:123], v[144:159]
    ds_read_b64_tr_b16 a[20:21], v214 offset:34816
    ds_read_b64_tr_b16 a[22:23], v214 offset:35328
    v_mfma_f32_32x32x16_bf16 v[144:159], a[4:7], v[124:127], v[144:159]
    s_waitcnt lgkmcnt(4)
    ds_read_b64_tr_b16 a[0:1], v215 offset:0
    ds_read_b64_tr_b16 a[2:3], v215 offset:512
    v_mfma_f32_32x32x16_bf16 v[144:159], a[8:11], v[128:131], v[144:159]
    s_add_u32 m0, s43, 115712
    s_add_u32 s101, s44, 1133568
    buffer_load_dwordx4 v220, s[28:31], s101 offen  lds
    ds_read_b64_tr_b16 a[4:5], v215 offset:2048
    ds_read_b64_tr_b16 a[6:7], v215 offset:2560
    v_mfma_f32_32x32x16_bf16 v[144:159], a[12:15], v[132:135], v[144:159]
    s_waitcnt lgkmcnt(4)
    ds_read_b64_tr_b16 a[8:9], v215 offset:4096
    ds_read_b64_tr_b16 a[10:11], v215 offset:4608
    v_mfma_f32_32x32x16_bf16 v[144:159], a[16:19], v[136:139], v[144:159]
    ds_read_b64_tr_b16 a[12:13], v215 offset:6144
    ds_read_b64_tr_b16 a[14:15], v215 offset:6656
    v_mfma_f32_32x32x16_bf16 v[144:159], a[20:23], v[140:143], v[144:159]
    s_waitcnt lgkmcnt(4)
    ds_read_b64_tr_b16 a[16:17], v215 offset:8192
    ds_read_b64_tr_b16 a[18:19], v215 offset:8704
    v_mfma_f32_32x32x16_bf16 v[160:175], a[0:3], v[72:75], v[160:175]
    s_add_u32 m0, s43, 116736
    s_add_u32 s101, s44, 1161216
    buffer_load_dwordx4 v220, s[28:31], s101 offen  lds
    ds_read_b64_tr_b16 a[20:21], v215 offset:10240
    ds_read_b64_tr_b16 a[22:23], v215 offset:10752
    v_mfma_f32_32x32x16_bf16 v[160:175], a[4:7], v[76:79], v[160:175]
    s_waitcnt lgkmcnt(4)
    ds_read_b64_tr_b16 a[0:1], v215 offset:12288
    ds_read_b64_tr_b16 a[2:3], v215 offset:12800
    v_mfma_f32_32x32x16_bf16 v[160:175], a[8:11], v[80:83], v[160:175]
    v_add_u32 v212, 73728, v208
    ds_read_b64_tr_b16 a[4:5], v215 offset:14336
    ds_read_b64_tr_b16 a[6:7], v215 offset:14848
    v_mfma_f32_32x32x16_bf16 v[160:175], a[12:15], v[84:87], v[160:175]
    v_mul_f32 v144, s53, v144
    v_xor_b32 v213, 64, v212
    s_waitcnt lgkmcnt(4)
    ds_read_b64_tr_b16 a[8:9], v215 offset:16384
    ds_read_b64_tr_b16 a[10:11], v215 offset:16896
    v_mfma_f32_32x32x16_bf16 v[160:175], a[16:19], v[88:91], v[160:175]
    v_mul_f32 v145, s53, v145
    v_mul_f32 v146, s53, v146
    s_add_u32 m0, s43, 117760
    s_add_u32 s101, s44, 1188864
    buffer_load_dwordx4 v220, s[28:31], s101 offen  lds
    ds_read_b64_tr_b16 a[12:13], v215 offset:18432
    ds_read_b64_tr_b16 a[14:15], v215 offset:18944
    v_mfma_f32_32x32x16_bf16 v[160:175], a[20:23], v[92:95], v[160:175]
    v_mul_f32 v147, s53, v147
    v_cvt_pk_bf16_f32 v176, v144, v145
    s_waitcnt lgkmcnt(4)
    ds_read_b64_tr_b16 a[16:17], v215 offset:20480
    ds_read_b64_tr_b16 a[18:19], v215 offset:20992
    v_mfma_f32_32x32x16_bf16 v[160:175], a[0:3], v[96:99], v[160:175]
    v_cvt_pk_bf16_f32 v177, v146, v147
    s_add_u32 s79, s60, 0
    buffer_store_dwordx2 v[176:177], v192, s[8:11], s79 offen sc1
    v_mul_f32 v148, s53, v148
    ds_read_b64_tr_b16 a[20:21], v215 offset:22528
    ds_read_b64_tr_b16 a[22:23], v215 offset:23040
    v_mfma_f32_32x32x16_bf16 v[160:175], a[4:7], v[100:103], v[160:175]
    v_mul_f32 v149, s53, v149
    v_mul_f32 v150, s53, v150
    s_waitcnt lgkmcnt(4)
    ds_read_b64_tr_b16 a[0:1], v215 offset:24576
    ds_read_b64_tr_b16 a[2:3], v215 offset:25088
    v_mfma_f32_32x32x16_bf16 v[160:175], a[8:11], v[104:107], v[160:175]
    v_mul_f32 v151, s53, v151
    v_cvt_pk_bf16_f32 v178, v148, v149
    s_add_u32 m0, s43, 118784
    s_add_u32 s101, s44, 1216512
    buffer_load_dwordx4 v220, s[28:31], s101 offen  lds
    ds_read_b64_tr_b16 a[4:5], v215 offset:26624
    ds_read_b64_tr_b16 a[6:7], v215 offset:27136
    v_mfma_f32_32x32x16_bf16 v[160:175], a[12:15], v[108:111], v[160:175]
    v_cvt_pk_bf16_f32 v179, v150, v151
    s_add_u32 s79, s60, 32768
    buffer_store_dwordx2 v[178:179], v192, s[8:11], s79 offen sc1
    v_mul_f32 v152, s53, v152
    s_waitcnt lgkmcnt(4)
    ds_read_b64_tr_b16 a[8:9], v215 offset:28672
    ds_read_b64_tr_b16 a[10:11], v215 offset:29184
    v_mfma_f32_32x32x16_bf16 v[160:175], a[16:19], v[112:115], v[160:175]
    v_mul_f32 v153, s53, v153
    v_mul_f32 v154, s53, v154
    ds_read_b64_tr_b16 a[12:13], v215 offset:30720
    ds_read_b64_tr_b16 a[14:15], v215 offset:31232
    v_mfma_f32_32x32x16_bf16 v[160:175], a[20:23], v[116:119], v[160:175]
    v_mul_f32 v155, s53, v155
    v_cvt_pk_bf16_f32 v180, v152, v153
    s_waitcnt lgkmcnt(4)
    ds_read_b64_tr_b16 a[16:17], v215 offset:32768
    ds_read_b64_tr_b16 a[18:19], v215 offset:33280
    v_mfma_f32_32x32x16_bf16 v[160:175], a[0:3], v[120:123], v[160:175]
    v_cvt_pk_bf16_f32 v181, v154, v155
    s_add_u32 s79, s60, 65536
    buffer_store_dwordx2 v[180:181], v192, s[8:11], s79 offen sc1
    s_waitcnt vmcnt(13)
    s_barrier
    v_add_u32 v220, s52, v218
    ds_read_b64_tr_b16 a[20:21], v215 offset:34816
    ds_read_b64_tr_b16 a[22:23], v215 offset:35328
    v_mfma_f32_32x32x16_bf16 v[160:175], a[4:7], v[124:127], v[160:175]
    v_mul_f32 v156, s53, v156
    v_mul_f32 v157, s53, v157
    s_add_u32 m0, s43, 0
    s_add_u32 s101, s46, 0
    buffer_load_dwordx4 v220, s[20:23], s101 offen  lds
    s_waitcnt lgkmcnt(4)
    ds_read_b64_tr_b16 a[0:1], v212 offset:0
    ds_read_b64_tr_b16 a[2:3], v212 offset:512
    v_mfma_f32_32x32x16_bf16 v[160:175], a[8:11], v[128:131], v[160:175]
    v_mul_f32 v158, s53, v158
    v_mul_f32 v159, s53, v159
    ds_read_b64_tr_b16 a[4:5], v212 offset:2048
    ds_read_b64_tr_b16 a[6:7], v212 offset:2560
    v_mfma_f32_32x32x16_bf16 v[160:175], a[12:15], v[132:135], v[160:175]
    v_cvt_pk_bf16_f32 v182, v156, v157
    v_cvt_pk_bf16_f32 v183, v158, v159
    s_add_u32 s79, s60, 98304
    buffer_store_dwordx2 v[182:183], v192, s[8:11], s79 offen sc1
    s_waitcnt lgkmcnt(4)
    ds_read_b64_tr_b16 a[8:9], v212 offset:4096
    ds_read_b64_tr_b16 a[10:11], v212 offset:4608
    v_mfma_f32_32x32x16_bf16 v[160:175], a[16:19], v[136:139], v[160:175]
    s_add_u32 m0, s43, 1024
    s_add_u32 s101, s46, 147456
    buffer_load_dwordx4 v220, s[20:23], s101 offen  lds
    ds_read_b64_tr_b16 a[12:13], v212 offset:6144
    ds_read_b64_tr_b16 a[14:15], v212 offset:6656
    v_mfma_f32_32x32x16_bf16 v[160:175], a[20:23], v[140:143], v[160:175]
    s_cmp_eq_u32 s100, 1
    s_cbranch_scc1 parallel_sum__softmax_full_mha__dense_activation_relu__prompt_kernel_u1v
    s_waitcnt lgkmcnt(4)
    ds_read_b64_tr_b16 a[16:17], v212 offset:8192
    ds_read_b64_tr_b16 a[18:19], v212 offset:8704
    v_mfma_f32_32x32x16_bf16 v[144:159], a[0:3], v[0:3], 0
    ds_read_b64_tr_b16 a[20:21], v212 offset:10240
    ds_read_b64_tr_b16 a[22:23], v212 offset:10752
    v_mfma_f32_32x32x16_bf16 v[144:159], a[4:7], v[4:7], v[144:159]
    s_waitcnt lgkmcnt(4)
    ds_read_b64_tr_b16 a[0:1], v212 offset:12288
    ds_read_b64_tr_b16 a[2:3], v212 offset:12800
    v_mfma_f32_32x32x16_bf16 v[144:159], a[8:11], v[8:11], v[144:159]
    s_add_u32 m0, s43, 2048
    s_add_u32 s101, s46, 294912
    buffer_load_dwordx4 v220, s[20:23], s101 offen  lds
    ds_read_b64_tr_b16 a[4:5], v212 offset:14336
    ds_read_b64_tr_b16 a[6:7], v212 offset:14848
    v_mfma_f32_32x32x16_bf16 v[144:159], a[12:15], v[12:15], v[144:159]
    v_mul_f32 v160, s53, v160
    v_mul_f32 v161, s53, v161
    s_waitcnt lgkmcnt(4)
    ds_read_b64_tr_b16 a[8:9], v212 offset:16384
    ds_read_b64_tr_b16 a[10:11], v212 offset:16896
    v_mfma_f32_32x32x16_bf16 v[144:159], a[16:19], v[16:19], v[144:159]
    v_mul_f32 v162, s53, v162
    v_mul_f32 v163, s53, v163
    ds_read_b64_tr_b16 a[12:13], v212 offset:18432
    ds_read_b64_tr_b16 a[14:15], v212 offset:18944
    v_mfma_f32_32x32x16_bf16 v[144:159], a[20:23], v[20:23], v[144:159]
    v_cvt_pk_bf16_f32 v184, v160, v161
    v_cvt_pk_bf16_f32 v185, v162, v163
    s_add_u32 s79, s60, 131072
    buffer_store_dwordx2 v[184:185], v192, s[8:11], s79 offen sc1
    s_waitcnt lgkmcnt(4)
    ds_read_b64_tr_b16 a[16:17], v212 offset:20480
    ds_read_b64_tr_b16 a[18:19], v212 offset:20992
    v_mfma_f32_32x32x16_bf16 v[144:159], a[0:3], v[24:27], v[144:159]
    v_mul_f32 v164, s53, v164
    v_mul_f32 v165, s53, v165
    s_add_u32 m0, s43, 3072
    s_add_u32 s101, s46, 442368
    buffer_load_dwordx4 v220, s[20:23], s101 offen  lds
    ds_read_b64_tr_b16 a[20:21], v212 offset:22528
    ds_read_b64_tr_b16 a[22:23], v212 offset:23040
    v_mfma_f32_32x32x16_bf16 v[144:159], a[4:7], v[28:31], v[144:159]
    v_mul_f32 v166, s53, v166
    v_mul_f32 v167, s53, v167
    s_waitcnt lgkmcnt(4)
    ds_read_b64_tr_b16 a[0:1], v212 offset:24576
    ds_read_b64_tr_b16 a[2:3], v212 offset:25088
    v_mfma_f32_32x32x16_bf16 v[144:159], a[8:11], v[32:35], v[144:159]
    v_cvt_pk_bf16_f32 v186, v164, v165
    v_cvt_pk_bf16_f32 v187, v166, v167
    s_add_u32 s79, s60, 163840
    buffer_store_dwordx2 v[186:187], v192, s[8:11], s79 offen sc1
    ds_read_b64_tr_b16 a[4:5], v212 offset:26624
    ds_read_b64_tr_b16 a[6:7], v212 offset:27136
    v_mfma_f32_32x32x16_bf16 v[144:159], a[12:15], v[36:39], v[144:159]
    v_mul_f32 v168, s53, v168
    v_mul_f32 v169, s53, v169
    s_waitcnt lgkmcnt(4)
    ds_read_b64_tr_b16 a[8:9], v212 offset:28672
    ds_read_b64_tr_b16 a[10:11], v212 offset:29184
    v_mfma_f32_32x32x16_bf16 v[144:159], a[16:19], v[40:43], v[144:159]
    v_mul_f32 v170, s53, v170
    v_mul_f32 v171, s53, v171
    s_add_u32 m0, s43, 4096
    s_add_u32 s101, s46, 589824
    buffer_load_dwordx4 v220, s[20:23], s101 offen  lds
    ds_read_b64_tr_b16 a[12:13], v212 offset:30720
    ds_read_b64_tr_b16 a[14:15], v212 offset:31232
    v_mfma_f32_32x32x16_bf16 v[144:159], a[20:23], v[44:47], v[144:159]
    v_cvt_pk_bf16_f32 v188, v168, v169
    v_cvt_pk_bf16_f32 v189, v170, v171
    s_add_u32 s79, s60, 196608
    buffer_store_dwordx2 v[188:189], v192, s[8:11], s79 offen sc1
    s_waitcnt lgkmcnt(4)
    ds_read_b64_tr_b16 a[16:17], v212 offset:32768
    ds_read_b64_tr_b16 a[18:19], v212 offset:33280
    v_mfma_f32_32x32x16_bf16 v[144:159], a[0:3], v[48:51], v[144:159]
    v_mul_f32 v172, s53, v172
    v_mul_f32 v173, s53, v173
    ds_read_b64_tr_b16 a[20:21], v212 offset:34816
    ds_read_b64_tr_b16 a[22:23], v212 offset:35328
    v_mfma_f32_32x32x16_bf16 v[144:159], a[4:7], v[52:55], v[144:159]
    v_mul_f32 v174, s53, v174
    v_mul_f32 v175, s53, v175
    s_waitcnt lgkmcnt(4)
    ds_read_b64_tr_b16 a[0:1], v213 offset:0
    ds_read_b64_tr_b16 a[2:3], v213 offset:512
    v_mfma_f32_32x32x16_bf16 v[144:159], a[8:11], v[56:59], v[144:159]
    v_cvt_pk_bf16_f32 v190, v172, v173
    v_cvt_pk_bf16_f32 v191, v174, v175
    s_add_u32 s79, s60, 229376
    buffer_store_dwordx2 v[190:191], v192, s[8:11], s79 offen sc1
    s_add_u32 m0, s43, 5120
    s_add_u32 s101, s46, 737280
    buffer_load_dwordx4 v220, s[20:23], s101 offen  lds
    ds_read_b64_tr_b16 a[4:5], v213 offset:2048
    ds_read_b64_tr_b16 a[6:7], v213 offset:2560
    v_mfma_f32_32x32x16_bf16 v[144:159], a[12:15], v[60:63], v[144:159]
    s_waitcnt lgkmcnt(4)
    ds_read_b64_tr_b16 a[8:9], v213 offset:4096
    ds_read_b64_tr_b16 a[10:11], v213 offset:4608
    v_mfma_f32_32x32x16_bf16 v[144:159], a[16:19], v[64:67], v[144:159]
    ds_read_b64_tr_b16 a[12:13], v213 offset:6144
    ds_read_b64_tr_b16 a[14:15], v213 offset:6656
    v_mfma_f32_32x32x16_bf16 v[144:159], a[20:23], v[68:71], v[144:159]
    s_waitcnt lgkmcnt(4)
    ds_read_b64_tr_b16 a[16:17], v213 offset:8192
    ds_read_b64_tr_b16 a[18:19], v213 offset:8704
    v_mfma_f32_32x32x16_bf16 v[160:175], a[0:3], v[0:3], 0
    s_add_u32 m0, s43, 6144
    s_add_u32 s101, s46, 884736
    buffer_load_dwordx4 v220, s[20:23], s101 offen  lds
    ds_read_b64_tr_b16 a[20:21], v213 offset:10240
    ds_read_b64_tr_b16 a[22:23], v213 offset:10752
    v_mfma_f32_32x32x16_bf16 v[160:175], a[4:7], v[4:7], v[160:175]
    s_waitcnt lgkmcnt(4)
    ds_read_b64_tr_b16 a[0:1], v213 offset:12288
    ds_read_b64_tr_b16 a[2:3], v213 offset:12800
    v_mfma_f32_32x32x16_bf16 v[160:175], a[8:11], v[8:11], v[160:175]
    v_add_u32 v214, 110592, v208
    ds_read_b64_tr_b16 a[4:5], v213 offset:14336
    ds_read_b64_tr_b16 a[6:7], v213 offset:14848
    v_mfma_f32_32x32x16_bf16 v[160:175], a[12:15], v[12:15], v[160:175]
    v_xor_b32 v215, 64, v214
    s_waitcnt lgkmcnt(4)
    ds_read_b64_tr_b16 a[8:9], v213 offset:16384
    ds_read_b64_tr_b16 a[10:11], v213 offset:16896
    v_mfma_f32_32x32x16_bf16 v[160:175], a[16:19], v[16:19], v[160:175]
    s_add_u32 m0, s43, 7168
    s_add_u32 s101, s46, 1032192
    buffer_load_dwordx4 v220, s[20:23], s101 offen  lds
    ds_read_b64_tr_b16 a[12:13], v213 offset:18432
    ds_read_b64_tr_b16 a[14:15], v213 offset:18944
    v_mfma_f32_32x32x16_bf16 v[160:175], a[20:23], v[20:23], v[160:175]
    s_waitcnt lgkmcnt(4)
    ds_read_b64_tr_b16 a[16:17], v213 offset:20480
    ds_read_b64_tr_b16 a[18:19], v213 offset:20992
    v_mfma_f32_32x32x16_bf16 v[160:175], a[0:3], v[24:27], v[160:175]
    ds_read_b64_tr_b16 a[20:21], v213 offset:22528
    ds_read_b64_tr_b16 a[22:23], v213 offset:23040
    v_mfma_f32_32x32x16_bf16 v[160:175], a[4:7], v[28:31], v[160:175]
    s_waitcnt lgkmcnt(4)
    ds_read_b64_tr_b16 a[0:1], v213 offset:24576
    ds_read_b64_tr_b16 a[2:3], v213 offset:25088
    v_mfma_f32_32x32x16_bf16 v[160:175], a[8:11], v[32:35], v[160:175]
    s_add_u32 m0, s43, 8192
    s_add_u32 s101, s46, 1179648
    buffer_load_dwordx4 v220, s[20:23], s101 offen  lds
    ds_read_b64_tr_b16 a[4:5], v213 offset:26624
    ds_read_b64_tr_b16 a[6:7], v213 offset:27136
    v_mfma_f32_32x32x16_bf16 v[160:175], a[12:15], v[36:39], v[160:175]
    s_waitcnt lgkmcnt(4)
    ds_read_b64_tr_b16 a[8:9], v213 offset:28672
    ds_read_b64_tr_b16 a[10:11], v213 offset:29184
    v_mfma_f32_32x32x16_bf16 v[160:175], a[16:19], v[40:43], v[160:175]
    ds_read_b64_tr_b16 a[12:13], v213 offset:30720
    ds_read_b64_tr_b16 a[14:15], v213 offset:31232
    v_mfma_f32_32x32x16_bf16 v[160:175], a[20:23], v[44:47], v[160:175]
    s_waitcnt lgkmcnt(4)
    ds_read_b64_tr_b16 a[16:17], v213 offset:32768
    ds_read_b64_tr_b16 a[18:19], v213 offset:33280
    v_mfma_f32_32x32x16_bf16 v[160:175], a[0:3], v[48:51], v[160:175]
    s_waitcnt vmcnt(16)
    s_barrier
    v_add_u32 v220, s51, v217
    ds_read_b64_tr_b16 a[20:21], v213 offset:34816
    ds_read_b64_tr_b16 a[22:23], v213 offset:35328
    v_mfma_f32_32x32x16_bf16 v[160:175], a[4:7], v[52:55], v[160:175]
    s_add_u32 m0, s43, 36864
    s_add_u32 s101, s45, 0
    buffer_load_dwordx4 v220, s[20:23], s101 offen  lds
    s_waitcnt lgkmcnt(4)
    ds_read_b64_tr_b16 a[0:1], v214 offset:0
    ds_read_b64_tr_b16 a[2:3], v214 offset:512
    v_mfma_f32_32x32x16_bf16 v[160:175], a[8:11], v[56:59], v[160:175]
    ds_read_b64_tr_b16 a[4:5], v214 offset:2048
    ds_read_b64_tr_b16 a[6:7], v214 offset:2560
    v_mfma_f32_32x32x16_bf16 v[160:175], a[12:15], v[60:63], v[160:175]
    s_waitcnt lgkmcnt(4)
    ds_read_b64_tr_b16 a[8:9], v214 offset:4096
    ds_read_b64_tr_b16 a[10:11], v214 offset:4608
    v_mfma_f32_32x32x16_bf16 v[160:175], a[16:19], v[64:67], v[160:175]
    s_add_u32 m0, s43, 37888
    s_add_u32 s101, s45, 73728
    buffer_load_dwordx4 v220, s[20:23], s101 offen  lds
    ds_read_b64_tr_b16 a[12:13], v214 offset:6144
    ds_read_b64_tr_b16 a[14:15], v214 offset:6656
    v_mfma_f32_32x32x16_bf16 v[160:175], a[20:23], v[68:71], v[160:175]
    s_waitcnt lgkmcnt(4)
    ds_read_b64_tr_b16 a[16:17], v214 offset:8192
    ds_read_b64_tr_b16 a[18:19], v214 offset:8704
    v_mfma_f32_32x32x16_bf16 v[144:159], a[0:3], v[72:75], v[144:159]
    ds_read_b64_tr_b16 a[20:21], v214 offset:10240
    ds_read_b64_tr_b16 a[22:23], v214 offset:10752
    v_mfma_f32_32x32x16_bf16 v[144:159], a[4:7], v[76:79], v[144:159]
    s_waitcnt lgkmcnt(4)
    ds_read_b64_tr_b16 a[0:1], v214 offset:12288
    ds_read_b64_tr_b16 a[2:3], v214 offset:12800
    v_mfma_f32_32x32x16_bf16 v[144:159], a[8:11], v[80:83], v[144:159]
    s_add_u32 m0, s43, 38912
    s_add_u32 s101, s45, 147456
    buffer_load_dwordx4 v220, s[20:23], s101 offen  lds
    ds_read_b64_tr_b16 a[4:5], v214 offset:14336
    ds_read_b64_tr_b16 a[6:7], v214 offset:14848
    v_mfma_f32_32x32x16_bf16 v[144:159], a[12:15], v[84:87], v[144:159]
    s_waitcnt lgkmcnt(4)
    ds_read_b64_tr_b16 a[8:9], v214 offset:16384
    ds_read_b64_tr_b16 a[10:11], v214 offset:16896
    v_mfma_f32_32x32x16_bf16 v[144:159], a[16:19], v[88:91], v[144:159]
    ds_read_b64_tr_b16 a[12:13], v214 offset:18432
    ds_read_b64_tr_b16 a[14:15], v214 offset:18944
    v_mfma_f32_32x32x16_bf16 v[144:159], a[20:23], v[92:95], v[144:159]
    s_waitcnt lgkmcnt(4)
    ds_read_b64_tr_b16 a[16:17], v214 offset:20480
    ds_read_b64_tr_b16 a[18:19], v214 offset:20992
    v_mfma_f32_32x32x16_bf16 v[144:159], a[0:3], v[96:99], v[144:159]
    s_add_u32 m0, s43, 39936
    s_add_u32 s101, s45, 221184
    buffer_load_dwordx4 v220, s[20:23], s101 offen  lds
    ds_read_b64_tr_b16 a[20:21], v214 offset:22528
    ds_read_b64_tr_b16 a[22:23], v214 offset:23040
    v_mfma_f32_32x32x16_bf16 v[144:159], a[4:7], v[100:103], v[144:159]
    s_waitcnt lgkmcnt(4)
    ds_read_b64_tr_b16 a[0:1], v214 offset:24576
    ds_read_b64_tr_b16 a[2:3], v214 offset:25088
    v_mfma_f32_32x32x16_bf16 v[144:159], a[8:11], v[104:107], v[144:159]
    ds_read_b64_tr_b16 a[4:5], v214 offset:26624
    ds_read_b64_tr_b16 a[6:7], v214 offset:27136
    v_mfma_f32_32x32x16_bf16 v[144:159], a[12:15], v[108:111], v[144:159]
    s_waitcnt lgkmcnt(4)
    ds_read_b64_tr_b16 a[8:9], v214 offset:28672
    ds_read_b64_tr_b16 a[10:11], v214 offset:29184
    v_mfma_f32_32x32x16_bf16 v[144:159], a[16:19], v[112:115], v[144:159]
    s_add_u32 m0, s43, 40960
    s_add_u32 s101, s45, 294912
    buffer_load_dwordx4 v220, s[20:23], s101 offen  lds
    ds_read_b64_tr_b16 a[12:13], v214 offset:30720
    ds_read_b64_tr_b16 a[14:15], v214 offset:31232
    v_mfma_f32_32x32x16_bf16 v[144:159], a[20:23], v[116:119], v[144:159]
    s_waitcnt lgkmcnt(4)
    ds_read_b64_tr_b16 a[16:17], v214 offset:32768
    ds_read_b64_tr_b16 a[18:19], v214 offset:33280
    v_mfma_f32_32x32x16_bf16 v[144:159], a[0:3], v[120:123], v[144:159]
    ds_read_b64_tr_b16 a[20:21], v214 offset:34816
    ds_read_b64_tr_b16 a[22:23], v214 offset:35328
    v_mfma_f32_32x32x16_bf16 v[144:159], a[4:7], v[124:127], v[144:159]
    s_waitcnt lgkmcnt(4)
    ds_read_b64_tr_b16 a[0:1], v215 offset:0
    ds_read_b64_tr_b16 a[2:3], v215 offset:512
    v_mfma_f32_32x32x16_bf16 v[144:159], a[8:11], v[128:131], v[144:159]
    s_add_u32 m0, s43, 41984
    s_add_u32 s101, s45, 368640
    buffer_load_dwordx4 v220, s[20:23], s101 offen  lds
    ds_read_b64_tr_b16 a[4:5], v215 offset:2048
    ds_read_b64_tr_b16 a[6:7], v215 offset:2560
    v_mfma_f32_32x32x16_bf16 v[144:159], a[12:15], v[132:135], v[144:159]
    s_waitcnt lgkmcnt(4)
    ds_read_b64_tr_b16 a[8:9], v215 offset:4096
    ds_read_b64_tr_b16 a[10:11], v215 offset:4608
    v_mfma_f32_32x32x16_bf16 v[144:159], a[16:19], v[136:139], v[144:159]
    ds_read_b64_tr_b16 a[12:13], v215 offset:6144
    ds_read_b64_tr_b16 a[14:15], v215 offset:6656
    v_mfma_f32_32x32x16_bf16 v[144:159], a[20:23], v[140:143], v[144:159]
    s_waitcnt lgkmcnt(4)
    ds_read_b64_tr_b16 a[16:17], v215 offset:8192
    ds_read_b64_tr_b16 a[18:19], v215 offset:8704
    v_mfma_f32_32x32x16_bf16 v[160:175], a[0:3], v[72:75], v[160:175]
    s_add_u32 m0, s43, 43008
    s_add_u32 s101, s45, 442368
    buffer_load_dwordx4 v220, s[20:23], s101 offen  lds
    ds_read_b64_tr_b16 a[20:21], v215 offset:10240
    ds_read_b64_tr_b16 a[22:23], v215 offset:10752
    v_mfma_f32_32x32x16_bf16 v[160:175], a[4:7], v[76:79], v[160:175]
    s_waitcnt lgkmcnt(4)
    ds_read_b64_tr_b16 a[0:1], v215 offset:12288
    ds_read_b64_tr_b16 a[2:3], v215 offset:12800
    v_mfma_f32_32x32x16_bf16 v[160:175], a[8:11], v[80:83], v[160:175]
    v_add_u32 v212, 0, v210
    ds_read_b64_tr_b16 a[4:5], v215 offset:14336
    ds_read_b64_tr_b16 a[6:7], v215 offset:14848
    v_mfma_f32_32x32x16_bf16 v[160:175], a[12:15], v[84:87], v[160:175]
    v_mul_f32 v144, s54, v144
    s_waitcnt lgkmcnt(4)
    ds_read_b64_tr_b16 a[8:9], v215 offset:16384
    ds_read_b64_tr_b16 a[10:11], v215 offset:16896
    v_mfma_f32_32x32x16_bf16 v[160:175], a[16:19], v[88:91], v[160:175]
    v_mul_f32 v145, s54, v145
    v_mul_f32 v146, s54, v146
    s_add_u32 m0, s43, 44032
    s_add_u32 s101, s45, 516096
    buffer_load_dwordx4 v220, s[20:23], s101 offen  lds
    ds_read_b64_tr_b16 a[12:13], v215 offset:18432
    ds_read_b64_tr_b16 a[14:15], v215 offset:18944
    v_mfma_f32_32x32x16_bf16 v[160:175], a[20:23], v[92:95], v[160:175]
    v_mul_f32 v147, s54, v147
    v_cvt_pk_bf16_f32 v176, v144, v145
    s_waitcnt lgkmcnt(4)
    ds_read_b64_tr_b16 a[16:17], v215 offset:20480
    ds_read_b64_tr_b16 a[18:19], v215 offset:20992
    v_mfma_f32_32x32x16_bf16 v[160:175], a[0:3], v[96:99], v[160:175]
    v_cvt_pk_bf16_f32 v177, v146, v147
    s_add_u32 s79, s61, 0
    buffer_store_dwordx2 v[176:177], v192, s[96:99], s79 offen sc1
    v_mul_f32 v148, s54, v148
    ds_read_b64_tr_b16 a[20:21], v215 offset:22528
    ds_read_b64_tr_b16 a[22:23], v215 offset:23040
    v_mfma_f32_32x32x16_bf16 v[160:175], a[4:7], v[100:103], v[160:175]
    v_mul_f32 v149, s54, v149
    v_mul_f32 v150, s54, v150
    s_waitcnt lgkmcnt(4)
    ds_read_b64_tr_b16 a[0:1], v215 offset:24576
    ds_read_b64_tr_b16 a[2:3], v215 offset:25088
    v_mfma_f32_32x32x16_bf16 v[160:175], a[8:11], v[104:107], v[160:175]
    v_mul_f32 v151, s54, v151
    v_cvt_pk_bf16_f32 v178, v148, v149
    s_add_u32 m0, s43, 45056
    s_add_u32 s101, s45, 589824
    buffer_load_dwordx4 v220, s[20:23], s101 offen  lds
    ds_read_b64_tr_b16 a[4:5], v215 offset:26624
    ds_read_b64_tr_b16 a[6:7], v215 offset:27136
    v_mfma_f32_32x32x16_bf16 v[160:175], a[12:15], v[108:111], v[160:175]
    v_cvt_pk_bf16_f32 v179, v150, v151
    s_add_u32 s79, s61, 32768
    buffer_store_dwordx2 v[178:179], v192, s[96:99], s79 offen sc1
    v_mul_f32 v152, s54, v152
    s_waitcnt lgkmcnt(4)
    ds_read_b64_tr_b16 a[8:9], v215 offset:28672
    ds_read_b64_tr_b16 a[10:11], v215 offset:29184
    v_mfma_f32_32x32x16_bf16 v[160:175], a[16:19], v[112:115], v[160:175]
    v_mul_f32 v153, s54, v153
    v_mul_f32 v154, s54, v154
    ds_read_b64_tr_b16 a[12:13], v215 offset:30720
    ds_read_b64_tr_b16 a[14:15], v215 offset:31232
    v_mfma_f32_32x32x16_bf16 v[160:175], a[20:23], v[116:119], v[160:175]
    v_mul_f32 v155, s54, v155
    v_cvt_pk_bf16_f32 v180, v152, v153
    s_waitcnt lgkmcnt(4)
    ds_read_b64_tr_b16 a[16:17], v215 offset:32768
    ds_read_b64_tr_b16 a[18:19], v215 offset:33280
    v_mfma_f32_32x32x16_bf16 v[160:175], a[0:3], v[120:123], v[160:175]
    v_cvt_pk_bf16_f32 v181, v154, v155
    s_add_u32 s79, s61, 65536
    buffer_store_dwordx2 v[180:181], v192, s[96:99], s79 offen sc1
    s_waitcnt vmcnt(12)
    s_barrier
    v_add_u32 v220, s51, v217
    ds_read_b64_tr_b16 a[20:21], v215 offset:34816
    ds_read_b64_tr_b16 a[22:23], v215 offset:35328
    v_mfma_f32_32x32x16_bf16 v[160:175], a[4:7], v[124:127], v[160:175]
    v_mul_f32 v156, s54, v156
    v_mul_f32 v157, s54, v157
    s_add_u32 m0, s43, 73728
    s_add_u32 s101, s45, 2654208
    buffer_load_dwordx4 v220, s[20:23], s101 offen  lds
    s_waitcnt lgkmcnt(4)
    ds_read_b64_tr_b16 a[0:1], v212 offset:0
    ds_read_b64_tr_b16 a[2:3], v212 offset:256
    v_mfma_f32_32x32x16_bf16 v[160:175], a[8:11], v[128:131], v[160:175]
    v_mul_f32 v158, s54, v158
    v_mul_f32 v159, s54, v159
    ds_read_b64_tr_b16 a[4:5], v212 offset:1024
    ds_read_b64_tr_b16 a[6:7], v212 offset:1280
    v_mfma_f32_32x32x16_bf16 v[160:175], a[12:15], v[132:135], v[160:175]
    v_cvt_pk_bf16_f32 v182, v156, v157
    v_cvt_pk_bf16_f32 v183, v158, v159
    s_add_u32 s79, s61, 98304
    buffer_store_dwordx2 v[182:183], v192, s[96:99], s79 offen sc1
    s_waitcnt lgkmcnt(4)
    ds_read_b64_tr_b16 a[8:9], v212 offset:2048
    ds_read_b64_tr_b16 a[10:11], v212 offset:2304
    v_mfma_f32_32x32x16_bf16 v[160:175], a[16:19], v[136:139], v[160:175]
    s_add_u32 m0, s43, 74752
    s_add_u32 s101, s45, 2727936
    buffer_load_dwordx4 v220, s[20:23], s101 offen  lds
    ds_read_b64_tr_b16 a[12:13], v212 offset:3072
    ds_read_b64_tr_b16 a[14:15], v212 offset:3328
    v_mfma_f32_32x32x16_bf16 v[160:175], a[20:23], v[140:143], v[160:175]
    s_waitcnt lgkmcnt(4)
    ds_read_b64_tr_b16 a[16:17], v212 offset:4096
    ds_read_b64_tr_b16 a[18:19], v212 offset:4352
    v_mfma_f32_32x32x16_bf16 v[144:159], a[0:3], v[0:3], 0
    ds_read_b64_tr_b16 a[20:21], v212 offset:5120
    ds_read_b64_tr_b16 a[22:23], v212 offset:5376
    v_mfma_f32_32x32x16_bf16 v[144:159], a[4:7], v[4:7], v[144:159]
    s_waitcnt lgkmcnt(4)
    ds_read_b64_tr_b16 a[0:1], v212 offset:6144
    ds_read_b64_tr_b16 a[2:3], v212 offset:6400
    v_mfma_f32_32x32x16_bf16 v[144:159], a[8:11], v[8:11], v[144:159]
    s_add_u32 m0, s43, 75776
    s_add_u32 s101, s45, 2801664
    buffer_load_dwordx4 v220, s[20:23], s101 offen  lds
    ds_read_b64_tr_b16 a[4:5], v212 offset:7168
    ds_read_b64_tr_b16 a[6:7], v212 offset:7424
    v_mfma_f32_32x32x16_bf16 v[144:159], a[12:15], v[12:15], v[144:159]
    v_mul_f32 v160, s54, v160
    s_waitcnt lgkmcnt(4)
    ds_read_b64_tr_b16 a[8:9], v212 offset:8192
    ds_read_b64_tr_b16 a[10:11], v212 offset:8448
    v_mfma_f32_32x32x16_bf16 v[144:159], a[16:19], v[16:19], v[144:159]
    v_mul_f32 v161, s54, v161
    ds_read_b64_tr_b16 a[12:13], v212 offset:9216
    ds_read_b64_tr_b16 a[14:15], v212 offset:9472
    v_mfma_f32_32x32x16_bf16 v[144:159], a[20:23], v[20:23], v[144:159]
    v_mul_f32 v162, s54, v162
    s_waitcnt lgkmcnt(4)
    ds_read_b64_tr_b16 a[16:17], v212 offset:10240
    ds_read_b64_tr_b16 a[18:19], v212 offset:10496
    v_mfma_f32_32x32x16_bf16 v[144:159], a[0:3], v[24:27], v[144:159]
    v_mul_f32 v163, s54, v163
    s_add_u32 m0, s43, 76800
    s_add_u32 s101, s45, 2875392
    buffer_load_dwordx4 v220, s[20:23], s101 offen  lds
    ds_read_b64_tr_b16 a[20:21], v212 offset:11264
    ds_read_b64_tr_b16 a[22:23], v212 offset:11520
    v_mfma_f32_32x32x16_bf16 v[144:159], a[4:7], v[28:31], v[144:159]
    v_cvt_pk_bf16_f32 v184, v160, v161
    s_waitcnt lgkmcnt(4)
    ds_read_b64_tr_b16 a[0:1], v212 offset:12288
    ds_read_b64_tr_b16 a[2:3], v212 offset:12544
    v_mfma_f32_32x32x16_bf16 v[144:159], a[8:11], v[32:35], v[144:159]
    v_cvt_pk_bf16_f32 v185, v162, v163
    s_add_u32 s79, s61, 131072
    buffer_store_dwordx2 v[184:185], v192, s[96:99], s79 offen sc1
    ds_read_b64_tr_b16 a[4:5], v212 offset:13312
    ds_read_b64_tr_b16 a[6:7], v212 offset:13568
    v_mfma_f32_32x32x16_bf16 v[144:159], a[12:15], v[36:39], v[144:159]
    v_mul_f32 v164, s54, v164
    s_waitcnt lgkmcnt(4)
    ds_read_b64_tr_b16 a[8:9], v212 offset:14336
    ds_read_b64_tr_b16 a[10:11], v212 offset:14592
    v_mfma_f32_32x32x16_bf16 v[144:159], a[16:19], v[40:43], v[144:159]
    v_mul_f32 v165, s54, v165
    s_add_u32 m0, s43, 77824
    s_add_u32 s101, s45, 2949120
    buffer_load_dwordx4 v220, s[20:23], s101 offen  lds
    ds_read_b64_tr_b16 a[12:13], v212 offset:15360
    ds_read_b64_tr_b16 a[14:15], v212 offset:15616
    v_mfma_f32_32x32x16_bf16 v[144:159], a[20:23], v[44:47], v[144:159]
    v_mul_f32 v166, s54, v166
    s_waitcnt lgkmcnt(4)
    ds_read_b64_tr_b16 a[16:17], v212 offset:16384
    ds_read_b64_tr_b16 a[18:19], v212 offset:16640
    v_mfma_f32_32x32x16_bf16 v[144:159], a[0:3], v[48:51], v[144:159]
    v_mul_f32 v167, s54, v167
    ds_read_b64_tr_b16 a[20:21], v212 offset:17408
    ds_read_b64_tr_b16 a[22:23], v212 offset:17664
    v_mfma_f32_32x32x16_bf16 v[144:159], a[4:7], v[52:55], v[144:159]
    v_cvt_pk_bf16_f32 v186, v164, v165
    s_waitcnt lgkmcnt(4)
    ds_read_b64_tr_b16 a[0:1], v212 offset:18432
    ds_read_b64_tr_b16 a[2:3], v212 offset:18688
    v_mfma_f32_32x32x16_bf16 v[144:159], a[8:11], v[56:59], v[144:159]
    v_cvt_pk_bf16_f32 v187, v166, v167
    s_add_u32 s79, s61, 163840
    buffer_store_dwordx2 v[186:187], v192, s[96:99], s79 offen sc1
    s_add_u32 m0, s43, 78848
    s_add_u32 s101, s45, 3022848
    buffer_load_dwordx4 v220, s[20:23], s101 offen  lds
    ds_read_b64_tr_b16 a[4:5], v212 offset:19456
    ds_read_b64_tr_b16 a[6:7], v212 offset:19712
    v_mfma_f32_32x32x16_bf16 v[144:159], a[12:15], v[60:63], v[144:159]
    v_mul_f32 v168, s54, v168
    s_waitcnt lgkmcnt(4)
    ds_read_b64_tr_b16 a[8:9], v212 offset:20480
    ds_read_b64_tr_b16 a[10:11], v212 offset:20736
    v_mfma_f32_32x32x16_bf16 v[144:159], a[16:19], v[64:67], v[144:159]
    v_mul_f32 v169, s54, v169
    ds_read_b64_tr_b16 a[12:13], v212 offset:21504
    ds_read_b64_tr_b16 a[14:15], v212 offset:21760
    v_mfma_f32_32x32x16_bf16 v[144:159], a[20:23], v[68:71], v[144:159]
    v_mul_f32 v170, s54, v170
    s_waitcnt lgkmcnt(4)
    ds_read_b64_tr_b16 a[16:17], v212 offset:22528
    ds_read_b64_tr_b16 a[18:19], v212 offset:22784
    v_mfma_f32_32x32x16_bf16 v[144:159], a[0:3], v[72:75], v[144:159]
    v_mul_f32 v171, s54, v171
    s_add_u32 m0, s43, 79872
    s_add_u32 s101, s45, 3096576
    buffer_load_dwordx4 v220, s[20:23], s101 offen  lds
    ds_read_b64_tr_b16 a[20:21], v212 offset:23552
    ds_read_b64_tr_b16 a[22:23], v212 offset:23808
    v_mfma_f32_32x32x16_bf16 v[144:159], a[4:7], v[76:79], v[144:159]
    v_cvt_pk_bf16_f32 v188, v168, v169
    s_waitcnt lgkmcnt(4)
    ds_read_b64_tr_b16 a[0:1], v212 offset:24576
    ds_read_b64_tr_b16 a[2:3], v212 offset:24832
    v_mfma_f32_32x32x16_bf16 v[144:159], a[8:11], v[80:83], v[144:159]
    v_add_u32 v214, 36864, v208
    ds_read_b64_tr_b16 a[4:5], v212 offset:25600
    ds_read_b64_tr_b16 a[6:7], v212 offset:25856
    v_mfma_f32_32x32x16_bf16 v[144:159], a[12:15], v[84:87], v[144:159]
    v_xor_b32 v215, 64, v214
    s_waitcnt lgkmcnt(4)
    ds_read_b64_tr_b16 a[8:9], v212 offset:26624
    ds_read_b64_tr_b16 a[10:11], v212 offset:26880
    v_mfma_f32_32x32x16_bf16 v[144:159], a[16:19], v[88:91], v[144:159]
    v_cvt_pk_bf16_f32 v189, v170, v171
    s_add_u32 s79, s61, 196608
    buffer_store_dwordx2 v[188:189], v192, s[96:99], s79 offen sc1
    s_add_u32 m0, s43, 80896
    s_add_u32 s101, s45, 3170304
    buffer_load_dwordx4 v220, s[20:23], s101 offen  lds
    ds_read_b64_tr_b16 a[12:13], v212 offset:27648
    ds_read_b64_tr_b16 a[14:15], v212 offset:27904
    v_mfma_f32_32x32x16_bf16 v[144:159], a[20:23], v[92:95], v[144:159]
    v_mul_f32 v172, s54, v172
    s_waitcnt lgkmcnt(4)
    ds_read_b64_tr_b16 a[16:17], v212 offset:28672
    ds_read_b64_tr_b16 a[18:19], v212 offset:28928
    v_mfma_f32_32x32x16_bf16 v[144:159], a[0:3], v[96:99], v[144:159]
    v_mul_f32 v173, s54, v173
    ds_read_b64_tr_b16 a[20:21], v212 offset:29696
    ds_read_b64_tr_b16 a[22:23], v212 offset:29952
    v_mfma_f32_32x32x16_bf16 v[144:159], a[4:7], v[100:103], v[144:159]
    v_mul_f32 v174, s54, v174
    s_waitcnt lgkmcnt(4)
    ds_read_b64_tr_b16 a[0:1], v212 offset:30720
    ds_read_b64_tr_b16 a[2:3], v212 offset:30976
    v_mfma_f32_32x32x16_bf16 v[144:159], a[8:11], v[104:107], v[144:159]
    v_mul_f32 v175, s54, v175
    s_add_u32 m0, s43, 81920
    s_add_u32 s101, s45, 3244032
    buffer_load_dwordx4 v220, s[20:23], s101 offen  lds
    ds_read_b64_tr_b16 a[4:5], v212 offset:31744
    ds_read_b64_tr_b16 a[6:7], v212 offset:32000
    v_mfma_f32_32x32x16_bf16 v[144:159], a[12:15], v[108:111], v[144:159]
    v_cvt_pk_bf16_f32 v190, v172, v173
    s_waitcnt lgkmcnt(4)
    ds_read_b64_tr_b16 a[8:9], v212 offset:32768
    ds_read_b64_tr_b16 a[10:11], v212 offset:33024
    v_mfma_f32_32x32x16_bf16 v[144:159], a[16:19], v[112:115], v[144:159]
    v_cvt_pk_bf16_f32 v191, v174, v175
    s_add_u32 s79, s61, 229376
    buffer_store_dwordx2 v[190:191], v192, s[96:99], s79 offen sc1
    ds_read_b64_tr_b16 a[12:13], v212 offset:33792
    ds_read_b64_tr_b16 a[14:15], v212 offset:34048
    v_mfma_f32_32x32x16_bf16 v[144:159], a[20:23], v[116:119], v[144:159]
    s_waitcnt lgkmcnt(4)
    ds_read_b64_tr_b16 a[16:17], v212 offset:34816
    ds_read_b64_tr_b16 a[18:19], v212 offset:35072
    v_mfma_f32_32x32x16_bf16 v[144:159], a[0:3], v[120:123], v[144:159]
    s_waitcnt vmcnt(16)
    s_barrier
    s_add_u32 s56, s51, 128
    v_add_u32 v220, s56, v217
    ds_read_b64_tr_b16 a[20:21], v212 offset:35840
    ds_read_b64_tr_b16 a[22:23], v212 offset:36096
    v_mfma_f32_32x32x16_bf16 v[144:159], a[4:7], v[124:127], v[144:159]
    s_add_u32 m0, s43, 110592
    s_add_u32 s101, s45, 0
    buffer_load_dwordx4 v220, s[20:23], s101 offen  lds
    s_waitcnt lgkmcnt(4)
    ds_read_b64_tr_b16 a[0:1], v214 offset:0
    ds_read_b64_tr_b16 a[2:3], v214 offset:512
    v_mfma_f32_32x32x16_bf16 v[144:159], a[8:11], v[128:131], v[144:159]
    ds_read_b64_tr_b16 a[4:5], v214 offset:2048
    ds_read_b64_tr_b16 a[6:7], v214 offset:2560
    v_mfma_f32_32x32x16_bf16 v[144:159], a[12:15], v[132:135], v[144:159]
    s_waitcnt lgkmcnt(4)
    ds_read_b64_tr_b16 a[8:9], v214 offset:4096
    ds_read_b64_tr_b16 a[10:11], v214 offset:4608
    v_mfma_f32_32x32x16_bf16 v[144:159], a[16:19], v[136:139], v[144:159]
    s_add_u32 m0, s43, 111616
    s_add_u32 s101, s45, 73728
    buffer_load_dwordx4 v220, s[20:23], s101 offen  lds
    ds_read_b64_tr_b16 a[12:13], v214 offset:6144
    ds_read_b64_tr_b16 a[14:15], v214 offset:6656
    v_mfma_f32_32x32x16_bf16 v[144:159], a[20:23], v[140:143], v[144:159]
    s_branch parallel_sum__softmax_full_mha__dense_activation_relu__prompt_kernel_join
parallel_sum__softmax_full_mha__dense_activation_relu__prompt_kernel_u1v:
    s_waitcnt lgkmcnt(4)
    ds_read_b64_tr_b16 a[16:17], v212 offset:8192
    ds_read_b64_tr_b16 a[18:19], v212 offset:8704
    v_mfma_f32_32x32x16_bf16 v[144:159], v[0:3], a[0:3], 0
    ds_read_b64_tr_b16 a[20:21], v212 offset:10240
    ds_read_b64_tr_b16 a[22:23], v212 offset:10752
    v_mfma_f32_32x32x16_bf16 v[144:159], v[4:7], a[4:7], v[144:159]
    s_waitcnt lgkmcnt(4)
    ds_read_b64_tr_b16 a[0:1], v212 offset:12288
    ds_read_b64_tr_b16 a[2:3], v212 offset:12800
    v_mfma_f32_32x32x16_bf16 v[144:159], v[8:11], a[8:11], v[144:159]
    s_add_u32 m0, s43, 2048
    s_add_u32 s101, s46, 294912
    buffer_load_dwordx4 v220, s[20:23], s101 offen  lds
    ds_read_b64_tr_b16 a[4:5], v212 offset:14336
    ds_read_b64_tr_b16 a[6:7], v212 offset:14848
    v_mfma_f32_32x32x16_bf16 v[144:159], v[12:15], a[12:15], v[144:159]
    v_mul_f32 v160, s53, v160
    v_mul_f32 v161, s53, v161
    s_waitcnt lgkmcnt(4)
    ds_read_b64_tr_b16 a[8:9], v212 offset:16384
    ds_read_b64_tr_b16 a[10:11], v212 offset:16896
    v_mfma_f32_32x32x16_bf16 v[144:159], v[16:19], a[16:19], v[144:159]
    v_mul_f32 v162, s53, v162
    v_mul_f32 v163, s53, v163
    ds_read_b64_tr_b16 a[12:13], v212 offset:18432
    ds_read_b64_tr_b16 a[14:15], v212 offset:18944
    v_mfma_f32_32x32x16_bf16 v[144:159], v[20:23], a[20:23], v[144:159]
    v_cvt_pk_bf16_f32 v184, v160, v161
    v_cvt_pk_bf16_f32 v185, v162, v163
    s_add_u32 s79, s60, 131072
    buffer_store_dwordx2 v[184:185], v192, s[8:11], s79 offen sc1
    s_waitcnt lgkmcnt(4)
    ds_read_b64_tr_b16 a[16:17], v212 offset:20480
    ds_read_b64_tr_b16 a[18:19], v212 offset:20992
    v_mfma_f32_32x32x16_bf16 v[144:159], v[24:27], a[0:3], v[144:159]
    v_mul_f32 v164, s53, v164
    v_mul_f32 v165, s53, v165
    s_add_u32 m0, s43, 3072
    s_add_u32 s101, s46, 442368
    buffer_load_dwordx4 v220, s[20:23], s101 offen  lds
    ds_read_b64_tr_b16 a[20:21], v212 offset:22528
    ds_read_b64_tr_b16 a[22:23], v212 offset:23040
    v_mfma_f32_32x32x16_bf16 v[144:159], v[28:31], a[4:7], v[144:159]
    v_mul_f32 v166, s53, v166
    v_mul_f32 v167, s53, v167
    s_waitcnt lgkmcnt(4)
    ds_read_b64_tr_b16 a[0:1], v212 offset:24576
    ds_read_b64_tr_b16 a[2:3], v212 offset:25088
    v_mfma_f32_32x32x16_bf16 v[144:159], v[32:35], a[8:11], v[144:159]
    v_cvt_pk_bf16_f32 v186, v164, v165
    v_cvt_pk_bf16_f32 v187, v166, v167
    s_add_u32 s79, s60, 163840
    buffer_store_dwordx2 v[186:187], v192, s[8:11], s79 offen sc1
    ds_read_b64_tr_b16 a[4:5], v212 offset:26624
    ds_read_b64_tr_b16 a[6:7], v212 offset:27136
    v_mfma_f32_32x32x16_bf16 v[144:159], v[36:39], a[12:15], v[144:159]
    v_mul_f32 v168, s53, v168
    v_mul_f32 v169, s53, v169
    s_waitcnt lgkmcnt(4)
    ds_read_b64_tr_b16 a[8:9], v212 offset:28672
    ds_read_b64_tr_b16 a[10:11], v212 offset:29184
    v_mfma_f32_32x32x16_bf16 v[144:159], v[40:43], a[16:19], v[144:159]
    v_mul_f32 v170, s53, v170
    v_mul_f32 v171, s53, v171
    s_add_u32 m0, s43, 4096
    s_add_u32 s101, s46, 589824
    buffer_load_dwordx4 v220, s[20:23], s101 offen  lds
    ds_read_b64_tr_b16 a[12:13], v212 offset:30720
    ds_read_b64_tr_b16 a[14:15], v212 offset:31232
    v_mfma_f32_32x32x16_bf16 v[144:159], v[44:47], a[20:23], v[144:159]
    v_cvt_pk_bf16_f32 v188, v168, v169
    v_cvt_pk_bf16_f32 v189, v170, v171
    s_add_u32 s79, s60, 196608
    buffer_store_dwordx2 v[188:189], v192, s[8:11], s79 offen sc1
    s_waitcnt lgkmcnt(4)
    ds_read_b64_tr_b16 a[16:17], v212 offset:32768
    ds_read_b64_tr_b16 a[18:19], v212 offset:33280
    v_mfma_f32_32x32x16_bf16 v[144:159], v[48:51], a[0:3], v[144:159]
    v_mul_f32 v172, s53, v172
    v_mul_f32 v173, s53, v173
    ds_read_b64_tr_b16 a[20:21], v212 offset:34816
    ds_read_b64_tr_b16 a[22:23], v212 offset:35328
    v_mfma_f32_32x32x16_bf16 v[144:159], v[52:55], a[4:7], v[144:159]
    v_mul_f32 v174, s53, v174
    v_mul_f32 v175, s53, v175
    s_waitcnt lgkmcnt(4)
    ds_read_b64_tr_b16 a[0:1], v213 offset:0
    ds_read_b64_tr_b16 a[2:3], v213 offset:512
    v_mfma_f32_32x32x16_bf16 v[144:159], v[56:59], a[8:11], v[144:159]
    v_cvt_pk_bf16_f32 v190, v172, v173
    v_cvt_pk_bf16_f32 v191, v174, v175
    s_add_u32 s79, s60, 229376
    buffer_store_dwordx2 v[190:191], v192, s[8:11], s79 offen sc1
    s_add_u32 m0, s43, 5120
    s_add_u32 s101, s46, 737280
    buffer_load_dwordx4 v220, s[20:23], s101 offen  lds
    ds_read_b64_tr_b16 a[4:5], v213 offset:2048
    ds_read_b64_tr_b16 a[6:7], v213 offset:2560
    v_mfma_f32_32x32x16_bf16 v[144:159], v[60:63], a[12:15], v[144:159]
    s_waitcnt lgkmcnt(4)
    ds_read_b64_tr_b16 a[8:9], v213 offset:4096
    ds_read_b64_tr_b16 a[10:11], v213 offset:4608
    v_mfma_f32_32x32x16_bf16 v[144:159], v[64:67], a[16:19], v[144:159]
    ds_read_b64_tr_b16 a[12:13], v213 offset:6144
    ds_read_b64_tr_b16 a[14:15], v213 offset:6656
    v_mfma_f32_32x32x16_bf16 v[144:159], v[68:71], a[20:23], v[144:159]
    s_waitcnt lgkmcnt(4)
    ds_read_b64_tr_b16 a[16:17], v213 offset:8192
    ds_read_b64_tr_b16 a[18:19], v213 offset:8704
    v_mfma_f32_32x32x16_bf16 v[160:175], v[0:3], a[0:3], 0
    s_add_u32 m0, s43, 6144
    s_add_u32 s101, s46, 884736
    buffer_load_dwordx4 v220, s[20:23], s101 offen  lds
    ds_read_b64_tr_b16 a[20:21], v213 offset:10240
    ds_read_b64_tr_b16 a[22:23], v213 offset:10752
    v_mfma_f32_32x32x16_bf16 v[160:175], v[4:7], a[4:7], v[160:175]
    s_waitcnt lgkmcnt(4)
    ds_read_b64_tr_b16 a[0:1], v213 offset:12288
    ds_read_b64_tr_b16 a[2:3], v213 offset:12800
    v_mfma_f32_32x32x16_bf16 v[160:175], v[8:11], a[8:11], v[160:175]
    v_add_u32 v214, 110592, v208
    ds_read_b64_tr_b16 a[4:5], v213 offset:14336
    ds_read_b64_tr_b16 a[6:7], v213 offset:14848
    v_mfma_f32_32x32x16_bf16 v[160:175], v[12:15], a[12:15], v[160:175]
    v_xor_b32 v215, 64, v214
    s_waitcnt lgkmcnt(4)
    ds_read_b64_tr_b16 a[8:9], v213 offset:16384
    ds_read_b64_tr_b16 a[10:11], v213 offset:16896
    v_mfma_f32_32x32x16_bf16 v[160:175], v[16:19], a[16:19], v[160:175]
    s_add_u32 m0, s43, 7168
    s_add_u32 s101, s46, 1032192
    buffer_load_dwordx4 v220, s[20:23], s101 offen  lds
    ds_read_b64_tr_b16 a[12:13], v213 offset:18432
    ds_read_b64_tr_b16 a[14:15], v213 offset:18944
    v_mfma_f32_32x32x16_bf16 v[160:175], v[20:23], a[20:23], v[160:175]
    s_waitcnt lgkmcnt(4)
    ds_read_b64_tr_b16 a[16:17], v213 offset:20480
    ds_read_b64_tr_b16 a[18:19], v213 offset:20992
    v_mfma_f32_32x32x16_bf16 v[160:175], v[24:27], a[0:3], v[160:175]
    ds_read_b64_tr_b16 a[20:21], v213 offset:22528
    ds_read_b64_tr_b16 a[22:23], v213 offset:23040
    v_mfma_f32_32x32x16_bf16 v[160:175], v[28:31], a[4:7], v[160:175]
    s_waitcnt lgkmcnt(4)
    ds_read_b64_tr_b16 a[0:1], v213 offset:24576
    ds_read_b64_tr_b16 a[2:3], v213 offset:25088
    v_mfma_f32_32x32x16_bf16 v[160:175], v[32:35], a[8:11], v[160:175]
    s_add_u32 m0, s43, 8192
    s_add_u32 s101, s46, 1179648
    buffer_load_dwordx4 v220, s[20:23], s101 offen  lds
    ds_read_b64_tr_b16 a[4:5], v213 offset:26624
    ds_read_b64_tr_b16 a[6:7], v213 offset:27136
    v_mfma_f32_32x32x16_bf16 v[160:175], v[36:39], a[12:15], v[160:175]
    s_waitcnt lgkmcnt(4)
    ds_read_b64_tr_b16 a[8:9], v213 offset:28672
    ds_read_b64_tr_b16 a[10:11], v213 offset:29184
    v_mfma_f32_32x32x16_bf16 v[160:175], v[40:43], a[16:19], v[160:175]
    ds_read_b64_tr_b16 a[12:13], v213 offset:30720
    ds_read_b64_tr_b16 a[14:15], v213 offset:31232
    v_mfma_f32_32x32x16_bf16 v[160:175], v[44:47], a[20:23], v[160:175]
    s_waitcnt lgkmcnt(4)
    ds_read_b64_tr_b16 a[16:17], v213 offset:32768
    ds_read_b64_tr_b16 a[18:19], v213 offset:33280
    v_mfma_f32_32x32x16_bf16 v[160:175], v[48:51], a[0:3], v[160:175]
    s_waitcnt vmcnt(16)
    s_barrier
    v_add_u32 v220, s51, v217
    ds_read_b64_tr_b16 a[20:21], v213 offset:34816
    ds_read_b64_tr_b16 a[22:23], v213 offset:35328
    v_mfma_f32_32x32x16_bf16 v[160:175], v[52:55], a[4:7], v[160:175]
    s_add_u32 m0, s43, 36864
    s_add_u32 s101, s45, 0
    buffer_load_dwordx4 v220, s[20:23], s101 offen  lds
    s_waitcnt lgkmcnt(4)
    ds_read_b64_tr_b16 a[0:1], v214 offset:0
    ds_read_b64_tr_b16 a[2:3], v214 offset:512
    v_mfma_f32_32x32x16_bf16 v[160:175], v[56:59], a[8:11], v[160:175]
    ds_read_b64_tr_b16 a[4:5], v214 offset:2048
    ds_read_b64_tr_b16 a[6:7], v214 offset:2560
    v_mfma_f32_32x32x16_bf16 v[160:175], v[60:63], a[12:15], v[160:175]
    s_waitcnt lgkmcnt(4)
    ds_read_b64_tr_b16 a[8:9], v214 offset:4096
    ds_read_b64_tr_b16 a[10:11], v214 offset:4608
    v_mfma_f32_32x32x16_bf16 v[160:175], v[64:67], a[16:19], v[160:175]
    s_add_u32 m0, s43, 37888
    s_add_u32 s101, s45, 73728
    buffer_load_dwordx4 v220, s[20:23], s101 offen  lds
    ds_read_b64_tr_b16 a[12:13], v214 offset:6144
    ds_read_b64_tr_b16 a[14:15], v214 offset:6656
    v_mfma_f32_32x32x16_bf16 v[160:175], v[68:71], a[20:23], v[160:175]
    s_waitcnt lgkmcnt(4)
    ds_read_b64_tr_b16 a[16:17], v214 offset:8192
    ds_read_b64_tr_b16 a[18:19], v214 offset:8704
    v_mfma_f32_32x32x16_bf16 v[144:159], v[72:75], a[0:3], v[144:159]
    ds_read_b64_tr_b16 a[20:21], v214 offset:10240
    ds_read_b64_tr_b16 a[22:23], v214 offset:10752
    v_mfma_f32_32x32x16_bf16 v[144:159], v[76:79], a[4:7], v[144:159]
    s_waitcnt lgkmcnt(4)
    ds_read_b64_tr_b16 a[0:1], v214 offset:12288
    ds_read_b64_tr_b16 a[2:3], v214 offset:12800
    v_mfma_f32_32x32x16_bf16 v[144:159], v[80:83], a[8:11], v[144:159]
    s_add_u32 m0, s43, 38912
    s_add_u32 s101, s45, 147456
    buffer_load_dwordx4 v220, s[20:23], s101 offen  lds
    ds_read_b64_tr_b16 a[4:5], v214 offset:14336
    ds_read_b64_tr_b16 a[6:7], v214 offset:14848
    v_mfma_f32_32x32x16_bf16 v[144:159], v[84:87], a[12:15], v[144:159]
    s_waitcnt lgkmcnt(4)
    ds_read_b64_tr_b16 a[8:9], v214 offset:16384
    ds_read_b64_tr_b16 a[10:11], v214 offset:16896
    v_mfma_f32_32x32x16_bf16 v[144:159], v[88:91], a[16:19], v[144:159]
    ds_read_b64_tr_b16 a[12:13], v214 offset:18432
    ds_read_b64_tr_b16 a[14:15], v214 offset:18944
    v_mfma_f32_32x32x16_bf16 v[144:159], v[92:95], a[20:23], v[144:159]
    s_waitcnt lgkmcnt(4)
    ds_read_b64_tr_b16 a[16:17], v214 offset:20480
    ds_read_b64_tr_b16 a[18:19], v214 offset:20992
    v_mfma_f32_32x32x16_bf16 v[144:159], v[96:99], a[0:3], v[144:159]
    s_add_u32 m0, s43, 39936
    s_add_u32 s101, s45, 221184
    buffer_load_dwordx4 v220, s[20:23], s101 offen  lds
    ds_read_b64_tr_b16 a[20:21], v214 offset:22528
    ds_read_b64_tr_b16 a[22:23], v214 offset:23040
    v_mfma_f32_32x32x16_bf16 v[144:159], v[100:103], a[4:7], v[144:159]
    s_waitcnt lgkmcnt(4)
    ds_read_b64_tr_b16 a[0:1], v214 offset:24576
    ds_read_b64_tr_b16 a[2:3], v214 offset:25088
    v_mfma_f32_32x32x16_bf16 v[144:159], v[104:107], a[8:11], v[144:159]
    ds_read_b64_tr_b16 a[4:5], v214 offset:26624
    ds_read_b64_tr_b16 a[6:7], v214 offset:27136
    v_mfma_f32_32x32x16_bf16 v[144:159], v[108:111], a[12:15], v[144:159]
    s_waitcnt lgkmcnt(4)
    ds_read_b64_tr_b16 a[8:9], v214 offset:28672
    ds_read_b64_tr_b16 a[10:11], v214 offset:29184
    v_mfma_f32_32x32x16_bf16 v[144:159], v[112:115], a[16:19], v[144:159]
    s_add_u32 m0, s43, 40960
    s_add_u32 s101, s45, 294912
    buffer_load_dwordx4 v220, s[20:23], s101 offen  lds
    ds_read_b64_tr_b16 a[12:13], v214 offset:30720
    ds_read_b64_tr_b16 a[14:15], v214 offset:31232
    v_mfma_f32_32x32x16_bf16 v[144:159], v[116:119], a[20:23], v[144:159]
    s_waitcnt lgkmcnt(4)
    ds_read_b64_tr_b16 a[16:17], v214 offset:32768
    ds_read_b64_tr_b16 a[18:19], v214 offset:33280
    v_mfma_f32_32x32x16_bf16 v[144:159], v[120:123], a[0:3], v[144:159]
    ds_read_b64_tr_b16 a[20:21], v214 offset:34816
    ds_read_b64_tr_b16 a[22:23], v214 offset:35328
    v_mfma_f32_32x32x16_bf16 v[144:159], v[124:127], a[4:7], v[144:159]
    s_waitcnt lgkmcnt(4)
    ds_read_b64_tr_b16 a[0:1], v215 offset:0
    ds_read_b64_tr_b16 a[2:3], v215 offset:512
    v_mfma_f32_32x32x16_bf16 v[144:159], v[128:131], a[8:11], v[144:159]
    s_add_u32 m0, s43, 41984
    s_add_u32 s101, s45, 368640
    buffer_load_dwordx4 v220, s[20:23], s101 offen  lds
    ds_read_b64_tr_b16 a[4:5], v215 offset:2048
    ds_read_b64_tr_b16 a[6:7], v215 offset:2560
    v_mfma_f32_32x32x16_bf16 v[144:159], v[132:135], a[12:15], v[144:159]
    s_waitcnt lgkmcnt(4)
    ds_read_b64_tr_b16 a[8:9], v215 offset:4096
    ds_read_b64_tr_b16 a[10:11], v215 offset:4608
    v_mfma_f32_32x32x16_bf16 v[144:159], v[136:139], a[16:19], v[144:159]
    ds_read_b64_tr_b16 a[12:13], v215 offset:6144
    ds_read_b64_tr_b16 a[14:15], v215 offset:6656
    v_mfma_f32_32x32x16_bf16 v[144:159], v[140:143], a[20:23], v[144:159]
    s_waitcnt lgkmcnt(4)
    ds_read_b64_tr_b16 a[16:17], v215 offset:8192
    ds_read_b64_tr_b16 a[18:19], v215 offset:8704
    v_mfma_f32_32x32x16_bf16 v[160:175], v[72:75], a[0:3], v[160:175]
    s_add_u32 m0, s43, 43008
    s_add_u32 s101, s45, 442368
    buffer_load_dwordx4 v220, s[20:23], s101 offen  lds
    ds_read_b64_tr_b16 a[20:21], v215 offset:10240
    ds_read_b64_tr_b16 a[22:23], v215 offset:10752
    v_mfma_f32_32x32x16_bf16 v[160:175], v[76:79], a[4:7], v[160:175]
    s_waitcnt lgkmcnt(4)
    ds_read_b64_tr_b16 a[0:1], v215 offset:12288
    ds_read_b64_tr_b16 a[2:3], v215 offset:12800
    v_mfma_f32_32x32x16_bf16 v[160:175], v[80:83], a[8:11], v[160:175]
    v_add_u32 v212, 0, v210
    ds_read_b64_tr_b16 a[4:5], v215 offset:14336
    ds_read_b64_tr_b16 a[6:7], v215 offset:14848
    v_mfma_f32_32x32x16_bf16 v[160:175], v[84:87], a[12:15], v[160:175]
    s_waitcnt lgkmcnt(4)
    ds_read_b64_tr_b16 a[8:9], v215 offset:16384
    ds_read_b64_tr_b16 a[10:11], v215 offset:16896
    v_mfma_f32_32x32x16_bf16 v[160:175], v[88:91], a[16:19], v[160:175]
    v_cvt_pk_bf16_f32 v176, v144, v145
    s_add_u32 m0, s43, 44032
    s_add_u32 s101, s45, 516096
    buffer_load_dwordx4 v220, s[20:23], s101 offen  lds
    ds_read_b64_tr_b16 a[12:13], v215 offset:18432
    ds_read_b64_tr_b16 a[14:15], v215 offset:18944
    v_mfma_f32_32x32x16_bf16 v[160:175], v[92:95], a[20:23], v[160:175]
    v_cvt_pk_bf16_f32 v177, v146, v147
    s_waitcnt lgkmcnt(4)
    ds_read_b64_tr_b16 a[16:17], v215 offset:20480
    ds_read_b64_tr_b16 a[18:19], v215 offset:20992
    v_mfma_f32_32x32x16_bf16 v[160:175], v[96:99], a[0:3], v[160:175]
    v_cvt_pk_bf16_f32 v178, v148, v149
    ds_read_b64_tr_b16 a[20:21], v215 offset:22528
    ds_read_b64_tr_b16 a[22:23], v215 offset:23040
    v_mfma_f32_32x32x16_bf16 v[160:175], v[100:103], a[4:7], v[160:175]
    v_cvt_pk_bf16_f32 v179, v150, v151
    buffer_store_dwordx4 v[176:179], v200, s[96:99], 0 offen sc1
    s_waitcnt lgkmcnt(4)
    ds_read_b64_tr_b16 a[0:1], v215 offset:24576
    ds_read_b64_tr_b16 a[2:3], v215 offset:25088
    v_mfma_f32_32x32x16_bf16 v[160:175], v[104:107], a[8:11], v[160:175]
    v_cvt_pk_bf16_f32 v180, v152, v153
    s_add_u32 m0, s43, 45056
    s_add_u32 s101, s45, 589824
    buffer_load_dwordx4 v220, s[20:23], s101 offen  lds
    ds_read_b64_tr_b16 a[4:5], v215 offset:26624
    ds_read_b64_tr_b16 a[6:7], v215 offset:27136
    v_mfma_f32_32x32x16_bf16 v[160:175], v[108:111], a[12:15], v[160:175]
    v_cvt_pk_bf16_f32 v181, v154, v155
    s_waitcnt lgkmcnt(4)
    ds_read_b64_tr_b16 a[8:9], v215 offset:28672
    ds_read_b64_tr_b16 a[10:11], v215 offset:29184
    v_mfma_f32_32x32x16_bf16 v[160:175], v[112:115], a[16:19], v[160:175]
    v_cvt_pk_bf16_f32 v182, v156, v157
    ds_read_b64_tr_b16 a[12:13], v215 offset:30720
    ds_read_b64_tr_b16 a[14:15], v215 offset:31232
    v_mfma_f32_32x32x16_bf16 v[160:175], v[116:119], a[20:23], v[160:175]
    v_cvt_pk_bf16_f32 v183, v158, v159
    buffer_store_dwordx4 v[180:183], v200, s[96:99], 0 offen offset:576 sc1
    s_waitcnt lgkmcnt(4)
    ds_read_b64_tr_b16 a[16:17], v215 offset:32768
    ds_read_b64_tr_b16 a[18:19], v215 offset:33280
    v_mfma_f32_32x32x16_bf16 v[160:175], v[120:123], a[0:3], v[160:175]
    s_waitcnt vmcnt(11)
    s_barrier
    v_add_u32 v220, s51, v217
    ds_read_b64_tr_b16 a[20:21], v215 offset:34816
    ds_read_b64_tr_b16 a[22:23], v215 offset:35328
    v_mfma_f32_32x32x16_bf16 v[160:175], v[124:127], a[4:7], v[160:175]
    s_add_u32 m0, s43, 73728
    s_add_u32 s101, s45, 2654208
    buffer_load_dwordx4 v220, s[20:23], s101 offen  lds
    s_waitcnt lgkmcnt(4)
    ds_read_b64_tr_b16 a[0:1], v212 offset:0
    ds_read_b64_tr_b16 a[2:3], v212 offset:256
    v_mfma_f32_32x32x16_bf16 v[160:175], v[128:131], a[8:11], v[160:175]
    ds_read_b64_tr_b16 a[4:5], v212 offset:1024
    ds_read_b64_tr_b16 a[6:7], v212 offset:1280
    v_mfma_f32_32x32x16_bf16 v[160:175], v[132:135], a[12:15], v[160:175]
    s_waitcnt lgkmcnt(4)
    ds_read_b64_tr_b16 a[8:9], v212 offset:2048
    ds_read_b64_tr_b16 a[10:11], v212 offset:2304
    v_mfma_f32_32x32x16_bf16 v[160:175], v[136:139], a[16:19], v[160:175]
    s_add_u32 m0, s43, 74752
    s_add_u32 s101, s45, 2727936
    buffer_load_dwordx4 v220, s[20:23], s101 offen  lds
    ds_read_b64_tr_b16 a[12:13], v212 offset:3072
    ds_read_b64_tr_b16 a[14:15], v212 offset:3328
    v_mfma_f32_32x32x16_bf16 v[160:175], v[140:143], a[20:23], v[160:175]
    s_waitcnt lgkmcnt(4)
    ds_read_b64_tr_b16 a[16:17], v212 offset:4096
    ds_read_b64_tr_b16 a[18:19], v212 offset:4352
    v_mfma_f32_32x32x16_bf16 v[144:159], a[0:3], v[0:3], 0
    ds_read_b64_tr_b16 a[20:21], v212 offset:5120
    ds_read_b64_tr_b16 a[22:23], v212 offset:5376
    v_mfma_f32_32x32x16_bf16 v[144:159], a[4:7], v[4:7], v[144:159]
    s_waitcnt lgkmcnt(4)
    ds_read_b64_tr_b16 a[0:1], v212 offset:6144
    ds_read_b64_tr_b16 a[2:3], v212 offset:6400
    v_mfma_f32_32x32x16_bf16 v[144:159], a[8:11], v[8:11], v[144:159]
    s_add_u32 m0, s43, 75776
    s_add_u32 s101, s45, 2801664
    buffer_load_dwordx4 v220, s[20:23], s101 offen  lds
    ds_read_b64_tr_b16 a[4:5], v212 offset:7168
    ds_read_b64_tr_b16 a[6:7], v212 offset:7424
    v_mfma_f32_32x32x16_bf16 v[144:159], a[12:15], v[12:15], v[144:159]
    v_cvt_pk_bf16_f32 v184, v160, v161
    s_waitcnt lgkmcnt(4)
    ds_read_b64_tr_b16 a[8:9], v212 offset:8192
    ds_read_b64_tr_b16 a[10:11], v212 offset:8448
    v_mfma_f32_32x32x16_bf16 v[144:159], a[16:19], v[16:19], v[144:159]
    v_cvt_pk_bf16_f32 v185, v162, v163
    ds_read_b64_tr_b16 a[12:13], v212 offset:9216
    ds_read_b64_tr_b16 a[14:15], v212 offset:9472
    v_mfma_f32_32x32x16_bf16 v[144:159], a[20:23], v[20:23], v[144:159]
    v_cvt_pk_bf16_f32 v186, v164, v165
    s_waitcnt lgkmcnt(4)
    ds_read_b64_tr_b16 a[16:17], v212 offset:10240
    ds_read_b64_tr_b16 a[18:19], v212 offset:10496
    v_mfma_f32_32x32x16_bf16 v[144:159], a[0:3], v[24:27], v[144:159]
    v_cvt_pk_bf16_f32 v187, v166, v167
    buffer_store_dwordx4 v[184:187], v201, s[96:99], 0 offen sc1
    s_add_u32 m0, s43, 76800
    s_add_u32 s101, s45, 2875392
    buffer_load_dwordx4 v220, s[20:23], s101 offen  lds
    ds_read_b64_tr_b16 a[20:21], v212 offset:11264
    ds_read_b64_tr_b16 a[22:23], v212 offset:11520
    v_mfma_f32_32x32x16_bf16 v[144:159], a[4:7], v[28:31], v[144:159]
    v_cvt_pk_bf16_f32 v188, v168, v169
    s_waitcnt lgkmcnt(4)
    ds_read_b64_tr_b16 a[0:1], v212 offset:12288
    ds_read_b64_tr_b16 a[2:3], v212 offset:12544
    v_mfma_f32_32x32x16_bf16 v[144:159], a[8:11], v[32:35], v[144:159]
    v_cvt_pk_bf16_f32 v189, v170, v171
    ds_read_b64_tr_b16 a[4:5], v212 offset:13312
    ds_read_b64_tr_b16 a[6:7], v212 offset:13568
    v_mfma_f32_32x32x16_bf16 v[144:159], a[12:15], v[36:39], v[144:159]
    v_cvt_pk_bf16_f32 v190, v172, v173
    s_waitcnt lgkmcnt(4)
    ds_read_b64_tr_b16 a[8:9], v212 offset:14336
    ds_read_b64_tr_b16 a[10:11], v212 offset:14592
    v_mfma_f32_32x32x16_bf16 v[144:159], a[16:19], v[40:43], v[144:159]
    v_cvt_pk_bf16_f32 v191, v174, v175
    buffer_store_dwordx4 v[188:191], v201, s[96:99], 0 offen offset:576 sc1
    s_add_u32 m0, s43, 77824
    s_add_u32 s101, s45, 2949120
    buffer_load_dwordx4 v220, s[20:23], s101 offen  lds
    ds_read_b64_tr_b16 a[12:13], v212 offset:15360
    ds_read_b64_tr_b16 a[14:15], v212 offset:15616
    v_mfma_f32_32x32x16_bf16 v[144:159], a[20:23], v[44:47], v[144:159]
    s_waitcnt lgkmcnt(4)
    ds_read_b64_tr_b16 a[16:17], v212 offset:16384
    ds_read_b64_tr_b16 a[18:19], v212 offset:16640
    v_mfma_f32_32x32x16_bf16 v[144:159], a[0:3], v[48:51], v[144:159]
    ds_read_b64_tr_b16 a[20:21], v212 offset:17408
    ds_read_b64_tr_b16 a[22:23], v212 offset:17664
    v_mfma_f32_32x32x16_bf16 v[144:159], a[4:7], v[52:55], v[144:159]
    s_waitcnt lgkmcnt(4)
    ds_read_b64_tr_b16 a[0:1], v212 offset:18432
    ds_read_b64_tr_b16 a[2:3], v212 offset:18688
    v_mfma_f32_32x32x16_bf16 v[144:159], a[8:11], v[56:59], v[144:159]
    s_add_u32 m0, s43, 78848
    s_add_u32 s101, s45, 3022848
    buffer_load_dwordx4 v220, s[20:23], s101 offen  lds
    ds_read_b64_tr_b16 a[4:5], v212 offset:19456
    ds_read_b64_tr_b16 a[6:7], v212 offset:19712
    v_mfma_f32_32x32x16_bf16 v[144:159], a[12:15], v[60:63], v[144:159]
    s_waitcnt lgkmcnt(4)
    ds_read_b64_tr_b16 a[8:9], v212 offset:20480
    ds_read_b64_tr_b16 a[10:11], v212 offset:20736
    v_mfma_f32_32x32x16_bf16 v[144:159], a[16:19], v[64:67], v[144:159]
    ds_read_b64_tr_b16 a[12:13], v212 offset:21504
    ds_read_b64_tr_b16 a[14:15], v212 offset:21760
    v_mfma_f32_32x32x16_bf16 v[144:159], a[20:23], v[68:71], v[144:159]
    s_waitcnt lgkmcnt(4)
    ds_read_b64_tr_b16 a[16:17], v212 offset:22528
    ds_read_b64_tr_b16 a[18:19], v212 offset:22784
    v_mfma_f32_32x32x16_bf16 v[144:159], a[0:3], v[72:75], v[144:159]
    s_add_u32 m0, s43, 79872
    s_add_u32 s101, s45, 3096576
    buffer_load_dwordx4 v220, s[20:23], s101 offen  lds
    ds_read_b64_tr_b16 a[20:21], v212 offset:23552
    ds_read_b64_tr_b16 a[22:23], v212 offset:23808
    v_mfma_f32_32x32x16_bf16 v[144:159], a[4:7], v[76:79], v[144:159]
    s_waitcnt lgkmcnt(4)
    ds_read_b64_tr_b16 a[0:1], v212 offset:24576
    ds_read_b64_tr_b16 a[2:3], v212 offset:24832
    v_mfma_f32_32x32x16_bf16 v[144:159], a[8:11], v[80:83], v[144:159]
    v_add_u32 v214, 36864, v208
    ds_read_b64_tr_b16 a[4:5], v212 offset:25600
    ds_read_b64_tr_b16 a[6:7], v212 offset:25856
    v_mfma_f32_32x32x16_bf16 v[144:159], a[12:15], v[84:87], v[144:159]
    v_xor_b32 v215, 64, v214
    s_waitcnt lgkmcnt(4)
    ds_read_b64_tr_b16 a[8:9], v212 offset:26624
    ds_read_b64_tr_b16 a[10:11], v212 offset:26880
    v_mfma_f32_32x32x16_bf16 v[144:159], a[16:19], v[88:91], v[144:159]
    s_add_u32 m0, s43, 80896
    s_add_u32 s101, s45, 3170304
    buffer_load_dwordx4 v220, s[20:23], s101 offen  lds
    ds_read_b64_tr_b16 a[12:13], v212 offset:27648
    ds_read_b64_tr_b16 a[14:15], v212 offset:27904
    v_mfma_f32_32x32x16_bf16 v[144:159], a[20:23], v[92:95], v[144:159]
    s_waitcnt lgkmcnt(4)
    ds_read_b64_tr_b16 a[16:17], v212 offset:28672
    ds_read_b64_tr_b16 a[18:19], v212 offset:28928
    v_mfma_f32_32x32x16_bf16 v[144:159], a[0:3], v[96:99], v[144:159]
    ds_read_b64_tr_b16 a[20:21], v212 offset:29696
    ds_read_b64_tr_b16 a[22:23], v212 offset:29952
    v_mfma_f32_32x32x16_bf16 v[144:159], a[4:7], v[100:103], v[144:159]
    s_waitcnt lgkmcnt(4)
    ds_read_b64_tr_b16 a[0:1], v212 offset:30720
    ds_read_b64_tr_b16 a[2:3], v212 offset:30976
    v_mfma_f32_32x32x16_bf16 v[144:159], a[8:11], v[104:107], v[144:159]
    s_add_u32 m0, s43, 81920
    s_add_u32 s101, s45, 3244032
    buffer_load_dwordx4 v220, s[20:23], s101 offen  lds
    ds_read_b64_tr_b16 a[4:5], v212 offset:31744
    ds_read_b64_tr_b16 a[6:7], v212 offset:32000
    v_mfma_f32_32x32x16_bf16 v[144:159], a[12:15], v[108:111], v[144:159]
    s_waitcnt lgkmcnt(4)
    ds_read_b64_tr_b16 a[8:9], v212 offset:32768
    ds_read_b64_tr_b16 a[10:11], v212 offset:33024
    v_mfma_f32_32x32x16_bf16 v[144:159], a[16:19], v[112:115], v[144:159]
    ds_read_b64_tr_b16 a[12:13], v212 offset:33792
    ds_read_b64_tr_b16 a[14:15], v212 offset:34048
    v_mfma_f32_32x32x16_bf16 v[144:159], a[20:23], v[116:119], v[144:159]
    s_waitcnt lgkmcnt(4)
    ds_read_b64_tr_b16 a[16:17], v212 offset:34816
    ds_read_b64_tr_b16 a[18:19], v212 offset:35072
    v_mfma_f32_32x32x16_bf16 v[144:159], a[0:3], v[120:123], v[144:159]
    s_waitcnt vmcnt(12)
    s_barrier
    s_add_u32 s56, s51, 128
    v_add_u32 v220, s56, v217
    ds_read_b64_tr_b16 a[20:21], v212 offset:35840
    ds_read_b64_tr_b16 a[22:23], v212 offset:36096
    v_mfma_f32_32x32x16_bf16 v[144:159], a[4:7], v[124:127], v[144:159]
    s_add_u32 m0, s43, 110592
    s_add_u32 s101, s45, 0
    buffer_load_dwordx4 v220, s[20:23], s101 offen  lds
    s_waitcnt lgkmcnt(4)
    ds_read_b64_tr_b16 a[0:1], v214 offset:0
    ds_read_b64_tr_b16 a[2:3], v214 offset:512
    v_mfma_f32_32x32x16_bf16 v[144:159], a[8:11], v[128:131], v[144:159]
    ds_read_b64_tr_b16 a[4:5], v214 offset:2048
    ds_read_b64_tr_b16 a[6:7], v214 offset:2560
    v_mfma_f32_32x32x16_bf16 v[144:159], a[12:15], v[132:135], v[144:159]
    s_waitcnt lgkmcnt(4)
    ds_read_b64_tr_b16 a[8:9], v214 offset:4096
    ds_read_b64_tr_b16 a[10:11], v214 offset:4608
    v_mfma_f32_32x32x16_bf16 v[144:159], a[16:19], v[136:139], v[144:159]
    s_add_u32 m0, s43, 111616
    s_add_u32 s101, s45, 73728
    buffer_load_dwordx4 v220, s[20:23], s101 offen  lds
    ds_read_b64_tr_b16 a[12:13], v214 offset:6144
    ds_read_b64_tr_b16 a[14:15], v214 offset:6656
    v_mfma_f32_32x32x16_bf16 v[144:159], a[20:23], v[140:143], v[144:159]
parallel_sum__softmax_full_mha__dense_activation_relu__prompt_kernel_join:
    s_waitcnt lgkmcnt(4)
    ds_read_b64_tr_b16 a[16:17], v214 offset:8192
    ds_read_b64_tr_b16 a[18:19], v214 offset:8704
    v_mfma_f32_32x32x16_bf16 v[160:175], a[0:3], v[0:3], 0
    ds_read_b64_tr_b16 a[20:21], v214 offset:10240
    ds_read_b64_tr_b16 a[22:23], v214 offset:10752
    v_mfma_f32_32x32x16_bf16 v[160:175], a[4:7], v[4:7], v[160:175]
    s_waitcnt lgkmcnt(4)
    ds_read_b64_tr_b16 a[0:1], v214 offset:12288
    ds_read_b64_tr_b16 a[2:3], v214 offset:12800
    v_mfma_f32_32x32x16_bf16 v[160:175], a[8:11], v[8:11], v[160:175]
    s_add_u32 m0, s43, 112640
    s_add_u32 s101, s45, 147456
    buffer_load_dwordx4 v220, s[20:23], s101 offen  lds
    ds_read_b64_tr_b16 a[4:5], v214 offset:14336
    ds_read_b64_tr_b16 a[6:7], v214 offset:14848
    v_mfma_f32_32x32x16_bf16 v[160:175], a[12:15], v[12:15], v[160:175]
    v_cvt_pk_bf16_f32 v176, v144, v145
    s_waitcnt lgkmcnt(4)
    ds_read_b64_tr_b16 a[8:9], v214 offset:16384
    ds_read_b64_tr_b16 a[10:11], v214 offset:16896
    v_mfma_f32_32x32x16_bf16 v[160:175], a[16:19], v[16:19], v[160:175]
    v_cvt_pk_bf16_f32 v177, v146, v147
    ds_read_b64_tr_b16 a[12:13], v214 offset:18432
    ds_read_b64_tr_b16 a[14:15], v214 offset:18944
    v_mfma_f32_32x32x16_bf16 v[160:175], a[20:23], v[20:23], v[160:175]
    v_cvt_pk_bf16_f32 v178, v148, v149
    s_waitcnt lgkmcnt(4)
    ds_read_b64_tr_b16 a[16:17], v214 offset:20480
    ds_read_b64_tr_b16 a[18:19], v214 offset:20992
    v_mfma_f32_32x32x16_bf16 v[160:175], a[0:3], v[24:27], v[160:175]
    v_cvt_pk_bf16_f32 v179, v150, v151
    s_add_u32 m0, s43, 113664
    s_add_u32 s101, s45, 221184
    buffer_load_dwordx4 v220, s[20:23], s101 offen  lds
    ds_read_b64_tr_b16 a[20:21], v214 offset:22528
    ds_read_b64_tr_b16 a[22:23], v214 offset:23040
    v_mfma_f32_32x32x16_bf16 v[160:175], a[4:7], v[28:31], v[160:175]
    v_cvt_pk_bf16_f32 v180, v152, v153
    s_waitcnt lgkmcnt(4)
    ds_read_b64_tr_b16 a[0:1], v214 offset:24576
    ds_read_b64_tr_b16 a[2:3], v214 offset:25088
    v_mfma_f32_32x32x16_bf16 v[160:175], a[8:11], v[32:35], v[160:175]
    v_cvt_pk_bf16_f32 v181, v154, v155
    ds_read_b64_tr_b16 a[4:5], v214 offset:26624
    ds_read_b64_tr_b16 a[6:7], v214 offset:27136
    v_mfma_f32_32x32x16_bf16 v[160:175], a[12:15], v[36:39], v[160:175]
    v_cvt_pk_bf16_f32 v182, v156, v157
    s_waitcnt lgkmcnt(4)
    ds_read_b64_tr_b16 a[8:9], v214 offset:28672
    ds_read_b64_tr_b16 a[10:11], v214 offset:29184
    v_mfma_f32_32x32x16_bf16 v[160:175], a[16:19], v[40:43], v[160:175]
    v_cvt_pk_bf16_f32 v183, v158, v159
    s_add_u32 m0, s43, 114688
    s_add_u32 s101, s45, 294912
    buffer_load_dwordx4 v220, s[20:23], s101 offen  lds
    ds_read_b64_tr_b16 a[12:13], v214 offset:30720
    ds_read_b64_tr_b16 a[14:15], v214 offset:31232
    v_mfma_f32_32x32x16_bf16 v[160:175], a[20:23], v[44:47], v[160:175]
    v_pk_max_i16 v176, v176, 0
    s_waitcnt lgkmcnt(4)
    ds_read_b64_tr_b16 a[16:17], v214 offset:32768
    ds_read_b64_tr_b16 a[18:19], v214 offset:33280
    v_mfma_f32_32x32x16_bf16 v[160:175], a[0:3], v[48:51], v[160:175]
    v_pk_max_i16 v177, v177, 0
    ds_read_b64_tr_b16 a[20:21], v214 offset:34816
    ds_read_b64_tr_b16 a[22:23], v214 offset:35328
    v_mfma_f32_32x32x16_bf16 v[160:175], a[4:7], v[52:55], v[160:175]
    v_pk_max_i16 v178, v178, 0
    s_waitcnt lgkmcnt(4)
    ds_read_b64_tr_b16 a[0:1], v215 offset:0
    ds_read_b64_tr_b16 a[2:3], v215 offset:512
    v_mfma_f32_32x32x16_bf16 v[160:175], a[8:11], v[56:59], v[160:175]
    v_pk_max_i16 v179, v179, 0
    s_add_u32 m0, s43, 115712
    s_add_u32 s101, s45, 368640
    buffer_load_dwordx4 v220, s[20:23], s101 offen  lds
    ds_read_b64_tr_b16 a[4:5], v215 offset:2048
    ds_read_b64_tr_b16 a[6:7], v215 offset:2560
    v_mfma_f32_32x32x16_bf16 v[160:175], a[12:15], v[60:63], v[160:175]
    v_pk_max_i16 v180, v180, 0
    s_waitcnt lgkmcnt(4)
    ds_read_b64_tr_b16 a[8:9], v215 offset:4096
    ds_read_b64_tr_b16 a[10:11], v215 offset:4608
    v_mfma_f32_32x32x16_bf16 v[160:175], a[16:19], v[64:67], v[160:175]
    v_pk_max_i16 v181, v181, 0
    ds_read_b64_tr_b16 a[12:13], v215 offset:6144
    ds_read_b64_tr_b16 a[14:15], v215 offset:6656
    v_mfma_f32_32x32x16_bf16 v[160:175], a[20:23], v[68:71], v[160:175]
    v_pk_max_i16 v182, v182, 0
    s_waitcnt lgkmcnt(4)
    ds_read_b64_tr_b16 a[16:17], v215 offset:8192
    ds_read_b64_tr_b16 a[18:19], v215 offset:8704
    v_mfma_f32_32x32x16_bf16 v[144:159], a[0:3], v[0:3], 0
    v_pk_max_i16 v183, v183, 0
    s_add_u32 m0, s43, 116736
    s_add_u32 s101, s45, 442368
    buffer_load_dwordx4 v220, s[20:23], s101 offen  lds
    ds_read_b64_tr_b16 a[20:21], v215 offset:10240
    ds_read_b64_tr_b16 a[22:23], v215 offset:10752
    v_mfma_f32_32x32x16_bf16 v[144:159], a[4:7], v[4:7], v[144:159]
    v_accvgpr_write_b32 a88, v176
    s_waitcnt lgkmcnt(4)
    ds_read_b64_tr_b16 a[0:1], v215 offset:12288
    ds_read_b64_tr_b16 a[2:3], v215 offset:12800
    v_mfma_f32_32x32x16_bf16 v[144:159], a[8:11], v[8:11], v[144:159]
    v_add_u32 v212, 73728, v208
    ds_read_b64_tr_b16 a[4:5], v215 offset:14336
    ds_read_b64_tr_b16 a[6:7], v215 offset:14848
    v_mfma_f32_32x32x16_bf16 v[144:159], a[12:15], v[12:15], v[144:159]
    v_xor_b32 v213, 64, v212
    s_waitcnt lgkmcnt(4)
    ds_read_b64_tr_b16 a[8:9], v215 offset:16384
    ds_read_b64_tr_b16 a[10:11], v215 offset:16896
    v_mfma_f32_32x32x16_bf16 v[144:159], a[16:19], v[16:19], v[144:159]
    v_accvgpr_write_b32 a89, v177
    s_add_u32 m0, s43, 117760
    s_add_u32 s101, s45, 516096
    buffer_load_dwordx4 v220, s[20:23], s101 offen  lds
    ds_read_b64_tr_b16 a[12:13], v215 offset:18432
    ds_read_b64_tr_b16 a[14:15], v215 offset:18944
    v_mfma_f32_32x32x16_bf16 v[144:159], a[20:23], v[20:23], v[144:159]
    v_accvgpr_write_b32 a90, v178
    s_waitcnt lgkmcnt(4)
    ds_read_b64_tr_b16 a[16:17], v215 offset:20480
    ds_read_b64_tr_b16 a[18:19], v215 offset:20992
    v_mfma_f32_32x32x16_bf16 v[144:159], a[0:3], v[24:27], v[144:159]
    v_accvgpr_write_b32 a91, v179
    ds_read_b64_tr_b16 a[20:21], v215 offset:22528
    ds_read_b64_tr_b16 a[22:23], v215 offset:23040
    v_mfma_f32_32x32x16_bf16 v[144:159], a[4:7], v[28:31], v[144:159]
    v_accvgpr_write_b32 a92, v180
    s_waitcnt lgkmcnt(4)
    ds_read_b64_tr_b16 a[0:1], v215 offset:24576
    ds_read_b64_tr_b16 a[2:3], v215 offset:25088
    v_mfma_f32_32x32x16_bf16 v[144:159], a[8:11], v[32:35], v[144:159]
    v_accvgpr_write_b32 a93, v181
    s_add_u32 m0, s43, 118784
    s_add_u32 s101, s45, 589824
    buffer_load_dwordx4 v220, s[20:23], s101 offen  lds
    ds_read_b64_tr_b16 a[4:5], v215 offset:26624
    ds_read_b64_tr_b16 a[6:7], v215 offset:27136
    v_mfma_f32_32x32x16_bf16 v[144:159], a[12:15], v[36:39], v[144:159]
    v_accvgpr_write_b32 a94, v182
    s_waitcnt lgkmcnt(4)
    ds_read_b64_tr_b16 a[8:9], v215 offset:28672
    ds_read_b64_tr_b16 a[10:11], v215 offset:29184
    v_mfma_f32_32x32x16_bf16 v[144:159], a[16:19], v[40:43], v[144:159]
    v_accvgpr_write_b32 a95, v183
    ds_read_b64_tr_b16 a[12:13], v215 offset:30720
    ds_read_b64_tr_b16 a[14:15], v215 offset:31232
    v_mfma_f32_32x32x16_bf16 v[144:159], a[20:23], v[44:47], v[144:159]
    s_waitcnt lgkmcnt(4)
    ds_read_b64_tr_b16 a[16:17], v215 offset:32768
    ds_read_b64_tr_b16 a[18:19], v215 offset:33280
    v_mfma_f32_32x32x16_bf16 v[144:159], a[0:3], v[48:51], v[144:159]
    s_waitcnt vmcnt(9)
    s_barrier
    s_add_u32 s56, s51, 128
    v_add_u32 v220, s56, v217
    ds_read_b64_tr_b16 a[20:21], v215 offset:34816
    ds_read_b64_tr_b16 a[22:23], v215 offset:35328
    v_mfma_f32_32x32x16_bf16 v[144:159], a[4:7], v[52:55], v[144:159]
    s_add_u32 m0, s43, 0
    s_add_u32 s101, s45, 2654208
    buffer_load_dwordx4 v220, s[20:23], s101 offen  lds
    s_waitcnt lgkmcnt(4)
    ds_read_b64_tr_b16 a[0:1], v212 offset:0
    ds_read_b64_tr_b16 a[2:3], v212 offset:512
    v_mfma_f32_32x32x16_bf16 v[144:159], a[8:11], v[56:59], v[144:159]
    ds_read_b64_tr_b16 a[4:5], v212 offset:2048
    ds_read_b64_tr_b16 a[6:7], v212 offset:2560
    v_mfma_f32_32x32x16_bf16 v[144:159], a[12:15], v[60:63], v[144:159]
    s_waitcnt lgkmcnt(4)
    ds_read_b64_tr_b16 a[8:9], v212 offset:4096
    ds_read_b64_tr_b16 a[10:11], v212 offset:4608
    v_mfma_f32_32x32x16_bf16 v[144:159], a[16:19], v[64:67], v[144:159]
    s_add_u32 m0, s43, 1024
    s_add_u32 s101, s45, 2727936
    buffer_load_dwordx4 v220, s[20:23], s101 offen  lds
    ds_read_b64_tr_b16 a[12:13], v212 offset:6144
    ds_read_b64_tr_b16 a[14:15], v212 offset:6656
    v_mfma_f32_32x32x16_bf16 v[144:159], a[20:23], v[68:71], v[144:159]
    s_waitcnt lgkmcnt(4)
    ds_read_b64_tr_b16 a[16:17], v212 offset:8192
    ds_read_b64_tr_b16 a[18:19], v212 offset:8704
    v_mfma_f32_32x32x16_bf16 v[160:175], a[0:3], v[72:75], v[160:175]
    ds_read_b64_tr_b16 a[20:21], v212 offset:10240
    ds_read_b64_tr_b16 a[22:23], v212 offset:10752
    v_mfma_f32_32x32x16_bf16 v[160:175], a[4:7], v[76:79], v[160:175]
    s_waitcnt lgkmcnt(4)
    ds_read_b64_tr_b16 a[0:1], v212 offset:12288
    ds_read_b64_tr_b16 a[2:3], v212 offset:12800
    v_mfma_f32_32x32x16_bf16 v[160:175], a[8:11], v[80:83], v[160:175]
    s_add_u32 m0, s43, 2048
    s_add_u32 s101, s45, 2801664
    buffer_load_dwordx4 v220, s[20:23], s101 offen  lds
    ds_read_b64_tr_b16 a[4:5], v212 offset:14336
    ds_read_b64_tr_b16 a[6:7], v212 offset:14848
    v_mfma_f32_32x32x16_bf16 v[160:175], a[12:15], v[84:87], v[160:175]
    s_waitcnt lgkmcnt(4)
    ds_read_b64_tr_b16 a[8:9], v212 offset:16384
    ds_read_b64_tr_b16 a[10:11], v212 offset:16896
    v_mfma_f32_32x32x16_bf16 v[160:175], a[16:19], v[88:91], v[160:175]
    ds_read_b64_tr_b16 a[12:13], v212 offset:18432
    ds_read_b64_tr_b16 a[14:15], v212 offset:18944
    v_mfma_f32_32x32x16_bf16 v[160:175], a[20:23], v[92:95], v[160:175]
    s_waitcnt lgkmcnt(4)
    ds_read_b64_tr_b16 a[16:17], v212 offset:20480
    ds_read_b64_tr_b16 a[18:19], v212 offset:20992
    v_mfma_f32_32x32x16_bf16 v[160:175], a[0:3], v[96:99], v[160:175]
    s_add_u32 m0, s43, 3072
    s_add_u32 s101, s45, 2875392
    buffer_load_dwordx4 v220, s[20:23], s101 offen  lds
    ds_read_b64_tr_b16 a[20:21], v212 offset:22528
    ds_read_b64_tr_b16 a[22:23], v212 offset:23040
    v_mfma_f32_32x32x16_bf16 v[160:175], a[4:7], v[100:103], v[160:175]
    s_waitcnt lgkmcnt(4)
    ds_read_b64_tr_b16 a[0:1], v212 offset:24576
    ds_read_b64_tr_b16 a[2:3], v212 offset:25088
    v_mfma_f32_32x32x16_bf16 v[160:175], a[8:11], v[104:107], v[160:175]
    ds_read_b64_tr_b16 a[4:5], v212 offset:26624
    ds_read_b64_tr_b16 a[6:7], v212 offset:27136
    v_mfma_f32_32x32x16_bf16 v[160:175], a[12:15], v[108:111], v[160:175]
    s_waitcnt lgkmcnt(4)
    ds_read_b64_tr_b16 a[8:9], v212 offset:28672
    ds_read_b64_tr_b16 a[10:11], v212 offset:29184
    v_mfma_f32_32x32x16_bf16 v[160:175], a[16:19], v[112:115], v[160:175]
    s_add_u32 m0, s43, 4096
    s_add_u32 s101, s45, 2949120
    buffer_load_dwordx4 v220, s[20:23], s101 offen  lds
    ds_read_b64_tr_b16 a[12:13], v212 offset:30720
    ds_read_b64_tr_b16 a[14:15], v212 offset:31232
    v_mfma_f32_32x32x16_bf16 v[160:175], a[20:23], v[116:119], v[160:175]
    s_waitcnt lgkmcnt(4)
    ds_read_b64_tr_b16 a[16:17], v212 offset:32768
    ds_read_b64_tr_b16 a[18:19], v212 offset:33280
    v_mfma_f32_32x32x16_bf16 v[160:175], a[0:3], v[120:123], v[160:175]
    ds_read_b64_tr_b16 a[20:21], v212 offset:34816
    ds_read_b64_tr_b16 a[22:23], v212 offset:35328
    v_mfma_f32_32x32x16_bf16 v[160:175], a[4:7], v[124:127], v[160:175]
    s_waitcnt lgkmcnt(4)
    ds_read_b64_tr_b16 a[0:1], v213 offset:0
    ds_read_b64_tr_b16 a[2:3], v213 offset:512
    v_mfma_f32_32x32x16_bf16 v[160:175], a[8:11], v[128:131], v[160:175]
    s_add_u32 m0, s43, 5120
    s_add_u32 s101, s45, 3022848
    buffer_load_dwordx4 v220, s[20:23], s101 offen  lds
    ds_read_b64_tr_b16 a[4:5], v213 offset:2048
    ds_read_b64_tr_b16 a[6:7], v213 offset:2560
    v_mfma_f32_32x32x16_bf16 v[160:175], a[12:15], v[132:135], v[160:175]
    s_waitcnt lgkmcnt(4)
    ds_read_b64_tr_b16 a[8:9], v213 offset:4096
    ds_read_b64_tr_b16 a[10:11], v213 offset:4608
    v_mfma_f32_32x32x16_bf16 v[160:175], a[16:19], v[136:139], v[160:175]
    ds_read_b64_tr_b16 a[12:13], v213 offset:6144
    ds_read_b64_tr_b16 a[14:15], v213 offset:6656
    v_mfma_f32_32x32x16_bf16 v[160:175], a[20:23], v[140:143], v[160:175]
    s_waitcnt lgkmcnt(4)
    ds_read_b64_tr_b16 a[16:17], v213 offset:8192
    ds_read_b64_tr_b16 a[18:19], v213 offset:8704
    v_mfma_f32_32x32x16_bf16 v[144:159], a[0:3], v[72:75], v[144:159]
    s_add_u32 m0, s43, 6144
    s_add_u32 s101, s45, 3096576
    buffer_load_dwordx4 v220, s[20:23], s101 offen  lds
    ds_read_b64_tr_b16 a[20:21], v213 offset:10240
    ds_read_b64_tr_b16 a[22:23], v213 offset:10752
    v_mfma_f32_32x32x16_bf16 v[144:159], a[4:7], v[76:79], v[144:159]
    s_waitcnt lgkmcnt(4)
    ds_read_b64_tr_b16 a[0:1], v213 offset:12288
    ds_read_b64_tr_b16 a[2:3], v213 offset:12800
    v_mfma_f32_32x32x16_bf16 v[144:159], a[8:11], v[80:83], v[144:159]
    v_add_u32 v214, 110592, v208
    ds_read_b64_tr_b16 a[4:5], v213 offset:14336
    ds_read_b64_tr_b16 a[6:7], v213 offset:14848
    v_mfma_f32_32x32x16_bf16 v[144:159], a[12:15], v[84:87], v[144:159]
    v_xor_b32 v215, 64, v214
    s_waitcnt lgkmcnt(4)
    ds_read_b64_tr_b16 a[8:9], v213 offset:16384
    ds_read_b64_tr_b16 a[10:11], v213 offset:16896
    v_mfma_f32_32x32x16_bf16 v[144:159], a[16:19], v[88:91], v[144:159]
    v_cvt_pk_bf16_f32 v184, v160, v161
    s_add_u32 m0, s43, 7168
    s_add_u32 s101, s45, 3170304
    buffer_load_dwordx4 v220, s[20:23], s101 offen  lds
    ds_read_b64_tr_b16 a[12:13], v213 offset:18432
    ds_read_b64_tr_b16 a[14:15], v213 offset:18944
    v_mfma_f32_32x32x16_bf16 v[144:159], a[20:23], v[92:95], v[144:159]
    v_cvt_pk_bf16_f32 v185, v162, v163
    s_waitcnt lgkmcnt(4)
    ds_read_b64_tr_b16 a[16:17], v213 offset:20480
    ds_read_b64_tr_b16 a[18:19], v213 offset:20992
    v_mfma_f32_32x32x16_bf16 v[144:159], a[0:3], v[96:99], v[144:159]
    v_cvt_pk_bf16_f32 v186, v164, v165
    ds_read_b64_tr_b16 a[20:21], v213 offset:22528
    ds_read_b64_tr_b16 a[22:23], v213 offset:23040
    v_mfma_f32_32x32x16_bf16 v[144:159], a[4:7], v[100:103], v[144:159]
    v_cvt_pk_bf16_f32 v187, v166, v167
    s_waitcnt lgkmcnt(4)
    ds_read_b64_tr_b16 a[0:1], v213 offset:24576
    ds_read_b64_tr_b16 a[2:3], v213 offset:25088
    v_mfma_f32_32x32x16_bf16 v[144:159], a[8:11], v[104:107], v[144:159]
    v_cvt_pk_bf16_f32 v188, v168, v169
    s_add_u32 m0, s43, 8192
    s_add_u32 s101, s45, 3244032
    buffer_load_dwordx4 v220, s[20:23], s101 offen  lds
    ds_read_b64_tr_b16 a[4:5], v213 offset:26624
    ds_read_b64_tr_b16 a[6:7], v213 offset:27136
    v_mfma_f32_32x32x16_bf16 v[144:159], a[12:15], v[108:111], v[144:159]
    v_cvt_pk_bf16_f32 v189, v170, v171
    s_waitcnt lgkmcnt(4)
    ds_read_b64_tr_b16 a[8:9], v213 offset:28672
    ds_read_b64_tr_b16 a[10:11], v213 offset:29184
    v_mfma_f32_32x32x16_bf16 v[144:159], a[16:19], v[112:115], v[144:159]
    v_cvt_pk_bf16_f32 v190, v172, v173
    ds_read_b64_tr_b16 a[12:13], v213 offset:30720
    ds_read_b64_tr_b16 a[14:15], v213 offset:31232
    v_mfma_f32_32x32x16_bf16 v[144:159], a[20:23], v[116:119], v[144:159]
    v_cvt_pk_bf16_f32 v191, v174, v175
    s_waitcnt lgkmcnt(4)
    ds_read_b64_tr_b16 a[16:17], v213 offset:32768
    ds_read_b64_tr_b16 a[18:19], v213 offset:33280
    v_mfma_f32_32x32x16_bf16 v[144:159], a[0:3], v[120:123], v[144:159]
    s_waitcnt vmcnt(9)
    s_barrier
    s_add_u32 s56, s51, 256
    v_add_u32 v220, s56, v217
    ds_read_b64_tr_b16 a[20:21], v213 offset:34816
    ds_read_b64_tr_b16 a[22:23], v213 offset:35328
    v_mfma_f32_32x32x16_bf16 v[144:159], a[4:7], v[124:127], v[144:159]
    v_pk_max_i16 v184, v184, 0
    s_lshl_b32 s3, s2, 2
    s_add_u32 s3, s3, 47923200
    v_mov_b32 v252, s3
    s_mov_b64 exec, 1
    buffer_store_dword v232, v252, s[8:11], 0 offen sc1
    s_mov_b64 exec, -1
    s_add_u32 m0, s43, 36864
    s_add_u32 s101, s45, 0
    buffer_load_dwordx4 v220, s[20:23], s101 offen  lds
    s_waitcnt lgkmcnt(4)
    ds_read_b64_tr_b16 a[0:1], v214 offset:0
    ds_read_b64_tr_b16 a[2:3], v214 offset:512
    v_mfma_f32_32x32x16_bf16 v[144:159], a[8:11], v[128:131], v[144:159]
    v_pk_max_i16 v185, v185, 0
    ds_read_b64_tr_b16 a[4:5], v214 offset:2048
    ds_read_b64_tr_b16 a[6:7], v214 offset:2560
    v_mfma_f32_32x32x16_bf16 v[144:159], a[12:15], v[132:135], v[144:159]
    v_pk_max_i16 v186, v186, 0
    s_waitcnt lgkmcnt(4)
    ds_read_b64_tr_b16 a[8:9], v214 offset:4096
    ds_read_b64_tr_b16 a[10:11], v214 offset:4608
    v_mfma_f32_32x32x16_bf16 v[144:159], a[16:19], v[136:139], v[144:159]
    v_pk_max_i16 v187, v187, 0
    s_add_u32 m0, s43, 37888
    s_add_u32 s101, s45, 73728
    buffer_load_dwordx4 v220, s[20:23], s101 offen  lds
    ds_read_b64_tr_b16 a[12:13], v214 offset:6144
    ds_read_b64_tr_b16 a[14:15], v214 offset:6656
    v_mfma_f32_32x32x16_bf16 v[144:159], a[20:23], v[140:143], v[144:159]
    v_pk_max_i16 v188, v188, 0
    s_waitcnt lgkmcnt(4)
    ds_read_b64_tr_b16 a[16:17], v214 offset:8192
    ds_read_b64_tr_b16 a[18:19], v214 offset:8704
    v_mfma_f32_32x32x16_bf16 v[160:175], a[0:3], v[0:3], 0
    v_pk_max_i16 v189, v189, 0
    ds_read_b64_tr_b16 a[20:21], v214 offset:10240
    ds_read_b64_tr_b16 a[22:23], v214 offset:10752
    v_mfma_f32_32x32x16_bf16 v[160:175], a[4:7], v[4:7], v[160:175]
    v_pk_max_i16 v190, v190, 0
    s_waitcnt lgkmcnt(4)
    ds_read_b64_tr_b16 a[0:1], v214 offset:12288
    ds_read_b64_tr_b16 a[2:3], v214 offset:12800
    v_mfma_f32_32x32x16_bf16 v[160:175], a[8:11], v[8:11], v[160:175]
    v_pk_max_i16 v191, v191, 0
    s_add_u32 m0, s43, 38912
    s_add_u32 s101, s45, 147456
    buffer_load_dwordx4 v220, s[20:23], s101 offen  lds
    ds_read_b64_tr_b16 a[4:5], v214 offset:14336
    ds_read_b64_tr_b16 a[6:7], v214 offset:14848
    v_mfma_f32_32x32x16_bf16 v[160:175], a[12:15], v[12:15], v[160:175]
    v_cvt_pk_bf16_f32 v176, v144, v145
    s_waitcnt lgkmcnt(4)
    ds_read_b64_tr_b16 a[8:9], v214 offset:16384
    ds_read_b64_tr_b16 a[10:11], v214 offset:16896
    v_mfma_f32_32x32x16_bf16 v[160:175], a[16:19], v[16:19], v[160:175]
    v_cvt_pk_bf16_f32 v177, v146, v147
    ds_read_b64_tr_b16 a[12:13], v214 offset:18432
    ds_read_b64_tr_b16 a[14:15], v214 offset:18944
    v_mfma_f32_32x32x16_bf16 v[160:175], a[20:23], v[20:23], v[160:175]
    v_cvt_pk_bf16_f32 v178, v148, v149
    s_waitcnt lgkmcnt(4)
    ds_read_b64_tr_b16 a[16:17], v214 offset:20480
    ds_read_b64_tr_b16 a[18:19], v214 offset:20992
    v_mfma_f32_32x32x16_bf16 v[160:175], a[0:3], v[24:27], v[160:175]
    v_cvt_pk_bf16_f32 v179, v150, v151
    s_add_u32 m0, s43, 39936
    s_add_u32 s101, s45, 221184
    buffer_load_dwordx4 v220, s[20:23], s101 offen  lds
    ds_read_b64_tr_b16 a[20:21], v214 offset:22528
    ds_read_b64_tr_b16 a[22:23], v214 offset:23040
    v_mfma_f32_32x32x16_bf16 v[160:175], a[4:7], v[28:31], v[160:175]
    v_cvt_pk_bf16_f32 v180, v152, v153
    s_waitcnt lgkmcnt(4)
    ds_read_b64_tr_b16 a[0:1], v214 offset:24576
    ds_read_b64_tr_b16 a[2:3], v214 offset:25088
    v_mfma_f32_32x32x16_bf16 v[160:175], a[8:11], v[32:35], v[160:175]
    v_cvt_pk_bf16_f32 v181, v154, v155
    ds_read_b64_tr_b16 a[4:5], v214 offset:26624
    ds_read_b64_tr_b16 a[6:7], v214 offset:27136
    v_mfma_f32_32x32x16_bf16 v[160:175], a[12:15], v[36:39], v[160:175]
    v_cvt_pk_bf16_f32 v182, v156, v157
    s_waitcnt lgkmcnt(4)
    ds_read_b64_tr_b16 a[8:9], v214 offset:28672
    ds_read_b64_tr_b16 a[10:11], v214 offset:29184
    v_mfma_f32_32x32x16_bf16 v[160:175], a[16:19], v[40:43], v[160:175]
    v_cvt_pk_bf16_f32 v183, v158, v159
    s_add_u32 m0, s43, 40960
    s_add_u32 s101, s45, 294912
    buffer_load_dwordx4 v220, s[20:23], s101 offen  lds
    ds_read_b64_tr_b16 a[12:13], v214 offset:30720
    ds_read_b64_tr_b16 a[14:15], v214 offset:31232
    v_mfma_f32_32x32x16_bf16 v[160:175], a[20:23], v[44:47], v[160:175]
    v_accvgpr_write_b32 a24, v184
    s_waitcnt lgkmcnt(4)
    ds_read_b64_tr_b16 a[16:17], v214 offset:32768
    ds_read_b64_tr_b16 a[18:19], v214 offset:33280
    v_mfma_f32_32x32x16_bf16 v[160:175], a[0:3], v[48:51], v[160:175]
    v_accvgpr_write_b32 a25, v185
    ds_read_b64_tr_b16 a[20:21], v214 offset:34816
    ds_read_b64_tr_b16 a[22:23], v214 offset:35328
    v_mfma_f32_32x32x16_bf16 v[160:175], a[4:7], v[52:55], v[160:175]
    v_accvgpr_write_b32 a26, v186
    s_waitcnt lgkmcnt(4)
    ds_read_b64_tr_b16 a[0:1], v215 offset:0
    ds_read_b64_tr_b16 a[2:3], v215 offset:512
    v_mfma_f32_32x32x16_bf16 v[160:175], a[8:11], v[56:59], v[160:175]
    v_accvgpr_write_b32 a27, v187
    s_add_u32 m0, s43, 41984
    s_add_u32 s101, s45, 368640
    buffer_load_dwordx4 v220, s[20:23], s101 offen  lds
    ds_read_b64_tr_b16 a[4:5], v215 offset:2048
    ds_read_b64_tr_b16 a[6:7], v215 offset:2560
    v_mfma_f32_32x32x16_bf16 v[160:175], a[12:15], v[60:63], v[160:175]
    v_accvgpr_write_b32 a28, v188
    s_waitcnt lgkmcnt(4)
    ds_read_b64_tr_b16 a[8:9], v215 offset:4096
    ds_read_b64_tr_b16 a[10:11], v215 offset:4608
    v_mfma_f32_32x32x16_bf16 v[160:175], a[16:19], v[64:67], v[160:175]
    v_accvgpr_write_b32 a29, v189
    ds_read_b64_tr_b16 a[12:13], v215 offset:6144
    ds_read_b64_tr_b16 a[14:15], v215 offset:6656
    v_mfma_f32_32x32x16_bf16 v[160:175], a[20:23], v[68:71], v[160:175]
    v_accvgpr_write_b32 a30, v190
    s_waitcnt lgkmcnt(4)
    ds_read_b64_tr_b16 a[16:17], v215 offset:8192
    ds_read_b64_tr_b16 a[18:19], v215 offset:8704
    v_mfma_f32_32x32x16_bf16 v[144:159], a[0:3], v[0:3], 0
    v_accvgpr_write_b32 a31, v191
    s_add_u32 m0, s43, 43008
    s_add_u32 s101, s45, 442368
    buffer_load_dwordx4 v220, s[20:23], s101 offen  lds
    ds_read_b64_tr_b16 a[20:21], v215 offset:10240
    ds_read_b64_tr_b16 a[22:23], v215 offset:10752
    v_mfma_f32_32x32x16_bf16 v[144:159], a[4:7], v[4:7], v[144:159]
    v_pk_max_i16 v176, v176, 0
    s_waitcnt lgkmcnt(4)
    ds_read_b64_tr_b16 a[0:1], v215 offset:12288
    ds_read_b64_tr_b16 a[2:3], v215 offset:12800
    v_mfma_f32_32x32x16_bf16 v[144:159], a[8:11], v[8:11], v[144:159]
    v_add_u32 v212, 0, v208
    ds_read_b64_tr_b16 a[4:5], v215 offset:14336
    ds_read_b64_tr_b16 a[6:7], v215 offset:14848
    v_mfma_f32_32x32x16_bf16 v[144:159], a[12:15], v[12:15], v[144:159]
    v_xor_b32 v213, 64, v212
    s_waitcnt lgkmcnt(4)
    ds_read_b64_tr_b16 a[8:9], v215 offset:16384
    ds_read_b64_tr_b16 a[10:11], v215 offset:16896
    v_mfma_f32_32x32x16_bf16 v[144:159], a[16:19], v[16:19], v[144:159]
    v_pk_max_i16 v177, v177, 0
    s_add_u32 m0, s43, 44032
    s_add_u32 s101, s45, 516096
    buffer_load_dwordx4 v220, s[20:23], s101 offen  lds
    ds_read_b64_tr_b16 a[12:13], v215 offset:18432
    ds_read_b64_tr_b16 a[14:15], v215 offset:18944
    v_mfma_f32_32x32x16_bf16 v[144:159], a[20:23], v[20:23], v[144:159]
    v_pk_max_i16 v178, v178, 0
    s_waitcnt lgkmcnt(4)
    ds_read_b64_tr_b16 a[16:17], v215 offset:20480
    ds_read_b64_tr_b16 a[18:19], v215 offset:20992
    v_mfma_f32_32x32x16_bf16 v[144:159], a[0:3], v[24:27], v[144:159]
    v_pk_max_i16 v179, v179, 0
    ds_read_b64_tr_b16 a[20:21], v215 offset:22528
    ds_read_b64_tr_b16 a[22:23], v215 offset:23040
    v_mfma_f32_32x32x16_bf16 v[144:159], a[4:7], v[28:31], v[144:159]
    v_pk_max_i16 v180, v180, 0
    s_waitcnt lgkmcnt(4)
    ds_read_b64_tr_b16 a[0:1], v215 offset:24576
    ds_read_b64_tr_b16 a[2:3], v215 offset:25088
    v_mfma_f32_32x32x16_bf16 v[144:159], a[8:11], v[32:35], v[144:159]
    v_pk_max_i16 v181, v181, 0
    s_add_u32 m0, s43, 45056
    s_add_u32 s101, s45, 589824
    buffer_load_dwordx4 v220, s[20:23], s101 offen  lds
    ds_read_b64_tr_b16 a[4:5], v215 offset:26624
    ds_read_b64_tr_b16 a[6:7], v215 offset:27136
    v_mfma_f32_32x32x16_bf16 v[144:159], a[12:15], v[36:39], v[144:159]
    v_pk_max_i16 v182, v182, 0
    s_waitcnt lgkmcnt(4)
    ds_read_b64_tr_b16 a[8:9], v215 offset:28672
    ds_read_b64_tr_b16 a[10:11], v215 offset:29184
    v_mfma_f32_32x32x16_bf16 v[144:159], a[16:19], v[40:43], v[144:159]
    v_pk_max_i16 v183, v183, 0
    ds_read_b64_tr_b16 a[12:13], v215 offset:30720
    ds_read_b64_tr_b16 a[14:15], v215 offset:31232
    v_mfma_f32_32x32x16_bf16 v[144:159], a[20:23], v[44:47], v[144:159]
    v_accvgpr_write_b32 a32, v176
    s_waitcnt lgkmcnt(4)
    ds_read_b64_tr_b16 a[16:17], v215 offset:32768
    ds_read_b64_tr_b16 a[18:19], v215 offset:33280
    v_mfma_f32_32x32x16_bf16 v[144:159], a[0:3], v[48:51], v[144:159]
    s_waitcnt vmcnt(10)
    s_barrier
    s_add_u32 s56, s51, 256
    v_add_u32 v220, s56, v217
    ds_read_b64_tr_b16 a[20:21], v215 offset:34816
    ds_read_b64_tr_b16 a[22:23], v215 offset:35328
    v_mfma_f32_32x32x16_bf16 v[144:159], a[4:7], v[52:55], v[144:159]
    v_accvgpr_write_b32 a33, v177
    s_add_u32 m0, s43, 73728
    s_add_u32 s101, s45, 2654208
    buffer_load_dwordx4 v220, s[20:23], s101 offen  lds
    s_waitcnt lgkmcnt(4)
    ds_read_b64_tr_b16 a[0:1], v212 offset:0
    ds_read_b64_tr_b16 a[2:3], v212 offset:512
    v_mfma_f32_32x32x16_bf16 v[144:159], a[8:11], v[56:59], v[144:159]
    v_accvgpr_write_b32 a34, v178
    ds_read_b64_tr_b16 a[4:5], v212 offset:2048
    ds_read_b64_tr_b16 a[6:7], v212 offset:2560
    v_mfma_f32_32x32x16_bf16 v[144:159], a[12:15], v[60:63], v[144:159]
    v_accvgpr_write_b32 a35, v179
    s_waitcnt lgkmcnt(4)
    ds_read_b64_tr_b16 a[8:9], v212 offset:4096
    ds_read_b64_tr_b16 a[10:11], v212 offset:4608
    v_mfma_f32_32x32x16_bf16 v[144:159], a[16:19], v[64:67], v[144:159]
    v_accvgpr_write_b32 a36, v180
    s_add_u32 m0, s43, 74752
    s_add_u32 s101, s45, 2727936
    buffer_load_dwordx4 v220, s[20:23], s101 offen  lds
    ds_read_b64_tr_b16 a[12:13], v212 offset:6144
    ds_read_b64_tr_b16 a[14:15], v212 offset:6656
    v_mfma_f32_32x32x16_bf16 v[144:159], a[20:23], v[68:71], v[144:159]
    v_accvgpr_write_b32 a37, v181
    s_waitcnt lgkmcnt(4)
    ds_read_b64_tr_b16 a[16:17], v212 offset:8192
    ds_read_b64_tr_b16 a[18:19], v212 offset:8704
    v_mfma_f32_32x32x16_bf16 v[160:175], a[0:3], v[72:75], v[160:175]
    v_accvgpr_write_b32 a38, v182
    ds_read_b64_tr_b16 a[20:21], v212 offset:10240
    ds_read_b64_tr_b16 a[22:23], v212 offset:10752
    v_mfma_f32_32x32x16_bf16 v[160:175], a[4:7], v[76:79], v[160:175]
    v_accvgpr_write_b32 a39, v183
    s_waitcnt lgkmcnt(4)
    ds_read_b64_tr_b16 a[0:1], v212 offset:12288
    ds_read_b64_tr_b16 a[2:3], v212 offset:12800
    v_mfma_f32_32x32x16_bf16 v[160:175], a[8:11], v[80:83], v[160:175]
    s_add_u32 m0, s43, 75776
    s_add_u32 s101, s45, 2801664
    buffer_load_dwordx4 v220, s[20:23], s101 offen  lds
    ds_read_b64_tr_b16 a[4:5], v212 offset:14336
    ds_read_b64_tr_b16 a[6:7], v212 offset:14848
    v_mfma_f32_32x32x16_bf16 v[160:175], a[12:15], v[84:87], v[160:175]
    s_waitcnt lgkmcnt(4)
    ds_read_b64_tr_b16 a[8:9], v212 offset:16384
    ds_read_b64_tr_b16 a[10:11], v212 offset:16896
    v_mfma_f32_32x32x16_bf16 v[160:175], a[16:19], v[88:91], v[160:175]
    ds_read_b64_tr_b16 a[12:13], v212 offset:18432
    ds_read_b64_tr_b16 a[14:15], v212 offset:18944
    v_mfma_f32_32x32x16_bf16 v[160:175], a[20:23], v[92:95], v[160:175]
    s_waitcnt lgkmcnt(4)
    ds_read_b64_tr_b16 a[16:17], v212 offset:20480
    ds_read_b64_tr_b16 a[18:19], v212 offset:20992
    v_mfma_f32_32x32x16_bf16 v[160:175], a[0:3], v[96:99], v[160:175]
    s_add_u32 m0, s43, 76800
    s_add_u32 s101, s45, 2875392
    buffer_load_dwordx4 v220, s[20:23], s101 offen  lds
    ds_read_b64_tr_b16 a[20:21], v212 offset:22528
    ds_read_b64_tr_b16 a[22:23], v212 offset:23040
    v_mfma_f32_32x32x16_bf16 v[160:175], a[4:7], v[100:103], v[160:175]
    s_waitcnt lgkmcnt(4)
    ds_read_b64_tr_b16 a[0:1], v212 offset:24576
    ds_read_b64_tr_b16 a[2:3], v212 offset:25088
    v_mfma_f32_32x32x16_bf16 v[160:175], a[8:11], v[104:107], v[160:175]
    ds_read_b64_tr_b16 a[4:5], v212 offset:26624
    ds_read_b64_tr_b16 a[6:7], v212 offset:27136
    v_mfma_f32_32x32x16_bf16 v[160:175], a[12:15], v[108:111], v[160:175]
    s_waitcnt lgkmcnt(4)
    ds_read_b64_tr_b16 a[8:9], v212 offset:28672
    ds_read_b64_tr_b16 a[10:11], v212 offset:29184
    v_mfma_f32_32x32x16_bf16 v[160:175], a[16:19], v[112:115], v[160:175]
    s_add_u32 m0, s43, 77824
    s_add_u32 s101, s45, 2949120
    buffer_load_dwordx4 v220, s[20:23], s101 offen  lds
    ds_read_b64_tr_b16 a[12:13], v212 offset:30720
    ds_read_b64_tr_b16 a[14:15], v212 offset:31232
    v_mfma_f32_32x32x16_bf16 v[160:175], a[20:23], v[116:119], v[160:175]
    s_waitcnt lgkmcnt(4)
    ds_read_b64_tr_b16 a[16:17], v212 offset:32768
    ds_read_b64_tr_b16 a[18:19], v212 offset:33280
    v_mfma_f32_32x32x16_bf16 v[160:175], a[0:3], v[120:123], v[160:175]
    ds_read_b64_tr_b16 a[20:21], v212 offset:34816
    ds_read_b64_tr_b16 a[22:23], v212 offset:35328
    v_mfma_f32_32x32x16_bf16 v[160:175], a[4:7], v[124:127], v[160:175]
    s_waitcnt lgkmcnt(4)
    ds_read_b64_tr_b16 a[0:1], v213 offset:0
    ds_read_b64_tr_b16 a[2:3], v213 offset:512
    v_mfma_f32_32x32x16_bf16 v[160:175], a[8:11], v[128:131], v[160:175]
    s_add_u32 m0, s43, 78848
    s_add_u32 s101, s45, 3022848
    buffer_load_dwordx4 v220, s[20:23], s101 offen  lds
    ds_read_b64_tr_b16 a[4:5], v213 offset:2048
    ds_read_b64_tr_b16 a[6:7], v213 offset:2560
    v_mfma_f32_32x32x16_bf16 v[160:175], a[12:15], v[132:135], v[160:175]
    s_waitcnt lgkmcnt(4)
    ds_read_b64_tr_b16 a[8:9], v213 offset:4096
    ds_read_b64_tr_b16 a[10:11], v213 offset:4608
    v_mfma_f32_32x32x16_bf16 v[160:175], a[16:19], v[136:139], v[160:175]
    ds_read_b64_tr_b16 a[12:13], v213 offset:6144
    ds_read_b64_tr_b16 a[14:15], v213 offset:6656
    v_mfma_f32_32x32x16_bf16 v[160:175], a[20:23], v[140:143], v[160:175]
    s_waitcnt lgkmcnt(4)
    ds_read_b64_tr_b16 a[16:17], v213 offset:8192
    ds_read_b64_tr_b16 a[18:19], v213 offset:8704
    v_mfma_f32_32x32x16_bf16 v[144:159], a[0:3], v[72:75], v[144:159]
    s_add_u32 m0, s43, 79872
    s_add_u32 s101, s45, 3096576
    buffer_load_dwordx4 v220, s[20:23], s101 offen  lds
    ds_read_b64_tr_b16 a[20:21], v213 offset:10240
    ds_read_b64_tr_b16 a[22:23], v213 offset:10752
    v_mfma_f32_32x32x16_bf16 v[144:159], a[4:7], v[76:79], v[144:159]
    s_waitcnt lgkmcnt(4)
    ds_read_b64_tr_b16 a[0:1], v213 offset:12288
    ds_read_b64_tr_b16 a[2:3], v213 offset:12800
    v_mfma_f32_32x32x16_bf16 v[144:159], a[8:11], v[80:83], v[144:159]
    v_add_u32 v214, 36864, v208
    ds_read_b64_tr_b16 a[4:5], v213 offset:14336
    ds_read_b64_tr_b16 a[6:7], v213 offset:14848
    v_mfma_f32_32x32x16_bf16 v[144:159], a[12:15], v[84:87], v[144:159]
    v_xor_b32 v215, 64, v214
    s_waitcnt lgkmcnt(4)
    ds_read_b64_tr_b16 a[8:9], v213 offset:16384
    ds_read_b64_tr_b16 a[10:11], v213 offset:16896
    v_mfma_f32_32x32x16_bf16 v[144:159], a[16:19], v[88:91], v[144:159]
    v_cvt_pk_bf16_f32 v184, v160, v161
    s_add_u32 m0, s43, 80896
    s_add_u32 s101, s45, 3170304
    buffer_load_dwordx4 v220, s[20:23], s101 offen  lds
    ds_read_b64_tr_b16 a[12:13], v213 offset:18432
    ds_read_b64_tr_b16 a[14:15], v213 offset:18944
    v_mfma_f32_32x32x16_bf16 v[144:159], a[20:23], v[92:95], v[144:159]
    v_cvt_pk_bf16_f32 v185, v162, v163
    s_waitcnt lgkmcnt(4)
    ds_read_b64_tr_b16 a[16:17], v213 offset:20480
    ds_read_b64_tr_b16 a[18:19], v213 offset:20992
    v_mfma_f32_32x32x16_bf16 v[144:159], a[0:3], v[96:99], v[144:159]
    v_cvt_pk_bf16_f32 v186, v164, v165
    ds_read_b64_tr_b16 a[20:21], v213 offset:22528
    ds_read_b64_tr_b16 a[22:23], v213 offset:23040
    v_mfma_f32_32x32x16_bf16 v[144:159], a[4:7], v[100:103], v[144:159]
    v_cvt_pk_bf16_f32 v187, v166, v167
    s_waitcnt lgkmcnt(4)
    ds_read_b64_tr_b16 a[0:1], v213 offset:24576
    ds_read_b64_tr_b16 a[2:3], v213 offset:25088
    v_mfma_f32_32x32x16_bf16 v[144:159], a[8:11], v[104:107], v[144:159]
    v_cvt_pk_bf16_f32 v188, v168, v169
    s_add_u32 m0, s43, 81920
    s_add_u32 s101, s45, 3244032
    buffer_load_dwordx4 v220, s[20:23], s101 offen  lds
    ds_read_b64_tr_b16 a[4:5], v213 offset:26624
    ds_read_b64_tr_b16 a[6:7], v213 offset:27136
    v_mfma_f32_32x32x16_bf16 v[144:159], a[12:15], v[108:111], v[144:159]
    v_cvt_pk_bf16_f32 v189, v170, v171
    s_waitcnt lgkmcnt(4)
    ds_read_b64_tr_b16 a[8:9], v213 offset:28672
    ds_read_b64_tr_b16 a[10:11], v213 offset:29184
    v_mfma_f32_32x32x16_bf16 v[144:159], a[16:19], v[112:115], v[144:159]
    v_cvt_pk_bf16_f32 v190, v172, v173
    ds_read_b64_tr_b16 a[12:13], v213 offset:30720
    ds_read_b64_tr_b16 a[14:15], v213 offset:31232
    v_mfma_f32_32x32x16_bf16 v[144:159], a[20:23], v[116:119], v[144:159]
    v_cvt_pk_bf16_f32 v191, v174, v175
    s_waitcnt lgkmcnt(4)
    ds_read_b64_tr_b16 a[16:17], v213 offset:32768
    ds_read_b64_tr_b16 a[18:19], v213 offset:33280
    v_mfma_f32_32x32x16_bf16 v[144:159], a[0:3], v[120:123], v[144:159]
    s_waitcnt vmcnt(9)
    s_barrier
    s_add_u32 s56, s51, 384
    v_add_u32 v220, s56, v217
    ds_read_b64_tr_b16 a[20:21], v213 offset:34816
    ds_read_b64_tr_b16 a[22:23], v213 offset:35328
    v_mfma_f32_32x32x16_bf16 v[144:159], a[4:7], v[124:127], v[144:159]
    v_pk_max_i16 v184, v184, 0
    s_add_u32 m0, s43, 110592
    s_add_u32 s101, s45, 0
    buffer_load_dwordx4 v220, s[20:23], s101 offen  lds
    s_waitcnt lgkmcnt(4)
    ds_read_b64_tr_b16 a[0:1], v214 offset:0
    ds_read_b64_tr_b16 a[2:3], v214 offset:512
    v_mfma_f32_32x32x16_bf16 v[144:159], a[8:11], v[128:131], v[144:159]
    v_pk_max_i16 v185, v185, 0
    ds_read_b64_tr_b16 a[4:5], v214 offset:2048
    ds_read_b64_tr_b16 a[6:7], v214 offset:2560
    v_mfma_f32_32x32x16_bf16 v[144:159], a[12:15], v[132:135], v[144:159]
    v_pk_max_i16 v186, v186, 0
    s_waitcnt lgkmcnt(4)
    ds_read_b64_tr_b16 a[8:9], v214 offset:4096
    ds_read_b64_tr_b16 a[10:11], v214 offset:4608
    v_mfma_f32_32x32x16_bf16 v[144:159], a[16:19], v[136:139], v[144:159]
    v_pk_max_i16 v187, v187, 0
    s_add_u32 m0, s43, 111616
    s_add_u32 s101, s45, 73728
    buffer_load_dwordx4 v220, s[20:23], s101 offen  lds
    ds_read_b64_tr_b16 a[12:13], v214 offset:6144
    ds_read_b64_tr_b16 a[14:15], v214 offset:6656
    v_mfma_f32_32x32x16_bf16 v[144:159], a[20:23], v[140:143], v[144:159]
    v_pk_max_i16 v188, v188, 0
    s_waitcnt lgkmcnt(4)
    ds_read_b64_tr_b16 a[16:17], v214 offset:8192
    ds_read_b64_tr_b16 a[18:19], v214 offset:8704
    v_mfma_f32_32x32x16_bf16 v[160:175], a[0:3], v[0:3], 0
    v_pk_max_i16 v189, v189, 0
    ds_read_b64_tr_b16 a[20:21], v214 offset:10240
    ds_read_b64_tr_b16 a[22:23], v214 offset:10752
    v_mfma_f32_32x32x16_bf16 v[160:175], a[4:7], v[4:7], v[160:175]
    v_pk_max_i16 v190, v190, 0
    s_waitcnt lgkmcnt(4)
    ds_read_b64_tr_b16 a[0:1], v214 offset:12288
    ds_read_b64_tr_b16 a[2:3], v214 offset:12800
    v_mfma_f32_32x32x16_bf16 v[160:175], a[8:11], v[8:11], v[160:175]
    v_pk_max_i16 v191, v191, 0
    s_add_u32 m0, s43, 112640
    s_add_u32 s101, s45, 147456
    buffer_load_dwordx4 v220, s[20:23], s101 offen  lds
    ds_read_b64_tr_b16 a[4:5], v214 offset:14336
    ds_read_b64_tr_b16 a[6:7], v214 offset:14848
    v_mfma_f32_32x32x16_bf16 v[160:175], a[12:15], v[12:15], v[160:175]
    v_cvt_pk_bf16_f32 v176, v144, v145
    s_waitcnt lgkmcnt(4)
    ds_read_b64_tr_b16 a[8:9], v214 offset:16384
    ds_read_b64_tr_b16 a[10:11], v214 offset:16896
    v_mfma_f32_32x32x16_bf16 v[160:175], a[16:19], v[16:19], v[160:175]
    v_cvt_pk_bf16_f32 v177, v146, v147
    ds_read_b64_tr_b16 a[12:13], v214 offset:18432
    ds_read_b64_tr_b16 a[14:15], v214 offset:18944
    v_mfma_f32_32x32x16_bf16 v[160:175], a[20:23], v[20:23], v[160:175]
    v_cvt_pk_bf16_f32 v178, v148, v149
    s_waitcnt lgkmcnt(4)
    ds_read_b64_tr_b16 a[16:17], v214 offset:20480
    ds_read_b64_tr_b16 a[18:19], v214 offset:20992
    v_mfma_f32_32x32x16_bf16 v[160:175], a[0:3], v[24:27], v[160:175]
    v_cvt_pk_bf16_f32 v179, v150, v151
    s_add_u32 m0, s43, 113664
    s_add_u32 s101, s45, 221184
    buffer_load_dwordx4 v220, s[20:23], s101 offen  lds
    ds_read_b64_tr_b16 a[20:21], v214 offset:22528
    ds_read_b64_tr_b16 a[22:23], v214 offset:23040
    v_mfma_f32_32x32x16_bf16 v[160:175], a[4:7], v[28:31], v[160:175]
    v_cvt_pk_bf16_f32 v180, v152, v153
    s_waitcnt lgkmcnt(4)
    ds_read_b64_tr_b16 a[0:1], v214 offset:24576
    ds_read_b64_tr_b16 a[2:3], v214 offset:25088
    v_mfma_f32_32x32x16_bf16 v[160:175], a[8:11], v[32:35], v[160:175]
    v_cvt_pk_bf16_f32 v181, v154, v155
    ds_read_b64_tr_b16 a[4:5], v214 offset:26624
    ds_read_b64_tr_b16 a[6:7], v214 offset:27136
    v_mfma_f32_32x32x16_bf16 v[160:175], a[12:15], v[36:39], v[160:175]
    v_cvt_pk_bf16_f32 v182, v156, v157
    s_waitcnt lgkmcnt(4)
    ds_read_b64_tr_b16 a[8:9], v214 offset:28672
    ds_read_b64_tr_b16 a[10:11], v214 offset:29184
    v_mfma_f32_32x32x16_bf16 v[160:175], a[16:19], v[40:43], v[160:175]
    v_cvt_pk_bf16_f32 v183, v158, v159
    s_add_u32 m0, s43, 114688
    s_add_u32 s101, s45, 294912
    buffer_load_dwordx4 v220, s[20:23], s101 offen  lds
    ds_read_b64_tr_b16 a[12:13], v214 offset:30720
    ds_read_b64_tr_b16 a[14:15], v214 offset:31232
    v_mfma_f32_32x32x16_bf16 v[160:175], a[20:23], v[44:47], v[160:175]
    v_accvgpr_write_b32 a40, v184
    s_waitcnt lgkmcnt(4)
    ds_read_b64_tr_b16 a[16:17], v214 offset:32768
    ds_read_b64_tr_b16 a[18:19], v214 offset:33280
    v_mfma_f32_32x32x16_bf16 v[160:175], a[0:3], v[48:51], v[160:175]
    v_accvgpr_write_b32 a41, v185
    ds_read_b64_tr_b16 a[20:21], v214 offset:34816
    ds_read_b64_tr_b16 a[22:23], v214 offset:35328
    v_mfma_f32_32x32x16_bf16 v[160:175], a[4:7], v[52:55], v[160:175]
    v_accvgpr_write_b32 a42, v186
    s_waitcnt lgkmcnt(4)
    ds_read_b64_tr_b16 a[0:1], v215 offset:0
    ds_read_b64_tr_b16 a[2:3], v215 offset:512
    v_mfma_f32_32x32x16_bf16 v[160:175], a[8:11], v[56:59], v[160:175]
    v_accvgpr_write_b32 a43, v187
    s_add_u32 m0, s43, 115712
    s_add_u32 s101, s45, 368640
    buffer_load_dwordx4 v220, s[20:23], s101 offen  lds
    ds_read_b64_tr_b16 a[4:5], v215 offset:2048
    ds_read_b64_tr_b16 a[6:7], v215 offset:2560
    v_mfma_f32_32x32x16_bf16 v[160:175], a[12:15], v[60:63], v[160:175]
    v_accvgpr_write_b32 a44, v188
    s_waitcnt lgkmcnt(4)
    ds_read_b64_tr_b16 a[8:9], v215 offset:4096
    ds_read_b64_tr_b16 a[10:11], v215 offset:4608
    v_mfma_f32_32x32x16_bf16 v[160:175], a[16:19], v[64:67], v[160:175]
    v_accvgpr_write_b32 a45, v189
    ds_read_b64_tr_b16 a[12:13], v215 offset:6144
    ds_read_b64_tr_b16 a[14:15], v215 offset:6656
    v_mfma_f32_32x32x16_bf16 v[160:175], a[20:23], v[68:71], v[160:175]
    v_accvgpr_write_b32 a46, v190
    s_waitcnt lgkmcnt(4)
    ds_read_b64_tr_b16 a[16:17], v215 offset:8192
    ds_read_b64_tr_b16 a[18:19], v215 offset:8704
    v_mfma_f32_32x32x16_bf16 v[144:159], a[0:3], v[0:3], 0
    v_accvgpr_write_b32 a47, v191
    s_add_u32 m0, s43, 116736
    s_add_u32 s101, s45, 442368
    buffer_load_dwordx4 v220, s[20:23], s101 offen  lds
    ds_read_b64_tr_b16 a[20:21], v215 offset:10240
    ds_read_b64_tr_b16 a[22:23], v215 offset:10752
    v_mfma_f32_32x32x16_bf16 v[144:159], a[4:7], v[4:7], v[144:159]
    v_pk_max_i16 v176, v176, 0
    s_waitcnt lgkmcnt(4)
    ds_read_b64_tr_b16 a[0:1], v215 offset:12288
    ds_read_b64_tr_b16 a[2:3], v215 offset:12800
    v_mfma_f32_32x32x16_bf16 v[144:159], a[8:11], v[8:11], v[144:159]
    v_lshlrev_b32 v252, 2, v255
    v_add_u32 v252, 47923200, v252
    buffer_load_dword v233, v252, s[8:11], 0 offen offset:0 sc1
    buffer_load_dword v234, v252, s[8:11], 0 offen offset:256 sc1
    buffer_load_dword v235, v252, s[8:11], 0 offen offset:512 sc1
    buffer_load_dword v236, v252, s[8:11], 0 offen offset:768 sc1
    v_add_u32 v212, 73728, v208
    ds_read_b64_tr_b16 a[4:5], v215 offset:14336
    ds_read_b64_tr_b16 a[6:7], v215 offset:14848
    v_mfma_f32_32x32x16_bf16 v[144:159], a[12:15], v[12:15], v[144:159]
    v_xor_b32 v213, 64, v212
    s_waitcnt lgkmcnt(4)
    ds_read_b64_tr_b16 a[8:9], v215 offset:16384
    ds_read_b64_tr_b16 a[10:11], v215 offset:16896
    v_mfma_f32_32x32x16_bf16 v[144:159], a[16:19], v[16:19], v[144:159]
    v_pk_max_i16 v177, v177, 0
    s_add_u32 m0, s43, 117760
    s_add_u32 s101, s45, 516096
    buffer_load_dwordx4 v220, s[20:23], s101 offen  lds
    ds_read_b64_tr_b16 a[12:13], v215 offset:18432
    ds_read_b64_tr_b16 a[14:15], v215 offset:18944
    v_mfma_f32_32x32x16_bf16 v[144:159], a[20:23], v[20:23], v[144:159]
    v_pk_max_i16 v178, v178, 0
    s_waitcnt lgkmcnt(4)
    ds_read_b64_tr_b16 a[16:17], v215 offset:20480
    ds_read_b64_tr_b16 a[18:19], v215 offset:20992
    v_mfma_f32_32x32x16_bf16 v[144:159], a[0:3], v[24:27], v[144:159]
    v_pk_max_i16 v179, v179, 0
    ds_read_b64_tr_b16 a[20:21], v215 offset:22528
    ds_read_b64_tr_b16 a[22:23], v215 offset:23040
    v_mfma_f32_32x32x16_bf16 v[144:159], a[4:7], v[28:31], v[144:159]
    v_pk_max_i16 v180, v180, 0
    s_waitcnt lgkmcnt(4)
    ds_read_b64_tr_b16 a[0:1], v215 offset:24576
    ds_read_b64_tr_b16 a[2:3], v215 offset:25088
    v_mfma_f32_32x32x16_bf16 v[144:159], a[8:11], v[32:35], v[144:159]
    v_pk_max_i16 v181, v181, 0
    s_add_u32 m0, s43, 118784
    s_add_u32 s101, s45, 589824
    buffer_load_dwordx4 v220, s[20:23], s101 offen  lds
    ds_read_b64_tr_b16 a[4:5], v215 offset:26624
    ds_read_b64_tr_b16 a[6:7], v215 offset:27136
    v_mfma_f32_32x32x16_bf16 v[144:159], a[12:15], v[36:39], v[144:159]
    v_pk_max_i16 v182, v182, 0
    s_waitcnt lgkmcnt(4)
    ds_read_b64_tr_b16 a[8:9], v215 offset:28672
    ds_read_b64_tr_b16 a[10:11], v215 offset:29184
    v_mfma_f32_32x32x16_bf16 v[144:159], a[16:19], v[40:43], v[144:159]
    v_pk_max_i16 v183, v183, 0
    ds_read_b64_tr_b16 a[12:13], v215 offset:30720
    ds_read_b64_tr_b16 a[14:15], v215 offset:31232
    v_mfma_f32_32x32x16_bf16 v[144:159], a[20:23], v[44:47], v[144:159]
    v_accvgpr_write_b32 a48, v176
    s_waitcnt lgkmcnt(4)
    ds_read_b64_tr_b16 a[16:17], v215 offset:32768
    ds_read_b64_tr_b16 a[18:19], v215 offset:33280
    v_mfma_f32_32x32x16_bf16 v[144:159], a[0:3], v[48:51], v[144:159]
    s_waitcnt vmcnt(13)
    s_barrier
    s_add_u32 s56, s51, 384
    v_add_u32 v220, s56, v217
    ds_read_b64_tr_b16 a[20:21], v215 offset:34816
    ds_read_b64_tr_b16 a[22:23], v215 offset:35328
    v_mfma_f32_32x32x16_bf16 v[144:159], a[4:7], v[52:55], v[144:159]
    v_accvgpr_write_b32 a49, v177
    s_add_u32 m0, s43, 0
    s_add_u32 s101, s45, 2654208
    buffer_load_dwordx4 v220, s[20:23], s101 offen  lds
    s_waitcnt lgkmcnt(4)
    ds_read_b64_tr_b16 a[0:1], v212 offset:0
    ds_read_b64_tr_b16 a[2:3], v212 offset:512
    v_mfma_f32_32x32x16_bf16 v[144:159], a[8:11], v[56:59], v[144:159]
    v_accvgpr_write_b32 a50, v178
    ds_read_b64_tr_b16 a[4:5], v212 offset:2048
    ds_read_b64_tr_b16 a[6:7], v212 offset:2560
    v_mfma_f32_32x32x16_bf16 v[144:159], a[12:15], v[60:63], v[144:159]
    v_accvgpr_write_b32 a51, v179
    s_waitcnt lgkmcnt(4)
    ds_read_b64_tr_b16 a[8:9], v212 offset:4096
    ds_read_b64_tr_b16 a[10:11], v212 offset:4608
    v_mfma_f32_32x32x16_bf16 v[144:159], a[16:19], v[64:67], v[144:159]
    v_accvgpr_write_b32 a52, v180
    s_add_u32 m0, s43, 1024
    s_add_u32 s101, s45, 2727936
    buffer_load_dwordx4 v220, s[20:23], s101 offen  lds
    ds_read_b64_tr_b16 a[12:13], v212 offset:6144
    ds_read_b64_tr_b16 a[14:15], v212 offset:6656
    v_mfma_f32_32x32x16_bf16 v[144:159], a[20:23], v[68:71], v[144:159]
    v_accvgpr_write_b32 a53, v181
    s_waitcnt lgkmcnt(4)
    ds_read_b64_tr_b16 a[16:17], v212 offset:8192
    ds_read_b64_tr_b16 a[18:19], v212 offset:8704
    v_mfma_f32_32x32x16_bf16 v[160:175], a[0:3], v[72:75], v[160:175]
    v_accvgpr_write_b32 a54, v182
    ds_read_b64_tr_b16 a[20:21], v212 offset:10240
    ds_read_b64_tr_b16 a[22:23], v212 offset:10752
    v_mfma_f32_32x32x16_bf16 v[160:175], a[4:7], v[76:79], v[160:175]
    v_accvgpr_write_b32 a55, v183
    s_waitcnt lgkmcnt(4)
    ds_read_b64_tr_b16 a[0:1], v212 offset:12288
    ds_read_b64_tr_b16 a[2:3], v212 offset:12800
    v_mfma_f32_32x32x16_bf16 v[160:175], a[8:11], v[80:83], v[160:175]
    s_add_u32 m0, s43, 2048
    s_add_u32 s101, s45, 2801664
    buffer_load_dwordx4 v220, s[20:23], s101 offen  lds
    ds_read_b64_tr_b16 a[4:5], v212 offset:14336
    ds_read_b64_tr_b16 a[6:7], v212 offset:14848
    v_mfma_f32_32x32x16_bf16 v[160:175], a[12:15], v[84:87], v[160:175]
    s_waitcnt lgkmcnt(4)
    ds_read_b64_tr_b16 a[8:9], v212 offset:16384
    ds_read_b64_tr_b16 a[10:11], v212 offset:16896
    v_mfma_f32_32x32x16_bf16 v[160:175], a[16:19], v[88:91], v[160:175]
    ds_read_b64_tr_b16 a[12:13], v212 offset:18432
    ds_read_b64_tr_b16 a[14:15], v212 offset:18944
    v_mfma_f32_32x32x16_bf16 v[160:175], a[20:23], v[92:95], v[160:175]
    s_waitcnt lgkmcnt(4)
    ds_read_b64_tr_b16 a[16:17], v212 offset:20480
    ds_read_b64_tr_b16 a[18:19], v212 offset:20992
    v_mfma_f32_32x32x16_bf16 v[160:175], a[0:3], v[96:99], v[160:175]
    s_add_u32 m0, s43, 3072
    s_add_u32 s101, s45, 2875392
    buffer_load_dwordx4 v220, s[20:23], s101 offen  lds
    ds_read_b64_tr_b16 a[20:21], v212 offset:22528
    ds_read_b64_tr_b16 a[22:23], v212 offset:23040
    v_mfma_f32_32x32x16_bf16 v[160:175], a[4:7], v[100:103], v[160:175]
    s_waitcnt lgkmcnt(4)
    ds_read_b64_tr_b16 a[0:1], v212 offset:24576
    ds_read_b64_tr_b16 a[2:3], v212 offset:25088
    v_mfma_f32_32x32x16_bf16 v[160:175], a[8:11], v[104:107], v[160:175]
    ds_read_b64_tr_b16 a[4:5], v212 offset:26624
    ds_read_b64_tr_b16 a[6:7], v212 offset:27136
    v_mfma_f32_32x32x16_bf16 v[160:175], a[12:15], v[108:111], v[160:175]
    s_waitcnt lgkmcnt(4)
    ds_read_b64_tr_b16 a[8:9], v212 offset:28672
    ds_read_b64_tr_b16 a[10:11], v212 offset:29184
    v_mfma_f32_32x32x16_bf16 v[160:175], a[16:19], v[112:115], v[160:175]
    s_add_u32 m0, s43, 4096
    s_add_u32 s101, s45, 2949120
    buffer_load_dwordx4 v220, s[20:23], s101 offen  lds
    ds_read_b64_tr_b16 a[12:13], v212 offset:30720
    ds_read_b64_tr_b16 a[14:15], v212 offset:31232
    v_mfma_f32_32x32x16_bf16 v[160:175], a[20:23], v[116:119], v[160:175]
    s_waitcnt lgkmcnt(4)
    ds_read_b64_tr_b16 a[16:17], v212 offset:32768
    ds_read_b64_tr_b16 a[18:19], v212 offset:33280
    v_mfma_f32_32x32x16_bf16 v[160:175], a[0:3], v[120:123], v[160:175]
    ds_read_b64_tr_b16 a[20:21], v212 offset:34816
    ds_read_b64_tr_b16 a[22:23], v212 offset:35328
    v_mfma_f32_32x32x16_bf16 v[160:175], a[4:7], v[124:127], v[160:175]
    s_waitcnt lgkmcnt(4)
    ds_read_b64_tr_b16 a[0:1], v213 offset:0
    ds_read_b64_tr_b16 a[2:3], v213 offset:512
    v_mfma_f32_32x32x16_bf16 v[160:175], a[8:11], v[128:131], v[160:175]
    s_add_u32 m0, s43, 5120
    s_add_u32 s101, s45, 3022848
    buffer_load_dwordx4 v220, s[20:23], s101 offen  lds
    ds_read_b64_tr_b16 a[4:5], v213 offset:2048
    ds_read_b64_tr_b16 a[6:7], v213 offset:2560
    v_mfma_f32_32x32x16_bf16 v[160:175], a[12:15], v[132:135], v[160:175]
    s_waitcnt lgkmcnt(4)
    ds_read_b64_tr_b16 a[8:9], v213 offset:4096
    ds_read_b64_tr_b16 a[10:11], v213 offset:4608
    v_mfma_f32_32x32x16_bf16 v[160:175], a[16:19], v[136:139], v[160:175]
    ds_read_b64_tr_b16 a[12:13], v213 offset:6144
    ds_read_b64_tr_b16 a[14:15], v213 offset:6656
    v_mfma_f32_32x32x16_bf16 v[160:175], a[20:23], v[140:143], v[160:175]
    s_waitcnt lgkmcnt(4)
    ds_read_b64_tr_b16 a[16:17], v213 offset:8192
    ds_read_b64_tr_b16 a[18:19], v213 offset:8704
    v_mfma_f32_32x32x16_bf16 v[144:159], a[0:3], v[72:75], v[144:159]
    s_add_u32 m0, s43, 6144
    s_add_u32 s101, s45, 3096576
    buffer_load_dwordx4 v220, s[20:23], s101 offen  lds
    ds_read_b64_tr_b16 a[20:21], v213 offset:10240
    ds_read_b64_tr_b16 a[22:23], v213 offset:10752
    v_mfma_f32_32x32x16_bf16 v[144:159], a[4:7], v[76:79], v[144:159]
    s_waitcnt lgkmcnt(4)
    ds_read_b64_tr_b16 a[0:1], v213 offset:12288
    ds_read_b64_tr_b16 a[2:3], v213 offset:12800
    v_mfma_f32_32x32x16_bf16 v[144:159], a[8:11], v[80:83], v[144:159]
    v_add_u32 v214, 110592, v208
    ds_read_b64_tr_b16 a[4:5], v213 offset:14336
    ds_read_b64_tr_b16 a[6:7], v213 offset:14848
    v_mfma_f32_32x32x16_bf16 v[144:159], a[12:15], v[84:87], v[144:159]
    v_xor_b32 v215, 64, v214
    s_waitcnt lgkmcnt(4)
    ds_read_b64_tr_b16 a[8:9], v213 offset:16384
    ds_read_b64_tr_b16 a[10:11], v213 offset:16896
    v_mfma_f32_32x32x16_bf16 v[144:159], a[16:19], v[88:91], v[144:159]
    v_cvt_pk_bf16_f32 v184, v160, v161
    s_add_u32 m0, s43, 7168
    s_add_u32 s101, s45, 3170304
    buffer_load_dwordx4 v220, s[20:23], s101 offen  lds
    ds_read_b64_tr_b16 a[12:13], v213 offset:18432
    ds_read_b64_tr_b16 a[14:15], v213 offset:18944
    v_mfma_f32_32x32x16_bf16 v[144:159], a[20:23], v[92:95], v[144:159]
    v_cvt_pk_bf16_f32 v185, v162, v163
    s_waitcnt lgkmcnt(4)
    ds_read_b64_tr_b16 a[16:17], v213 offset:20480
    ds_read_b64_tr_b16 a[18:19], v213 offset:20992
    v_mfma_f32_32x32x16_bf16 v[144:159], a[0:3], v[96:99], v[144:159]
    v_cvt_pk_bf16_f32 v186, v164, v165
    ds_read_b64_tr_b16 a[20:21], v213 offset:22528
    ds_read_b64_tr_b16 a[22:23], v213 offset:23040
    v_mfma_f32_32x32x16_bf16 v[144:159], a[4:7], v[100:103], v[144:159]
    v_cvt_pk_bf16_f32 v187, v166, v167
    s_waitcnt lgkmcnt(4)
    ds_read_b64_tr_b16 a[0:1], v213 offset:24576
    ds_read_b64_tr_b16 a[2:3], v213 offset:25088
    v_mfma_f32_32x32x16_bf16 v[144:159], a[8:11], v[104:107], v[144:159]
    v_cvt_pk_bf16_f32 v188, v168, v169
    s_add_u32 m0, s43, 8192
    s_add_u32 s101, s45, 3244032
    buffer_load_dwordx4 v220, s[20:23], s101 offen  lds
    ds_read_b64_tr_b16 a[4:5], v213 offset:26624
    ds_read_b64_tr_b16 a[6:7], v213 offset:27136
    v_mfma_f32_32x32x16_bf16 v[144:159], a[12:15], v[108:111], v[144:159]
    v_cvt_pk_bf16_f32 v189, v170, v171
    s_waitcnt lgkmcnt(4)
    ds_read_b64_tr_b16 a[8:9], v213 offset:28672
    ds_read_b64_tr_b16 a[10:11], v213 offset:29184
    v_mfma_f32_32x32x16_bf16 v[144:159], a[16:19], v[112:115], v[144:159]
    v_cvt_pk_bf16_f32 v190, v172, v173
    ds_read_b64_tr_b16 a[12:13], v213 offset:30720
    ds_read_b64_tr_b16 a[14:15], v213 offset:31232
    v_mfma_f32_32x32x16_bf16 v[144:159], a[20:23], v[116:119], v[144:159]
    v_cvt_pk_bf16_f32 v191, v174, v175
    s_waitcnt lgkmcnt(4)
    ds_read_b64_tr_b16 a[16:17], v213 offset:32768
    ds_read_b64_tr_b16 a[18:19], v213 offset:33280
    v_mfma_f32_32x32x16_bf16 v[144:159], a[0:3], v[120:123], v[144:159]
    s_waitcnt vmcnt(9)
    s_barrier
    v_add_u32 v220, 0, v219
    ds_read_b64_tr_b16 a[20:21], v213 offset:34816
    ds_read_b64_tr_b16 a[22:23], v213 offset:35328
    v_mfma_f32_32x32x16_bf16 v[144:159], a[4:7], v[124:127], v[144:159]
    v_pk_max_i16 v184, v184, 0
    v_cmp_eq_u32 vcc, s78, v233
    v_cmp_eq_u32 s[4:5], s78, v234
    s_and_b64 vcc, vcc, s[4:5]
    v_cmp_eq_u32 s[4:5], s78, v235
    s_and_b64 vcc, vcc, s[4:5]
    v_cmp_eq_u32 s[4:5], s78, v236
    s_and_b64 vcc, vcc, s[4:5]
    s_cmp_eq_u64 vcc, -1
    s_cbranch_scc0 parallel_sum__softmax_full_mha__dense_activation_relu__prompt_kernel_spin_q
parallel_sum__softmax_full_mha__dense_activation_relu__prompt_kernel_spin_q_ret:
    s_add_u32 m0, s43, 36864
    s_add_u32 s101, s47, 0
    buffer_load_dwordx4 v220, s[24:27], s101 offen  lds
    s_waitcnt lgkmcnt(4)
    ds_read_b64_tr_b16 a[0:1], v214 offset:0
    ds_read_b64_tr_b16 a[2:3], v214 offset:512
    v_mfma_f32_32x32x16_bf16 v[144:159], a[8:11], v[128:131], v[144:159]
    v_pk_max_i16 v185, v185, 0
    ds_read_b64_tr_b16 a[4:5], v214 offset:2048
    ds_read_b64_tr_b16 a[6:7], v214 offset:2560
    v_mfma_f32_32x32x16_bf16 v[144:159], a[12:15], v[132:135], v[144:159]
    v_pk_max_i16 v186, v186, 0
    s_waitcnt lgkmcnt(4)
    ds_read_b64_tr_b16 a[8:9], v214 offset:4096
    ds_read_b64_tr_b16 a[10:11], v214 offset:4608
    v_mfma_f32_32x32x16_bf16 v[144:159], a[16:19], v[136:139], v[144:159]
    v_pk_max_i16 v187, v187, 0
    s_add_u32 m0, s43, 37888
    s_add_u32 s101, s47, 9216
    buffer_load_dwordx4 v220, s[24:27], s101 offen  lds
    ds_read_b64_tr_b16 a[12:13], v214 offset:6144
    ds_read_b64_tr_b16 a[14:15], v214 offset:6656
    v_mfma_f32_32x32x16_bf16 v[144:159], a[20:23], v[140:143], v[144:159]
    v_pk_max_i16 v188, v188, 0
    s_waitcnt lgkmcnt(4)
    ds_read_b64_tr_b16 a[16:17], v214 offset:8192
    ds_read_b64_tr_b16 a[18:19], v214 offset:8704
    v_mfma_f32_32x32x16_bf16 v[160:175], a[0:3], v[0:3], 0
    v_pk_max_i16 v189, v189, 0
    ds_read_b64_tr_b16 a[20:21], v214 offset:10240
    ds_read_b64_tr_b16 a[22:23], v214 offset:10752
    v_mfma_f32_32x32x16_bf16 v[160:175], a[4:7], v[4:7], v[160:175]
    v_pk_max_i16 v190, v190, 0
    s_waitcnt lgkmcnt(4)
    ds_read_b64_tr_b16 a[0:1], v214 offset:12288
    ds_read_b64_tr_b16 a[2:3], v214 offset:12800
    v_mfma_f32_32x32x16_bf16 v[160:175], a[8:11], v[8:11], v[160:175]
    v_pk_max_i16 v191, v191, 0
    s_add_u32 m0, s43, 38912
    s_add_u32 s101, s47, 18432
    buffer_load_dwordx4 v220, s[24:27], s101 offen  lds
    ds_read_b64_tr_b16 a[4:5], v214 offset:14336
    ds_read_b64_tr_b16 a[6:7], v214 offset:14848
    v_mfma_f32_32x32x16_bf16 v[160:175], a[12:15], v[12:15], v[160:175]
    v_cvt_pk_bf16_f32 v176, v144, v145
    s_waitcnt lgkmcnt(4)
    ds_read_b64_tr_b16 a[8:9], v214 offset:16384
    ds_read_b64_tr_b16 a[10:11], v214 offset:16896
    v_mfma_f32_32x32x16_bf16 v[160:175], a[16:19], v[16:19], v[160:175]
    v_cvt_pk_bf16_f32 v177, v146, v147
    ds_read_b64_tr_b16 a[12:13], v214 offset:18432
    ds_read_b64_tr_b16 a[14:15], v214 offset:18944
    v_mfma_f32_32x32x16_bf16 v[160:175], a[20:23], v[20:23], v[160:175]
    v_cvt_pk_bf16_f32 v178, v148, v149
    s_waitcnt lgkmcnt(4)
    ds_read_b64_tr_b16 a[16:17], v214 offset:20480
    ds_read_b64_tr_b16 a[18:19], v214 offset:20992
    v_mfma_f32_32x32x16_bf16 v[160:175], a[0:3], v[24:27], v[160:175]
    v_cvt_pk_bf16_f32 v179, v150, v151
    s_add_u32 m0, s43, 39936
    s_add_u32 s101, s47, 27648
    buffer_load_dwordx4 v220, s[24:27], s101 offen  lds
    ds_read_b64_tr_b16 a[20:21], v214 offset:22528
    ds_read_b64_tr_b16 a[22:23], v214 offset:23040
    v_mfma_f32_32x32x16_bf16 v[160:175], a[4:7], v[28:31], v[160:175]
    v_cvt_pk_bf16_f32 v180, v152, v153
    s_waitcnt lgkmcnt(4)
    ds_read_b64_tr_b16 a[0:1], v214 offset:24576
    ds_read_b64_tr_b16 a[2:3], v214 offset:25088
    v_mfma_f32_32x32x16_bf16 v[160:175], a[8:11], v[32:35], v[160:175]
    v_cvt_pk_bf16_f32 v181, v154, v155
    ds_read_b64_tr_b16 a[4:5], v214 offset:26624
    ds_read_b64_tr_b16 a[6:7], v214 offset:27136
    v_mfma_f32_32x32x16_bf16 v[160:175], a[12:15], v[36:39], v[160:175]
    v_cvt_pk_bf16_f32 v182, v156, v157
    s_waitcnt lgkmcnt(4)
    ds_read_b64_tr_b16 a[8:9], v214 offset:28672
    ds_read_b64_tr_b16 a[10:11], v214 offset:29184
    v_mfma_f32_32x32x16_bf16 v[160:175], a[16:19], v[40:43], v[160:175]
    v_cvt_pk_bf16_f32 v183, v158, v159
    s_add_u32 m0, s43, 40960
    s_add_u32 s101, s47, 36864
    buffer_load_dwordx4 v220, s[24:27], s101 offen  lds
    ds_read_b64_tr_b16 a[12:13], v214 offset:30720
    ds_read_b64_tr_b16 a[14:15], v214 offset:31232
    v_mfma_f32_32x32x16_bf16 v[160:175], a[20:23], v[44:47], v[160:175]
    v_accvgpr_write_b32 a56, v184
    s_waitcnt lgkmcnt(4)
    ds_read_b64_tr_b16 a[16:17], v214 offset:32768
    ds_read_b64_tr_b16 a[18:19], v214 offset:33280
    v_mfma_f32_32x32x16_bf16 v[160:175], a[0:3], v[48:51], v[160:175]
    v_accvgpr_write_b32 a57, v185
    ds_read_b64_tr_b16 a[20:21], v214 offset:34816
    ds_read_b64_tr_b16 a[22:23], v214 offset:35328
    v_mfma_f32_32x32x16_bf16 v[160:175], a[4:7], v[52:55], v[160:175]
    v_accvgpr_write_b32 a58, v186
    s_waitcnt lgkmcnt(4)
    ds_read_b64_tr_b16 a[0:1], v215 offset:0
    ds_read_b64_tr_b16 a[2:3], v215 offset:512
    v_mfma_f32_32x32x16_bf16 v[160:175], a[8:11], v[56:59], v[160:175]
    v_accvgpr_write_b32 a59, v187
    s_add_u32 m0, s43, 41984
    s_add_u32 s101, s48, 46080
    buffer_load_dwordx4 v220, s[24:27], s101 offen  lds
    ds_read_b64_tr_b16 a[4:5], v215 offset:2048
    ds_read_b64_tr_b16 a[6:7], v215 offset:2560
    v_mfma_f32_32x32x16_bf16 v[160:175], a[12:15], v[60:63], v[160:175]
    v_accvgpr_write_b32 a60, v188
    s_waitcnt lgkmcnt(4)
    ds_read_b64_tr_b16 a[8:9], v215 offset:4096
    ds_read_b64_tr_b16 a[10:11], v215 offset:4608
    v_mfma_f32_32x32x16_bf16 v[160:175], a[16:19], v[64:67], v[160:175]
    v_accvgpr_write_b32 a61, v189
    ds_read_b64_tr_b16 a[12:13], v215 offset:6144
    ds_read_b64_tr_b16 a[14:15], v215 offset:6656
    v_mfma_f32_32x32x16_bf16 v[160:175], a[20:23], v[68:71], v[160:175]
    v_accvgpr_write_b32 a62, v190
    s_waitcnt lgkmcnt(4)
    ds_read_b64_tr_b16 a[16:17], v215 offset:8192
    ds_read_b64_tr_b16 a[18:19], v215 offset:8704
    v_mfma_f32_32x32x16_bf16 v[144:159], a[0:3], v[0:3], 0
    v_accvgpr_write_b32 a63, v191
    s_add_u32 m0, s43, 43008
    s_add_u32 s101, s48, 55296
    buffer_load_dwordx4 v220, s[24:27], s101 offen  lds
    ds_read_b64_tr_b16 a[20:21], v215 offset:10240
    ds_read_b64_tr_b16 a[22:23], v215 offset:10752
    v_mfma_f32_32x32x16_bf16 v[144:159], a[4:7], v[4:7], v[144:159]
    v_pk_max_i16 v176, v176, 0
    s_waitcnt lgkmcnt(4)
    ds_read_b64_tr_b16 a[0:1], v215 offset:12288
    ds_read_b64_tr_b16 a[2:3], v215 offset:12800
    v_mfma_f32_32x32x16_bf16 v[144:159], a[8:11], v[8:11], v[144:159]
    v_add_u32 v212, 0, v208
    ds_read_b64_tr_b16 a[4:5], v215 offset:14336
    ds_read_b64_tr_b16 a[6:7], v215 offset:14848
    v_mfma_f32_32x32x16_bf16 v[144:159], a[12:15], v[12:15], v[144:159]
    v_xor_b32 v213, 64, v212
    s_waitcnt lgkmcnt(4)
    ds_read_b64_tr_b16 a[8:9], v215 offset:16384
    ds_read_b64_tr_b16 a[10:11], v215 offset:16896
    v_mfma_f32_32x32x16_bf16 v[144:159], a[16:19], v[16:19], v[144:159]
    v_pk_max_i16 v177, v177, 0
    s_add_u32 m0, s43, 44032
    s_add_u32 s101, s48, 64512
    buffer_load_dwordx4 v220, s[24:27], s101 offen  lds
    ds_read_b64_tr_b16 a[12:13], v215 offset:18432
    ds_read_b64_tr_b16 a[14:15], v215 offset:18944
    v_mfma_f32_32x32x16_bf16 v[144:159], a[20:23], v[20:23], v[144:159]
    v_pk_max_i16 v178, v178, 0
    s_waitcnt lgkmcnt(4)
    ds_read_b64_tr_b16 a[16:17], v215 offset:20480
    ds_read_b64_tr_b16 a[18:19], v215 offset:20992
    v_mfma_f32_32x32x16_bf16 v[144:159], a[0:3], v[24:27], v[144:159]
    v_pk_max_i16 v179, v179, 0
    ds_read_b64_tr_b16 a[20:21], v215 offset:22528
    ds_read_b64_tr_b16 a[22:23], v215 offset:23040
    v_mfma_f32_32x32x16_bf16 v[144:159], a[4:7], v[28:31], v[144:159]
    v_pk_max_i16 v180, v180, 0
    s_waitcnt lgkmcnt(4)
    ds_read_b64_tr_b16 a[0:1], v215 offset:24576
    ds_read_b64_tr_b16 a[2:3], v215 offset:25088
    v_mfma_f32_32x32x16_bf16 v[144:159], a[8:11], v[32:35], v[144:159]
    v_pk_max_i16 v181, v181, 0
    s_add_u32 m0, s43, 45056
    s_add_u32 s101, s48, 73728
    buffer_load_dwordx4 v220, s[24:27], s101 offen  lds
    ds_read_b64_tr_b16 a[4:5], v215 offset:26624
    ds_read_b64_tr_b16 a[6:7], v215 offset:27136
    v_mfma_f32_32x32x16_bf16 v[144:159], a[12:15], v[36:39], v[144:159]
    v_pk_max_i16 v182, v182, 0
    s_waitcnt lgkmcnt(4)
    ds_read_b64_tr_b16 a[8:9], v215 offset:28672
    ds_read_b64_tr_b16 a[10:11], v215 offset:29184
    v_mfma_f32_32x32x16_bf16 v[144:159], a[16:19], v[40:43], v[144:159]
    v_pk_max_i16 v183, v183, 0
    ds_read_b64_tr_b16 a[12:13], v215 offset:30720
    ds_read_b64_tr_b16 a[14:15], v215 offset:31232
    v_mfma_f32_32x32x16_bf16 v[144:159], a[20:23], v[44:47], v[144:159]
    v_accvgpr_write_b32 a64, v176
    s_waitcnt lgkmcnt(4)
    ds_read_b64_tr_b16 a[16:17], v215 offset:32768
    ds_read_b64_tr_b16 a[18:19], v215 offset:33280
    v_mfma_f32_32x32x16_bf16 v[144:159], a[0:3], v[48:51], v[144:159]
    s_waitcnt vmcnt(9)
    s_barrier
    v_add_u32 v220, 128, v219
    ds_read_b64_tr_b16 a[20:21], v215 offset:34816
    ds_read_b64_tr_b16 a[22:23], v215 offset:35328
    v_mfma_f32_32x32x16_bf16 v[144:159], a[4:7], v[52:55], v[144:159]
    v_accvgpr_write_b32 a65, v177
    s_add_u32 m0, s43, 73728
    s_add_u32 s101, s47, 0
    buffer_load_dwordx4 v220, s[24:27], s101 offen  lds
    s_waitcnt lgkmcnt(4)
    ds_read_b64_tr_b16 a[0:1], v212 offset:0
    ds_read_b64_tr_b16 a[2:3], v212 offset:512
    v_mfma_f32_32x32x16_bf16 v[144:159], a[8:11], v[56:59], v[144:159]
    v_accvgpr_write_b32 a66, v178
    ds_read_b64_tr_b16 a[4:5], v212 offset:2048
    ds_read_b64_tr_b16 a[6:7], v212 offset:2560
    v_mfma_f32_32x32x16_bf16 v[144:159], a[12:15], v[60:63], v[144:159]
    v_accvgpr_write_b32 a67, v179
    s_waitcnt lgkmcnt(4)
    ds_read_b64_tr_b16 a[8:9], v212 offset:4096
    ds_read_b64_tr_b16 a[10:11], v212 offset:4608
    v_mfma_f32_32x32x16_bf16 v[144:159], a[16:19], v[64:67], v[144:159]
    v_accvgpr_write_b32 a68, v180
    s_add_u32 m0, s43, 74752
    s_add_u32 s101, s47, 9216
    buffer_load_dwordx4 v220, s[24:27], s101 offen  lds
    ds_read_b64_tr_b16 a[12:13], v212 offset:6144
    ds_read_b64_tr_b16 a[14:15], v212 offset:6656
    v_mfma_f32_32x32x16_bf16 v[144:159], a[20:23], v[68:71], v[144:159]
    v_accvgpr_write_b32 a69, v181
    s_waitcnt lgkmcnt(4)
    ds_read_b64_tr_b16 a[16:17], v212 offset:8192
    ds_read_b64_tr_b16 a[18:19], v212 offset:8704
    v_mfma_f32_32x32x16_bf16 v[160:175], a[0:3], v[72:75], v[160:175]
    v_accvgpr_write_b32 a70, v182
    v_and_b32 v30, 31, v255
    ds_read_b64_tr_b16 a[20:21], v212 offset:10240
    ds_read_b64_tr_b16 a[22:23], v212 offset:10752
    v_mfma_f32_32x32x16_bf16 v[160:175], a[4:7], v[76:79], v[160:175]
    v_accvgpr_write_b32 a71, v183
    v_lshrrev_b32 v31, 5, v255
    s_lshl_b32 s77, s71, 2
    s_and_b32 s68, s40, 1
    s_waitcnt lgkmcnt(4)
    ds_read_b64_tr_b16 a[0:1], v212 offset:12288
    ds_read_b64_tr_b16 a[2:3], v212 offset:12800
    v_mfma_f32_32x32x16_bf16 v[160:175], a[8:11], v[80:83], v[160:175]
    v_lshl_add_u32 v24, v30, 3, s77
    v_lshlrev_b32 v26, 15, v31
    s_add_u32 m0, s43, 75776
    s_add_u32 s101, s47, 18432
    buffer_load_dwordx4 v220, s[24:27], s101 offen  lds
    ds_read_b64_tr_b16 a[4:5], v212 offset:14336
    ds_read_b64_tr_b16 a[6:7], v212 offset:14848
    v_mfma_f32_32x32x16_bf16 v[160:175], a[12:15], v[84:87], v[160:175]
    v_lshl_add_u32 v26, v30, 3, v26
    s_mul_i32 s66, s42, 9
    s_mul_i32 s77, s71, 5
    s_add_u32 s66, s66, s77
    s_lshl_b32 s66, s66, 14
    s_add_u32 s66, s66, 2359296
    s_lshl_b32 s77, s68, 13
    s_add_u32 s65, s66, s77
    s_mul_i32 s77, s69, 73728
    s_mul_i32 s76, s68, 36864
    s_add_u32 s77, s77, s76
    s_add_u32 s77, s77, 4718592
    v_mul_u32_u24 v27, 288, v31
    s_waitcnt lgkmcnt(4)
    ds_read_b64_tr_b16 a[8:9], v212 offset:16384
    ds_read_b64_tr_b16 a[10:11], v212 offset:16896
    v_mfma_f32_32x32x16_bf16 v[160:175], a[16:19], v[88:91], v[160:175]
    v_lshl_add_u32 v27, v30, 4, v27
    v_add_u32 v27, s77, v27
    ds_read_b64_tr_b16 a[12:13], v212 offset:18432
    ds_read_b64_tr_b16 a[14:15], v212 offset:18944
    v_mfma_f32_32x32x16_bf16 v[160:175], a[20:23], v[92:95], v[160:175]
    v_cmp_eq_u32 vcc, 18, v30
    v_mov_b32 v31, 47965184
    s_waitcnt lgkmcnt(4)
    ds_read_b64_tr_b16 a[16:17], v212 offset:20480
    ds_read_b64_tr_b16 a[18:19], v212 offset:20992
    v_mfma_f32_32x32x16_bf16 v[160:175], a[0:3], v[96:99], v[160:175]
    v_mov_b32 v28, 47961088
    v_cndmask_b32 v31, v31, v28, vcc
    s_add_u32 m0, s43, 76800
    s_add_u32 s101, s47, 27648
    buffer_load_dwordx4 v220, s[24:27], s101 offen  lds
    ds_read_b64_tr_b16 a[20:21], v212 offset:22528
    ds_read_b64_tr_b16 a[22:23], v212 offset:23040
    v_mfma_f32_32x32x16_bf16 v[160:175], a[4:7], v[100:103], v[160:175]
    v_cmp_gt_u32 vcc, 18, v30
    v_mov_b32 v30, 4608
    s_nop 0
    s_waitcnt lgkmcnt(4)
    ds_read_b64_tr_b16 a[0:1], v212 offset:24576
    ds_read_b64_tr_b16 a[2:3], v212 offset:25088
    v_mfma_f32_32x32x16_bf16 v[160:175], a[8:11], v[104:107], v[160:175]
    v_cndmask_b32 v27, v31, v27, vcc
    v_cndmask_b32 v28, 0, v30, vcc
    ds_read_b64_tr_b16 a[4:5], v212 offset:26624
    ds_read_b64_tr_b16 a[6:7], v212 offset:27136
    v_mfma_f32_32x32x16_bf16 v[160:175], a[12:15], v[108:111], v[160:175]
    v_cmp_gt_u32 s[74:75], 32, v255
    v_mov_b32 v31, 0x3f803f80
    s_waitcnt lgkmcnt(4)
    ds_read_b64_tr_b16 a[8:9], v212 offset:28672
    ds_read_b64_tr_b16 a[10:11], v212 offset:29184
    v_mfma_f32_32x32x16_bf16 v[160:175], a[16:19], v[112:115], v[160:175]
    v_accvgpr_write_b32 a165, v31
    v_accvgpr_write_b32 a181, v31
    s_add_u32 m0, s43, 77824
    s_add_u32 s101, s47, 36864
    buffer_load_dwordx4 v220, s[24:27], s101 offen  lds
    ds_read_b64_tr_b16 a[12:13], v212 offset:30720
    ds_read_b64_tr_b16 a[14:15], v212 offset:31232
    v_mfma_f32_32x32x16_bf16 v[160:175], a[20:23], v[116:119], v[160:175]
    v_accvgpr_write_b32 a197, v31
    v_accvgpr_write_b32 a213, v31
    s_waitcnt lgkmcnt(4)
    ds_read_b64_tr_b16 a[16:17], v212 offset:32768
    ds_read_b64_tr_b16 a[18:19], v212 offset:33280
    v_mfma_f32_32x32x16_bf16 v[160:175], a[0:3], v[120:123], v[160:175]
    v_accvgpr_write_b32 a229, v31
    v_accvgpr_write_b32 a245, v31
    ds_read_b64_tr_b16 a[20:21], v212 offset:34816
    ds_read_b64_tr_b16 a[22:23], v212 offset:35328
    v_mfma_f32_32x32x16_bf16 v[160:175], a[4:7], v[124:127], v[160:175]
    s_waitcnt lgkmcnt(4)
    ds_read_b64_tr_b16 a[0:1], v213 offset:0
    ds_read_b64_tr_b16 a[2:3], v213 offset:512
    v_mfma_f32_32x32x16_bf16 v[160:175], a[8:11], v[128:131], v[160:175]
    s_add_u32 m0, s43, 78848
    s_add_u32 s101, s48, 46080
    buffer_load_dwordx4 v220, s[24:27], s101 offen  lds
    ds_read_b64_tr_b16 a[4:5], v213 offset:2048
    ds_read_b64_tr_b16 a[6:7], v213 offset:2560
    v_mfma_f32_32x32x16_bf16 v[160:175], a[12:15], v[132:135], v[160:175]
    s_waitcnt lgkmcnt(4)
    ds_read_b64_tr_b16 a[8:9], v213 offset:4096
    ds_read_b64_tr_b16 a[10:11], v213 offset:4608
    v_mfma_f32_32x32x16_bf16 v[160:175], a[16:19], v[136:139], v[160:175]
    ds_read_b64_tr_b16 a[12:13], v213 offset:6144
    ds_read_b64_tr_b16 a[14:15], v213 offset:6656
    v_mfma_f32_32x32x16_bf16 v[160:175], a[20:23], v[140:143], v[160:175]
    s_waitcnt lgkmcnt(4)
    ds_read_b64_tr_b16 a[16:17], v213 offset:8192
    ds_read_b64_tr_b16 a[18:19], v213 offset:8704
    v_mfma_f32_32x32x16_bf16 v[144:159], a[0:3], v[72:75], v[144:159]
    s_add_u32 m0, s43, 79872
    s_add_u32 s101, s48, 55296
    buffer_load_dwordx4 v220, s[24:27], s101 offen  lds
    ds_read_b64_tr_b16 a[20:21], v213 offset:10240
    ds_read_b64_tr_b16 a[22:23], v213 offset:10752
    v_mfma_f32_32x32x16_bf16 v[144:159], a[4:7], v[76:79], v[144:159]
    s_waitcnt lgkmcnt(4)
    ds_read_b64_tr_b16 a[0:1], v213 offset:12288
    ds_read_b64_tr_b16 a[2:3], v213 offset:12800
    v_mfma_f32_32x32x16_bf16 v[144:159], a[8:11], v[80:83], v[144:159]
    v_add_u32 v214, 36864, v209
    ds_read_b64_tr_b16 a[4:5], v213 offset:14336
    ds_read_b64_tr_b16 a[6:7], v213 offset:14848
    v_mfma_f32_32x32x16_bf16 v[144:159], a[12:15], v[84:87], v[144:159]
    v_xor_b32 v215, 64, v214
    s_waitcnt lgkmcnt(4)
    ds_read_b64_tr_b16 a[8:9], v213 offset:16384
    ds_read_b64_tr_b16 a[10:11], v213 offset:16896
    v_mfma_f32_32x32x16_bf16 v[144:159], a[16:19], v[88:91], v[144:159]
    v_cvt_pk_bf16_f32 v184, v160, v161
    s_lshl_b32 s64, s41, 10
    s_add_u32 s62, s66, s64
    s_sub_u32 s62, s62, 2359296
    s_add_u32 s63, s62, 16384
    buffer_load_dwordx2 v[0:1], v26, s[8:11], s62 offen offset:0 sc1
    s_add_u32 m0, s43, 80896
    s_add_u32 s101, s48, 64512
    buffer_load_dwordx4 v220, s[24:27], s101 offen  lds
    ds_read_b64_tr_b16 a[12:13], v213 offset:18432
    ds_read_b64_tr_b16 a[14:15], v213 offset:18944
    v_mfma_f32_32x32x16_bf16 v[144:159], a[20:23], v[92:95], v[144:159]
    v_cvt_pk_bf16_f32 v185, v162, v163
    buffer_load_dwordx2 v[2:3], v26, s[8:11], s63 offen offset:0 sc1
    s_waitcnt lgkmcnt(4)
    ds_read_b64_tr_b16 a[16:17], v213 offset:20480
    ds_read_b64_tr_b16 a[18:19], v213 offset:20992
    v_mfma_f32_32x32x16_bf16 v[144:159], a[0:3], v[96:99], v[144:159]
    v_cvt_pk_bf16_f32 v186, v164, v165
    buffer_load_dwordx2 v[4:5], v26, s[8:11], s62 offen offset:256 sc1
    ds_read_b64_tr_b16 a[20:21], v213 offset:22528
    ds_read_b64_tr_b16 a[22:23], v213 offset:23040
    v_mfma_f32_32x32x16_bf16 v[144:159], a[4:7], v[100:103], v[144:159]
    v_cvt_pk_bf16_f32 v187, v166, v167
    buffer_load_dwordx2 v[6:7], v26, s[8:11], s63 offen offset:256 sc1
    s_waitcnt lgkmcnt(4)
    ds_read_b64_tr_b16 a[0:1], v213 offset:24576
    ds_read_b64_tr_b16 a[2:3], v213 offset:25088
    v_mfma_f32_32x32x16_bf16 v[144:159], a[8:11], v[104:107], v[144:159]
    v_cvt_pk_bf16_f32 v188, v168, v169
    buffer_load_dwordx2 v[8:9], v26, s[8:11], s62 offen offset:512 sc1
    s_add_u32 m0, s43, 81920
    s_add_u32 s101, s48, 73728
    buffer_load_dwordx4 v220, s[24:27], s101 offen  lds
    ds_read_b64_tr_b16 a[4:5], v213 offset:26624
    ds_read_b64_tr_b16 a[6:7], v213 offset:27136
    v_mfma_f32_32x32x16_bf16 v[144:159], a[12:15], v[108:111], v[144:159]
    v_cvt_pk_bf16_f32 v189, v170, v171
    buffer_load_dwordx2 v[10:11], v26, s[8:11], s63 offen offset:512 sc1
    s_waitcnt lgkmcnt(4)
    ds_read_b64_tr_b16 a[8:9], v213 offset:28672
    ds_read_b64_tr_b16 a[10:11], v213 offset:29184
    v_mfma_f32_32x32x16_bf16 v[144:159], a[16:19], v[112:115], v[144:159]
    v_cvt_pk_bf16_f32 v190, v172, v173
    buffer_load_dwordx2 v[12:13], v26, s[8:11], s62 offen offset:768 sc1
    ds_read_b64_tr_b16 a[12:13], v213 offset:30720
    ds_read_b64_tr_b16 a[14:15], v213 offset:31232
    v_mfma_f32_32x32x16_bf16 v[144:159], a[20:23], v[116:119], v[144:159]
    v_cvt_pk_bf16_f32 v191, v174, v175
    v_pk_max_i16 v184, v184, 0
    buffer_load_dwordx2 v[14:15], v26, s[8:11], s63 offen offset:768 sc1
    s_mul_i32 s62, s42, 147456
    s_add_u32 s62, s62, s64
    s_add_u32 s62, s62, 65536
    s_waitcnt lgkmcnt(4)
    ds_read_b64_tr_b16 a[16:17], v213 offset:32768
    ds_read_b64_tr_b16 a[18:19], v213 offset:33280
    v_mfma_f32_32x32x16_bf16 v[144:159], a[0:3], v[120:123], v[144:159]
    v_pk_max_i16 v185, v185, 0
    buffer_load_dword v16, v24, s[8:11], s62 offen offset:0 sc1
    s_waitcnt vmcnt(18)
    s_barrier
    v_add_u32 v220, 256, v219
    ds_read_b64_tr_b16 a[20:21], v213 offset:34816
    ds_read_b64_tr_b16 a[22:23], v213 offset:35328
    v_mfma_f32_32x32x16_bf16 v[144:159], a[4:7], v[124:127], v[144:159]
    v_pk_max_i16 v186, v186, 0
    v_pk_max_i16 v187, v187, 0
    buffer_load_dword v18, v24, s[8:11], s62 offen offset:256 sc1
    s_add_u32 m0, s43, 110592
    s_add_u32 s101, s47, 0
    buffer_load_dwordx4 v220, s[24:27], s101 offen  lds
    s_waitcnt lgkmcnt(4)
    ds_read_b64_tr_b16 a[0:1], v214 offset:0
    ds_read_b64_tr_b16 a[2:3], v214 offset:1024
    v_mfma_f32_32x32x16_bf16 v[144:159], a[8:11], v[128:131], v[144:159]
    v_pk_max_i16 v188, v188, 0
    v_pk_max_i16 v189, v189, 0
    buffer_load_dword v20, v24, s[8:11], s62 offen offset:512 sc1
    ds_read_b64_tr_b16 a[4:5], v214 offset:2048
    ds_read_b64_tr_b16 a[6:7], v214 offset:3072
    v_mfma_f32_32x32x16_bf16 v[144:159], a[12:15], v[132:135], v[144:159]
    v_pk_max_i16 v190, v190, 0
    v_pk_max_i16 v191, v191, 0
    buffer_load_dword v22, v24, s[8:11], s62 offen offset:768 sc1
    s_waitcnt lgkmcnt(4)
    ds_read_b64_tr_b16 a[8:9], v214 offset:4096
    ds_read_b64_tr_b16 a[10:11], v214 offset:5120
    v_mfma_f32_32x32x16_bf16 v[144:159], a[16:19], v[136:139], v[144:159]
    v_accvgpr_write_b32 a72, v184
    v_accvgpr_write_b32 a73, v185
    s_add_u32 m0, s43, 111616
    s_add_u32 s101, s47, 9216
    buffer_load_dwordx4 v220, s[24:27], s101 offen  lds
    ds_read_b64_tr_b16 a[12:13], v214 offset:6144
    ds_read_b64_tr_b16 a[14:15], v214 offset:7168
    v_mfma_f32_32x32x16_bf16 v[144:159], a[20:23], v[140:143], v[144:159]
    v_accvgpr_write_b32 a74, v186
    v_accvgpr_write_b32 a75, v187
    s_waitcnt lgkmcnt(4)
    ds_read_b64_tr_b16 a[16:17], v214 offset:8192
    ds_read_b64_tr_b16 a[18:19], v214 offset:9216
    v_mfma_f32_32x32x16_bf16 v[160:175], a[0:3], a[24:27], 0
    v_accvgpr_write_b32 a76, v188
    v_accvgpr_write_b32 a77, v189
    s_add_u32 s63, s66, 16384
    s_mul_i32 s64, s42, 147456
    s_add_u32 s64, s64, 2424832
    buffer_load_dwordx2 v[64:65], v26, s[8:11], s66 offen offset:0 sc1
    ds_read_b64_tr_b16 a[20:21], v214 offset:10240
    ds_read_b64_tr_b16 a[22:23], v214 offset:11264
    v_mfma_f32_32x32x16_bf16 v[160:175], a[4:7], a[28:31], v[160:175]
    v_accvgpr_write_b32 a78, v190
    v_accvgpr_write_b32 a79, v191
    buffer_load_dwordx2 v[66:67], v26, s[8:11], s63 offen offset:0 sc1
    s_waitcnt lgkmcnt(4)
    ds_read_b64_tr_b16 a[0:1], v214 offset:12288
    ds_read_b64_tr_b16 a[2:3], v214 offset:13312
    v_mfma_f32_32x32x16_bf16 v[160:175], a[8:11], a[32:35], v[160:175]
    buffer_load_dword v68, v24, s[8:11], s64 offen offset:0 sc1
    s_add_u32 m0, s43, 112640
    s_add_u32 s101, s47, 18432
    buffer_load_dwordx4 v220, s[24:27], s101 offen  lds
    ds_read_b64_tr_b16 a[4:5], v214 offset:14336
    ds_read_b64_tr_b16 a[6:7], v214 offset:15360
    v_mfma_f32_32x32x16_bf16 v[160:175], a[12:15], a[36:39], v[160:175]
    v_cvt_pk_bf16_f32 v176, v144, v145
    v_cvt_pk_bf16_f32 v177, v146, v147
    v_cvt_pk_bf16_f32 v178, v148, v149
    buffer_load_dwordx2 v[72:73], v26, s[8:11], s66 offen offset:256 sc1
    s_waitcnt lgkmcnt(4)
    ds_read_b64_tr_b16 a[8:9], v214 offset:16384
    ds_read_b64_tr_b16 a[10:11], v214 offset:17408
    v_mfma_f32_32x32x16_bf16 v[160:175], a[16:19], a[40:43], v[160:175]
    v_cvt_pk_bf16_f32 v179, v150, v151
    v_cvt_pk_bf16_f32 v180, v152, v153
    v_cvt_pk_bf16_f32 v181, v154, v155
    buffer_load_dwordx2 v[74:75], v26, s[8:11], s63 offen offset:256 sc1
    ds_read_b64_tr_b16 a[12:13], v214 offset:18432
    ds_read_b64_tr_b16 a[14:15], v214 offset:19456
    v_mfma_f32_32x32x16_bf16 v[160:175], a[20:23], a[44:47], v[160:175]
    v_cvt_pk_bf16_f32 v182, v156, v157
    v_cvt_pk_bf16_f32 v183, v158, v159
    v_pk_max_i16 v176, v176, 0
    buffer_load_dword v76, v24, s[8:11], s64 offen offset:256 sc1
    s_mov_b32 s62, s65
    s_add_u32 s63, s65, 16384
    s_mul_i32 s64, s42, 147456
    s_lshl_b32 s77, s68, 13
    s_add_u32 s64, s64, s77
    s_add_u32 s64, s64, 2424832
    v_mov_b32 v25, v27
    s_waitcnt lgkmcnt(4)
    ds_read_b64_tr_b16 a[16:17], v214 offset:20480
    ds_read_b64_tr_b16 a[18:19], v214 offset:21504
    v_mfma_f32_32x32x16_bf16 v[160:175], a[0:3], a[48:51], v[160:175]
    v_pk_max_i16 v177, v177, 0
    v_pk_max_i16 v178, v178, 0
    v_pk_max_i16 v179, v179, 0
    buffer_load_dwordx2 a[160:161], v26, s[8:11], s62 offen offset:0 sc1
    s_add_u32 m0, s43, 113664
    s_add_u32 s101, s47, 27648
    buffer_load_dwordx4 v220, s[24:27], s101 offen  lds
    ds_read_b64_tr_b16 a[20:21], v214 offset:22528
    ds_read_b64_tr_b16 a[22:23], v214 offset:23552
    v_mfma_f32_32x32x16_bf16 v[160:175], a[4:7], a[52:55], v[160:175]
    v_pk_max_i16 v180, v180, 0
    v_pk_max_i16 v181, v181, 0
    v_pk_max_i16 v182, v182, 0
    buffer_load_dwordx2 a[162:163], v26, s[8:11], s63 offen offset:0 sc1
    s_waitcnt lgkmcnt(4)
    ds_read_b64_tr_b16 a[0:1], v214 offset:24576
    ds_read_b64_tr_b16 a[2:3], v214 offset:25600
    v_mfma_f32_32x32x16_bf16 v[160:175], a[8:11], a[56:59], v[160:175]
    v_pk_max_i16 v183, v183, 0
    v_accvgpr_write_b32 a80, v176
    v_accvgpr_write_b32 a81, v177
    buffer_load_dword a164, v24, s[8:11], s64 offen offset:0 sc1
    ds_read_b64_tr_b16 a[4:5], v214 offset:26624
    ds_read_b64_tr_b16 a[6:7], v214 offset:27648
    v_mfma_f32_32x32x16_bf16 v[160:175], a[12:15], a[60:63], v[160:175]
    v_accvgpr_write_b32 a82, v178
    v_accvgpr_write_b32 a83, v179
    v_accvgpr_write_b32 a84, v180
    buffer_load_dwordx4 a[168:171], v25, s[8:11], 0 offen offset:0 sc1
    s_waitcnt lgkmcnt(4)
    ds_read_b64_tr_b16 a[8:9], v214 offset:32768
    ds_read_b64_tr_b16 a[10:11], v214 offset:33792
    v_mfma_f32_32x32x16_bf16 v[160:175], a[16:19], a[64:67], v[160:175]
    v_accvgpr_write_b32 a85, v181
    v_accvgpr_write_b32 a86, v182
    v_accvgpr_write_b32 a87, v183
    buffer_load_dwordx4 a[172:175], v25, s[8:11], 0 offen offset:576 sc1
    s_add_u32 m0, s43, 114688
    s_add_u32 s101, s47, 36864
    buffer_load_dwordx4 v220, s[24:27], s101 offen  lds
    ds_read_b64_tr_b16 a[12:13], v214 offset:34816
    ds_read_b64_tr_b16 a[14:15], v214 offset:35840
    v_mfma_f32_32x32x16_bf16 v[160:175], a[20:23], a[68:71], v[160:175]
    buffer_load_dwordx2 a[176:177], v26, s[8:11], s62 offen offset:256 sc1
    s_waitcnt lgkmcnt(4)
    ds_read_b64_tr_b16 a[16:17], v214 offset:28672
    ds_read_b64_tr_b16 a[18:19], v214 offset:29696
    v_mfma_f32_32x32x16_bf16 v[160:175], a[0:3], a[72:75], v[160:175]
    buffer_load_dwordx2 a[178:179], v26, s[8:11], s63 offen offset:256 sc1
    ds_read_b64_tr_b16 a[20:21], v214 offset:30720
    ds_read_b64_tr_b16 a[22:23], v214 offset:31744
    v_mfma_f32_32x32x16_bf16 v[160:175], a[4:7], a[76:79], v[160:175]
    buffer_load_dword a180, v24, s[8:11], s64 offen offset:256 sc1
    s_waitcnt lgkmcnt(4)
    ds_read_b64_tr_b16 a[0:1], v215 offset:0
    ds_read_b64_tr_b16 a[2:3], v215 offset:1024
    v_mfma_f32_32x32x16_bf16 v[160:175], a[8:11], a[88:91], v[160:175]
    buffer_load_dwordx4 a[184:187], v25, s[8:11], 0 offen offset:1152 sc1
    s_add_u32 m0, s43, 115712
    s_add_u32 s101, s48, 46080
    buffer_load_dwordx4 v220, s[24:27], s101 offen  lds
    ds_read_b64_tr_b16 a[4:5], v215 offset:2048
    ds_read_b64_tr_b16 a[6:7], v215 offset:3072
    v_mfma_f32_32x32x16_bf16 v[160:175], a[12:15], a[92:95], v[160:175]
    buffer_load_dwordx4 a[188:191], v25, s[8:11], 0 offen offset:1728 sc1
    s_waitcnt lgkmcnt(4)
    ds_read_b64_tr_b16 a[8:9], v215 offset:4096
    ds_read_b64_tr_b16 a[10:11], v215 offset:5120
    v_mfma_f32_32x32x16_bf16 v[160:175], a[16:19], a[80:83], v[160:175]
    ds_read_b64_tr_b16 a[12:13], v215 offset:6144
    ds_read_b64_tr_b16 a[14:15], v215 offset:7168
    v_mfma_f32_32x32x16_bf16 v[160:175], a[20:23], a[84:87], v[160:175]
    s_waitcnt lgkmcnt(4)
    ds_read_b64_tr_b16 a[16:17], v215 offset:8192
    ds_read_b64_tr_b16 a[18:19], v215 offset:9216
    v_mfma_f32_32x32x16_bf16 v[144:159], a[0:3], a[24:27], 0
    s_add_u32 m0, s43, 116736
    s_add_u32 s101, s48, 55296
    buffer_load_dwordx4 v220, s[24:27], s101 offen  lds
    ds_read_b64_tr_b16 a[20:21], v215 offset:10240
    ds_read_b64_tr_b16 a[22:23], v215 offset:11264
    v_mfma_f32_32x32x16_bf16 v[144:159], a[4:7], a[28:31], v[144:159]
    s_waitcnt lgkmcnt(4)
    ds_read_b64_tr_b16 a[0:1], v215 offset:12288
    ds_read_b64_tr_b16 a[2:3], v215 offset:13312
    v_mfma_f32_32x32x16_bf16 v[144:159], a[8:11], a[32:35], v[144:159]
    v_add_u32 v212, 73728, v209
    ds_read_b64_tr_b16 a[4:5], v215 offset:14336
    ds_read_b64_tr_b16 a[6:7], v215 offset:15360
    v_mfma_f32_32x32x16_bf16 v[144:159], a[12:15], a[36:39], v[144:159]
    v_xor_b32 v213, 64, v212
    s_waitcnt lgkmcnt(4)
    ds_read_b64_tr_b16 a[8:9], v215 offset:16384
    ds_read_b64_tr_b16 a[10:11], v215 offset:17408
    v_mfma_f32_32x32x16_bf16 v[144:159], a[16:19], a[40:43], v[144:159]
    v_cvt_pk_bf16_f32 v184, v160, v161
    s_add_u32 m0, s43, 117760
    s_add_u32 s101, s48, 64512
    buffer_load_dwordx4 v220, s[24:27], s101 offen  lds
    ds_read_b64_tr_b16 a[12:13], v215 offset:18432
    ds_read_b64_tr_b16 a[14:15], v215 offset:19456
    v_mfma_f32_32x32x16_bf16 v[144:159], a[20:23], a[44:47], v[144:159]
    v_cvt_pk_bf16_f32 v185, v162, v163
    s_waitcnt lgkmcnt(4)
    ds_read_b64_tr_b16 a[16:17], v215 offset:20480
    ds_read_b64_tr_b16 a[18:19], v215 offset:21504
    v_mfma_f32_32x32x16_bf16 v[144:159], a[0:3], a[48:51], v[144:159]
    v_cvt_pk_bf16_f32 v186, v164, v165
    ds_read_b64_tr_b16 a[20:21], v215 offset:22528
    ds_read_b64_tr_b16 a[22:23], v215 offset:23552
    v_mfma_f32_32x32x16_bf16 v[144:159], a[4:7], a[52:55], v[144:159]
    v_cvt_pk_bf16_f32 v187, v166, v167
    s_add_u32 s79, s55, 0
    buffer_store_dwordx4 v[184:187], v254, s[8:11], s79 offen sc1
    s_waitcnt lgkmcnt(4)
    ds_read_b64_tr_b16 a[0:1], v215 offset:24576
    ds_read_b64_tr_b16 a[2:3], v215 offset:25600
    v_mfma_f32_32x32x16_bf16 v[144:159], a[8:11], a[56:59], v[144:159]
    v_cvt_pk_bf16_f32 v188, v168, v169
    s_add_u32 m0, s43, 118784
    s_add_u32 s101, s48, 73728
    buffer_load_dwordx4 v220, s[24:27], s101 offen  lds
    ds_read_b64_tr_b16 a[4:5], v215 offset:26624
    ds_read_b64_tr_b16 a[6:7], v215 offset:27648
    v_mfma_f32_32x32x16_bf16 v[144:159], a[12:15], a[60:63], v[144:159]
    v_cvt_pk_bf16_f32 v189, v170, v171
    s_waitcnt lgkmcnt(4)
    ds_read_b64_tr_b16 a[8:9], v215 offset:32768
    ds_read_b64_tr_b16 a[10:11], v215 offset:33792
    v_mfma_f32_32x32x16_bf16 v[144:159], a[16:19], a[64:67], v[144:159]
    v_cvt_pk_bf16_f32 v190, v172, v173
    ds_read_b64_tr_b16 a[12:13], v215 offset:34816
    ds_read_b64_tr_b16 a[14:15], v215 offset:35840
    v_mfma_f32_32x32x16_bf16 v[144:159], a[20:23], a[68:71], v[144:159]
    v_cvt_pk_bf16_f32 v191, v174, v175
    s_add_u32 s79, s55, 1048576
    buffer_store_dwordx4 v[188:191], v254, s[8:11], s79 offen sc1
    s_waitcnt lgkmcnt(4)
    ds_read_b64_tr_b16 a[16:17], v215 offset:28672
    ds_read_b64_tr_b16 a[18:19], v215 offset:29696
    v_mfma_f32_32x32x16_bf16 v[144:159], a[0:3], a[72:75], v[144:159]
    s_waitcnt vmcnt(34)
    s_barrier
    v_add_u32 v220, 384, v219
    ds_read_b64_tr_b16 a[20:21], v215 offset:30720
    ds_read_b64_tr_b16 a[22:23], v215 offset:31744
    v_mfma_f32_32x32x16_bf16 v[144:159], a[4:7], a[76:79], v[144:159]
    s_add_u32 m0, s43, 0
    s_add_u32 s101, s47, 0
    buffer_load_dwordx4 v220, s[24:27], s101 offen  lds
    s_waitcnt lgkmcnt(4)
    ds_read_b64_tr_b16 a[0:1], v212 offset:0
    ds_read_b64_tr_b16 a[2:3], v212 offset:1024
    v_mfma_f32_32x32x16_bf16 v[144:159], a[8:11], a[88:91], v[144:159]
    ds_read_b64_tr_b16 a[4:5], v212 offset:2048
    ds_read_b64_tr_b16 a[6:7], v212 offset:3072
    v_mfma_f32_32x32x16_bf16 v[144:159], a[12:15], a[92:95], v[144:159]
    s_waitcnt lgkmcnt(4)
    ds_read_b64_tr_b16 a[8:9], v212 offset:4096
    ds_read_b64_tr_b16 a[10:11], v212 offset:5120
    v_mfma_f32_32x32x16_bf16 v[144:159], a[16:19], a[80:83], v[144:159]
    s_add_u32 m0, s43, 1024
    s_add_u32 s101, s47, 9216
    buffer_load_dwordx4 v220, s[24:27], s101 offen  lds
    ds_read_b64_tr_b16 a[12:13], v212 offset:6144
    ds_read_b64_tr_b16 a[14:15], v212 offset:7168
    v_mfma_f32_32x32x16_bf16 v[144:159], a[20:23], a[84:87], v[144:159]
    v_mov_b32 v117, s78
    s_waitcnt vmcnt(14)
    s_mov_b32 s67, 0x42c00000
    v_cndmask_b32 v16, 0, v16, s[74:75]
    v_mov_b32 v17, 0
    v_cndmask_b32 v18, 0, v18, s[74:75]
    v_mov_b32 v19, 0
    v_cndmask_b32 v20, 0, v20, s[74:75]
    v_mov_b32 v21, 0
    v_cndmask_b32 v22, 0, v22, s[74:75]
    v_mov_b32 v23, 0
    v_mov_b32 v69, 0x3f803f80
    v_mov_b32 v77, 0x3f803f80
    s_nop 1
    v_mfma_f32_32x32x16_bf16 v[32:47], v[64:67], v[0:3], 0
    v_mfma_f32_32x32x8bf16_1k v[32:47], v[68:69], v[16:17], v[32:47]
    v_mfma_f32_32x32x16_bf16 v[48:63], v[64:67], v[4:7], 0
    v_mfma_f32_32x32x8bf16_1k v[48:63], v[68:69], v[18:19], v[48:63]
    s_nop 10
    v_max3_f32 v80, v32, v33, v34
    v_max_f32 v80, v80, v35
    v_max3_f32 v80, v80, v36, v37
    v_max3_f32 v80, v80, v38, v39
    v_max3_f32 v80, v80, v40, v41
    v_max3_f32 v80, v80, v42, v43
    v_max3_f32 v80, v80, v44, v45
    v_max3_f32 v80, v80, v46, v47
    v_mfma_f32_32x32x16_bf16 v[32:47], v[64:67], v[8:11], 0
    v_mfma_f32_32x32x8bf16_1k v[32:47], v[68:69], v[20:21], v[32:47]
    s_nop 1
    v_max3_f32 v81, v48, v49, v50
    v_max_f32 v81, v81, v51
    v_max3_f32 v81, v81, v52, v53
    v_max3_f32 v81, v81, v54, v55
    v_max3_f32 v81, v81, v56, v57
    v_max3_f32 v81, v81, v58, v59
    v_max3_f32 v81, v81, v60, v61
    v_max3_f32 v81, v81, v62, v63
    v_mfma_f32_32x32x16_bf16 v[48:63], v[64:67], v[12:15], 0
    v_mfma_f32_32x32x8bf16_1k v[48:63], v[68:69], v[22:23], v[48:63]
    s_nop 1
    v_max3_f32 v82, v32, v33, v34
    v_max_f32 v82, v82, v35
    v_max3_f32 v82, v82, v36, v37
    v_max3_f32 v82, v82, v38, v39
    v_max3_f32 v82, v82, v40, v41
    v_max3_f32 v82, v82, v42, v43
    v_max3_f32 v82, v82, v44, v45
    v_max3_f32 v82, v82, v46, v47
    v_mfma_f32_32x32x16_bf16 v[32:47], v[72:75], v[0:3], 0
    v_mfma_f32_32x32x8bf16_1k v[32:47], v[76:77], v[16:17], v[32:47]
    s_nop 1
    v_max3_f32 v83, v48, v49, v50
    v_max_f32 v83, v83, v51
    v_max3_f32 v83, v83, v52, v53
    v_max3_f32 v83, v83, v54, v55
    v_max3_f32 v83, v83, v56, v57
    v_max3_f32 v83, v83, v58, v59
    v_max3_f32 v83, v83, v60, v61
    v_max3_f32 v83, v83, v62, v63
    v_mfma_f32_32x32x16_bf16 v[48:63], v[72:75], v[4:7], 0
    v_mfma_f32_32x32x8bf16_1k v[48:63], v[76:77], v[18:19], v[48:63]
    s_nop 1
    v_max3_f32 v80, v80, v32, v33
    v_max3_f32 v80, v80, v34, v35
    v_max3_f32 v80, v80, v36, v37
    v_max3_f32 v80, v80, v38, v39
    v_max3_f32 v80, v80, v40, v41
    v_max3_f32 v80, v80, v42, v43
    v_max3_f32 v80, v80, v44, v45
    v_max3_f32 v80, v80, v46, v47
    v_mfma_f32_32x32x16_bf16 v[32:47], v[72:75], v[8:11], 0
    v_mfma_f32_32x32x8bf16_1k v[32:47], v[76:77], v[20:21], v[32:47]
    s_nop 1
    v_max3_f32 v81, v81, v48, v49
    v_max3_f32 v81, v81, v50, v51
    v_max3_f32 v81, v81, v52, v53
    v_max3_f32 v81, v81, v54, v55
    v_max3_f32 v81, v81, v56, v57
    v_max3_f32 v81, v81, v58, v59
    v_max3_f32 v81, v81, v60, v61
    v_max3_f32 v81, v81, v62, v63
    v_mfma_f32_32x32x16_bf16 v[48:63], v[72:75], v[12:15], 0
    v_mfma_f32_32x32x8bf16_1k v[48:63], v[76:77], v[22:23], v[48:63]
    s_nop 1
    v_max3_f32 v82, v82, v32, v33
    v_max3_f32 v82, v82, v34, v35
    v_max3_f32 v82, v82, v36, v37
    v_max3_f32 v82, v82, v38, v39
    v_max3_f32 v82, v82, v40, v41
    v_max3_f32 v82, v82, v42, v43
    v_max3_f32 v82, v82, v44, v45
    v_max3_f32 v82, v82, v46, v47
    s_nop 10
    v_max3_f32 v83, v83, v48, v49
    v_max3_f32 v83, v83, v50, v51
    v_max3_f32 v83, v83, v52, v53
    v_max3_f32 v83, v83, v54, v55
    v_max3_f32 v83, v83, v56, v57
    v_max3_f32 v83, v83, v58, v59
    v_max3_f32 v83, v83, v60, v61
    v_max3_f32 v83, v83, v62, v63
    v_mov_b32 v84, v80
    v_mov_b32 v85, v80
    s_nop 1
    v_permlane32_swap_b32 v84, v85
    s_nop 1
    v_max_f32 v80, v84, v85
    v_add_f32 v84, s67, v80
    v_sub_f32 v84, 0, v84
    v_cvt_pk_bf16_f32 v85, v84, v84
    v_lshlrev_b32 v85, 16, v85
    v_sub_f32 v86, v84, v85
    v_cvt_pk_bf16_f32 v84, v85, v86
    v_cndmask_b32 v17, 0, v84, s[74:75]
    v_mov_b32 v84, v81
    v_mov_b32 v85, v81
    s_nop 1
    v_permlane32_swap_b32 v84, v85
    s_nop 1
    v_max_f32 v81, v84, v85
    v_add_f32 v84, s67, v81
    v_sub_f32 v84, 0, v84
    v_cvt_pk_bf16_f32 v85, v84, v84
    v_lshlrev_b32 v85, 16, v85
    v_sub_f32 v86, v84, v85
    v_cvt_pk_bf16_f32 v84, v85, v86
    v_cndmask_b32 v19, 0, v84, s[74:75]
    v_mov_b32 v84, v82
    v_mov_b32 v85, v82
    s_nop 1
    v_permlane32_swap_b32 v84, v85
    s_nop 1
    v_max_f32 v82, v84, v85
    v_add_f32 v84, s67, v82
    v_sub_f32 v84, 0, v84
    v_cvt_pk_bf16_f32 v85, v84, v84
    v_lshlrev_b32 v85, 16, v85
    v_sub_f32 v86, v84, v85
    v_cvt_pk_bf16_f32 v84, v85, v86
    v_cndmask_b32 v21, 0, v84, s[74:75]
    v_mov_b32 v84, v83
    v_mov_b32 v85, v83
    s_nop 1
    v_permlane32_swap_b32 v84, v85
    s_nop 1
    v_max_f32 v83, v84, v85
    v_add_f32 v84, s67, v83
    v_sub_f32 v84, 0, v84
    v_cvt_pk_bf16_f32 v85, v84, v84
    v_lshlrev_b32 v85, 16, v85
    v_sub_f32 v86, v84, v85
    v_cvt_pk_bf16_f32 v84, v85, v86
    v_cndmask_b32 v23, 0, v84, s[74:75]
    s_nop 0
    v_mfma_f32_32x32x16_bf16 v[32:47], a[160:163], v[0:3], 0
    v_mfma_f32_32x32x8bf16_1k v[32:47], a[164:165], v[16:17], v[32:47]
    s_nop 10
    v_mfma_f32_32x32x16_bf16 v[48:63], a[160:163], v[4:7], 0
    v_exp_f32 v32, v32
    v_exp_f32 v33, v33
    v_exp_f32 v34, v34
    v_exp_f32 v35, v35
    buffer_load_dwordx2 a[192:193], v26, s[8:11], s62 offen offset:512 sc1
    buffer_load_dwordx2 a[194:195], v26, s[8:11], s63 offen offset:512 sc1
    buffer_load_dword a196, v24, s[8:11], s64 offen offset:512 sc1
    buffer_load_dwordx4 a[200:203], v25, s[8:11], 0 offen offset:2304 sc1
    v_mfma_f32_32x32x8bf16_1k v[48:63], a[164:165], v[18:19], v[48:63]
    v_exp_f32 v36, v36
    v_exp_f32 v37, v37
    v_cvt_pk_bf16_f32 v64, v32, v33
    v_exp_f32 v38, v38
    v_exp_f32 v39, v39
    v_cvt_pk_bf16_f32 v65, v34, v35
    buffer_load_dwordx4 a[204:207], v25, s[8:11], 0 offen offset:2880 sc1
    buffer_load_dwordx2 a[208:209], v26, s[8:11], s62 offen offset:768 sc1
    buffer_load_dwordx2 a[210:211], v26, s[8:11], s63 offen offset:768 sc1
    buffer_load_dword a212, v24, s[8:11], s64 offen offset:768 sc1
    v_exp_f32 v40, v40
    v_exp_f32 v41, v41
    v_cvt_pk_bf16_f32 v66, v36, v37
    v_exp_f32 v42, v42
    v_exp_f32 v43, v43
    v_cvt_pk_bf16_f32 v67, v38, v39
    buffer_load_dwordx4 a[216:219], v25, s[8:11], 0 offen offset:3456 sc1
    buffer_load_dwordx4 a[220:223], v25, s[8:11], 0 offen offset:4032 sc1
    buffer_load_dwordx2 a[224:225], v26, s[8:11], s62 offen offset:1024 sc1
    buffer_load_dwordx2 a[226:227], v26, s[8:11], s63 offen offset:1024 sc1
    v_exp_f32 v44, v44
    v_exp_f32 v45, v45
    v_cvt_pk_bf16_f32 v68, v40, v41
    v_exp_f32 v46, v46
    v_exp_f32 v47, v47
    v_cvt_pk_bf16_f32 v69, v42, v43
    v_cvt_pk_bf16_f32 v70, v44, v45
    v_cvt_pk_bf16_f32 v71, v46, v47
    buffer_load_dword a228, v24, s[8:11], s64 offen offset:1024 sc1
    v_add_u32 v25, v28, v25
    buffer_load_dwordx4 a[232:235], v25, s[8:11], 0 offen offset:0 sc1
    buffer_load_dwordx4 a[236:239], v25, s[8:11], 0 offen offset:576 sc1
    v_mfma_f32_32x32x16_bf16 v[32:47], a[160:163], v[8:11], 0
    v_exp_f32 v48, v48
    v_exp_f32 v49, v49
    v_exp_f32 v50, v50
    v_exp_f32 v51, v51
    buffer_load_dwordx2 a[240:241], v26, s[8:11], s62 offen offset:1280 sc1
    buffer_load_dwordx2 a[242:243], v26, s[8:11], s63 offen offset:1280 sc1
    v_mfma_f32_32x32x8bf16_1k v[32:47], a[164:165], v[20:21], v[32:47]
    v_exp_f32 v52, v52
    v_exp_f32 v53, v53
    v_cvt_pk_bf16_f32 v72, v48, v49
    v_exp_f32 v54, v54
    v_exp_f32 v55, v55
    v_cvt_pk_bf16_f32 v73, v50, v51
    v_mfma_f32_32x32x16_bf16 a[96:111], a[168:171], v[64:67], 0
    v_exp_f32 v56, v56
    v_exp_f32 v57, v57
    v_cvt_pk_bf16_f32 v74, v52, v53
    v_exp_f32 v58, v58
    v_exp_f32 v59, v59
    v_cvt_pk_bf16_f32 v75, v54, v55
    buffer_load_dword a244, v24, s[8:11], s64 offen offset:1280 sc1
    v_mfma_f32_32x32x16_bf16 a[96:111], a[172:175], v[68:71], a[96:111]
    v_exp_f32 v60, v60
    v_exp_f32 v61, v61
    v_cvt_pk_bf16_f32 v76, v56, v57
    v_exp_f32 v62, v62
    v_exp_f32 v63, v63
    v_cvt_pk_bf16_f32 v77, v58, v59
    v_cvt_pk_bf16_f32 v78, v60, v61
    v_cvt_pk_bf16_f32 v79, v62, v63
    v_mfma_f32_32x32x16_bf16 v[48:63], a[160:163], v[12:15], 0
    v_exp_f32 v32, v32
    v_exp_f32 v33, v33
    v_exp_f32 v34, v34
    v_exp_f32 v35, v35
    v_mfma_f32_32x32x8bf16_1k v[48:63], a[164:165], v[22:23], v[48:63]
    v_exp_f32 v36, v36
    v_exp_f32 v37, v37
    v_cvt_pk_bf16_f32 v64, v32, v33
    v_exp_f32 v38, v38
    v_exp_f32 v39, v39
    v_cvt_pk_bf16_f32 v65, v34, v35
    buffer_load_dwordx4 a[248:251], v25, s[8:11], 0 offen offset:1152 sc1
    buffer_load_dwordx4 a[252:255], v25, s[8:11], 0 offen offset:1728 sc1
    v_mfma_f32_32x32x16_bf16 a[112:127], a[168:171], v[72:75], 0
    v_exp_f32 v40, v40
    v_exp_f32 v41, v41
    v_cvt_pk_bf16_f32 v66, v36, v37
    v_exp_f32 v42, v42
    v_exp_f32 v43, v43
    v_cvt_pk_bf16_f32 v67, v38, v39
    v_mfma_f32_32x32x16_bf16 a[112:127], a[172:175], v[76:79], a[112:127]
    v_exp_f32 v44, v44
    v_exp_f32 v45, v45
    v_cvt_pk_bf16_f32 v68, v40, v41
    v_exp_f32 v46, v46
    v_exp_f32 v47, v47
    v_cvt_pk_bf16_f32 v69, v42, v43
    v_cvt_pk_bf16_f32 v70, v44, v45
    v_cvt_pk_bf16_f32 v71, v46, v47
    s_waitcnt vmcnt(27)
    v_mfma_f32_32x32x16_bf16 v[32:47], a[176:179], v[0:3], 0
    v_exp_f32 v48, v48
    v_exp_f32 v49, v49
    v_exp_f32 v50, v50
    v_exp_f32 v51, v51
    v_mfma_f32_32x32x8bf16_1k v[32:47], a[180:181], v[16:17], v[32:47]
    v_exp_f32 v52, v52
    v_exp_f32 v53, v53
    v_cvt_pk_bf16_f32 v72, v48, v49
    v_exp_f32 v54, v54
    v_exp_f32 v55, v55
    v_cvt_pk_bf16_f32 v73, v50, v51
    v_mfma_f32_32x32x16_bf16 a[128:143], a[168:171], v[64:67], 0
    v_exp_f32 v56, v56
    v_exp_f32 v57, v57
    v_cvt_pk_bf16_f32 v74, v52, v53
    v_exp_f32 v58, v58
    v_exp_f32 v59, v59
    v_cvt_pk_bf16_f32 v75, v54, v55
    v_mfma_f32_32x32x16_bf16 a[128:143], a[172:175], v[68:71], a[128:143]
    v_exp_f32 v60, v60
    v_exp_f32 v61, v61
    v_cvt_pk_bf16_f32 v76, v56, v57
    v_exp_f32 v62, v62
    v_exp_f32 v63, v63
    v_cvt_pk_bf16_f32 v77, v58, v59
    v_cvt_pk_bf16_f32 v78, v60, v61
    v_cvt_pk_bf16_f32 v79, v62, v63
    s_waitcnt lgkmcnt(4)
    ds_read_b64_tr_b16 a[16:17], v212 offset:8192
    ds_read_b64_tr_b16 a[18:19], v212 offset:9216
    v_mfma_f32_32x32x16_bf16 v[160:175], a[0:3], a[24:27], 0
    ds_read_b64_tr_b16 a[20:21], v212 offset:10240
    ds_read_b64_tr_b16 a[22:23], v212 offset:11264
    v_mfma_f32_32x32x16_bf16 v[160:175], a[4:7], a[28:31], v[160:175]
    s_waitcnt lgkmcnt(4)
    ds_read_b64_tr_b16 a[0:1], v212 offset:12288
    ds_read_b64_tr_b16 a[2:3], v212 offset:13312
    v_mfma_f32_32x32x16_bf16 v[160:175], a[8:11], a[32:35], v[160:175]
    s_add_u32 m0, s43, 2048
    s_add_u32 s101, s47, 18432
    buffer_load_dwordx4 v220, s[24:27], s101 offen  lds
    ds_read_b64_tr_b16 a[4:5], v212 offset:14336
    ds_read_b64_tr_b16 a[6:7], v212 offset:15360
    v_mfma_f32_32x32x16_bf16 v[160:175], a[12:15], a[36:39], v[160:175]
    v_cvt_pk_bf16_f32 v176, v144, v145
    s_waitcnt lgkmcnt(4)
    ds_read_b64_tr_b16 a[8:9], v212 offset:16384
    ds_read_b64_tr_b16 a[10:11], v212 offset:17408
    v_mfma_f32_32x32x16_bf16 v[160:175], a[16:19], a[40:43], v[160:175]
    v_cvt_pk_bf16_f32 v177, v146, v147
    ds_read_b64_tr_b16 a[12:13], v212 offset:18432
    ds_read_b64_tr_b16 a[14:15], v212 offset:19456
    v_mfma_f32_32x32x16_bf16 v[160:175], a[20:23], a[44:47], v[160:175]
    v_cvt_pk_bf16_f32 v178, v148, v149
    s_waitcnt lgkmcnt(4)
    ds_read_b64_tr_b16 a[16:17], v212 offset:20480
    ds_read_b64_tr_b16 a[18:19], v212 offset:21504
    v_mfma_f32_32x32x16_bf16 v[160:175], a[0:3], a[48:51], v[160:175]
    v_cvt_pk_bf16_f32 v179, v150, v151
    s_add_u32 s79, s55, 2097152
    buffer_store_dwordx4 v[176:179], v254, s[8:11], s79 offen sc1
    s_add_u32 m0, s43, 3072
    s_add_u32 s101, s47, 27648
    buffer_load_dwordx4 v220, s[24:27], s101 offen  lds
    ds_read_b64_tr_b16 a[20:21], v212 offset:22528
    ds_read_b64_tr_b16 a[22:23], v212 offset:23552
    v_mfma_f32_32x32x16_bf16 v[160:175], a[4:7], a[52:55], v[160:175]
    v_cvt_pk_bf16_f32 v180, v152, v153
    s_waitcnt lgkmcnt(4)
    ds_read_b64_tr_b16 a[0:1], v212 offset:24576
    ds_read_b64_tr_b16 a[2:3], v212 offset:25600
    v_mfma_f32_32x32x16_bf16 v[160:175], a[8:11], a[56:59], v[160:175]
    v_cvt_pk_bf16_f32 v181, v154, v155
    ds_read_b64_tr_b16 a[4:5], v212 offset:26624
    ds_read_b64_tr_b16 a[6:7], v212 offset:27648
    v_mfma_f32_32x32x16_bf16 v[160:175], a[12:15], a[60:63], v[160:175]
    v_cvt_pk_bf16_f32 v182, v156, v157
    s_waitcnt lgkmcnt(4)
    ds_read_b64_tr_b16 a[8:9], v212 offset:32768
    ds_read_b64_tr_b16 a[10:11], v212 offset:33792
    v_mfma_f32_32x32x16_bf16 v[160:175], a[16:19], a[64:67], v[160:175]
    v_cvt_pk_bf16_f32 v183, v158, v159
    s_add_u32 s79, s55, 3145728
    buffer_store_dwordx4 v[180:183], v254, s[8:11], s79 offen sc1
    s_add_u32 m0, s43, 4096
    s_add_u32 s101, s47, 36864
    buffer_load_dwordx4 v220, s[24:27], s101 offen  lds
    ds_read_b64_tr_b16 a[12:13], v212 offset:34816
    ds_read_b64_tr_b16 a[14:15], v212 offset:35840
    v_mfma_f32_32x32x16_bf16 v[160:175], a[20:23], a[68:71], v[160:175]
    s_waitcnt lgkmcnt(4)
    ds_read_b64_tr_b16 a[16:17], v212 offset:28672
    ds_read_b64_tr_b16 a[18:19], v212 offset:29696
    v_mfma_f32_32x32x16_bf16 v[160:175], a[0:3], a[72:75], v[160:175]
    ds_read_b64_tr_b16 a[20:21], v212 offset:30720
    ds_read_b64_tr_b16 a[22:23], v212 offset:31744
    v_mfma_f32_32x32x16_bf16 v[160:175], a[4:7], a[76:79], v[160:175]
    s_waitcnt lgkmcnt(4)
    ds_read_b64_tr_b16 a[0:1], v213 offset:0
    ds_read_b64_tr_b16 a[2:3], v213 offset:1024
    v_mfma_f32_32x32x16_bf16 v[160:175], a[8:11], a[88:91], v[160:175]
    s_add_u32 m0, s43, 5120
    s_add_u32 s101, s48, 46080
    buffer_load_dwordx4 v220, s[24:27], s101 offen  lds
    ds_read_b64_tr_b16 a[4:5], v213 offset:2048
    ds_read_b64_tr_b16 a[6:7], v213 offset:3072
    v_mfma_f32_32x32x16_bf16 v[160:175], a[12:15], a[92:95], v[160:175]
    s_waitcnt lgkmcnt(4)
    ds_read_b64_tr_b16 a[8:9], v213 offset:4096
    ds_read_b64_tr_b16 a[10:11], v213 offset:5120
    v_mfma_f32_32x32x16_bf16 v[160:175], a[16:19], a[80:83], v[160:175]
    ds_read_b64_tr_b16 a[12:13], v213 offset:6144
    ds_read_b64_tr_b16 a[14:15], v213 offset:7168
    v_mfma_f32_32x32x16_bf16 v[160:175], a[20:23], a[84:87], v[160:175]
    s_waitcnt lgkmcnt(4)
    ds_read_b64_tr_b16 a[16:17], v213 offset:8192
    ds_read_b64_tr_b16 a[18:19], v213 offset:9216
    v_mfma_f32_32x32x16_bf16 v[144:159], a[0:3], a[24:27], 0
    s_add_u32 m0, s43, 6144
    s_add_u32 s101, s48, 55296
    buffer_load_dwordx4 v220, s[24:27], s101 offen  lds
    ds_read_b64_tr_b16 a[20:21], v213 offset:10240
    ds_read_b64_tr_b16 a[22:23], v213 offset:11264
    v_mfma_f32_32x32x16_bf16 v[144:159], a[4:7], a[28:31], v[144:159]
    s_waitcnt lgkmcnt(4)
    ds_read_b64_tr_b16 a[0:1], v213 offset:12288
    ds_read_b64_tr_b16 a[2:3], v213 offset:13312
    v_mfma_f32_32x32x16_bf16 v[144:159], a[8:11], a[32:35], v[144:159]
    v_add_u32 v214, 110592, v209
    ds_read_b64_tr_b16 a[4:5], v213 offset:14336
    ds_read_b64_tr_b16 a[6:7], v213 offset:15360
    v_mfma_f32_32x32x16_bf16 v[144:159], a[12:15], a[36:39], v[144:159]
    v_xor_b32 v215, 64, v214
    s_waitcnt lgkmcnt(4)
    ds_read_b64_tr_b16 a[8:9], v213 offset:16384
    ds_read_b64_tr_b16 a[10:11], v213 offset:17408
    v_mfma_f32_32x32x16_bf16 v[144:159], a[16:19], a[40:43], v[144:159]
    v_cvt_pk_bf16_f32 v184, v160, v161
    s_add_u32 m0, s43, 7168
    s_add_u32 s101, s48, 64512
    buffer_load_dwordx4 v220, s[24:27], s101 offen  lds
    ds_read_b64_tr_b16 a[12:13], v213 offset:18432
    ds_read_b64_tr_b16 a[14:15], v213 offset:19456
    v_mfma_f32_32x32x16_bf16 v[144:159], a[20:23], a[44:47], v[144:159]
    v_cvt_pk_bf16_f32 v185, v162, v163
    s_waitcnt lgkmcnt(4)
    ds_read_b64_tr_b16 a[16:17], v213 offset:20480
    ds_read_b64_tr_b16 a[18:19], v213 offset:21504
    v_mfma_f32_32x32x16_bf16 v[144:159], a[0:3], a[48:51], v[144:159]
    v_cvt_pk_bf16_f32 v186, v164, v165
    ds_read_b64_tr_b16 a[20:21], v213 offset:22528
    ds_read_b64_tr_b16 a[22:23], v213 offset:23552
    v_mfma_f32_32x32x16_bf16 v[144:159], a[4:7], a[52:55], v[144:159]
    v_cvt_pk_bf16_f32 v187, v166, v167
    s_add_u32 s79, s55, 4194304
    buffer_store_dwordx4 v[184:187], v254, s[8:11], s79 offen sc1
    s_waitcnt lgkmcnt(4)
    ds_read_b64_tr_b16 a[0:1], v213 offset:24576
    ds_read_b64_tr_b16 a[2:3], v213 offset:25600
    v_mfma_f32_32x32x16_bf16 v[144:159], a[8:11], a[56:59], v[144:159]
    v_cvt_pk_bf16_f32 v188, v168, v169
    s_add_u32 m0, s43, 8192
    s_add_u32 s101, s48, 73728
    buffer_load_dwordx4 v220, s[24:27], s101 offen  lds
    ds_read_b64_tr_b16 a[4:5], v213 offset:26624
    ds_read_b64_tr_b16 a[6:7], v213 offset:27648
    v_mfma_f32_32x32x16_bf16 v[144:159], a[12:15], a[60:63], v[144:159]
    v_cvt_pk_bf16_f32 v189, v170, v171
    s_waitcnt lgkmcnt(4)
    ds_read_b64_tr_b16 a[8:9], v213 offset:32768
    ds_read_b64_tr_b16 a[10:11], v213 offset:33792
    v_mfma_f32_32x32x16_bf16 v[144:159], a[16:19], a[64:67], v[144:159]
    v_cvt_pk_bf16_f32 v190, v172, v173
    ds_read_b64_tr_b16 a[12:13], v213 offset:34816
    ds_read_b64_tr_b16 a[14:15], v213 offset:35840
    v_mfma_f32_32x32x16_bf16 v[144:159], a[20:23], a[68:71], v[144:159]
    v_cvt_pk_bf16_f32 v191, v174, v175
    s_add_u32 s79, s55, 5242880
    buffer_store_dwordx4 v[188:191], v254, s[8:11], s79 offen sc1
    s_waitcnt lgkmcnt(4)
    ds_read_b64_tr_b16 a[16:17], v213 offset:28672
    ds_read_b64_tr_b16 a[18:19], v213 offset:29696
    v_mfma_f32_32x32x16_bf16 v[144:159], a[0:3], a[72:75], v[144:159]
    s_waitcnt vmcnt(34)
    s_barrier
    v_add_u32 v220, 512, v219
    ds_read_b64_tr_b16 a[20:21], v213 offset:30720
    ds_read_b64_tr_b16 a[22:23], v213 offset:31744
    v_mfma_f32_32x32x16_bf16 v[144:159], a[4:7], a[76:79], v[144:159]
    s_add_u32 m0, s43, 36864
    s_add_u32 s101, s47, 0
    buffer_load_dwordx4 v220, s[24:27], s101 offen  lds
    s_waitcnt lgkmcnt(4)
    ds_read_b64_tr_b16 a[0:1], v214 offset:0
    ds_read_b64_tr_b16 a[2:3], v214 offset:1024
    v_mfma_f32_32x32x16_bf16 v[144:159], a[8:11], a[88:91], v[144:159]
    ds_read_b64_tr_b16 a[4:5], v214 offset:2048
    ds_read_b64_tr_b16 a[6:7], v214 offset:3072
    v_mfma_f32_32x32x16_bf16 v[144:159], a[12:15], a[92:95], v[144:159]
    s_waitcnt lgkmcnt(4)
    ds_read_b64_tr_b16 a[8:9], v214 offset:4096
    ds_read_b64_tr_b16 a[10:11], v214 offset:5120
    v_mfma_f32_32x32x16_bf16 v[144:159], a[16:19], a[80:83], v[144:159]
    s_add_u32 m0, s43, 37888
    s_add_u32 s101, s47, 9216
    buffer_load_dwordx4 v220, s[24:27], s101 offen  lds
    ds_read_b64_tr_b16 a[12:13], v214 offset:6144
    ds_read_b64_tr_b16 a[14:15], v214 offset:7168
    v_mfma_f32_32x32x16_bf16 v[144:159], a[20:23], a[84:87], v[144:159]
    s_waitcnt lgkmcnt(4)
    ds_read_b64_tr_b16 a[16:17], v214 offset:8192
    ds_read_b64_tr_b16 a[18:19], v214 offset:9216
    v_mfma_f32_32x32x16_bf16 v[160:175], a[0:3], a[24:27], 0
    ds_read_b64_tr_b16 a[20:21], v214 offset:10240
    ds_read_b64_tr_b16 a[22:23], v214 offset:11264
    v_mfma_f32_32x32x16_bf16 v[160:175], a[4:7], a[28:31], v[160:175]
    s_waitcnt lgkmcnt(4)
    ds_read_b64_tr_b16 a[0:1], v214 offset:12288
    ds_read_b64_tr_b16 a[2:3], v214 offset:13312
    v_mfma_f32_32x32x16_bf16 v[160:175], a[8:11], a[32:35], v[160:175]
    s_add_u32 m0, s43, 38912
    s_add_u32 s101, s47, 18432
    buffer_load_dwordx4 v220, s[24:27], s101 offen  lds
    ds_read_b64_tr_b16 a[4:5], v214 offset:14336
    ds_read_b64_tr_b16 a[6:7], v214 offset:15360
    v_mfma_f32_32x32x16_bf16 v[160:175], a[12:15], a[36:39], v[160:175]
    v_cvt_pk_bf16_f32 v176, v144, v145
    s_waitcnt lgkmcnt(4)
    ds_read_b64_tr_b16 a[8:9], v214 offset:16384
    ds_read_b64_tr_b16 a[10:11], v214 offset:17408
    v_mfma_f32_32x32x16_bf16 v[160:175], a[16:19], a[40:43], v[160:175]
    v_cvt_pk_bf16_f32 v177, v146, v147
    ds_read_b64_tr_b16 a[12:13], v214 offset:18432
    ds_read_b64_tr_b16 a[14:15], v214 offset:19456
    v_mfma_f32_32x32x16_bf16 v[160:175], a[20:23], a[44:47], v[160:175]
    v_cvt_pk_bf16_f32 v178, v148, v149
    s_waitcnt lgkmcnt(4)
    ds_read_b64_tr_b16 a[16:17], v214 offset:20480
    ds_read_b64_tr_b16 a[18:19], v214 offset:21504
    v_mfma_f32_32x32x16_bf16 v[160:175], a[0:3], a[48:51], v[160:175]
    v_cvt_pk_bf16_f32 v179, v150, v151
    s_add_u32 s79, s55, 6291456
    buffer_store_dwordx4 v[176:179], v254, s[8:11], s79 offen sc1
    s_add_u32 m0, s43, 39936
    s_add_u32 s101, s47, 27648
    buffer_load_dwordx4 v220, s[24:27], s101 offen  lds
    ds_read_b64_tr_b16 a[20:21], v214 offset:22528
    ds_read_b64_tr_b16 a[22:23], v214 offset:23552
    v_mfma_f32_32x32x16_bf16 v[160:175], a[4:7], a[52:55], v[160:175]
    v_cvt_pk_bf16_f32 v180, v152, v153
    s_waitcnt lgkmcnt(4)
    ds_read_b64_tr_b16 a[0:1], v214 offset:24576
    ds_read_b64_tr_b16 a[2:3], v214 offset:25600
    v_mfma_f32_32x32x16_bf16 v[160:175], a[8:11], a[56:59], v[160:175]
    v_cvt_pk_bf16_f32 v181, v154, v155
    ds_read_b64_tr_b16 a[4:5], v214 offset:26624
    ds_read_b64_tr_b16 a[6:7], v214 offset:27648
    v_mfma_f32_32x32x16_bf16 v[160:175], a[12:15], a[60:63], v[160:175]
    v_cvt_pk_bf16_f32 v182, v156, v157
    s_waitcnt lgkmcnt(4)
    ds_read_b64_tr_b16 a[8:9], v214 offset:32768
    ds_read_b64_tr_b16 a[10:11], v214 offset:33792
    v_mfma_f32_32x32x16_bf16 v[160:175], a[16:19], a[64:67], v[160:175]
    v_cvt_pk_bf16_f32 v183, v158, v159
    s_add_u32 s79, s55, 7340032
    buffer_store_dwordx4 v[180:183], v254, s[8:11], s79 offen sc1
    s_add_u32 m0, s43, 40960
    s_add_u32 s101, s47, 36864
    buffer_load_dwordx4 v220, s[24:27], s101 offen  lds
    ds_read_b64_tr_b16 a[12:13], v214 offset:34816
    ds_read_b64_tr_b16 a[14:15], v214 offset:35840
    v_mfma_f32_32x32x16_bf16 v[160:175], a[20:23], a[68:71], v[160:175]
    s_waitcnt lgkmcnt(4)
    ds_read_b64_tr_b16 a[16:17], v214 offset:28672
    ds_read_b64_tr_b16 a[18:19], v214 offset:29696
    v_mfma_f32_32x32x16_bf16 v[160:175], a[0:3], a[72:75], v[160:175]
    ds_read_b64_tr_b16 a[20:21], v214 offset:30720
    ds_read_b64_tr_b16 a[22:23], v214 offset:31744
    v_mfma_f32_32x32x16_bf16 v[160:175], a[4:7], a[76:79], v[160:175]
    s_waitcnt lgkmcnt(4)
    ds_read_b64_tr_b16 a[0:1], v215 offset:0
    ds_read_b64_tr_b16 a[2:3], v215 offset:1024
    v_mfma_f32_32x32x16_bf16 v[160:175], a[8:11], a[88:91], v[160:175]
    s_add_u32 m0, s43, 41984
    s_add_u32 s101, s48, 46080
    buffer_load_dwordx4 v220, s[24:27], s101 offen  lds
    ds_read_b64_tr_b16 a[4:5], v215 offset:2048
    ds_read_b64_tr_b16 a[6:7], v215 offset:3072
    v_mfma_f32_32x32x16_bf16 v[160:175], a[12:15], a[92:95], v[160:175]
    s_waitcnt lgkmcnt(4)
    ds_read_b64_tr_b16 a[8:9], v215 offset:4096
    ds_read_b64_tr_b16 a[10:11], v215 offset:5120
    v_mfma_f32_32x32x16_bf16 v[160:175], a[16:19], a[80:83], v[160:175]
    ds_read_b64_tr_b16 a[12:13], v215 offset:6144
    ds_read_b64_tr_b16 a[14:15], v215 offset:7168
    v_mfma_f32_32x32x16_bf16 v[160:175], a[20:23], a[84:87], v[160:175]
    s_waitcnt lgkmcnt(4)
    ds_read_b64_tr_b16 a[16:17], v215 offset:8192
    ds_read_b64_tr_b16 a[18:19], v215 offset:9216
    v_mfma_f32_32x32x16_bf16 v[144:159], a[0:3], a[24:27], 0
    s_add_u32 m0, s43, 43008
    s_add_u32 s101, s48, 55296
    buffer_load_dwordx4 v220, s[24:27], s101 offen  lds
    ds_read_b64_tr_b16 a[20:21], v215 offset:10240
    ds_read_b64_tr_b16 a[22:23], v215 offset:11264
    v_mfma_f32_32x32x16_bf16 v[144:159], a[4:7], a[28:31], v[144:159]
    s_waitcnt lgkmcnt(4)
    ds_read_b64_tr_b16 a[0:1], v215 offset:12288
    ds_read_b64_tr_b16 a[2:3], v215 offset:13312
    v_mfma_f32_32x32x16_bf16 v[144:159], a[8:11], a[32:35], v[144:159]
    v_add_u32 v212, 0, v209
    ds_read_b64_tr_b16 a[4:5], v215 offset:14336
    ds_read_b64_tr_b16 a[6:7], v215 offset:15360
    v_mfma_f32_32x32x16_bf16 v[144:159], a[12:15], a[36:39], v[144:159]
    v_xor_b32 v213, 64, v212
    s_waitcnt lgkmcnt(4)
    ds_read_b64_tr_b16 a[8:9], v215 offset:16384
    ds_read_b64_tr_b16 a[10:11], v215 offset:17408
    v_mfma_f32_32x32x16_bf16 v[144:159], a[16:19], a[40:43], v[144:159]
    v_cvt_pk_bf16_f32 v184, v160, v161
    s_add_u32 m0, s43, 44032
    s_add_u32 s101, s48, 64512
    buffer_load_dwordx4 v220, s[24:27], s101 offen  lds
    ds_read_b64_tr_b16 a[12:13], v215 offset:18432
    ds_read_b64_tr_b16 a[14:15], v215 offset:19456
    v_mfma_f32_32x32x16_bf16 v[144:159], a[20:23], a[44:47], v[144:159]
    v_cvt_pk_bf16_f32 v185, v162, v163
    s_waitcnt lgkmcnt(4)
    ds_read_b64_tr_b16 a[16:17], v215 offset:20480
    ds_read_b64_tr_b16 a[18:19], v215 offset:21504
    v_mfma_f32_32x32x16_bf16 v[144:159], a[0:3], a[48:51], v[144:159]
    v_cvt_pk_bf16_f32 v186, v164, v165
    ds_read_b64_tr_b16 a[20:21], v215 offset:22528
    ds_read_b64_tr_b16 a[22:23], v215 offset:23552
    v_mfma_f32_32x32x16_bf16 v[144:159], a[4:7], a[52:55], v[144:159]
    v_cvt_pk_bf16_f32 v187, v166, v167
    s_add_u32 s79, s55, 8388608
    buffer_store_dwordx4 v[184:187], v254, s[8:11], s79 offen sc1
    s_waitcnt lgkmcnt(4)
    ds_read_b64_tr_b16 a[0:1], v215 offset:24576
    ds_read_b64_tr_b16 a[2:3], v215 offset:25600
    v_mfma_f32_32x32x16_bf16 v[144:159], a[8:11], a[56:59], v[144:159]
    v_cvt_pk_bf16_f32 v188, v168, v169
    s_add_u32 m0, s43, 45056
    s_add_u32 s101, s48, 73728
    buffer_load_dwordx4 v220, s[24:27], s101 offen  lds
    ds_read_b64_tr_b16 a[4:5], v215 offset:26624
    ds_read_b64_tr_b16 a[6:7], v215 offset:27648
    v_mfma_f32_32x32x16_bf16 v[144:159], a[12:15], a[60:63], v[144:159]
    v_cvt_pk_bf16_f32 v189, v170, v171
    s_waitcnt lgkmcnt(4)
    ds_read_b64_tr_b16 a[8:9], v215 offset:32768
    ds_read_b64_tr_b16 a[10:11], v215 offset:33792
    v_mfma_f32_32x32x16_bf16 v[144:159], a[16:19], a[64:67], v[144:159]
    v_cvt_pk_bf16_f32 v190, v172, v173
    ds_read_b64_tr_b16 a[12:13], v215 offset:34816
    ds_read_b64_tr_b16 a[14:15], v215 offset:35840
    v_mfma_f32_32x32x16_bf16 v[144:159], a[20:23], a[68:71], v[144:159]
    v_cvt_pk_bf16_f32 v191, v174, v175
    s_add_u32 s79, s55, 9437184
    buffer_store_dwordx4 v[188:191], v254, s[8:11], s79 offen sc1
    s_waitcnt lgkmcnt(4)
    ds_read_b64_tr_b16 a[16:17], v215 offset:28672
    ds_read_b64_tr_b16 a[18:19], v215 offset:29696
    v_mfma_f32_32x32x16_bf16 v[144:159], a[0:3], a[72:75], v[144:159]
    s_waitcnt vmcnt(14)
    s_barrier
    v_add_u32 v220, 640, v219
    ds_read_b64_tr_b16 a[20:21], v215 offset:30720
    ds_read_b64_tr_b16 a[22:23], v215 offset:31744
    v_mfma_f32_32x32x16_bf16 v[144:159], a[4:7], a[76:79], v[144:159]
    s_add_u32 m0, s43, 73728
    s_add_u32 s101, s47, 0
    buffer_load_dwordx4 v220, s[24:27], s101 offen  lds
    s_waitcnt lgkmcnt(4)
    ds_read_b64_tr_b16 a[0:1], v212 offset:0
    ds_read_b64_tr_b16 a[2:3], v212 offset:1024
    v_mfma_f32_32x32x16_bf16 v[144:159], a[8:11], a[88:91], v[144:159]
    ds_read_b64_tr_b16 a[4:5], v212 offset:2048
    ds_read_b64_tr_b16 a[6:7], v212 offset:3072
    v_mfma_f32_32x32x16_bf16 v[144:159], a[12:15], a[92:95], v[144:159]
    s_waitcnt lgkmcnt(4)
    ds_read_b64_tr_b16 a[8:9], v212 offset:4096
    ds_read_b64_tr_b16 a[10:11], v212 offset:5120
    v_mfma_f32_32x32x16_bf16 v[144:159], a[16:19], a[80:83], v[144:159]
    s_add_u32 m0, s43, 74752
    s_add_u32 s101, s47, 9216
    buffer_load_dwordx4 v220, s[24:27], s101 offen  lds
    ds_read_b64_tr_b16 a[12:13], v212 offset:6144
    ds_read_b64_tr_b16 a[14:15], v212 offset:7168
    v_mfma_f32_32x32x16_bf16 v[144:159], a[20:23], a[84:87], v[144:159]
    v_mfma_f32_32x32x16_bf16 v[48:63], a[176:179], v[4:7], 0
    v_exp_f32 v32, v32
    v_exp_f32 v33, v33
    v_exp_f32 v34, v34
    v_exp_f32 v35, v35
    v_mfma_f32_32x32x8bf16_1k v[48:63], a[180:181], v[18:19], v[48:63]
    v_exp_f32 v36, v36
    v_exp_f32 v37, v37
    v_cvt_pk_bf16_f32 v64, v32, v33
    v_exp_f32 v38, v38
    v_exp_f32 v39, v39
    v_cvt_pk_bf16_f32 v65, v34, v35
    v_mfma_f32_32x32x16_bf16 a[144:159], a[168:171], v[72:75], 0
    v_exp_f32 v40, v40
    v_exp_f32 v41, v41
    v_cvt_pk_bf16_f32 v66, v36, v37
    v_exp_f32 v42, v42
    v_exp_f32 v43, v43
    v_cvt_pk_bf16_f32 v67, v38, v39
    v_mfma_f32_32x32x16_bf16 a[144:159], a[172:175], v[76:79], a[144:159]
    v_exp_f32 v44, v44
    v_exp_f32 v45, v45
    v_cvt_pk_bf16_f32 v68, v40, v41
    v_exp_f32 v46, v46
    v_exp_f32 v47, v47
    v_cvt_pk_bf16_f32 v69, v42, v43
    v_cvt_pk_bf16_f32 v70, v44, v45
    v_cvt_pk_bf16_f32 v71, v46, v47
    v_mfma_f32_32x32x16_bf16 v[32:47], a[176:179], v[8:11], 0
    v_exp_f32 v48, v48
    v_exp_f32 v49, v49
    v_exp_f32 v50, v50
    v_exp_f32 v51, v51
    buffer_load_dwordx2 a[160:161], v26, s[8:11], s62 offen offset:1536 sc1
    buffer_load_dwordx2 a[162:163], v26, s[8:11], s63 offen offset:1536 sc1
    v_mfma_f32_32x32x8bf16_1k v[32:47], a[180:181], v[20:21], v[32:47]
    v_exp_f32 v52, v52
    v_exp_f32 v53, v53
    v_cvt_pk_bf16_f32 v72, v48, v49
    v_exp_f32 v54, v54
    v_exp_f32 v55, v55
    v_cvt_pk_bf16_f32 v73, v50, v51
    v_mfma_f32_32x32x16_bf16 a[96:111], a[184:187], v[64:67], a[96:111]
    v_exp_f32 v56, v56
    v_exp_f32 v57, v57
    v_cvt_pk_bf16_f32 v74, v52, v53
    v_exp_f32 v58, v58
    v_exp_f32 v59, v59
    v_cvt_pk_bf16_f32 v75, v54, v55
    buffer_load_dword a164, v24, s[8:11], s64 offen offset:1536 sc1
    v_mfma_f32_32x32x16_bf16 a[96:111], a[188:191], v[68:71], a[96:111]
    v_exp_f32 v60, v60
    v_exp_f32 v61, v61
    v_cvt_pk_bf16_f32 v76, v56, v57
    v_exp_f32 v62, v62
    v_exp_f32 v63, v63
    v_cvt_pk_bf16_f32 v77, v58, v59
    v_cvt_pk_bf16_f32 v78, v60, v61
    v_cvt_pk_bf16_f32 v79, v62, v63
    v_mfma_f32_32x32x16_bf16 v[48:63], a[176:179], v[12:15], 0
    v_exp_f32 v32, v32
    v_exp_f32 v33, v33
    v_exp_f32 v34, v34
    v_exp_f32 v35, v35
    v_mfma_f32_32x32x8bf16_1k v[48:63], a[180:181], v[22:23], v[48:63]
    v_exp_f32 v36, v36
    v_exp_f32 v37, v37
    v_cvt_pk_bf16_f32 v64, v32, v33
    v_exp_f32 v38, v38
    v_exp_f32 v39, v39
    v_cvt_pk_bf16_f32 v65, v34, v35
    buffer_load_dwordx4 a[168:171], v25, s[8:11], 0 offen offset:2304 sc1
    buffer_load_dwordx4 a[172:175], v25, s[8:11], 0 offen offset:2880 sc1
    v_mfma_f32_32x32x16_bf16 a[112:127], a[184:187], v[72:75], a[112:127]
    v_exp_f32 v40, v40
    v_exp_f32 v41, v41
    v_cvt_pk_bf16_f32 v66, v36, v37
    v_exp_f32 v42, v42
    v_exp_f32 v43, v43
    v_cvt_pk_bf16_f32 v67, v38, v39
    v_mfma_f32_32x32x16_bf16 a[112:127], a[188:191], v[76:79], a[112:127]
    v_exp_f32 v44, v44
    v_exp_f32 v45, v45
    v_cvt_pk_bf16_f32 v68, v40, v41
    v_exp_f32 v46, v46
    v_exp_f32 v47, v47
    v_cvt_pk_bf16_f32 v69, v42, v43
    v_cvt_pk_bf16_f32 v70, v44, v45
    v_cvt_pk_bf16_f32 v71, v46, v47
    s_waitcnt vmcnt(46)
    v_mfma_f32_32x32x16_bf16 v[32:47], a[192:195], v[0:3], 0
    v_exp_f32 v48, v48
    v_exp_f32 v49, v49
    v_exp_f32 v50, v50
    v_exp_f32 v51, v51
    v_mfma_f32_32x32x8bf16_1k v[32:47], a[196:197], v[16:17], v[32:47]
    v_exp_f32 v52, v52
    v_exp_f32 v53, v53
    v_cvt_pk_bf16_f32 v72, v48, v49
    v_exp_f32 v54, v54
    v_exp_f32 v55, v55
    v_cvt_pk_bf16_f32 v73, v50, v51
    v_mfma_f32_32x32x16_bf16 a[128:143], a[184:187], v[64:67], a[128:143]
    v_exp_f32 v56, v56
    v_exp_f32 v57, v57
    v_cvt_pk_bf16_f32 v74, v52, v53
    v_exp_f32 v58, v58
    v_exp_f32 v59, v59
    v_cvt_pk_bf16_f32 v75, v54, v55
    v_mfma_f32_32x32x16_bf16 a[128:143], a[188:191], v[68:71], a[128:143]
    v_exp_f32 v60, v60
    v_exp_f32 v61, v61
    v_cvt_pk_bf16_f32 v76, v56, v57
    v_exp_f32 v62, v62
    v_exp_f32 v63, v63
    v_cvt_pk_bf16_f32 v77, v58, v59
    v_cvt_pk_bf16_f32 v78, v60, v61
    v_cvt_pk_bf16_f32 v79, v62, v63
    s_waitcnt lgkmcnt(4)
    ds_read_b64_tr_b16 a[16:17], v212 offset:8192
    ds_read_b64_tr_b16 a[18:19], v212 offset:9216
    v_mfma_f32_32x32x16_bf16 v[160:175], a[0:3], a[24:27], 0
    ds_read_b64_tr_b16 a[20:21], v212 offset:10240
    ds_read_b64_tr_b16 a[22:23], v212 offset:11264
    v_mfma_f32_32x32x16_bf16 v[160:175], a[4:7], a[28:31], v[160:175]
    s_waitcnt lgkmcnt(4)
    ds_read_b64_tr_b16 a[0:1], v212 offset:12288
    ds_read_b64_tr_b16 a[2:3], v212 offset:13312
    v_mfma_f32_32x32x16_bf16 v[160:175], a[8:11], a[32:35], v[160:175]
    s_add_u32 m0, s43, 75776
    s_add_u32 s101, s47, 18432
    buffer_load_dwordx4 v220, s[24:27], s101 offen  lds
    ds_read_b64_tr_b16 a[4:5], v212 offset:14336
    ds_read_b64_tr_b16 a[6:7], v212 offset:15360
    v_mfma_f32_32x32x16_bf16 v[160:175], a[12:15], a[36:39], v[160:175]
    v_cvt_pk_bf16_f32 v176, v144, v145
    s_waitcnt lgkmcnt(4)
    ds_read_b64_tr_b16 a[8:9], v212 offset:16384
    ds_read_b64_tr_b16 a[10:11], v212 offset:17408
    v_mfma_f32_32x32x16_bf16 v[160:175], a[16:19], a[40:43], v[160:175]
    v_cvt_pk_bf16_f32 v177, v146, v147
    ds_read_b64_tr_b16 a[12:13], v212 offset:18432
    ds_read_b64_tr_b16 a[14:15], v212 offset:19456
    v_mfma_f32_32x32x16_bf16 v[160:175], a[20:23], a[44:47], v[160:175]
    v_cvt_pk_bf16_f32 v178, v148, v149
    s_waitcnt lgkmcnt(4)
    ds_read_b64_tr_b16 a[16:17], v212 offset:20480
    ds_read_b64_tr_b16 a[18:19], v212 offset:21504
    v_mfma_f32_32x32x16_bf16 v[160:175], a[0:3], a[48:51], v[160:175]
    v_cvt_pk_bf16_f32 v179, v150, v151
    s_add_u32 s79, s55, 10485760
    buffer_store_dwordx4 v[176:179], v254, s[8:11], s79 offen sc1
    s_add_u32 m0, s43, 76800
    s_add_u32 s101, s47, 27648
    buffer_load_dwordx4 v220, s[24:27], s101 offen  lds
    ds_read_b64_tr_b16 a[20:21], v212 offset:22528
    ds_read_b64_tr_b16 a[22:23], v212 offset:23552
    v_mfma_f32_32x32x16_bf16 v[160:175], a[4:7], a[52:55], v[160:175]
    v_cvt_pk_bf16_f32 v180, v152, v153
    s_waitcnt lgkmcnt(4)
    ds_read_b64_tr_b16 a[0:1], v212 offset:24576
    ds_read_b64_tr_b16 a[2:3], v212 offset:25600
    v_mfma_f32_32x32x16_bf16 v[160:175], a[8:11], a[56:59], v[160:175]
    v_cvt_pk_bf16_f32 v181, v154, v155
    ds_read_b64_tr_b16 a[4:5], v212 offset:26624
    ds_read_b64_tr_b16 a[6:7], v212 offset:27648
    v_mfma_f32_32x32x16_bf16 v[160:175], a[12:15], a[60:63], v[160:175]
    v_cvt_pk_bf16_f32 v182, v156, v157
    s_waitcnt lgkmcnt(4)
    ds_read_b64_tr_b16 a[8:9], v212 offset:32768
    ds_read_b64_tr_b16 a[10:11], v212 offset:33792
    v_mfma_f32_32x32x16_bf16 v[160:175], a[16:19], a[64:67], v[160:175]
    v_cvt_pk_bf16_f32 v183, v158, v159
    s_add_u32 s79, s55, 11534336
    buffer_store_dwordx4 v[180:183], v254, s[8:11], s79 offen sc1
    s_add_u32 m0, s43, 77824
    s_add_u32 s101, s47, 36864
    buffer_load_dwordx4 v220, s[24:27], s101 offen  lds
    ds_read_b64_tr_b16 a[12:13], v212 offset:34816
    ds_read_b64_tr_b16 a[14:15], v212 offset:35840
    v_mfma_f32_32x32x16_bf16 v[160:175], a[20:23], a[68:71], v[160:175]
    s_waitcnt lgkmcnt(4)
    ds_read_b64_tr_b16 a[16:17], v212 offset:28672
    ds_read_b64_tr_b16 a[18:19], v212 offset:29696
    v_mfma_f32_32x32x16_bf16 v[160:175], a[0:3], a[72:75], v[160:175]
    ds_read_b64_tr_b16 a[20:21], v212 offset:30720
    ds_read_b64_tr_b16 a[22:23], v212 offset:31744
    v_mfma_f32_32x32x16_bf16 v[160:175], a[4:7], a[76:79], v[160:175]
    s_waitcnt lgkmcnt(4)
    ds_read_b64_tr_b16 a[0:1], v213 offset:0
    ds_read_b64_tr_b16 a[2:3], v213 offset:1024
    v_mfma_f32_32x32x16_bf16 v[160:175], a[8:11], a[88:91], v[160:175]
    s_add_u32 m0, s43, 78848
    s_add_u32 s101, s48, 46080
    buffer_load_dwordx4 v220, s[24:27], s101 offen  lds
    ds_read_b64_tr_b16 a[4:5], v213 offset:2048
    ds_read_b64_tr_b16 a[6:7], v213 offset:3072
    v_mfma_f32_32x32x16_bf16 v[160:175], a[12:15], a[92:95], v[160:175]
    s_waitcnt lgkmcnt(4)
    ds_read_b64_tr_b16 a[8:9], v213 offset:4096
    ds_read_b64_tr_b16 a[10:11], v213 offset:5120
    v_mfma_f32_32x32x16_bf16 v[160:175], a[16:19], a[80:83], v[160:175]
    ds_read_b64_tr_b16 a[12:13], v213 offset:6144
    ds_read_b64_tr_b16 a[14:15], v213 offset:7168
    v_mfma_f32_32x32x16_bf16 v[160:175], a[20:23], a[84:87], v[160:175]
    s_waitcnt lgkmcnt(4)
    ds_read_b64_tr_b16 a[16:17], v213 offset:8192
    ds_read_b64_tr_b16 a[18:19], v213 offset:9216
    v_mfma_f32_32x32x16_bf16 v[144:159], a[0:3], a[24:27], 0
    s_add_u32 m0, s43, 79872
    s_add_u32 s101, s48, 55296
    buffer_load_dwordx4 v220, s[24:27], s101 offen  lds
    ds_read_b64_tr_b16 a[20:21], v213 offset:10240
    ds_read_b64_tr_b16 a[22:23], v213 offset:11264
    v_mfma_f32_32x32x16_bf16 v[144:159], a[4:7], a[28:31], v[144:159]
    s_waitcnt lgkmcnt(4)
    ds_read_b64_tr_b16 a[0:1], v213 offset:12288
    ds_read_b64_tr_b16 a[2:3], v213 offset:13312
    v_mfma_f32_32x32x16_bf16 v[144:159], a[8:11], a[32:35], v[144:159]
    v_add_u32 v214, 36864, v209
    ds_read_b64_tr_b16 a[4:5], v213 offset:14336
    ds_read_b64_tr_b16 a[6:7], v213 offset:15360
    v_mfma_f32_32x32x16_bf16 v[144:159], a[12:15], a[36:39], v[144:159]
    v_xor_b32 v215, 64, v214
    s_waitcnt lgkmcnt(4)
    ds_read_b64_tr_b16 a[8:9], v213 offset:16384
    ds_read_b64_tr_b16 a[10:11], v213 offset:17408
    v_mfma_f32_32x32x16_bf16 v[144:159], a[16:19], a[40:43], v[144:159]
    v_cvt_pk_bf16_f32 v184, v160, v161
    s_add_u32 m0, s43, 80896
    s_add_u32 s101, s48, 64512
    buffer_load_dwordx4 v220, s[24:27], s101 offen  lds
    ds_read_b64_tr_b16 a[12:13], v213 offset:18432
    ds_read_b64_tr_b16 a[14:15], v213 offset:19456
    v_mfma_f32_32x32x16_bf16 v[144:159], a[20:23], a[44:47], v[144:159]
    v_cvt_pk_bf16_f32 v185, v162, v163
    s_waitcnt lgkmcnt(4)
    ds_read_b64_tr_b16 a[16:17], v213 offset:20480
    ds_read_b64_tr_b16 a[18:19], v213 offset:21504
    v_mfma_f32_32x32x16_bf16 v[144:159], a[0:3], a[48:51], v[144:159]
    v_cvt_pk_bf16_f32 v186, v164, v165
    ds_read_b64_tr_b16 a[20:21], v213 offset:22528
    ds_read_b64_tr_b16 a[22:23], v213 offset:23552
    v_mfma_f32_32x32x16_bf16 v[144:159], a[4:7], a[52:55], v[144:159]
    v_cvt_pk_bf16_f32 v187, v166, v167
    s_add_u32 s79, s55, 12582912
    buffer_store_dwordx4 v[184:187], v254, s[8:11], s79 offen sc1
    s_waitcnt lgkmcnt(4)
    ds_read_b64_tr_b16 a[0:1], v213 offset:24576
    ds_read_b64_tr_b16 a[2:3], v213 offset:25600
    v_mfma_f32_32x32x16_bf16 v[144:159], a[8:11], a[56:59], v[144:159]
    v_cvt_pk_bf16_f32 v188, v168, v169
    s_add_u32 m0, s43, 81920
    s_add_u32 s101, s48, 73728
    buffer_load_dwordx4 v220, s[24:27], s101 offen  lds
    ds_read_b64_tr_b16 a[4:5], v213 offset:26624
    ds_read_b64_tr_b16 a[6:7], v213 offset:27648
    v_mfma_f32_32x32x16_bf16 v[144:159], a[12:15], a[60:63], v[144:159]
    v_cvt_pk_bf16_f32 v189, v170, v171
    s_waitcnt lgkmcnt(4)
    ds_read_b64_tr_b16 a[8:9], v213 offset:32768
    ds_read_b64_tr_b16 a[10:11], v213 offset:33792
    v_mfma_f32_32x32x16_bf16 v[144:159], a[16:19], a[64:67], v[144:159]
    v_cvt_pk_bf16_f32 v190, v172, v173
    ds_read_b64_tr_b16 a[12:13], v213 offset:34816
    ds_read_b64_tr_b16 a[14:15], v213 offset:35840
    v_mfma_f32_32x32x16_bf16 v[144:159], a[20:23], a[68:71], v[144:159]
    v_cvt_pk_bf16_f32 v191, v174, v175
    s_add_u32 s79, s55, 13631488
    buffer_store_dwordx4 v[188:191], v254, s[8:11], s79 offen sc1
    s_waitcnt lgkmcnt(4)
    ds_read_b64_tr_b16 a[16:17], v213 offset:28672
    ds_read_b64_tr_b16 a[18:19], v213 offset:29696
    v_mfma_f32_32x32x16_bf16 v[144:159], a[0:3], a[72:75], v[144:159]
    s_waitcnt vmcnt(19)
    s_barrier
    v_add_u32 v220, 768, v219
    ds_read_b64_tr_b16 a[20:21], v213 offset:30720
    ds_read_b64_tr_b16 a[22:23], v213 offset:31744
    v_mfma_f32_32x32x16_bf16 v[144:159], a[4:7], a[76:79], v[144:159]
    s_add_u32 m0, s43, 110592
    s_add_u32 s101, s47, 0
    buffer_load_dwordx4 v220, s[24:27], s101 offen  lds
    s_waitcnt lgkmcnt(4)
    ds_read_b64_tr_b16 a[0:1], v214 offset:0
    ds_read_b64_tr_b16 a[2:3], v214 offset:1024
    v_mfma_f32_32x32x16_bf16 v[144:159], a[8:11], a[88:91], v[144:159]
    ds_read_b64_tr_b16 a[4:5], v214 offset:2048
    ds_read_b64_tr_b16 a[6:7], v214 offset:3072
    v_mfma_f32_32x32x16_bf16 v[144:159], a[12:15], a[92:95], v[144:159]
    s_waitcnt lgkmcnt(4)
    ds_read_b64_tr_b16 a[8:9], v214 offset:4096
    ds_read_b64_tr_b16 a[10:11], v214 offset:5120
    v_mfma_f32_32x32x16_bf16 v[144:159], a[16:19], a[80:83], v[144:159]
    s_add_u32 m0, s43, 111616
    s_add_u32 s101, s47, 9216
    buffer_load_dwordx4 v220, s[24:27], s101 offen  lds
    ds_read_b64_tr_b16 a[12:13], v214 offset:6144
    ds_read_b64_tr_b16 a[14:15], v214 offset:7168
    v_mfma_f32_32x32x16_bf16 v[144:159], a[20:23], a[84:87], v[144:159]
    s_waitcnt lgkmcnt(4)
    ds_read_b64_tr_b16 a[16:17], v214 offset:8192
    ds_read_b64_tr_b16 a[18:19], v214 offset:9216
    v_mfma_f32_32x32x16_bf16 v[160:175], a[0:3], a[24:27], 0
    s_mul_i32 s36, s40, 21504
    s_add_u32 s36, s36, 0
    s_mul_i32 s3, s33, 576
    s_add_u32 s3, s3, s32
    s_lshl_b32 s3, s3, 4
    s_lshl_b32 s59, s40, 2
    s_add_u32 s3, s3, s59
    s_lshl_b32 s3, s3, 10
    s_add_u32 s35, s3, 9437184
    s_lshl_b32 s3, s41, 8
    s_add_u32 s3, s3, 47924224
    v_lshl_add_u32 v252, v255, 2, s3
    s_lshl_b32 s59, s42, 4
    s_add_u32 s3, s3, s59
    s_lshl_b32 s59, s40, 2
    s_add_u32 s3, s3, s59
    ds_read_b64_tr_b16 a[20:21], v214 offset:10240
    ds_read_b64_tr_b16 a[22:23], v214 offset:11264
    v_mfma_f32_32x32x16_bf16 v[160:175], a[4:7], a[28:31], v[160:175]
    v_mov_b32 v253, s3
    s_waitcnt lgkmcnt(4)
    ds_read_b64_tr_b16 a[0:1], v214 offset:12288
    ds_read_b64_tr_b16 a[2:3], v214 offset:13312
    v_mfma_f32_32x32x16_bf16 v[160:175], a[8:11], a[32:35], v[160:175]
    v_and_b32 v118, 31, v255
    s_add_u32 m0, s43, 112640
    s_add_u32 s101, s47, 18432
    buffer_load_dwordx4 v220, s[24:27], s101 offen  lds
    ds_read_b64_tr_b16 a[4:5], v214 offset:14336
    ds_read_b64_tr_b16 a[6:7], v214 offset:15360
    v_mfma_f32_32x32x16_bf16 v[160:175], a[12:15], a[36:39], v[160:175]
    v_cvt_pk_bf16_f32 v176, v144, v145
    s_waitcnt lgkmcnt(4)
    ds_read_b64_tr_b16 a[8:9], v214 offset:16384
    ds_read_b64_tr_b16 a[10:11], v214 offset:17408
    v_mfma_f32_32x32x16_bf16 v[160:175], a[16:19], a[40:43], v[160:175]
    v_cvt_pk_bf16_f32 v177, v146, v147
    ds_read_b64_tr_b16 a[12:13], v214 offset:18432
    ds_read_b64_tr_b16 a[14:15], v214 offset:19456
    v_mfma_f32_32x32x16_bf16 v[160:175], a[20:23], a[44:47], v[160:175]
    v_cvt_pk_bf16_f32 v178, v148, v149
    s_waitcnt lgkmcnt(4)
    ds_read_b64_tr_b16 a[16:17], v214 offset:20480
    ds_read_b64_tr_b16 a[18:19], v214 offset:21504
    v_mfma_f32_32x32x16_bf16 v[160:175], a[0:3], a[48:51], v[160:175]
    v_cvt_pk_bf16_f32 v179, v150, v151
    s_add_u32 s79, s55, 14680064
    buffer_store_dwordx4 v[176:179], v254, s[8:11], s79 offen sc1
    s_add_u32 m0, s43, 113664
    s_add_u32 s101, s47, 27648
    buffer_load_dwordx4 v220, s[24:27], s101 offen  lds
    ds_read_b64_tr_b16 a[20:21], v214 offset:22528
    ds_read_b64_tr_b16 a[22:23], v214 offset:23552
    v_mfma_f32_32x32x16_bf16 v[160:175], a[4:7], a[52:55], v[160:175]
    v_cvt_pk_bf16_f32 v180, v152, v153
    s_waitcnt lgkmcnt(4)
    ds_read_b64_tr_b16 a[0:1], v214 offset:24576
    ds_read_b64_tr_b16 a[2:3], v214 offset:25600
    v_mfma_f32_32x32x16_bf16 v[160:175], a[8:11], a[56:59], v[160:175]
    v_cvt_pk_bf16_f32 v181, v154, v155
    ds_read_b64_tr_b16 a[4:5], v214 offset:26624
    ds_read_b64_tr_b16 a[6:7], v214 offset:27648
    v_mfma_f32_32x32x16_bf16 v[160:175], a[12:15], a[60:63], v[160:175]
    v_cvt_pk_bf16_f32 v182, v156, v157
    s_waitcnt lgkmcnt(4)
    ds_read_b64_tr_b16 a[8:9], v214 offset:32768
    ds_read_b64_tr_b16 a[10:11], v214 offset:33792
    v_mfma_f32_32x32x16_bf16 v[160:175], a[16:19], a[64:67], v[160:175]
    v_cvt_pk_bf16_f32 v183, v158, v159
    s_add_u32 s79, s55, 15728640
    buffer_store_dwordx4 v[180:183], v254, s[8:11], s79 offen sc1
    s_add_u32 m0, s43, 114688
    s_add_u32 s101, s47, 36864
    buffer_load_dwordx4 v220, s[24:27], s101 offen  lds
    ds_read_b64_tr_b16 a[12:13], v214 offset:34816
    ds_read_b64_tr_b16 a[14:15], v214 offset:35840
    v_mfma_f32_32x32x16_bf16 v[160:175], a[20:23], a[68:71], v[160:175]
    v_lshrrev_b32 v119, 5, v255
    s_waitcnt lgkmcnt(4)
    ds_read_b64_tr_b16 a[16:17], v214 offset:28672
    ds_read_b64_tr_b16 a[18:19], v214 offset:29696
    v_mfma_f32_32x32x16_bf16 v[160:175], a[0:3], a[72:75], v[160:175]
    v_lshlrev_b32 v119, 2, v119
    ds_read_b64_tr_b16 a[20:21], v214 offset:30720
    ds_read_b64_tr_b16 a[22:23], v214 offset:31744
    v_mfma_f32_32x32x16_bf16 v[160:175], a[4:7], a[76:79], v[160:175]
    v_sub_u32 v118, v118, v119
    s_waitcnt lgkmcnt(4)
    ds_read_b64_tr_b16 a[0:1], v215 offset:0
    ds_read_b64_tr_b16 a[2:3], v215 offset:1024
    v_mfma_f32_32x32x16_bf16 v[160:175], a[8:11], a[88:91], v[160:175]
    v_mov_b32 v120, 0x3f80
    s_add_u32 m0, s43, 115712
    s_add_u32 s101, s48, 46080
    buffer_load_dwordx4 v220, s[24:27], s101 offen  lds
    ds_read_b64_tr_b16 a[4:5], v215 offset:2048
    ds_read_b64_tr_b16 a[6:7], v215 offset:3072
    v_mfma_f32_32x32x16_bf16 v[160:175], a[12:15], a[92:95], v[160:175]
    v_mov_b32 v121, 0x3f800000
    s_waitcnt lgkmcnt(4)
    ds_read_b64_tr_b16 a[8:9], v215 offset:4096
    ds_read_b64_tr_b16 a[10:11], v215 offset:5120
    v_mfma_f32_32x32x16_bf16 v[160:175], a[16:19], a[80:83], v[160:175]
    v_cmp_eq_u32 vcc, 0, v118
    ds_read_b64_tr_b16 a[12:13], v215 offset:6144
    ds_read_b64_tr_b16 a[14:15], v215 offset:7168
    v_mfma_f32_32x32x16_bf16 v[160:175], a[20:23], a[84:87], v[160:175]
    v_cmp_eq_u32 s[4:5], 1, v118
    s_nop 0
    s_waitcnt lgkmcnt(4)
    ds_read_b64_tr_b16 a[16:17], v215 offset:8192
    ds_read_b64_tr_b16 a[18:19], v215 offset:9216
    v_mfma_f32_32x32x16_bf16 v[144:159], a[0:3], a[24:27], 0
    v_cndmask_b32 v122, 0, v120, vcc
    s_add_u32 m0, s43, 116736
    s_add_u32 s101, s48, 55296
    buffer_load_dwordx4 v220, s[24:27], s101 offen  lds
    ds_read_b64_tr_b16 a[20:21], v215 offset:10240
    ds_read_b64_tr_b16 a[22:23], v215 offset:11264
    v_mfma_f32_32x32x16_bf16 v[144:159], a[4:7], a[28:31], v[144:159]
    v_cndmask_b32 v123, 0, v121, s[4:5]
    s_waitcnt lgkmcnt(4)
    ds_read_b64_tr_b16 a[0:1], v215 offset:12288
    ds_read_b64_tr_b16 a[2:3], v215 offset:13312
    v_mfma_f32_32x32x16_bf16 v[144:159], a[8:11], a[32:35], v[144:159]
    v_add_u32 v212, 73728, v209
    ds_read_b64_tr_b16 a[4:5], v215 offset:14336
    ds_read_b64_tr_b16 a[6:7], v215 offset:15360
    v_mfma_f32_32x32x16_bf16 v[144:159], a[12:15], a[36:39], v[144:159]
    v_xor_b32 v213, 64, v212
    s_waitcnt lgkmcnt(4)
    ds_read_b64_tr_b16 a[8:9], v215 offset:16384
    ds_read_b64_tr_b16 a[10:11], v215 offset:17408
    v_mfma_f32_32x32x16_bf16 v[144:159], a[16:19], a[40:43], v[144:159]
    v_cvt_pk_bf16_f32 v184, v160, v161
    s_add_u32 m0, s43, 117760
    s_add_u32 s101, s48, 64512
    buffer_load_dwordx4 v220, s[24:27], s101 offen  lds
    ds_read_b64_tr_b16 a[12:13], v215 offset:18432
    ds_read_b64_tr_b16 a[14:15], v215 offset:19456
    v_mfma_f32_32x32x16_bf16 v[144:159], a[20:23], a[44:47], v[144:159]
    v_cvt_pk_bf16_f32 v185, v162, v163
    s_waitcnt lgkmcnt(4)
    ds_read_b64_tr_b16 a[16:17], v215 offset:20480
    ds_read_b64_tr_b16 a[18:19], v215 offset:21504
    v_mfma_f32_32x32x16_bf16 v[144:159], a[0:3], a[48:51], v[144:159]
    v_cvt_pk_bf16_f32 v186, v164, v165
    ds_read_b64_tr_b16 a[20:21], v215 offset:22528
    ds_read_b64_tr_b16 a[22:23], v215 offset:23552
    v_mfma_f32_32x32x16_bf16 v[144:159], a[4:7], a[52:55], v[144:159]
    v_cvt_pk_bf16_f32 v187, v166, v167
    s_add_u32 s79, s55, 16777216
    buffer_store_dwordx4 v[184:187], v254, s[8:11], s79 offen sc1
    s_waitcnt lgkmcnt(4)
    ds_read_b64_tr_b16 a[0:1], v215 offset:24576
    ds_read_b64_tr_b16 a[2:3], v215 offset:25600
    v_mfma_f32_32x32x16_bf16 v[144:159], a[8:11], a[56:59], v[144:159]
    v_cvt_pk_bf16_f32 v188, v168, v169
    s_add_u32 m0, s43, 118784
    s_add_u32 s101, s48, 73728
    buffer_load_dwordx4 v220, s[24:27], s101 offen  lds
    ds_read_b64_tr_b16 a[4:5], v215 offset:26624
    ds_read_b64_tr_b16 a[6:7], v215 offset:27648
    v_mfma_f32_32x32x16_bf16 v[144:159], a[12:15], a[60:63], v[144:159]
    v_cvt_pk_bf16_f32 v189, v170, v171
    s_waitcnt lgkmcnt(4)
    ds_read_b64_tr_b16 a[8:9], v215 offset:32768
    ds_read_b64_tr_b16 a[10:11], v215 offset:33792
    v_mfma_f32_32x32x16_bf16 v[144:159], a[16:19], a[64:67], v[144:159]
    v_cvt_pk_bf16_f32 v190, v172, v173
    ds_read_b64_tr_b16 a[12:13], v215 offset:34816
    ds_read_b64_tr_b16 a[14:15], v215 offset:35840
    v_mfma_f32_32x32x16_bf16 v[144:159], a[20:23], a[68:71], v[144:159]
    v_cvt_pk_bf16_f32 v191, v174, v175
    s_add_u32 s79, s55, 17825792
    buffer_store_dwordx4 v[188:191], v254, s[8:11], s79 offen sc1
    s_waitcnt lgkmcnt(4)
    ds_read_b64_tr_b16 a[16:17], v215 offset:28672
    ds_read_b64_tr_b16 a[18:19], v215 offset:29696
    v_mfma_f32_32x32x16_bf16 v[144:159], a[0:3], a[72:75], v[144:159]
    s_waitcnt vmcnt(14)
    s_barrier
    v_add_u32 v220, 896, v219
    ds_read_b64_tr_b16 a[20:21], v215 offset:30720
    ds_read_b64_tr_b16 a[22:23], v215 offset:31744
    v_mfma_f32_32x32x16_bf16 v[144:159], a[4:7], a[76:79], v[144:159]
    v_or_b32 v244, v122, v123
    s_add_u32 m0, s43, 0
    s_add_u32 s101, s47, 0
    buffer_load_dwordx4 v220, s[24:27], s101 offen  lds
    s_waitcnt lgkmcnt(4)
    ds_read_b64_tr_b16 a[0:1], v212 offset:0
    ds_read_b64_tr_b16 a[2:3], v212 offset:1024
    v_mfma_f32_32x32x16_bf16 v[144:159], a[8:11], a[88:91], v[144:159]
    v_cmp_eq_u32 vcc, 2, v118
    ds_read_b64_tr_b16 a[4:5], v212 offset:2048
    ds_read_b64_tr_b16 a[6:7], v212 offset:3072
    v_mfma_f32_32x32x16_bf16 v[144:159], a[12:15], a[92:95], v[144:159]
    v_cmp_eq_u32 s[4:5], 3, v118
    s_nop 0
    s_waitcnt lgkmcnt(4)
    ds_read_b64_tr_b16 a[8:9], v212 offset:4096
    ds_read_b64_tr_b16 a[10:11], v212 offset:5120
    v_mfma_f32_32x32x16_bf16 v[144:159], a[16:19], a[80:83], v[144:159]
    v_cndmask_b32 v122, 0, v120, vcc
    s_add_u32 m0, s43, 1024
    s_add_u32 s101, s47, 9216
    buffer_load_dwordx4 v220, s[24:27], s101 offen  lds
    ds_read_b64_tr_b16 a[12:13], v212 offset:6144
    ds_read_b64_tr_b16 a[14:15], v212 offset:7168
    v_mfma_f32_32x32x16_bf16 v[144:159], a[20:23], a[84:87], v[144:159]
    v_cndmask_b32 v123, 0, v121, s[4:5]
    v_mfma_f32_32x32x16_bf16 v[48:63], a[192:195], v[4:7], 0
    v_exp_f32 v32, v32
    v_exp_f32 v33, v33
    v_exp_f32 v34, v34
    v_exp_f32 v35, v35
    v_mfma_f32_32x32x8bf16_1k v[48:63], a[196:197], v[18:19], v[48:63]
    v_exp_f32 v36, v36
    v_exp_f32 v37, v37
    v_cvt_pk_bf16_f32 v64, v32, v33
    v_exp_f32 v38, v38
    v_exp_f32 v39, v39
    v_cvt_pk_bf16_f32 v65, v34, v35
    v_mfma_f32_32x32x16_bf16 a[144:159], a[184:187], v[72:75], a[144:159]
    v_exp_f32 v40, v40
    v_exp_f32 v41, v41
    v_cvt_pk_bf16_f32 v66, v36, v37
    v_exp_f32 v42, v42
    v_exp_f32 v43, v43
    v_cvt_pk_bf16_f32 v67, v38, v39
    v_mfma_f32_32x32x16_bf16 a[144:159], a[188:191], v[76:79], a[144:159]
    v_exp_f32 v44, v44
    v_exp_f32 v45, v45
    v_cvt_pk_bf16_f32 v68, v40, v41
    v_exp_f32 v46, v46
    v_exp_f32 v47, v47
    v_cvt_pk_bf16_f32 v69, v42, v43
    v_cvt_pk_bf16_f32 v70, v44, v45
    v_cvt_pk_bf16_f32 v71, v46, v47
    v_mfma_f32_32x32x16_bf16 v[32:47], a[192:195], v[8:11], 0
    v_exp_f32 v48, v48
    v_exp_f32 v49, v49
    v_exp_f32 v50, v50
    v_exp_f32 v51, v51
    buffer_load_dwordx2 a[176:177], v26, s[8:11], s62 offen offset:1792 sc1
    buffer_load_dwordx2 a[178:179], v26, s[8:11], s63 offen offset:1792 sc1
    v_mfma_f32_32x32x8bf16_1k v[32:47], a[196:197], v[20:21], v[32:47]
    v_exp_f32 v52, v52
    v_exp_f32 v53, v53
    v_cvt_pk_bf16_f32 v72, v48, v49
    v_exp_f32 v54, v54
    v_exp_f32 v55, v55
    v_cvt_pk_bf16_f32 v73, v50, v51
    v_mfma_f32_32x32x16_bf16 a[96:111], a[200:203], v[64:67], a[96:111]
    v_exp_f32 v56, v56
    v_exp_f32 v57, v57
    v_cvt_pk_bf16_f32 v74, v52, v53
    v_exp_f32 v58, v58
    v_exp_f32 v59, v59
    v_cvt_pk_bf16_f32 v75, v54, v55
    buffer_load_dword a180, v24, s[8:11], s64 offen offset:1792 sc1
    v_mfma_f32_32x32x16_bf16 a[96:111], a[204:207], v[68:71], a[96:111]
    v_exp_f32 v60, v60
    v_exp_f32 v61, v61
    v_cvt_pk_bf16_f32 v76, v56, v57
    v_exp_f32 v62, v62
    v_exp_f32 v63, v63
    v_cvt_pk_bf16_f32 v77, v58, v59
    v_cvt_pk_bf16_f32 v78, v60, v61
    v_cvt_pk_bf16_f32 v79, v62, v63
    v_mfma_f32_32x32x16_bf16 v[48:63], a[192:195], v[12:15], 0
    v_exp_f32 v32, v32
    v_exp_f32 v33, v33
    v_exp_f32 v34, v34
    v_exp_f32 v35, v35
    v_mfma_f32_32x32x8bf16_1k v[48:63], a[196:197], v[22:23], v[48:63]
    v_exp_f32 v36, v36
    v_exp_f32 v37, v37
    v_cvt_pk_bf16_f32 v64, v32, v33
    v_exp_f32 v38, v38
    v_exp_f32 v39, v39
    v_cvt_pk_bf16_f32 v65, v34, v35
    buffer_load_dwordx4 a[184:187], v25, s[8:11], 0 offen offset:3456 sc1
    buffer_load_dwordx4 a[188:191], v25, s[8:11], 0 offen offset:4032 sc1
    v_mfma_f32_32x32x16_bf16 a[112:127], a[200:203], v[72:75], a[112:127]
    v_exp_f32 v40, v40
    v_exp_f32 v41, v41
    v_cvt_pk_bf16_f32 v66, v36, v37
    v_exp_f32 v42, v42
    v_exp_f32 v43, v43
    v_cvt_pk_bf16_f32 v67, v38, v39
    v_mfma_f32_32x32x16_bf16 a[112:127], a[204:207], v[76:79], a[112:127]
    v_exp_f32 v44, v44
    v_exp_f32 v45, v45
    v_cvt_pk_bf16_f32 v68, v40, v41
    v_exp_f32 v46, v46
    v_exp_f32 v47, v47
    v_cvt_pk_bf16_f32 v69, v42, v43
    v_cvt_pk_bf16_f32 v70, v44, v45
    v_cvt_pk_bf16_f32 v71, v46, v47
    s_waitcnt vmcnt(63)
    v_mfma_f32_32x32x16_bf16 v[32:47], a[208:211], v[0:3], 0
    v_exp_f32 v48, v48
    v_exp_f32 v49, v49
    v_exp_f32 v50, v50
    v_exp_f32 v51, v51
    v_mfma_f32_32x32x8bf16_1k v[32:47], a[212:213], v[16:17], v[32:47]
    v_exp_f32 v52, v52
    v_exp_f32 v53, v53
    v_cvt_pk_bf16_f32 v72, v48, v49
    v_exp_f32 v54, v54
    v_exp_f32 v55, v55
    v_cvt_pk_bf16_f32 v73, v50, v51
    v_mfma_f32_32x32x16_bf16 a[128:143], a[200:203], v[64:67], a[128:143]
    v_exp_f32 v56, v56
    v_exp_f32 v57, v57
    v_cvt_pk_bf16_f32 v74, v52, v53
    v_exp_f32 v58, v58
    v_exp_f32 v59, v59
    v_cvt_pk_bf16_f32 v75, v54, v55
    v_mfma_f32_32x32x16_bf16 a[128:143], a[204:207], v[68:71], a[128:143]
    v_exp_f32 v60, v60
    v_exp_f32 v61, v61
    v_cvt_pk_bf16_f32 v76, v56, v57
    v_exp_f32 v62, v62
    v_exp_f32 v63, v63
    v_cvt_pk_bf16_f32 v77, v58, v59
    v_cvt_pk_bf16_f32 v78, v60, v61
    v_cvt_pk_bf16_f32 v79, v62, v63
    s_waitcnt lgkmcnt(4)
    ds_read_b64_tr_b16 a[16:17], v212 offset:8192
    ds_read_b64_tr_b16 a[18:19], v212 offset:9216
    v_mfma_f32_32x32x16_bf16 v[160:175], a[0:3], a[24:27], 0
    v_or_b32 v245, v122, v123
    ds_read_b64_tr_b16 a[20:21], v212 offset:10240
    ds_read_b64_tr_b16 a[22:23], v212 offset:11264
    v_mfma_f32_32x32x16_bf16 v[160:175], a[4:7], a[28:31], v[160:175]
    v_cmp_eq_u32 vcc, 8, v118
    s_waitcnt lgkmcnt(4)
    ds_read_b64_tr_b16 a[0:1], v212 offset:12288
    ds_read_b64_tr_b16 a[2:3], v212 offset:13312
    v_mfma_f32_32x32x16_bf16 v[160:175], a[8:11], a[32:35], v[160:175]
    v_cmp_eq_u32 s[4:5], 9, v118
    s_nop 0
    s_add_u32 m0, s43, 2048
    s_add_u32 s101, s47, 18432
    buffer_load_dwordx4 v220, s[24:27], s101 offen  lds
    ds_read_b64_tr_b16 a[4:5], v212 offset:14336
    ds_read_b64_tr_b16 a[6:7], v212 offset:15360
    v_mfma_f32_32x32x16_bf16 v[160:175], a[12:15], a[36:39], v[160:175]
    v_cvt_pk_bf16_f32 v176, v144, v145
    s_waitcnt lgkmcnt(4)
    ds_read_b64_tr_b16 a[8:9], v212 offset:16384
    ds_read_b64_tr_b16 a[10:11], v212 offset:17408
    v_mfma_f32_32x32x16_bf16 v[160:175], a[16:19], a[40:43], v[160:175]
    v_cvt_pk_bf16_f32 v177, v146, v147
    ds_read_b64_tr_b16 a[12:13], v212 offset:18432
    ds_read_b64_tr_b16 a[14:15], v212 offset:19456
    v_mfma_f32_32x32x16_bf16 v[160:175], a[20:23], a[44:47], v[160:175]
    v_cvt_pk_bf16_f32 v178, v148, v149
    s_waitcnt lgkmcnt(4)
    ds_read_b64_tr_b16 a[16:17], v212 offset:20480
    ds_read_b64_tr_b16 a[18:19], v212 offset:21504
    v_mfma_f32_32x32x16_bf16 v[160:175], a[0:3], a[48:51], v[160:175]
    v_cvt_pk_bf16_f32 v179, v150, v151
    s_add_u32 s79, s55, 18874368
    buffer_store_dwordx4 v[176:179], v254, s[8:11], s79 offen sc1
    s_add_u32 m0, s43, 3072
    s_add_u32 s101, s47, 27648
    buffer_load_dwordx4 v220, s[24:27], s101 offen  lds
    ds_read_b64_tr_b16 a[20:21], v212 offset:22528
    ds_read_b64_tr_b16 a[22:23], v212 offset:23552
    v_mfma_f32_32x32x16_bf16 v[160:175], a[4:7], a[52:55], v[160:175]
    v_cvt_pk_bf16_f32 v180, v152, v153
    s_waitcnt lgkmcnt(4)
    ds_read_b64_tr_b16 a[0:1], v212 offset:24576
    ds_read_b64_tr_b16 a[2:3], v212 offset:25600
    v_mfma_f32_32x32x16_bf16 v[160:175], a[8:11], a[56:59], v[160:175]
    v_cvt_pk_bf16_f32 v181, v154, v155
    ds_read_b64_tr_b16 a[4:5], v212 offset:26624
    ds_read_b64_tr_b16 a[6:7], v212 offset:27648
    v_mfma_f32_32x32x16_bf16 v[160:175], a[12:15], a[60:63], v[160:175]
    v_cvt_pk_bf16_f32 v182, v156, v157
    s_waitcnt lgkmcnt(4)
    ds_read_b64_tr_b16 a[8:9], v212 offset:32768
    ds_read_b64_tr_b16 a[10:11], v212 offset:33792
    v_mfma_f32_32x32x16_bf16 v[160:175], a[16:19], a[64:67], v[160:175]
    v_cvt_pk_bf16_f32 v183, v158, v159
    s_add_u32 s79, s55, 19922944
    buffer_store_dwordx4 v[180:183], v254, s[8:11], s79 offen sc1
    s_add_u32 m0, s43, 4096
    s_add_u32 s101, s47, 36864
    buffer_load_dwordx4 v220, s[24:27], s101 offen  lds
    ds_read_b64_tr_b16 a[12:13], v212 offset:34816
    ds_read_b64_tr_b16 a[14:15], v212 offset:35840
    v_mfma_f32_32x32x16_bf16 v[160:175], a[20:23], a[68:71], v[160:175]
    v_cndmask_b32 v122, 0, v120, vcc
    s_waitcnt lgkmcnt(4)
    ds_read_b64_tr_b16 a[16:17], v212 offset:28672
    ds_read_b64_tr_b16 a[18:19], v212 offset:29696
    v_mfma_f32_32x32x16_bf16 v[160:175], a[0:3], a[72:75], v[160:175]
    v_cndmask_b32 v123, 0, v121, s[4:5]
    ds_read_b64_tr_b16 a[20:21], v212 offset:30720
    ds_read_b64_tr_b16 a[22:23], v212 offset:31744
    v_mfma_f32_32x32x16_bf16 v[160:175], a[4:7], a[76:79], v[160:175]
    v_or_b32 v246, v122, v123
    s_waitcnt lgkmcnt(4)
    ds_read_b64_tr_b16 a[0:1], v213 offset:0
    ds_read_b64_tr_b16 a[2:3], v213 offset:1024
    v_mfma_f32_32x32x16_bf16 v[160:175], a[8:11], a[88:91], v[160:175]
    v_cmp_eq_u32 vcc, 10, v118
    s_add_u32 m0, s43, 5120
    s_add_u32 s101, s48, 46080
    buffer_load_dwordx4 v220, s[24:27], s101 offen  lds
    ds_read_b64_tr_b16 a[4:5], v213 offset:2048
    ds_read_b64_tr_b16 a[6:7], v213 offset:3072
    v_mfma_f32_32x32x16_bf16 v[160:175], a[12:15], a[92:95], v[160:175]
    v_cmp_eq_u32 s[4:5], 11, v118
    s_nop 0
    s_waitcnt lgkmcnt(4)
    ds_read_b64_tr_b16 a[8:9], v213 offset:4096
    ds_read_b64_tr_b16 a[10:11], v213 offset:5120
    v_mfma_f32_32x32x16_bf16 v[160:175], a[16:19], a[80:83], v[160:175]
    v_cndmask_b32 v122, 0, v120, vcc
    ds_read_b64_tr_b16 a[12:13], v213 offset:6144
    ds_read_b64_tr_b16 a[14:15], v213 offset:7168
    v_mfma_f32_32x32x16_bf16 v[160:175], a[20:23], a[84:87], v[160:175]
    v_cndmask_b32 v123, 0, v121, s[4:5]
    s_waitcnt lgkmcnt(4)
    ds_read_b64_tr_b16 a[16:17], v213 offset:8192
    ds_read_b64_tr_b16 a[18:19], v213 offset:9216
    v_mfma_f32_32x32x16_bf16 v[144:159], a[0:3], a[24:27], 0
    v_or_b32 v247, v122, v123
    s_add_u32 m0, s43, 6144
    s_add_u32 s101, s48, 55296
    buffer_load_dwordx4 v220, s[24:27], s101 offen  lds
    ds_read_b64_tr_b16 a[20:21], v213 offset:10240
    ds_read_b64_tr_b16 a[22:23], v213 offset:11264
    v_mfma_f32_32x32x16_bf16 v[144:159], a[4:7], a[28:31], v[144:159]
    v_cmp_eq_u32 vcc, 16, v118
    s_waitcnt lgkmcnt(4)
    ds_read_b64_tr_b16 a[0:1], v213 offset:12288
    ds_read_b64_tr_b16 a[2:3], v213 offset:13312
    v_mfma_f32_32x32x16_bf16 v[144:159], a[8:11], a[32:35], v[144:159]
    v_add_u32 v214, 110592, v209
    ds_read_b64_tr_b16 a[4:5], v213 offset:14336
    ds_read_b64_tr_b16 a[6:7], v213 offset:15360
    v_mfma_f32_32x32x16_bf16 v[144:159], a[12:15], a[36:39], v[144:159]
    v_xor_b32 v215, 64, v214
    s_waitcnt lgkmcnt(4)
    ds_read_b64_tr_b16 a[8:9], v213 offset:16384
    ds_read_b64_tr_b16 a[10:11], v213 offset:17408
    v_mfma_f32_32x32x16_bf16 v[144:159], a[16:19], a[40:43], v[144:159]
    v_cvt_pk_bf16_f32 v184, v160, v161
    s_add_u32 m0, s43, 7168
    s_add_u32 s101, s48, 64512
    buffer_load_dwordx4 v220, s[24:27], s101 offen  lds
    ds_read_b64_tr_b16 a[12:13], v213 offset:18432
    ds_read_b64_tr_b16 a[14:15], v213 offset:19456
    v_mfma_f32_32x32x16_bf16 v[144:159], a[20:23], a[44:47], v[144:159]
    v_cvt_pk_bf16_f32 v185, v162, v163
    s_waitcnt lgkmcnt(4)
    ds_read_b64_tr_b16 a[16:17], v213 offset:20480
    ds_read_b64_tr_b16 a[18:19], v213 offset:21504
    v_mfma_f32_32x32x16_bf16 v[144:159], a[0:3], a[48:51], v[144:159]
    v_cvt_pk_bf16_f32 v186, v164, v165
    ds_read_b64_tr_b16 a[20:21], v213 offset:22528
    ds_read_b64_tr_b16 a[22:23], v213 offset:23552
    v_mfma_f32_32x32x16_bf16 v[144:159], a[4:7], a[52:55], v[144:159]
    v_cvt_pk_bf16_f32 v187, v166, v167
    s_add_u32 s79, s55, 20971520
    buffer_store_dwordx4 v[184:187], v254, s[8:11], s79 offen sc1
    s_waitcnt lgkmcnt(4)
    ds_read_b64_tr_b16 a[0:1], v213 offset:24576
    ds_read_b64_tr_b16 a[2:3], v213 offset:25600
    v_mfma_f32_32x32x16_bf16 v[144:159], a[8:11], a[56:59], v[144:159]
    v_cvt_pk_bf16_f32 v188, v168, v169
    s_add_u32 m0, s43, 8192
    s_add_u32 s101, s48, 73728
    buffer_load_dwordx4 v220, s[24:27], s101 offen  lds
    ds_read_b64_tr_b16 a[4:5], v213 offset:26624
    ds_read_b64_tr_b16 a[6:7], v213 offset:27648
    v_mfma_f32_32x32x16_bf16 v[144:159], a[12:15], a[60:63], v[144:159]
    v_cvt_pk_bf16_f32 v189, v170, v171
    s_waitcnt lgkmcnt(4)
    ds_read_b64_tr_b16 a[8:9], v213 offset:32768
    ds_read_b64_tr_b16 a[10:11], v213 offset:33792
    v_mfma_f32_32x32x16_bf16 v[144:159], a[16:19], a[64:67], v[144:159]
    v_cvt_pk_bf16_f32 v190, v172, v173
    ds_read_b64_tr_b16 a[12:13], v213 offset:34816
    ds_read_b64_tr_b16 a[14:15], v213 offset:35840
    v_mfma_f32_32x32x16_bf16 v[144:159], a[20:23], a[68:71], v[144:159]
    v_cvt_pk_bf16_f32 v191, v174, v175
    s_add_u32 s79, s55, 22020096
    buffer_store_dwordx4 v[188:191], v254, s[8:11], s79 offen sc1
    s_waitcnt lgkmcnt(4)
    ds_read_b64_tr_b16 a[16:17], v213 offset:28672
    ds_read_b64_tr_b16 a[18:19], v213 offset:29696
    v_mfma_f32_32x32x16_bf16 v[144:159], a[0:3], a[72:75], v[144:159]
    s_waitcnt vmcnt(19)
    s_barrier
    v_add_u32 v220, 1024, v219
    ds_read_b64_tr_b16 a[20:21], v213 offset:30720
    ds_read_b64_tr_b16 a[22:23], v213 offset:31744
    v_mfma_f32_32x32x16_bf16 v[144:159], a[4:7], a[76:79], v[144:159]
    v_cmp_eq_u32 s[4:5], 17, v118
    s_nop 0
    s_add_u32 m0, s43, 36864
    s_add_u32 s101, s47, 0
    buffer_load_dwordx4 v220, s[24:27], s101 offen  lds
    s_waitcnt lgkmcnt(4)
    ds_read_b64_tr_b16 a[0:1], v214 offset:0
    ds_read_b64_tr_b16 a[2:3], v214 offset:1024
    v_mfma_f32_32x32x16_bf16 v[144:159], a[8:11], a[88:91], v[144:159]
    v_cndmask_b32 v122, 0, v120, vcc
    ds_read_b64_tr_b16 a[4:5], v214 offset:2048
    ds_read_b64_tr_b16 a[6:7], v214 offset:3072
    v_mfma_f32_32x32x16_bf16 v[144:159], a[12:15], a[92:95], v[144:159]
    v_cndmask_b32 v123, 0, v121, s[4:5]
    s_waitcnt lgkmcnt(4)
    ds_read_b64_tr_b16 a[8:9], v214 offset:4096
    ds_read_b64_tr_b16 a[10:11], v214 offset:5120
    v_mfma_f32_32x32x16_bf16 v[144:159], a[16:19], a[80:83], v[144:159]
    v_or_b32 v248, v122, v123
    s_add_u32 m0, s43, 37888
    s_add_u32 s101, s47, 9216
    buffer_load_dwordx4 v220, s[24:27], s101 offen  lds
    ds_read_b64_tr_b16 a[12:13], v214 offset:6144
    ds_read_b64_tr_b16 a[14:15], v214 offset:7168
    v_mfma_f32_32x32x16_bf16 v[144:159], a[20:23], a[84:87], v[144:159]
    v_cmp_eq_u32 vcc, 18, v118
    s_waitcnt lgkmcnt(4)
    ds_read_b64_tr_b16 a[16:17], v214 offset:8192
    ds_read_b64_tr_b16 a[18:19], v214 offset:9216
    v_mfma_f32_32x32x16_bf16 v[160:175], a[0:3], a[24:27], 0
    v_cmp_eq_u32 s[4:5], 19, v118
    s_nop 0
    ds_read_b64_tr_b16 a[20:21], v214 offset:10240
    ds_read_b64_tr_b16 a[22:23], v214 offset:11264
    v_mfma_f32_32x32x16_bf16 v[160:175], a[4:7], a[28:31], v[160:175]
    v_cndmask_b32 v122, 0, v120, vcc
    s_waitcnt lgkmcnt(4)
    ds_read_b64_tr_b16 a[0:1], v214 offset:12288
    ds_read_b64_tr_b16 a[2:3], v214 offset:13312
    v_mfma_f32_32x32x16_bf16 v[160:175], a[8:11], a[32:35], v[160:175]
    v_cndmask_b32 v123, 0, v121, s[4:5]
    s_add_u32 m0, s43, 38912
    s_add_u32 s101, s47, 18432
    buffer_load_dwordx4 v220, s[24:27], s101 offen  lds
    ds_read_b64_tr_b16 a[4:5], v214 offset:14336
    ds_read_b64_tr_b16 a[6:7], v214 offset:15360
    v_mfma_f32_32x32x16_bf16 v[160:175], a[12:15], a[36:39], v[160:175]
    v_cvt_pk_bf16_f32 v176, v144, v145
    s_waitcnt lgkmcnt(4)
    ds_read_b64_tr_b16 a[8:9], v214 offset:16384
    ds_read_b64_tr_b16 a[10:11], v214 offset:17408
    v_mfma_f32_32x32x16_bf16 v[160:175], a[16:19], a[40:43], v[160:175]
    v_cvt_pk_bf16_f32 v177, v146, v147
    ds_read_b64_tr_b16 a[12:13], v214 offset:18432
    ds_read_b64_tr_b16 a[14:15], v214 offset:19456
    v_mfma_f32_32x32x16_bf16 v[160:175], a[20:23], a[44:47], v[160:175]
    v_cvt_pk_bf16_f32 v178, v148, v149
    s_waitcnt lgkmcnt(4)
    ds_read_b64_tr_b16 a[16:17], v214 offset:20480
    ds_read_b64_tr_b16 a[18:19], v214 offset:21504
    v_mfma_f32_32x32x16_bf16 v[160:175], a[0:3], a[48:51], v[160:175]
    v_cvt_pk_bf16_f32 v179, v150, v151
    s_add_u32 s79, s55, 23068672
    buffer_store_dwordx4 v[176:179], v254, s[8:11], s79 offen sc1
    s_add_u32 m0, s43, 39936
    s_add_u32 s101, s47, 27648
    buffer_load_dwordx4 v220, s[24:27], s101 offen  lds
    ds_read_b64_tr_b16 a[20:21], v214 offset:22528
    ds_read_b64_tr_b16 a[22:23], v214 offset:23552
    v_mfma_f32_32x32x16_bf16 v[160:175], a[4:7], a[52:55], v[160:175]
    v_cvt_pk_bf16_f32 v180, v152, v153
    s_waitcnt lgkmcnt(4)
    ds_read_b64_tr_b16 a[0:1], v214 offset:24576
    ds_read_b64_tr_b16 a[2:3], v214 offset:25600
    v_mfma_f32_32x32x16_bf16 v[160:175], a[8:11], a[56:59], v[160:175]
    v_cvt_pk_bf16_f32 v181, v154, v155
    ds_read_b64_tr_b16 a[4:5], v214 offset:26624
    ds_read_b64_tr_b16 a[6:7], v214 offset:27648
    v_mfma_f32_32x32x16_bf16 v[160:175], a[12:15], a[60:63], v[160:175]
    v_cvt_pk_bf16_f32 v182, v156, v157
    s_waitcnt lgkmcnt(4)
    ds_read_b64_tr_b16 a[8:9], v214 offset:32768
    ds_read_b64_tr_b16 a[10:11], v214 offset:33792
    v_mfma_f32_32x32x16_bf16 v[160:175], a[16:19], a[64:67], v[160:175]
    v_cvt_pk_bf16_f32 v183, v158, v159
    s_add_u32 s79, s55, 24117248
    buffer_store_dwordx4 v[180:183], v254, s[8:11], s79 offen sc1
    s_add_u32 m0, s43, 40960
    s_add_u32 s101, s47, 36864
    buffer_load_dwordx4 v220, s[24:27], s101 offen  lds
    ds_read_b64_tr_b16 a[12:13], v214 offset:34816
    ds_read_b64_tr_b16 a[14:15], v214 offset:35840
    v_mfma_f32_32x32x16_bf16 v[160:175], a[20:23], a[68:71], v[160:175]
    v_or_b32 v249, v122, v123
    s_waitcnt lgkmcnt(4)
    ds_read_b64_tr_b16 a[16:17], v214 offset:28672
    ds_read_b64_tr_b16 a[18:19], v214 offset:29696
    v_mfma_f32_32x32x16_bf16 v[160:175], a[0:3], a[72:75], v[160:175]
    v_cmp_eq_u32 vcc, 24, v118
    ds_read_b64_tr_b16 a[20:21], v214 offset:30720
    ds_read_b64_tr_b16 a[22:23], v214 offset:31744
    v_mfma_f32_32x32x16_bf16 v[160:175], a[4:7], a[76:79], v[160:175]
    v_cmp_eq_u32 s[4:5], 25, v118
    s_nop 0
    s_waitcnt lgkmcnt(4)
    ds_read_b64_tr_b16 a[0:1], v215 offset:0
    ds_read_b64_tr_b16 a[2:3], v215 offset:1024
    v_mfma_f32_32x32x16_bf16 v[160:175], a[8:11], a[88:91], v[160:175]
    v_cndmask_b32 v122, 0, v120, vcc
    s_add_u32 m0, s43, 41984
    s_add_u32 s101, s48, 46080
    buffer_load_dwordx4 v220, s[24:27], s101 offen  lds
    ds_read_b64_tr_b16 a[4:5], v215 offset:2048
    ds_read_b64_tr_b16 a[6:7], v215 offset:3072
    v_mfma_f32_32x32x16_bf16 v[160:175], a[12:15], a[92:95], v[160:175]
    v_cndmask_b32 v123, 0, v121, s[4:5]
    s_waitcnt lgkmcnt(4)
    ds_read_b64_tr_b16 a[8:9], v215 offset:4096
    ds_read_b64_tr_b16 a[10:11], v215 offset:5120
    v_mfma_f32_32x32x16_bf16 v[160:175], a[16:19], a[80:83], v[160:175]
    v_or_b32 v250, v122, v123
    ds_read_b64_tr_b16 a[12:13], v215 offset:6144
    ds_read_b64_tr_b16 a[14:15], v215 offset:7168
    v_mfma_f32_32x32x16_bf16 v[160:175], a[20:23], a[84:87], v[160:175]
    v_cmp_eq_u32 vcc, 26, v118
    s_waitcnt lgkmcnt(4)
    ds_read_b64_tr_b16 a[16:17], v215 offset:8192
    ds_read_b64_tr_b16 a[18:19], v215 offset:9216
    v_mfma_f32_32x32x16_bf16 v[144:159], a[0:3], a[24:27], 0
    v_cmp_eq_u32 s[4:5], 27, v118
    s_nop 0
    s_add_u32 m0, s43, 43008
    s_add_u32 s101, s48, 55296
    buffer_load_dwordx4 v220, s[24:27], s101 offen  lds
    ds_read_b64_tr_b16 a[20:21], v215 offset:10240
    ds_read_b64_tr_b16 a[22:23], v215 offset:11264
    v_mfma_f32_32x32x16_bf16 v[144:159], a[4:7], a[28:31], v[144:159]
    v_cndmask_b32 v122, 0, v120, vcc
    s_waitcnt lgkmcnt(4)
    ds_read_b64_tr_b16 a[0:1], v215 offset:12288
    ds_read_b64_tr_b16 a[2:3], v215 offset:13312
    v_mfma_f32_32x32x16_bf16 v[144:159], a[8:11], a[32:35], v[144:159]
    v_add_u32 v212, 0, v209
    ds_read_b64_tr_b16 a[4:5], v215 offset:14336
    ds_read_b64_tr_b16 a[6:7], v215 offset:15360
    v_mfma_f32_32x32x16_bf16 v[144:159], a[12:15], a[36:39], v[144:159]
    v_xor_b32 v213, 64, v212
    s_waitcnt lgkmcnt(4)
    ds_read_b64_tr_b16 a[8:9], v215 offset:16384
    ds_read_b64_tr_b16 a[10:11], v215 offset:17408
    v_mfma_f32_32x32x16_bf16 v[144:159], a[16:19], a[40:43], v[144:159]
    v_cvt_pk_bf16_f32 v184, v160, v161
    s_add_u32 m0, s43, 44032
    s_add_u32 s101, s48, 64512
    buffer_load_dwordx4 v220, s[24:27], s101 offen  lds
    ds_read_b64_tr_b16 a[12:13], v215 offset:18432
    ds_read_b64_tr_b16 a[14:15], v215 offset:19456
    v_mfma_f32_32x32x16_bf16 v[144:159], a[20:23], a[44:47], v[144:159]
    v_cvt_pk_bf16_f32 v185, v162, v163
    s_waitcnt lgkmcnt(4)
    ds_read_b64_tr_b16 a[16:17], v215 offset:20480
    ds_read_b64_tr_b16 a[18:19], v215 offset:21504
    v_mfma_f32_32x32x16_bf16 v[144:159], a[0:3], a[48:51], v[144:159]
    v_cvt_pk_bf16_f32 v186, v164, v165
    ds_read_b64_tr_b16 a[20:21], v215 offset:22528
    ds_read_b64_tr_b16 a[22:23], v215 offset:23552
    v_mfma_f32_32x32x16_bf16 v[144:159], a[4:7], a[52:55], v[144:159]
    v_cvt_pk_bf16_f32 v187, v166, v167
    s_add_u32 s79, s55, 25165824
    buffer_store_dwordx4 v[184:187], v254, s[8:11], s79 offen sc1
    s_waitcnt lgkmcnt(4)
    ds_read_b64_tr_b16 a[0:1], v215 offset:24576
    ds_read_b64_tr_b16 a[2:3], v215 offset:25600
    v_mfma_f32_32x32x16_bf16 v[144:159], a[8:11], a[56:59], v[144:159]
    v_cvt_pk_bf16_f32 v188, v168, v169
    s_add_u32 m0, s43, 45056
    s_add_u32 s101, s48, 73728
    buffer_load_dwordx4 v220, s[24:27], s101 offen  lds
    ds_read_b64_tr_b16 a[4:5], v215 offset:26624
    ds_read_b64_tr_b16 a[6:7], v215 offset:27648
    v_mfma_f32_32x32x16_bf16 v[144:159], a[12:15], a[60:63], v[144:159]
    v_cvt_pk_bf16_f32 v189, v170, v171
    s_waitcnt lgkmcnt(4)
    ds_read_b64_tr_b16 a[8:9], v215 offset:32768
    ds_read_b64_tr_b16 a[10:11], v215 offset:33792
    v_mfma_f32_32x32x16_bf16 v[144:159], a[16:19], a[64:67], v[144:159]
    v_cvt_pk_bf16_f32 v190, v172, v173
    ds_read_b64_tr_b16 a[12:13], v215 offset:34816
    ds_read_b64_tr_b16 a[14:15], v215 offset:35840
    v_mfma_f32_32x32x16_bf16 v[144:159], a[20:23], a[68:71], v[144:159]
    v_cvt_pk_bf16_f32 v191, v174, v175
    s_add_u32 s79, s55, 26214400
    buffer_store_dwordx4 v[188:191], v254, s[8:11], s79 offen sc1
    s_waitcnt lgkmcnt(4)
    ds_read_b64_tr_b16 a[16:17], v215 offset:28672
    ds_read_b64_tr_b16 a[18:19], v215 offset:29696
    v_mfma_f32_32x32x16_bf16 v[144:159], a[0:3], a[72:75], v[144:159]
    s_waitcnt vmcnt(14)
    s_barrier
    ds_read_b64_tr_b16 a[20:21], v215 offset:30720
    ds_read_b64_tr_b16 a[22:23], v215 offset:31744
    v_mfma_f32_32x32x16_bf16 v[144:159], a[4:7], a[76:79], v[144:159]
    v_cndmask_b32 v123, 0, v121, s[4:5]
    s_waitcnt lgkmcnt(4)
    ds_read_b64_tr_b16 a[0:1], v212 offset:0
    ds_read_b64_tr_b16 a[2:3], v212 offset:1024
    v_mfma_f32_32x32x16_bf16 v[144:159], a[8:11], a[88:91], v[144:159]
    v_or_b32 v251, v122, v123
    ds_read_b64_tr_b16 a[4:5], v212 offset:2048
    ds_read_b64_tr_b16 a[6:7], v212 offset:3072
    v_mfma_f32_32x32x16_bf16 v[144:159], a[12:15], a[92:95], v[144:159]
    s_waitcnt lgkmcnt(4)
    ds_read_b64_tr_b16 a[8:9], v212 offset:4096
    ds_read_b64_tr_b16 a[10:11], v212 offset:5120
    v_mfma_f32_32x32x16_bf16 v[144:159], a[16:19], a[80:83], v[144:159]
    ds_read_b64_tr_b16 a[12:13], v212 offset:6144
    ds_read_b64_tr_b16 a[14:15], v212 offset:7168
    v_mfma_f32_32x32x16_bf16 v[144:159], a[20:23], a[84:87], v[144:159]
    v_mfma_f32_32x32x16_bf16 v[48:63], a[208:211], v[4:7], 0
    v_exp_f32 v32, v32
    v_exp_f32 v33, v33
    v_exp_f32 v34, v34
    v_exp_f32 v35, v35
    v_mfma_f32_32x32x8bf16_1k v[48:63], a[212:213], v[18:19], v[48:63]
    v_exp_f32 v36, v36
    v_exp_f32 v37, v37
    v_cvt_pk_bf16_f32 v64, v32, v33
    v_exp_f32 v38, v38
    v_exp_f32 v39, v39
    v_cvt_pk_bf16_f32 v65, v34, v35
    v_mfma_f32_32x32x16_bf16 a[144:159], a[200:203], v[72:75], a[144:159]
    v_exp_f32 v40, v40
    v_exp_f32 v41, v41
    v_cvt_pk_bf16_f32 v66, v36, v37
    v_exp_f32 v42, v42
    v_exp_f32 v43, v43
    v_cvt_pk_bf16_f32 v67, v38, v39
    v_mfma_f32_32x32x16_bf16 a[144:159], a[204:207], v[76:79], a[144:159]
    v_exp_f32 v44, v44
    v_exp_f32 v45, v45
    v_cvt_pk_bf16_f32 v68, v40, v41
    v_exp_f32 v46, v46
    v_exp_f32 v47, v47
    v_cvt_pk_bf16_f32 v69, v42, v43
    v_cvt_pk_bf16_f32 v70, v44, v45
    v_cvt_pk_bf16_f32 v71, v46, v47
    v_mfma_f32_32x32x16_bf16 v[32:47], a[208:211], v[8:11], 0
    v_exp_f32 v48, v48
    v_exp_f32 v49, v49
    v_exp_f32 v50, v50
    v_exp_f32 v51, v51
    buffer_load_dwordx2 a[192:193], v26, s[8:11], s62 offen offset:2048 sc1
    buffer_load_dwordx2 a[194:195], v26, s[8:11], s63 offen offset:2048 sc1
    v_mfma_f32_32x32x8bf16_1k v[32:47], a[212:213], v[20:21], v[32:47]
    v_exp_f32 v52, v52
    v_exp_f32 v53, v53
    v_cvt_pk_bf16_f32 v72, v48, v49
    v_exp_f32 v54, v54
    v_exp_f32 v55, v55
    v_cvt_pk_bf16_f32 v73, v50, v51
    v_mfma_f32_32x32x16_bf16 a[96:111], a[216:219], v[64:67], a[96:111]
    v_exp_f32 v56, v56
    v_exp_f32 v57, v57
    v_cvt_pk_bf16_f32 v74, v52, v53
    v_exp_f32 v58, v58
    v_exp_f32 v59, v59
    v_cvt_pk_bf16_f32 v75, v54, v55
    buffer_load_dword a196, v24, s[8:11], s64 offen offset:2048 sc1
    v_mfma_f32_32x32x16_bf16 a[96:111], a[220:223], v[68:71], a[96:111]
    v_exp_f32 v60, v60
    v_exp_f32 v61, v61
    v_cvt_pk_bf16_f32 v76, v56, v57
    v_exp_f32 v62, v62
    v_exp_f32 v63, v63
    v_cvt_pk_bf16_f32 v77, v58, v59
    v_cvt_pk_bf16_f32 v78, v60, v61
    v_cvt_pk_bf16_f32 v79, v62, v63
    v_mfma_f32_32x32x16_bf16 v[48:63], a[208:211], v[12:15], 0
    v_exp_f32 v32, v32
    v_exp_f32 v33, v33
    v_exp_f32 v34, v34
    v_exp_f32 v35, v35
    v_mfma_f32_32x32x8bf16_1k v[48:63], a[212:213], v[22:23], v[48:63]
    v_exp_f32 v36, v36
    v_exp_f32 v37, v37
    v_cvt_pk_bf16_f32 v64, v32, v33
    v_exp_f32 v38, v38
    v_exp_f32 v39, v39
    v_cvt_pk_bf16_f32 v65, v34, v35
    v_add_u32 v25, v28, v25
    buffer_load_dwordx4 a[200:203], v25, s[8:11], 0 offen offset:0 sc1
    buffer_load_dwordx4 a[204:207], v25, s[8:11], 0 offen offset:576 sc1
    v_mfma_f32_32x32x16_bf16 a[112:127], a[216:219], v[72:75], a[112:127]
    v_exp_f32 v40, v40
    v_exp_f32 v41, v41
    v_cvt_pk_bf16_f32 v66, v36, v37
    v_exp_f32 v42, v42
    v_exp_f32 v43, v43
    v_cvt_pk_bf16_f32 v67, v38, v39
    v_mfma_f32_32x32x16_bf16 a[112:127], a[220:223], v[76:79], a[112:127]
    v_exp_f32 v44, v44
    v_exp_f32 v45, v45
    v_cvt_pk_bf16_f32 v68, v40, v41
    v_exp_f32 v46, v46
    v_exp_f32 v47, v47
    v_cvt_pk_bf16_f32 v69, v42, v43
    v_cvt_pk_bf16_f32 v70, v44, v45
    v_cvt_pk_bf16_f32 v71, v46, v47
    v_mfma_f32_32x32x16_bf16 v[32:47], a[224:227], v[0:3], 0
    v_exp_f32 v48, v48
    v_exp_f32 v49, v49
    v_exp_f32 v50, v50
    v_exp_f32 v51, v51
    v_mfma_f32_32x32x8bf16_1k v[32:47], a[228:229], v[16:17], v[32:47]
    v_exp_f32 v52, v52
    v_exp_f32 v53, v53
    v_cvt_pk_bf16_f32 v72, v48, v49
    v_exp_f32 v54, v54
    v_exp_f32 v55, v55
    v_cvt_pk_bf16_f32 v73, v50, v51
    v_mfma_f32_32x32x16_bf16 a[128:143], a[216:219], v[64:67], a[128:143]
    v_exp_f32 v56, v56
    v_exp_f32 v57, v57
    v_cvt_pk_bf16_f32 v74, v52, v53
    v_exp_f32 v58, v58
    v_exp_f32 v59, v59
    v_cvt_pk_bf16_f32 v75, v54, v55
    v_mfma_f32_32x32x16_bf16 a[128:143], a[220:223], v[68:71], a[128:143]
    v_exp_f32 v60, v60
    v_exp_f32 v61, v61
    v_cvt_pk_bf16_f32 v76, v56, v57
    v_exp_f32 v62, v62
    v_exp_f32 v63, v63
    v_cvt_pk_bf16_f32 v77, v58, v59
    v_cvt_pk_bf16_f32 v78, v60, v61
    v_cvt_pk_bf16_f32 v79, v62, v63
    s_waitcnt lgkmcnt(4)
    ds_read_b64_tr_b16 a[16:17], v212 offset:8192
    ds_read_b64_tr_b16 a[18:19], v212 offset:9216
    v_mfma_f32_32x32x16_bf16 v[160:175], a[0:3], a[24:27], 0
    ds_read_b64_tr_b16 a[20:21], v212 offset:10240
    ds_read_b64_tr_b16 a[22:23], v212 offset:11264
    v_mfma_f32_32x32x16_bf16 v[160:175], a[4:7], a[28:31], v[160:175]
    s_waitcnt lgkmcnt(4)
    ds_read_b64_tr_b16 a[0:1], v212 offset:12288
    ds_read_b64_tr_b16 a[2:3], v212 offset:13312
    v_mfma_f32_32x32x16_bf16 v[160:175], a[8:11], a[32:35], v[160:175]
    ds_read_b64_tr_b16 a[4:5], v212 offset:14336
    ds_read_b64_tr_b16 a[6:7], v212 offset:15360
    v_mfma_f32_32x32x16_bf16 v[160:175], a[12:15], a[36:39], v[160:175]
    v_cvt_pk_bf16_f32 v176, v144, v145
    s_waitcnt lgkmcnt(4)
    ds_read_b64_tr_b16 a[8:9], v212 offset:16384
    ds_read_b64_tr_b16 a[10:11], v212 offset:17408
    v_mfma_f32_32x32x16_bf16 v[160:175], a[16:19], a[40:43], v[160:175]
    v_cvt_pk_bf16_f32 v177, v146, v147
    ds_read_b64_tr_b16 a[12:13], v212 offset:18432
    ds_read_b64_tr_b16 a[14:15], v212 offset:19456
    v_mfma_f32_32x32x16_bf16 v[160:175], a[20:23], a[44:47], v[160:175]
    v_cvt_pk_bf16_f32 v178, v148, v149
    s_waitcnt lgkmcnt(4)
    ds_read_b64_tr_b16 a[16:17], v212 offset:20480
    ds_read_b64_tr_b16 a[18:19], v212 offset:21504
    v_mfma_f32_32x32x16_bf16 v[160:175], a[0:3], a[48:51], v[160:175]
    v_cvt_pk_bf16_f32 v179, v150, v151
    s_add_u32 s79, s55, 27262976
    buffer_store_dwordx4 v[176:179], v254, s[8:11], s79 offen sc1
    ds_read_b64_tr_b16 a[20:21], v212 offset:22528
    ds_read_b64_tr_b16 a[22:23], v212 offset:23552
    v_mfma_f32_32x32x16_bf16 v[160:175], a[4:7], a[52:55], v[160:175]
    v_cvt_pk_bf16_f32 v180, v152, v153
    s_waitcnt lgkmcnt(4)
    ds_read_b64_tr_b16 a[0:1], v212 offset:24576
    ds_read_b64_tr_b16 a[2:3], v212 offset:25600
    v_mfma_f32_32x32x16_bf16 v[160:175], a[8:11], a[56:59], v[160:175]
    v_cvt_pk_bf16_f32 v181, v154, v155
    ds_read_b64_tr_b16 a[4:5], v212 offset:26624
    ds_read_b64_tr_b16 a[6:7], v212 offset:27648
    v_mfma_f32_32x32x16_bf16 v[160:175], a[12:15], a[60:63], v[160:175]
    v_cvt_pk_bf16_f32 v182, v156, v157
    s_waitcnt lgkmcnt(4)
    ds_read_b64_tr_b16 a[8:9], v212 offset:32768
    ds_read_b64_tr_b16 a[10:11], v212 offset:33792
    v_mfma_f32_32x32x16_bf16 v[160:175], a[16:19], a[64:67], v[160:175]
    v_cvt_pk_bf16_f32 v183, v158, v159
    s_add_u32 s79, s55, 28311552
    buffer_store_dwordx4 v[180:183], v254, s[8:11], s79 offen sc1
    ds_read_b64_tr_b16 a[12:13], v212 offset:34816
    ds_read_b64_tr_b16 a[14:15], v212 offset:35840
    v_mfma_f32_32x32x16_bf16 v[160:175], a[20:23], a[68:71], v[160:175]
    s_waitcnt lgkmcnt(4)
    ds_read_b64_tr_b16 a[16:17], v212 offset:28672
    ds_read_b64_tr_b16 a[18:19], v212 offset:29696
    v_mfma_f32_32x32x16_bf16 v[160:175], a[0:3], a[72:75], v[160:175]
    ds_read_b64_tr_b16 a[20:21], v212 offset:30720
    ds_read_b64_tr_b16 a[22:23], v212 offset:31744
    v_mfma_f32_32x32x16_bf16 v[160:175], a[4:7], a[76:79], v[160:175]
    s_waitcnt lgkmcnt(4)
    ds_read_b64_tr_b16 a[0:1], v213 offset:0
    ds_read_b64_tr_b16 a[2:3], v213 offset:1024
    v_mfma_f32_32x32x16_bf16 v[160:175], a[8:11], a[88:91], v[160:175]
    ds_read_b64_tr_b16 a[4:5], v213 offset:2048
    ds_read_b64_tr_b16 a[6:7], v213 offset:3072
    v_mfma_f32_32x32x16_bf16 v[160:175], a[12:15], a[92:95], v[160:175]
    s_waitcnt lgkmcnt(4)
    ds_read_b64_tr_b16 a[8:9], v213 offset:4096
    ds_read_b64_tr_b16 a[10:11], v213 offset:5120
    v_mfma_f32_32x32x16_bf16 v[160:175], a[16:19], a[80:83], v[160:175]
    ds_read_b64_tr_b16 a[12:13], v213 offset:6144
    ds_read_b64_tr_b16 a[14:15], v213 offset:7168
    v_mfma_f32_32x32x16_bf16 v[160:175], a[20:23], a[84:87], v[160:175]
    s_waitcnt lgkmcnt(4)
    ds_read_b64_tr_b16 a[16:17], v213 offset:8192
    ds_read_b64_tr_b16 a[18:19], v213 offset:9216
    v_mfma_f32_32x32x16_bf16 v[144:159], a[0:3], a[24:27], 0
    ds_read_b64_tr_b16 a[20:21], v213 offset:10240
    ds_read_b64_tr_b16 a[22:23], v213 offset:11264
    v_mfma_f32_32x32x16_bf16 v[144:159], a[4:7], a[28:31], v[144:159]
    s_waitcnt lgkmcnt(4)
    ds_read_b64_tr_b16 a[0:1], v213 offset:12288
    ds_read_b64_tr_b16 a[2:3], v213 offset:13312
    v_mfma_f32_32x32x16_bf16 v[144:159], a[8:11], a[32:35], v[144:159]
    v_add_u32 v214, 36864, v209
    ds_read_b64_tr_b16 a[4:5], v213 offset:14336
    ds_read_b64_tr_b16 a[6:7], v213 offset:15360
    v_mfma_f32_32x32x16_bf16 v[144:159], a[12:15], a[36:39], v[144:159]
    v_xor_b32 v215, 64, v214
    s_waitcnt lgkmcnt(4)
    ds_read_b64_tr_b16 a[8:9], v213 offset:16384
    ds_read_b64_tr_b16 a[10:11], v213 offset:17408
    v_mfma_f32_32x32x16_bf16 v[144:159], a[16:19], a[40:43], v[144:159]
    v_cvt_pk_bf16_f32 v184, v160, v161
    ds_read_b64_tr_b16 a[12:13], v213 offset:18432
    ds_read_b64_tr_b16 a[14:15], v213 offset:19456
    v_mfma_f32_32x32x16_bf16 v[144:159], a[20:23], a[44:47], v[144:159]
    v_cvt_pk_bf16_f32 v185, v162, v163
    s_waitcnt lgkmcnt(4)
    ds_read_b64_tr_b16 a[16:17], v213 offset:20480
    ds_read_b64_tr_b16 a[18:19], v213 offset:21504
    v_mfma_f32_32x32x16_bf16 v[144:159], a[0:3], a[48:51], v[144:159]
    v_cvt_pk_bf16_f32 v186, v164, v165
    ds_read_b64_tr_b16 a[20:21], v213 offset:22528
    ds_read_b64_tr_b16 a[22:23], v213 offset:23552
    v_mfma_f32_32x32x16_bf16 v[144:159], a[4:7], a[52:55], v[144:159]
    v_cvt_pk_bf16_f32 v187, v166, v167
    s_add_u32 s79, s55, 29360128
    buffer_store_dwordx4 v[184:187], v254, s[8:11], s79 offen sc1
    s_waitcnt lgkmcnt(4)
    ds_read_b64_tr_b16 a[0:1], v213 offset:24576
    ds_read_b64_tr_b16 a[2:3], v213 offset:25600
    v_mfma_f32_32x32x16_bf16 v[144:159], a[8:11], a[56:59], v[144:159]
    v_cvt_pk_bf16_f32 v188, v168, v169
    ds_read_b64_tr_b16 a[4:5], v213 offset:26624
    ds_read_b64_tr_b16 a[6:7], v213 offset:27648
    v_mfma_f32_32x32x16_bf16 v[144:159], a[12:15], a[60:63], v[144:159]
    v_cvt_pk_bf16_f32 v189, v170, v171
    s_waitcnt lgkmcnt(4)
    ds_read_b64_tr_b16 a[8:9], v213 offset:32768
    ds_read_b64_tr_b16 a[10:11], v213 offset:33792
    v_mfma_f32_32x32x16_bf16 v[144:159], a[16:19], a[64:67], v[144:159]
    v_cvt_pk_bf16_f32 v190, v172, v173
    ds_read_b64_tr_b16 a[12:13], v213 offset:34816
    ds_read_b64_tr_b16 a[14:15], v213 offset:35840
    v_mfma_f32_32x32x16_bf16 v[144:159], a[20:23], a[68:71], v[144:159]
    v_cvt_pk_bf16_f32 v191, v174, v175
    s_add_u32 s79, s55, 30408704
    buffer_store_dwordx4 v[188:191], v254, s[8:11], s79 offen sc1
    s_waitcnt lgkmcnt(4)
    ds_read_b64_tr_b16 a[16:17], v213 offset:28672
    ds_read_b64_tr_b16 a[18:19], v213 offset:29696
    v_mfma_f32_32x32x16_bf16 v[144:159], a[0:3], a[72:75], v[144:159]
    s_waitcnt vmcnt(10)
    s_barrier
    ds_read_b64_tr_b16 a[20:21], v213 offset:30720
    ds_read_b64_tr_b16 a[22:23], v213 offset:31744
    v_mfma_f32_32x32x16_bf16 v[144:159], a[4:7], a[76:79], v[144:159]
    s_waitcnt lgkmcnt(4)
    ds_read_b64_tr_b16 a[0:1], v214 offset:0
    ds_read_b64_tr_b16 a[2:3], v214 offset:1024
    v_mfma_f32_32x32x16_bf16 v[144:159], a[8:11], a[88:91], v[144:159]
    ds_read_b64_tr_b16 a[4:5], v214 offset:2048
    ds_read_b64_tr_b16 a[6:7], v214 offset:3072
    v_mfma_f32_32x32x16_bf16 v[144:159], a[12:15], a[92:95], v[144:159]
    s_waitcnt lgkmcnt(4)
    ds_read_b64_tr_b16 a[8:9], v214 offset:4096
    ds_read_b64_tr_b16 a[10:11], v214 offset:5120
    v_mfma_f32_32x32x16_bf16 v[144:159], a[16:19], a[80:83], v[144:159]
    ds_read_b64_tr_b16 a[12:13], v214 offset:6144
    ds_read_b64_tr_b16 a[14:15], v214 offset:7168
    v_mfma_f32_32x32x16_bf16 v[144:159], a[20:23], a[84:87], v[144:159]
    v_mfma_f32_32x32x16_bf16 v[48:63], a[224:227], v[4:7], 0
    v_exp_f32 v32, v32
    v_exp_f32 v33, v33
    v_exp_f32 v34, v34
    v_exp_f32 v35, v35
    v_mfma_f32_32x32x8bf16_1k v[48:63], a[228:229], v[18:19], v[48:63]
    v_exp_f32 v36, v36
    v_exp_f32 v37, v37
    v_cvt_pk_bf16_f32 v64, v32, v33
    v_exp_f32 v38, v38
    v_exp_f32 v39, v39
    v_cvt_pk_bf16_f32 v65, v34, v35
    v_mfma_f32_32x32x16_bf16 a[144:159], a[216:219], v[72:75], a[144:159]
    v_exp_f32 v40, v40
    v_exp_f32 v41, v41
    v_cvt_pk_bf16_f32 v66, v36, v37
    v_exp_f32 v42, v42
    v_exp_f32 v43, v43
    v_cvt_pk_bf16_f32 v67, v38, v39
    v_mfma_f32_32x32x16_bf16 a[144:159], a[220:223], v[76:79], a[144:159]
    v_exp_f32 v44, v44
    v_exp_f32 v45, v45
    v_cvt_pk_bf16_f32 v68, v40, v41
    v_exp_f32 v46, v46
    v_exp_f32 v47, v47
    v_cvt_pk_bf16_f32 v69, v42, v43
    v_cvt_pk_bf16_f32 v70, v44, v45
    v_cvt_pk_bf16_f32 v71, v46, v47
    v_mfma_f32_32x32x16_bf16 v[32:47], a[224:227], v[8:11], 0
    v_exp_f32 v48, v48
    v_exp_f32 v49, v49
    v_exp_f32 v50, v50
    v_exp_f32 v51, v51
    buffer_load_dwordx2 a[208:209], v26, s[8:11], s62 offen offset:2304 sc1
    buffer_load_dwordx2 a[210:211], v26, s[8:11], s63 offen offset:2304 sc1
    v_mfma_f32_32x32x8bf16_1k v[32:47], a[228:229], v[20:21], v[32:47]
    v_exp_f32 v52, v52
    v_exp_f32 v53, v53
    v_cvt_pk_bf16_f32 v72, v48, v49
    v_exp_f32 v54, v54
    v_exp_f32 v55, v55
    v_cvt_pk_bf16_f32 v73, v50, v51
    v_mfma_f32_32x32x16_bf16 a[96:111], a[232:235], v[64:67], a[96:111]
    v_exp_f32 v56, v56
    v_exp_f32 v57, v57
    v_cvt_pk_bf16_f32 v74, v52, v53
    v_exp_f32 v58, v58
    v_exp_f32 v59, v59
    v_cvt_pk_bf16_f32 v75, v54, v55
    buffer_load_dword a212, v24, s[8:11], s64 offen offset:2304 sc1
    v_mfma_f32_32x32x16_bf16 a[96:111], a[236:239], v[68:71], a[96:111]
    v_exp_f32 v60, v60
    v_exp_f32 v61, v61
    v_cvt_pk_bf16_f32 v76, v56, v57
    v_exp_f32 v62, v62
    v_exp_f32 v63, v63
    v_cvt_pk_bf16_f32 v77, v58, v59
    v_cvt_pk_bf16_f32 v78, v60, v61
    v_cvt_pk_bf16_f32 v79, v62, v63
    v_mfma_f32_32x32x16_bf16 v[48:63], a[224:227], v[12:15], 0
    v_exp_f32 v32, v32
    v_exp_f32 v33, v33
    v_exp_f32 v34, v34
    v_exp_f32 v35, v35
    v_mfma_f32_32x32x8bf16_1k v[48:63], a[228:229], v[22:23], v[48:63]
    v_exp_f32 v36, v36
    v_exp_f32 v37, v37
    v_cvt_pk_bf16_f32 v64, v32, v33
    v_exp_f32 v38, v38
    v_exp_f32 v39, v39
    v_cvt_pk_bf16_f32 v65, v34, v35
    buffer_load_dwordx4 a[216:219], v25, s[8:11], 0 offen offset:1152 sc1
    buffer_load_dwordx4 a[220:223], v25, s[8:11], 0 offen offset:1728 sc1
    v_mfma_f32_32x32x16_bf16 a[112:127], a[232:235], v[72:75], a[112:127]
    v_exp_f32 v40, v40
    v_exp_f32 v41, v41
    v_cvt_pk_bf16_f32 v66, v36, v37
    v_exp_f32 v42, v42
    v_exp_f32 v43, v43
    v_cvt_pk_bf16_f32 v67, v38, v39
    v_mfma_f32_32x32x16_bf16 a[112:127], a[236:239], v[76:79], a[112:127]
    v_exp_f32 v44, v44
    v_exp_f32 v45, v45
    v_cvt_pk_bf16_f32 v68, v40, v41
    v_exp_f32 v46, v46
    v_exp_f32 v47, v47
    v_cvt_pk_bf16_f32 v69, v42, v43
    v_cvt_pk_bf16_f32 v70, v44, v45
    v_cvt_pk_bf16_f32 v71, v46, v47
    s_waitcnt vmcnt(63)
    v_mfma_f32_32x32x16_bf16 v[32:47], a[240:243], v[0:3], 0
    v_exp_f32 v48, v48
    v_exp_f32 v49, v49
    v_exp_f32 v50, v50
    v_exp_f32 v51, v51
    v_mfma_f32_32x32x8bf16_1k v[32:47], a[244:245], v[16:17], v[32:47]
    v_exp_f32 v52, v52
    v_exp_f32 v53, v53
    v_cvt_pk_bf16_f32 v72, v48, v49
    v_exp_f32 v54, v54
    v_exp_f32 v55, v55
    v_cvt_pk_bf16_f32 v73, v50, v51
    v_mfma_f32_32x32x16_bf16 a[128:143], a[232:235], v[64:67], a[128:143]
    v_exp_f32 v56, v56
    v_exp_f32 v57, v57
    v_cvt_pk_bf16_f32 v74, v52, v53
    v_exp_f32 v58, v58
    v_exp_f32 v59, v59
    v_cvt_pk_bf16_f32 v75, v54, v55
    v_mfma_f32_32x32x16_bf16 a[128:143], a[236:239], v[68:71], a[128:143]
    v_exp_f32 v60, v60
    v_exp_f32 v61, v61
    v_cvt_pk_bf16_f32 v76, v56, v57
    v_exp_f32 v62, v62
    v_exp_f32 v63, v63
    v_cvt_pk_bf16_f32 v77, v58, v59
    v_cvt_pk_bf16_f32 v78, v60, v61
    v_cvt_pk_bf16_f32 v79, v62, v63
    s_waitcnt lgkmcnt(4)
    ds_read_b64_tr_b16 a[16:17], v214 offset:8192
    ds_read_b64_tr_b16 a[18:19], v214 offset:9216
    v_mfma_f32_32x32x16_bf16 v[160:175], a[0:3], a[24:27], 0
    ds_read_b64_tr_b16 a[20:21], v214 offset:10240
    ds_read_b64_tr_b16 a[22:23], v214 offset:11264
    v_mfma_f32_32x32x16_bf16 v[160:175], a[4:7], a[28:31], v[160:175]
    s_waitcnt lgkmcnt(4)
    ds_read_b64_tr_b16 a[0:1], v214 offset:12288
    ds_read_b64_tr_b16 a[2:3], v214 offset:13312
    v_mfma_f32_32x32x16_bf16 v[160:175], a[8:11], a[32:35], v[160:175]
    ds_read_b64_tr_b16 a[4:5], v214 offset:14336
    ds_read_b64_tr_b16 a[6:7], v214 offset:15360
    v_mfma_f32_32x32x16_bf16 v[160:175], a[12:15], a[36:39], v[160:175]
    v_cvt_pk_bf16_f32 v176, v144, v145
    s_waitcnt lgkmcnt(4)
    ds_read_b64_tr_b16 a[8:9], v214 offset:16384
    ds_read_b64_tr_b16 a[10:11], v214 offset:17408
    v_mfma_f32_32x32x16_bf16 v[160:175], a[16:19], a[40:43], v[160:175]
    v_cvt_pk_bf16_f32 v177, v146, v147
    ds_read_b64_tr_b16 a[12:13], v214 offset:18432
    ds_read_b64_tr_b16 a[14:15], v214 offset:19456
    v_mfma_f32_32x32x16_bf16 v[160:175], a[20:23], a[44:47], v[160:175]
    v_cvt_pk_bf16_f32 v178, v148, v149
    s_waitcnt lgkmcnt(4)
    ds_read_b64_tr_b16 a[16:17], v214 offset:20480
    ds_read_b64_tr_b16 a[18:19], v214 offset:21504
    v_mfma_f32_32x32x16_bf16 v[160:175], a[0:3], a[48:51], v[160:175]
    v_cvt_pk_bf16_f32 v179, v150, v151
    s_add_u32 s79, s55, 31457280
    buffer_store_dwordx4 v[176:179], v254, s[8:11], s79 offen sc1
    ds_read_b64_tr_b16 a[20:21], v214 offset:22528
    ds_read_b64_tr_b16 a[22:23], v214 offset:23552
    v_mfma_f32_32x32x16_bf16 v[160:175], a[4:7], a[52:55], v[160:175]
    v_cvt_pk_bf16_f32 v180, v152, v153
    s_waitcnt lgkmcnt(4)
    ds_read_b64_tr_b16 a[0:1], v214 offset:24576
    ds_read_b64_tr_b16 a[2:3], v214 offset:25600
    v_mfma_f32_32x32x16_bf16 v[160:175], a[8:11], a[56:59], v[160:175]
    v_cvt_pk_bf16_f32 v181, v154, v155
    ds_read_b64_tr_b16 a[4:5], v214 offset:26624
    ds_read_b64_tr_b16 a[6:7], v214 offset:27648
    v_mfma_f32_32x32x16_bf16 v[160:175], a[12:15], a[60:63], v[160:175]
    v_cvt_pk_bf16_f32 v182, v156, v157
    s_waitcnt lgkmcnt(4)
    ds_read_b64_tr_b16 a[8:9], v214 offset:32768
    ds_read_b64_tr_b16 a[10:11], v214 offset:33792
    v_mfma_f32_32x32x16_bf16 v[160:175], a[16:19], a[64:67], v[160:175]
    v_cvt_pk_bf16_f32 v183, v158, v159
    s_add_u32 s79, s55, 32505856
    buffer_store_dwordx4 v[180:183], v254, s[8:11], s79 offen sc1
    ds_read_b64_tr_b16 a[12:13], v214 offset:34816
    ds_read_b64_tr_b16 a[14:15], v214 offset:35840
    v_mfma_f32_32x32x16_bf16 v[160:175], a[20:23], a[68:71], v[160:175]
    s_waitcnt lgkmcnt(4)
    ds_read_b64_tr_b16 a[16:17], v214 offset:28672
    ds_read_b64_tr_b16 a[18:19], v214 offset:29696
    v_mfma_f32_32x32x16_bf16 v[160:175], a[0:3], a[72:75], v[160:175]
    ds_read_b64_tr_b16 a[20:21], v214 offset:30720
    ds_read_b64_tr_b16 a[22:23], v214 offset:31744
    v_mfma_f32_32x32x16_bf16 v[160:175], a[4:7], a[76:79], v[160:175]
    s_waitcnt lgkmcnt(4)
    ds_read_b64_tr_b16 a[0:1], v215 offset:0
    ds_read_b64_tr_b16 a[2:3], v215 offset:1024
    v_mfma_f32_32x32x16_bf16 v[160:175], a[8:11], a[88:91], v[160:175]
    ds_read_b64_tr_b16 a[4:5], v215 offset:2048
    ds_read_b64_tr_b16 a[6:7], v215 offset:3072
    v_mfma_f32_32x32x16_bf16 v[160:175], a[12:15], a[92:95], v[160:175]
    s_waitcnt lgkmcnt(4)
    ds_read_b64_tr_b16 a[8:9], v215 offset:4096
    ds_read_b64_tr_b16 a[10:11], v215 offset:5120
    v_mfma_f32_32x32x16_bf16 v[160:175], a[16:19], a[80:83], v[160:175]
    ds_read_b64_tr_b16 a[12:13], v215 offset:6144
    ds_read_b64_tr_b16 a[14:15], v215 offset:7168
    v_mfma_f32_32x32x16_bf16 v[160:175], a[20:23], a[84:87], v[160:175]
    s_waitcnt lgkmcnt(4)
    ds_read_b64_tr_b16 a[16:17], v215 offset:8192
    ds_read_b64_tr_b16 a[18:19], v215 offset:9216
    v_mfma_f32_32x32x16_bf16 v[144:159], a[0:3], a[24:27], 0
    ds_read_b64_tr_b16 a[20:21], v215 offset:10240
    ds_read_b64_tr_b16 a[22:23], v215 offset:11264
    v_mfma_f32_32x32x16_bf16 v[144:159], a[4:7], a[28:31], v[144:159]
    s_waitcnt lgkmcnt(4)
    ds_read_b64_tr_b16 a[0:1], v215 offset:12288
    ds_read_b64_tr_b16 a[2:3], v215 offset:13312
    v_mfma_f32_32x32x16_bf16 v[144:159], a[8:11], a[32:35], v[144:159]
    ds_read_b64_tr_b16 a[4:5], v215 offset:14336
    ds_read_b64_tr_b16 a[6:7], v215 offset:15360
    v_mfma_f32_32x32x16_bf16 v[144:159], a[12:15], a[36:39], v[144:159]
    s_waitcnt lgkmcnt(4)
    ds_read_b64_tr_b16 a[8:9], v215 offset:16384
    ds_read_b64_tr_b16 a[10:11], v215 offset:17408
    v_mfma_f32_32x32x16_bf16 v[144:159], a[16:19], a[40:43], v[144:159]
    v_cvt_pk_bf16_f32 v184, v160, v161
    ds_read_b64_tr_b16 a[12:13], v215 offset:18432
    ds_read_b64_tr_b16 a[14:15], v215 offset:19456
    v_mfma_f32_32x32x16_bf16 v[144:159], a[20:23], a[44:47], v[144:159]
    v_cvt_pk_bf16_f32 v185, v162, v163
    s_waitcnt lgkmcnt(4)
    ds_read_b64_tr_b16 a[16:17], v215 offset:20480
    ds_read_b64_tr_b16 a[18:19], v215 offset:21504
    v_mfma_f32_32x32x16_bf16 v[144:159], a[0:3], a[48:51], v[144:159]
    v_cvt_pk_bf16_f32 v186, v164, v165
    ds_read_b64_tr_b16 a[20:21], v215 offset:22528
    ds_read_b64_tr_b16 a[22:23], v215 offset:23552
    v_mfma_f32_32x32x16_bf16 v[144:159], a[4:7], a[52:55], v[144:159]
    v_cvt_pk_bf16_f32 v187, v166, v167
    s_add_u32 s79, s55, 33554432
    buffer_store_dwordx4 v[184:187], v254, s[8:11], s79 offen sc1
    s_waitcnt lgkmcnt(4)
    ds_read_b64_tr_b16 a[0:1], v215 offset:24576
    ds_read_b64_tr_b16 a[2:3], v215 offset:25600
    v_mfma_f32_32x32x16_bf16 v[144:159], a[8:11], a[56:59], v[144:159]
    v_cvt_pk_bf16_f32 v188, v168, v169
    ds_read_b64_tr_b16 a[4:5], v215 offset:26624
    ds_read_b64_tr_b16 a[6:7], v215 offset:27648
    v_mfma_f32_32x32x16_bf16 v[144:159], a[12:15], a[60:63], v[144:159]
    v_cvt_pk_bf16_f32 v189, v170, v171
    s_waitcnt lgkmcnt(4)
    ds_read_b64_tr_b16 a[8:9], v215 offset:32768
    ds_read_b64_tr_b16 a[10:11], v215 offset:33792
    v_mfma_f32_32x32x16_bf16 v[144:159], a[16:19], a[64:67], v[144:159]
    v_cvt_pk_bf16_f32 v190, v172, v173
    ds_read_b64_tr_b16 a[12:13], v215 offset:34816
    ds_read_b64_tr_b16 a[14:15], v215 offset:35840
    v_mfma_f32_32x32x16_bf16 v[144:159], a[20:23], a[68:71], v[144:159]
    v_cvt_pk_bf16_f32 v191, v174, v175
    s_add_u32 s79, s55, 34603008
    buffer_store_dwordx4 v[188:191], v254, s[8:11], s79 offen sc1
    s_waitcnt lgkmcnt(4)
    ds_read_b64_tr_b16 a[16:17], v215 offset:28672
    ds_read_b64_tr_b16 a[18:19], v215 offset:29696
    v_mfma_f32_32x32x16_bf16 v[144:159], a[0:3], a[72:75], v[144:159]
    ds_read_b64_tr_b16 a[20:21], v215 offset:30720
    ds_read_b64_tr_b16 a[22:23], v215 offset:31744
    v_mfma_f32_32x32x16_bf16 v[144:159], a[4:7], a[76:79], v[144:159]
    s_waitcnt lgkmcnt(4)
    v_mfma_f32_32x32x16_bf16 v[144:159], a[8:11], a[88:91], v[144:159]
    v_mfma_f32_32x32x16_bf16 v[144:159], a[12:15], a[92:95], v[144:159]
    s_waitcnt lgkmcnt(0)
    v_mfma_f32_32x32x16_bf16 v[144:159], a[16:19], a[80:83], v[144:159]
    v_mfma_f32_32x32x16_bf16 v[144:159], a[20:23], a[84:87], v[144:159]
    s_nop 11
    v_cvt_pk_bf16_f32 v176, v144, v145
    v_cvt_pk_bf16_f32 v177, v146, v147
    v_cvt_pk_bf16_f32 v178, v148, v149
    v_cvt_pk_bf16_f32 v179, v150, v151
    s_add_u32 s79, s55, 35651584
    buffer_store_dwordx4 v[176:179], v254, s[8:11], s79 offen sc1
    v_cvt_pk_bf16_f32 v180, v152, v153
    v_cvt_pk_bf16_f32 v181, v154, v155
    v_cvt_pk_bf16_f32 v182, v156, v157
    v_cvt_pk_bf16_f32 v183, v158, v159
    s_add_u32 s79, s55, 36700160
    buffer_store_dwordx4 v[180:183], v254, s[8:11], s79 offen sc1
    s_barrier
    v_mfma_f32_32x32x16_bf16 v[48:63], a[240:243], v[4:7], 0
    v_exp_f32 v32, v32
    v_exp_f32 v33, v33
    v_exp_f32 v34, v34
    v_exp_f32 v35, v35
    v_mfma_f32_32x32x8bf16_1k v[48:63], a[244:245], v[18:19], v[48:63]
    v_exp_f32 v36, v36
    v_exp_f32 v37, v37
    v_cvt_pk_bf16_f32 v64, v32, v33
    v_exp_f32 v38, v38
    v_exp_f32 v39, v39
    v_cvt_pk_bf16_f32 v65, v34, v35
    v_mfma_f32_32x32x16_bf16 a[144:159], a[232:235], v[72:75], a[144:159]
    v_exp_f32 v40, v40
    v_exp_f32 v41, v41
    v_cvt_pk_bf16_f32 v66, v36, v37
    v_exp_f32 v42, v42
    v_exp_f32 v43, v43
    v_cvt_pk_bf16_f32 v67, v38, v39
    v_mfma_f32_32x32x16_bf16 a[144:159], a[236:239], v[76:79], a[144:159]
    v_exp_f32 v44, v44
    v_exp_f32 v45, v45
    v_cvt_pk_bf16_f32 v68, v40, v41
    v_exp_f32 v46, v46
    v_exp_f32 v47, v47
    v_cvt_pk_bf16_f32 v69, v42, v43
    v_cvt_pk_bf16_f32 v70, v44, v45
    v_cvt_pk_bf16_f32 v71, v46, v47
    s_add_u32 m0, s36, 1024
    s_add_u32 s59, s34, 147456
    buffer_load_dwordx4 v254, s[8:11], s59 offen offset:3072 sc1 lds
    v_mfma_f32_32x32x16_bf16 v[32:47], a[240:243], v[8:11], 0
    v_exp_f32 v48, v48
    v_exp_f32 v49, v49
    v_exp_f32 v50, v50
    v_exp_f32 v51, v51
    buffer_load_dwordx2 a[224:225], v26, s[8:11], s62 offen offset:2560 sc1
    buffer_load_dwordx2 a[226:227], v26, s[8:11], s63 offen offset:2560 sc1
    v_mfma_f32_32x32x8bf16_1k v[32:47], a[244:245], v[20:21], v[32:47]
    v_exp_f32 v52, v52
    v_exp_f32 v53, v53
    v_cvt_pk_bf16_f32 v72, v48, v49
    v_exp_f32 v54, v54
    v_exp_f32 v55, v55
    v_cvt_pk_bf16_f32 v73, v50, v51
    v_mfma_f32_32x32x16_bf16 a[96:111], a[248:251], v[64:67], a[96:111]
    v_exp_f32 v56, v56
    v_exp_f32 v57, v57
    v_cvt_pk_bf16_f32 v74, v52, v53
    v_exp_f32 v58, v58
    v_exp_f32 v59, v59
    v_cvt_pk_bf16_f32 v75, v54, v55
    buffer_load_dword a228, v24, s[8:11], s64 offen offset:2560 sc1
    v_mfma_f32_32x32x16_bf16 a[96:111], a[252:255], v[68:71], a[96:111]
    v_exp_f32 v60, v60
    v_exp_f32 v61, v61
    v_cvt_pk_bf16_f32 v76, v56, v57
    v_exp_f32 v62, v62
    v_exp_f32 v63, v63
    v_cvt_pk_bf16_f32 v77, v58, v59
    v_cvt_pk_bf16_f32 v78, v60, v61
    v_cvt_pk_bf16_f32 v79, v62, v63
    s_add_u32 m0, s36, 5120
    s_add_u32 s59, s34, 4096
    buffer_load_dwordx4 v254, s[8:11], s59 offen offset:0 sc1 lds
    v_mfma_f32_32x32x16_bf16 v[48:63], a[240:243], v[12:15], 0
    v_exp_f32 v32, v32
    v_exp_f32 v33, v33
    v_exp_f32 v34, v34
    v_exp_f32 v35, v35
    v_mfma_f32_32x32x8bf16_1k v[48:63], a[244:245], v[22:23], v[48:63]
    v_exp_f32 v36, v36
    v_exp_f32 v37, v37
    v_cvt_pk_bf16_f32 v64, v32, v33
    v_exp_f32 v38, v38
    v_exp_f32 v39, v39
    v_cvt_pk_bf16_f32 v65, v34, v35
    buffer_load_dwordx4 a[232:235], v25, s[8:11], 0 offen offset:2304 sc1
    buffer_load_dwordx4 a[236:239], v25, s[8:11], 0 offen offset:2880 sc1
    v_mfma_f32_32x32x16_bf16 a[112:127], a[248:251], v[72:75], a[112:127]
    v_exp_f32 v40, v40
    v_exp_f32 v41, v41
    v_cvt_pk_bf16_f32 v66, v36, v37
    v_exp_f32 v42, v42
    v_exp_f32 v43, v43
    v_cvt_pk_bf16_f32 v67, v38, v39
    v_mfma_f32_32x32x16_bf16 a[112:127], a[252:255], v[76:79], a[112:127]
    v_exp_f32 v44, v44
    v_exp_f32 v45, v45
    v_cvt_pk_bf16_f32 v68, v40, v41
    v_exp_f32 v46, v46
    v_exp_f32 v47, v47
    v_cvt_pk_bf16_f32 v69, v42, v43
    v_cvt_pk_bf16_f32 v70, v44, v45
    v_cvt_pk_bf16_f32 v71, v46, v47
    buffer_load_dwordx4 v254, s[8:11], s59 offen offset:1024 sc1 lds
    v_mfma_f32_32x32x16_bf16 v[32:47], a[160:163], v[0:3], 0
    v_exp_f32 v48, v48
    v_exp_f32 v49, v49
    v_exp_f32 v50, v50
    v_exp_f32 v51, v51
    v_mfma_f32_32x32x8bf16_1k v[32:47], a[164:165], v[16:17], v[32:47]
    v_exp_f32 v52, v52
    v_exp_f32 v53, v53
    v_cvt_pk_bf16_f32 v72, v48, v49
    v_exp_f32 v54, v54
    v_exp_f32 v55, v55
    v_cvt_pk_bf16_f32 v73, v50, v51
    v_mfma_f32_32x32x16_bf16 a[128:143], a[248:251], v[64:67], a[128:143]
    v_exp_f32 v56, v56
    v_exp_f32 v57, v57
    v_cvt_pk_bf16_f32 v74, v52, v53
    v_exp_f32 v58, v58
    v_exp_f32 v59, v59
    v_cvt_pk_bf16_f32 v75, v54, v55
    v_mfma_f32_32x32x16_bf16 a[128:143], a[252:255], v[68:71], a[128:143]
    v_exp_f32 v60, v60
    v_exp_f32 v61, v61
    v_cvt_pk_bf16_f32 v76, v56, v57
    v_exp_f32 v62, v62
    v_exp_f32 v63, v63
    v_cvt_pk_bf16_f32 v77, v58, v59
    v_cvt_pk_bf16_f32 v78, v60, v61
    v_cvt_pk_bf16_f32 v79, v62, v63
    buffer_load_dwordx4 v254, s[8:11], s59 offen offset:2048 sc1 lds
    v_mfma_f32_32x32x16_bf16 v[48:63], a[160:163], v[4:7], 0
    v_exp_f32 v32, v32
    v_exp_f32 v33, v33
    v_exp_f32 v34, v34
    v_exp_f32 v35, v35
    v_mfma_f32_32x32x8bf16_1k v[48:63], a[164:165], v[18:19], v[48:63]
    v_exp_f32 v36, v36
    v_exp_f32 v37, v37
    v_cvt_pk_bf16_f32 v64, v32, v33
    v_exp_f32 v38, v38
    v_exp_f32 v39, v39
    v_cvt_pk_bf16_f32 v65, v34, v35
    v_mfma_f32_32x32x16_bf16 a[144:159], a[248:251], v[72:75], a[144:159]
    v_exp_f32 v40, v40
    v_exp_f32 v41, v41
    v_cvt_pk_bf16_f32 v66, v36, v37
    v_exp_f32 v42, v42
    v_exp_f32 v43, v43
    v_cvt_pk_bf16_f32 v67, v38, v39
    v_mfma_f32_32x32x16_bf16 a[144:159], a[252:255], v[76:79], a[144:159]
    v_exp_f32 v44, v44
    v_exp_f32 v45, v45
    v_cvt_pk_bf16_f32 v68, v40, v41
    v_exp_f32 v46, v46
    v_exp_f32 v47, v47
    v_cvt_pk_bf16_f32 v69, v42, v43
    v_cvt_pk_bf16_f32 v70, v44, v45
    v_cvt_pk_bf16_f32 v71, v46, v47
    buffer_load_dwordx4 v254, s[8:11], s59 offen offset:3072 sc1 lds
    v_mfma_f32_32x32x16_bf16 v[32:47], a[160:163], v[8:11], 0
    v_exp_f32 v48, v48
    v_exp_f32 v49, v49
    v_exp_f32 v50, v50
    v_exp_f32 v51, v51
    buffer_load_dwordx2 a[240:241], v26, s[8:11], s62 offen offset:2816 sc1
    buffer_load_dwordx2 a[242:243], v26, s[8:11], s63 offen offset:2816 sc1
    v_mfma_f32_32x32x8bf16_1k v[32:47], a[164:165], v[20:21], v[32:47]
    v_exp_f32 v52, v52
    v_exp_f32 v53, v53
    v_cvt_pk_bf16_f32 v72, v48, v49
    v_exp_f32 v54, v54
    v_exp_f32 v55, v55
    v_cvt_pk_bf16_f32 v73, v50, v51
    v_mfma_f32_32x32x16_bf16 a[96:111], a[168:171], v[64:67], a[96:111]
    v_exp_f32 v56, v56
    v_exp_f32 v57, v57
    v_cvt_pk_bf16_f32 v74, v52, v53
    v_exp_f32 v58, v58
    v_exp_f32 v59, v59
    v_cvt_pk_bf16_f32 v75, v54, v55
    buffer_load_dword a244, v24, s[8:11], s64 offen offset:2816 sc1
    v_mfma_f32_32x32x16_bf16 a[96:111], a[172:175], v[68:71], a[96:111]
    v_exp_f32 v60, v60
    v_exp_f32 v61, v61
    v_cvt_pk_bf16_f32 v76, v56, v57
    v_exp_f32 v62, v62
    v_exp_f32 v63, v63
    v_cvt_pk_bf16_f32 v77, v58, v59
    v_cvt_pk_bf16_f32 v78, v60, v61
    v_cvt_pk_bf16_f32 v79, v62, v63
    s_add_u32 m0, s36, 9216
    s_add_u32 s59, s34, 40960
    buffer_load_dwordx4 v254, s[8:11], s59 offen offset:0 sc1 lds
    v_mfma_f32_32x32x16_bf16 v[48:63], a[160:163], v[12:15], 0
    v_exp_f32 v32, v32
    v_exp_f32 v33, v33
    v_exp_f32 v34, v34
    v_exp_f32 v35, v35
    v_mfma_f32_32x32x8bf16_1k v[48:63], a[164:165], v[22:23], v[48:63]
    v_exp_f32 v36, v36
    v_exp_f32 v37, v37
    v_cvt_pk_bf16_f32 v64, v32, v33
    v_exp_f32 v38, v38
    v_exp_f32 v39, v39
    v_cvt_pk_bf16_f32 v65, v34, v35
    buffer_load_dwordx4 a[248:251], v25, s[8:11], 0 offen offset:3456 sc1
    buffer_load_dwordx4 a[252:255], v25, s[8:11], 0 offen offset:4032 sc1
    v_mfma_f32_32x32x16_bf16 a[112:127], a[168:171], v[72:75], a[112:127]
    v_exp_f32 v40, v40
    v_exp_f32 v41, v41
    v_cvt_pk_bf16_f32 v66, v36, v37
    v_exp_f32 v42, v42
    v_exp_f32 v43, v43
    v_cvt_pk_bf16_f32 v67, v38, v39
    v_mfma_f32_32x32x16_bf16 a[112:127], a[172:175], v[76:79], a[112:127]
    v_exp_f32 v44, v44
    v_exp_f32 v45, v45
    v_cvt_pk_bf16_f32 v68, v40, v41
    v_exp_f32 v46, v46
    v_exp_f32 v47, v47
    v_cvt_pk_bf16_f32 v69, v42, v43
    v_cvt_pk_bf16_f32 v70, v44, v45
    v_cvt_pk_bf16_f32 v71, v46, v47
    buffer_load_dwordx4 v254, s[8:11], s59 offen offset:1024 sc1 lds
    s_waitcnt vmcnt(61)
    v_mfma_f32_32x32x16_bf16 v[32:47], a[176:179], v[0:3], 0
    v_exp_f32 v48, v48
    v_exp_f32 v49, v49
    v_exp_f32 v50, v50
    v_exp_f32 v51, v51
    v_mfma_f32_32x32x8bf16_1k v[32:47], a[180:181], v[16:17], v[32:47]
    v_exp_f32 v52, v52
    v_exp_f32 v53, v53
    v_cvt_pk_bf16_f32 v72, v48, v49
    v_exp_f32 v54, v54
    v_exp_f32 v55, v55
    v_cvt_pk_bf16_f32 v73, v50, v51
    v_mfma_f32_32x32x16_bf16 a[128:143], a[168:171], v[64:67], a[128:143]
    v_exp_f32 v56, v56
    v_exp_f32 v57, v57
    v_cvt_pk_bf16_f32 v74, v52, v53
    v_exp_f32 v58, v58
    v_exp_f32 v59, v59
    v_cvt_pk_bf16_f32 v75, v54, v55
    v_mfma_f32_32x32x16_bf16 a[128:143], a[172:175], v[68:71], a[128:143]
    v_exp_f32 v60, v60
    v_exp_f32 v61, v61
    v_cvt_pk_bf16_f32 v76, v56, v57
    v_exp_f32 v62, v62
    v_exp_f32 v63, v63
    v_cvt_pk_bf16_f32 v77, v58, v59
    v_cvt_pk_bf16_f32 v78, v60, v61
    v_cvt_pk_bf16_f32 v79, v62, v63
    buffer_load_dwordx4 v254, s[8:11], s59 offen offset:2048 sc1 lds
    v_mfma_f32_32x32x16_bf16 v[48:63], a[176:179], v[4:7], 0
    v_exp_f32 v32, v32
    v_exp_f32 v33, v33
    v_exp_f32 v34, v34
    v_exp_f32 v35, v35
    v_mfma_f32_32x32x8bf16_1k v[48:63], a[180:181], v[18:19], v[48:63]
    v_exp_f32 v36, v36
    v_exp_f32 v37, v37
    v_cvt_pk_bf16_f32 v64, v32, v33
    v_exp_f32 v38, v38
    v_exp_f32 v39, v39
    v_cvt_pk_bf16_f32 v65, v34, v35
    v_mfma_f32_32x32x16_bf16 a[144:159], a[168:171], v[72:75], a[144:159]
    v_exp_f32 v40, v40
    v_exp_f32 v41, v41
    v_cvt_pk_bf16_f32 v66, v36, v37
    v_exp_f32 v42, v42
    v_exp_f32 v43, v43
    v_cvt_pk_bf16_f32 v67, v38, v39
    v_mfma_f32_32x32x16_bf16 a[144:159], a[172:175], v[76:79], a[144:159]
    v_exp_f32 v44, v44
    v_exp_f32 v45, v45
    v_cvt_pk_bf16_f32 v68, v40, v41
    v_exp_f32 v46, v46
    v_exp_f32 v47, v47
    v_cvt_pk_bf16_f32 v69, v42, v43
    v_cvt_pk_bf16_f32 v70, v44, v45
    v_cvt_pk_bf16_f32 v71, v46, v47
    buffer_load_dwordx4 v254, s[8:11], s59 offen offset:3072 sc1 lds
    v_mfma_f32_32x32x16_bf16 v[32:47], a[176:179], v[8:11], 0
    v_exp_f32 v48, v48
    v_exp_f32 v49, v49
    v_exp_f32 v50, v50
    v_exp_f32 v51, v51
    buffer_load_dwordx2 a[160:161], v26, s[8:11], s62 offen offset:3072 sc1
    buffer_load_dwordx2 a[162:163], v26, s[8:11], s63 offen offset:3072 sc1
    v_mfma_f32_32x32x8bf16_1k v[32:47], a[180:181], v[20:21], v[32:47]
    v_exp_f32 v52, v52
    v_exp_f32 v53, v53
    v_cvt_pk_bf16_f32 v72, v48, v49
    v_exp_f32 v54, v54
    v_exp_f32 v55, v55
    v_cvt_pk_bf16_f32 v73, v50, v51
    v_mfma_f32_32x32x16_bf16 a[96:111], a[184:187], v[64:67], a[96:111]
    v_exp_f32 v56, v56
    v_exp_f32 v57, v57
    v_cvt_pk_bf16_f32 v74, v52, v53
    v_exp_f32 v58, v58
    v_exp_f32 v59, v59
    v_cvt_pk_bf16_f32 v75, v54, v55
    buffer_load_dword a164, v24, s[8:11], s64 offen offset:3072 sc1
    v_mfma_f32_32x32x16_bf16 a[96:111], a[188:191], v[68:71], a[96:111]
    v_exp_f32 v60, v60
    v_exp_f32 v61, v61
    v_cvt_pk_bf16_f32 v76, v56, v57
    v_exp_f32 v62, v62
    v_exp_f32 v63, v63
    v_cvt_pk_bf16_f32 v77, v58, v59
    v_cvt_pk_bf16_f32 v78, v60, v61
    v_cvt_pk_bf16_f32 v79, v62, v63
    s_add_u32 m0, s36, 13312
    s_add_u32 s59, s34, 77824
    buffer_load_dwordx4 v254, s[8:11], s59 offen offset:0 sc1 lds
    v_mfma_f32_32x32x16_bf16 v[48:63], a[176:179], v[12:15], 0
    v_exp_f32 v32, v32
    v_exp_f32 v33, v33
    v_exp_f32 v34, v34
    v_exp_f32 v35, v35
    v_mfma_f32_32x32x8bf16_1k v[48:63], a[180:181], v[22:23], v[48:63]
    v_exp_f32 v36, v36
    v_exp_f32 v37, v37
    v_cvt_pk_bf16_f32 v64, v32, v33
    v_exp_f32 v38, v38
    v_exp_f32 v39, v39
    v_cvt_pk_bf16_f32 v65, v34, v35
    v_add_u32 v25, v28, v25
    buffer_load_dwordx4 a[168:171], v25, s[8:11], 0 offen offset:0 sc1
    buffer_load_dwordx4 a[172:175], v25, s[8:11], 0 offen offset:576 sc1
    v_mfma_f32_32x32x16_bf16 a[112:127], a[184:187], v[72:75], a[112:127]
    v_exp_f32 v40, v40
    v_exp_f32 v41, v41
    v_cvt_pk_bf16_f32 v66, v36, v37
    v_exp_f32 v42, v42
    v_exp_f32 v43, v43
    v_cvt_pk_bf16_f32 v67, v38, v39
    v_mfma_f32_32x32x16_bf16 a[112:127], a[188:191], v[76:79], a[112:127]
    v_exp_f32 v44, v44
    v_exp_f32 v45, v45
    v_cvt_pk_bf16_f32 v68, v40, v41
    v_exp_f32 v46, v46
    v_exp_f32 v47, v47
    v_cvt_pk_bf16_f32 v69, v42, v43
    v_cvt_pk_bf16_f32 v70, v44, v45
    v_cvt_pk_bf16_f32 v71, v46, v47
    buffer_load_dwordx4 v254, s[8:11], s59 offen offset:1024 sc1 lds
    s_waitcnt vmcnt(41)
    v_mfma_f32_32x32x16_bf16 v[32:47], a[192:195], v[0:3], 0
    v_exp_f32 v48, v48
    v_exp_f32 v49, v49
    v_exp_f32 v50, v50
    v_exp_f32 v51, v51
    v_mfma_f32_32x32x8bf16_1k v[32:47], a[196:197], v[16:17], v[32:47]
    v_exp_f32 v52, v52
    v_exp_f32 v53, v53
    v_cvt_pk_bf16_f32 v72, v48, v49
    v_exp_f32 v54, v54
    v_exp_f32 v55, v55
    v_cvt_pk_bf16_f32 v73, v50, v51
    v_mfma_f32_32x32x16_bf16 a[128:143], a[184:187], v[64:67], a[128:143]
    v_exp_f32 v56, v56
    v_exp_f32 v57, v57
    v_cvt_pk_bf16_f32 v74, v52, v53
    v_exp_f32 v58, v58
    v_exp_f32 v59, v59
    v_cvt_pk_bf16_f32 v75, v54, v55
    v_mfma_f32_32x32x16_bf16 a[128:143], a[188:191], v[68:71], a[128:143]
    v_exp_f32 v60, v60
    v_exp_f32 v61, v61
    v_cvt_pk_bf16_f32 v76, v56, v57
    v_exp_f32 v62, v62
    v_exp_f32 v63, v63
    v_cvt_pk_bf16_f32 v77, v58, v59
    v_cvt_pk_bf16_f32 v78, v60, v61
    v_cvt_pk_bf16_f32 v79, v62, v63
    buffer_load_dwordx4 v254, s[8:11], s59 offen offset:2048 sc1 lds
    v_mfma_f32_32x32x16_bf16 v[48:63], a[192:195], v[4:7], 0
    v_exp_f32 v32, v32
    v_exp_f32 v33, v33
    v_exp_f32 v34, v34
    v_exp_f32 v35, v35
    v_mfma_f32_32x32x8bf16_1k v[48:63], a[196:197], v[18:19], v[48:63]
    v_exp_f32 v36, v36
    v_exp_f32 v37, v37
    v_cvt_pk_bf16_f32 v64, v32, v33
    v_exp_f32 v38, v38
    v_exp_f32 v39, v39
    v_cvt_pk_bf16_f32 v65, v34, v35
    v_mfma_f32_32x32x16_bf16 a[144:159], a[184:187], v[72:75], a[144:159]
    v_exp_f32 v40, v40
    v_exp_f32 v41, v41
    v_cvt_pk_bf16_f32 v66, v36, v37
    v_exp_f32 v42, v42
    v_exp_f32 v43, v43
    v_cvt_pk_bf16_f32 v67, v38, v39
    v_mfma_f32_32x32x16_bf16 a[144:159], a[188:191], v[76:79], a[144:159]
    v_exp_f32 v44, v44
    v_exp_f32 v45, v45
    v_cvt_pk_bf16_f32 v68, v40, v41
    v_exp_f32 v46, v46
    v_exp_f32 v47, v47
    v_cvt_pk_bf16_f32 v69, v42, v43
    v_cvt_pk_bf16_f32 v70, v44, v45
    v_cvt_pk_bf16_f32 v71, v46, v47
    buffer_load_dwordx4 v254, s[8:11], s59 offen offset:3072 sc1 lds
    v_mfma_f32_32x32x16_bf16 v[32:47], a[192:195], v[8:11], 0
    v_exp_f32 v48, v48
    v_exp_f32 v49, v49
    v_exp_f32 v50, v50
    v_exp_f32 v51, v51
    buffer_load_dwordx2 a[176:177], v26, s[8:11], s62 offen offset:3328 sc1
    buffer_load_dwordx2 a[178:179], v26, s[8:11], s63 offen offset:3328 sc1
    v_mfma_f32_32x32x8bf16_1k v[32:47], a[196:197], v[20:21], v[32:47]
    v_exp_f32 v52, v52
    v_exp_f32 v53, v53
    v_cvt_pk_bf16_f32 v72, v48, v49
    v_exp_f32 v54, v54
    v_exp_f32 v55, v55
    v_cvt_pk_bf16_f32 v73, v50, v51
    v_mfma_f32_32x32x16_bf16 a[96:111], a[200:203], v[64:67], a[96:111]
    v_exp_f32 v56, v56
    v_exp_f32 v57, v57
    v_cvt_pk_bf16_f32 v74, v52, v53
    v_exp_f32 v58, v58
    v_exp_f32 v59, v59
    v_cvt_pk_bf16_f32 v75, v54, v55
    buffer_load_dword a180, v24, s[8:11], s64 offen offset:3328 sc1
    v_mfma_f32_32x32x16_bf16 a[96:111], a[204:207], v[68:71], a[96:111]
    v_exp_f32 v60, v60
    v_exp_f32 v61, v61
    v_cvt_pk_bf16_f32 v76, v56, v57
    v_exp_f32 v62, v62
    v_exp_f32 v63, v63
    v_cvt_pk_bf16_f32 v77, v58, v59
    v_cvt_pk_bf16_f32 v78, v60, v61
    v_cvt_pk_bf16_f32 v79, v62, v63
    s_add_u32 m0, s36, 17408
    s_add_u32 s59, s34, 114688
    buffer_load_dwordx4 v254, s[8:11], s59 offen offset:0 sc1 lds
    v_mfma_f32_32x32x16_bf16 v[48:63], a[192:195], v[12:15], 0
    v_exp_f32 v32, v32
    v_exp_f32 v33, v33
    v_exp_f32 v34, v34
    v_exp_f32 v35, v35
    v_mfma_f32_32x32x8bf16_1k v[48:63], a[196:197], v[22:23], v[48:63]
    v_exp_f32 v36, v36
    v_exp_f32 v37, v37
    v_cvt_pk_bf16_f32 v64, v32, v33
    v_exp_f32 v38, v38
    v_exp_f32 v39, v39
    v_cvt_pk_bf16_f32 v65, v34, v35
    buffer_load_dwordx4 a[184:187], v25, s[8:11], 0 offen offset:1152 sc1
    buffer_load_dwordx4 a[188:191], v25, s[8:11], 0 offen offset:1728 sc1
    v_mfma_f32_32x32x16_bf16 a[112:127], a[200:203], v[72:75], a[112:127]
    v_exp_f32 v40, v40
    v_exp_f32 v41, v41
    v_cvt_pk_bf16_f32 v66, v36, v37
    v_exp_f32 v42, v42
    v_exp_f32 v43, v43
    v_cvt_pk_bf16_f32 v67, v38, v39
    v_mfma_f32_32x32x16_bf16 a[112:127], a[204:207], v[76:79], a[112:127]
    v_exp_f32 v44, v44
    v_exp_f32 v45, v45
    v_cvt_pk_bf16_f32 v68, v40, v41
    v_exp_f32 v46, v46
    v_exp_f32 v47, v47
    v_cvt_pk_bf16_f32 v69, v42, v43
    v_cvt_pk_bf16_f32 v70, v44, v45
    v_cvt_pk_bf16_f32 v71, v46, v47
    buffer_load_dwordx4 v254, s[8:11], s59 offen offset:1024 sc1 lds
    s_waitcnt vmcnt(41)
    v_mfma_f32_32x32x16_bf16 v[32:47], a[208:211], v[0:3], 0
    v_exp_f32 v48, v48
    v_exp_f32 v49, v49
    v_exp_f32 v50, v50
    v_exp_f32 v51, v51
    v_mfma_f32_32x32x8bf16_1k v[32:47], a[212:213], v[16:17], v[32:47]
    v_exp_f32 v52, v52
    v_exp_f32 v53, v53
    v_cvt_pk_bf16_f32 v72, v48, v49
    v_exp_f32 v54, v54
    v_exp_f32 v55, v55
    v_cvt_pk_bf16_f32 v73, v50, v51
    v_mfma_f32_32x32x16_bf16 a[128:143], a[200:203], v[64:67], a[128:143]
    v_exp_f32 v56, v56
    v_exp_f32 v57, v57
    v_cvt_pk_bf16_f32 v74, v52, v53
    v_exp_f32 v58, v58
    v_exp_f32 v59, v59
    v_cvt_pk_bf16_f32 v75, v54, v55
    v_mfma_f32_32x32x16_bf16 a[128:143], a[204:207], v[68:71], a[128:143]
    v_exp_f32 v60, v60
    v_exp_f32 v61, v61
    v_cvt_pk_bf16_f32 v76, v56, v57
    v_exp_f32 v62, v62
    v_exp_f32 v63, v63
    v_cvt_pk_bf16_f32 v77, v58, v59
    v_cvt_pk_bf16_f32 v78, v60, v61
    v_cvt_pk_bf16_f32 v79, v62, v63
    buffer_load_dwordx4 v254, s[8:11], s59 offen offset:2048 sc1 lds
    v_mfma_f32_32x32x16_bf16 v[48:63], a[208:211], v[4:7], 0
    v_exp_f32 v32, v32
    v_exp_f32 v33, v33
    v_exp_f32 v34, v34
    v_exp_f32 v35, v35
    v_mfma_f32_32x32x8bf16_1k v[48:63], a[212:213], v[18:19], v[48:63]
    v_exp_f32 v36, v36
    v_exp_f32 v37, v37
    v_cvt_pk_bf16_f32 v64, v32, v33
    v_exp_f32 v38, v38
    v_exp_f32 v39, v39
    v_cvt_pk_bf16_f32 v65, v34, v35
    v_mfma_f32_32x32x16_bf16 a[144:159], a[200:203], v[72:75], a[144:159]
    v_exp_f32 v40, v40
    v_exp_f32 v41, v41
    v_cvt_pk_bf16_f32 v66, v36, v37
    v_exp_f32 v42, v42
    v_exp_f32 v43, v43
    v_cvt_pk_bf16_f32 v67, v38, v39
    v_mfma_f32_32x32x16_bf16 a[144:159], a[204:207], v[76:79], a[144:159]
    v_exp_f32 v44, v44
    v_exp_f32 v45, v45
    v_cvt_pk_bf16_f32 v68, v40, v41
    v_exp_f32 v46, v46
    v_exp_f32 v47, v47
    v_cvt_pk_bf16_f32 v69, v42, v43
    v_cvt_pk_bf16_f32 v70, v44, v45
    v_cvt_pk_bf16_f32 v71, v46, v47
    buffer_load_dwordx4 v254, s[8:11], s59 offen offset:3072 sc1 lds
    v_mfma_f32_32x32x16_bf16 v[32:47], a[208:211], v[8:11], 0
    v_exp_f32 v48, v48
    v_exp_f32 v49, v49
    v_exp_f32 v50, v50
    v_exp_f32 v51, v51
    buffer_load_dwordx2 a[192:193], v26, s[8:11], s62 offen offset:3584 sc1
    buffer_load_dwordx2 a[194:195], v26, s[8:11], s63 offen offset:3584 sc1
    v_mfma_f32_32x32x8bf16_1k v[32:47], a[212:213], v[20:21], v[32:47]
    v_exp_f32 v52, v52
    v_exp_f32 v53, v53
    v_cvt_pk_bf16_f32 v72, v48, v49
    v_exp_f32 v54, v54
    v_exp_f32 v55, v55
    v_cvt_pk_bf16_f32 v73, v50, v51
    v_mfma_f32_32x32x16_bf16 a[96:111], a[216:219], v[64:67], a[96:111]
    v_exp_f32 v56, v56
    v_exp_f32 v57, v57
    v_cvt_pk_bf16_f32 v74, v52, v53
    v_exp_f32 v58, v58
    v_exp_f32 v59, v59
    v_cvt_pk_bf16_f32 v75, v54, v55
    buffer_load_dword a196, v24, s[8:11], s64 offen offset:3584 sc1
    v_mfma_f32_32x32x16_bf16 a[96:111], a[220:223], v[68:71], a[96:111]
    v_exp_f32 v60, v60
    v_exp_f32 v61, v61
    v_cvt_pk_bf16_f32 v76, v56, v57
    v_exp_f32 v62, v62
    v_exp_f32 v63, v63
    v_cvt_pk_bf16_f32 v77, v58, v59
    v_cvt_pk_bf16_f32 v78, v60, v61
    v_cvt_pk_bf16_f32 v79, v62, v63
    s_add_u32 m0, s36, 21504
    s_add_u32 s59, s34, 151552
    buffer_load_dwordx4 v254, s[8:11], s59 offen offset:0 sc1 lds
    v_mfma_f32_32x32x16_bf16 v[48:63], a[208:211], v[12:15], 0
    v_exp_f32 v32, v32
    v_exp_f32 v33, v33
    v_exp_f32 v34, v34
    v_exp_f32 v35, v35
    v_mfma_f32_32x32x8bf16_1k v[48:63], a[212:213], v[22:23], v[48:63]
    v_exp_f32 v36, v36
    v_exp_f32 v37, v37
    v_cvt_pk_bf16_f32 v64, v32, v33
    v_exp_f32 v38, v38
    v_exp_f32 v39, v39
    v_cvt_pk_bf16_f32 v65, v34, v35
    buffer_load_dwordx4 a[200:203], v25, s[8:11], 0 offen offset:2304 sc1
    buffer_load_dwordx4 a[204:207], v25, s[8:11], 0 offen offset:2880 sc1
    v_mfma_f32_32x32x16_bf16 a[112:127], a[216:219], v[72:75], a[112:127]
    v_exp_f32 v40, v40
    v_exp_f32 v41, v41
    v_cvt_pk_bf16_f32 v66, v36, v37
    v_exp_f32 v42, v42
    v_exp_f32 v43, v43
    v_cvt_pk_bf16_f32 v67, v38, v39
    v_mfma_f32_32x32x16_bf16 a[112:127], a[220:223], v[76:79], a[112:127]
    v_exp_f32 v44, v44
    v_exp_f32 v45, v45
    v_cvt_pk_bf16_f32 v68, v40, v41
    v_exp_f32 v46, v46
    v_exp_f32 v47, v47
    v_cvt_pk_bf16_f32 v69, v42, v43
    v_cvt_pk_bf16_f32 v70, v44, v45
    v_cvt_pk_bf16_f32 v71, v46, v47
    buffer_load_dwordx4 v254, s[8:11], s59 offen offset:1024 sc1 lds
    s_waitcnt vmcnt(37)
    v_mfma_f32_32x32x16_bf16 v[32:47], a[224:227], v[0:3], 0
    v_exp_f32 v48, v48
    v_exp_f32 v49, v49
    v_exp_f32 v50, v50
    v_exp_f32 v51, v51
    v_mfma_f32_32x32x8bf16_1k v[32:47], a[228:229], v[16:17], v[32:47]
    v_exp_f32 v52, v52
    v_exp_f32 v53, v53
    v_cvt_pk_bf16_f32 v72, v48, v49
    v_exp_f32 v54, v54
    v_exp_f32 v55, v55
    v_cvt_pk_bf16_f32 v73, v50, v51
    v_mfma_f32_32x32x16_bf16 a[128:143], a[216:219], v[64:67], a[128:143]
    v_exp_f32 v56, v56
    v_exp_f32 v57, v57
    v_cvt_pk_bf16_f32 v74, v52, v53
    v_exp_f32 v58, v58
    v_exp_f32 v59, v59
    v_cvt_pk_bf16_f32 v75, v54, v55
    v_mfma_f32_32x32x16_bf16 a[128:143], a[220:223], v[68:71], a[128:143]
    v_exp_f32 v60, v60
    v_exp_f32 v61, v61
    v_cvt_pk_bf16_f32 v76, v56, v57
    v_exp_f32 v62, v62
    v_exp_f32 v63, v63
    v_cvt_pk_bf16_f32 v77, v58, v59
    v_cvt_pk_bf16_f32 v78, v60, v61
    v_cvt_pk_bf16_f32 v79, v62, v63
    buffer_load_dwordx4 v254, s[8:11], s59 offen offset:2048 sc1 lds
    v_mfma_f32_32x32x16_bf16 v[48:63], a[224:227], v[4:7], 0
    v_exp_f32 v32, v32
    v_exp_f32 v33, v33
    v_exp_f32 v34, v34
    v_exp_f32 v35, v35
    v_mfma_f32_32x32x8bf16_1k v[48:63], a[228:229], v[18:19], v[48:63]
    v_exp_f32 v36, v36
    v_exp_f32 v37, v37
    v_cvt_pk_bf16_f32 v64, v32, v33
    v_exp_f32 v38, v38
    v_exp_f32 v39, v39
    v_cvt_pk_bf16_f32 v65, v34, v35
    v_mfma_f32_32x32x16_bf16 a[144:159], a[216:219], v[72:75], a[144:159]
    v_exp_f32 v40, v40
    v_exp_f32 v41, v41
    v_cvt_pk_bf16_f32 v66, v36, v37
    v_exp_f32 v42, v42
    v_exp_f32 v43, v43
    v_cvt_pk_bf16_f32 v67, v38, v39
    v_mfma_f32_32x32x16_bf16 a[144:159], a[220:223], v[76:79], a[144:159]
    v_exp_f32 v44, v44
    v_exp_f32 v45, v45
    v_cvt_pk_bf16_f32 v68, v40, v41
    v_exp_f32 v46, v46
    v_exp_f32 v47, v47
    v_cvt_pk_bf16_f32 v69, v42, v43
    v_cvt_pk_bf16_f32 v70, v44, v45
    v_cvt_pk_bf16_f32 v71, v46, v47
    s_mov_b64 exec, 1
    buffer_store_dword v117, v253, s[8:11], 0 offen sc1
    s_mov_b64 exec, -1
    buffer_load_dwordx4 v254, s[8:11], s59 offen offset:3072 sc1 lds
    v_mfma_f32_32x32x16_bf16 v[32:47], a[224:227], v[8:11], 0
    v_exp_f32 v48, v48
    v_exp_f32 v49, v49
    v_exp_f32 v50, v50
    v_exp_f32 v51, v51
    buffer_load_dwordx2 a[208:209], v26, s[8:11], s62 offen offset:3840 sc1
    buffer_load_dwordx2 a[210:211], v26, s[8:11], s63 offen offset:3840 sc1
    v_mfma_f32_32x32x8bf16_1k v[32:47], a[228:229], v[20:21], v[32:47]
    v_exp_f32 v52, v52
    v_exp_f32 v53, v53
    v_cvt_pk_bf16_f32 v72, v48, v49
    v_exp_f32 v54, v54
    v_exp_f32 v55, v55
    v_cvt_pk_bf16_f32 v73, v50, v51
    v_mfma_f32_32x32x16_bf16 a[96:111], a[232:235], v[64:67], a[96:111]
    v_exp_f32 v56, v56
    v_exp_f32 v57, v57
    v_cvt_pk_bf16_f32 v74, v52, v53
    v_exp_f32 v58, v58
    v_exp_f32 v59, v59
    v_cvt_pk_bf16_f32 v75, v54, v55
    buffer_load_dword a212, v24, s[8:11], s64 offen offset:3840 sc1
    v_mfma_f32_32x32x16_bf16 a[96:111], a[236:239], v[68:71], a[96:111]
    v_exp_f32 v60, v60
    v_exp_f32 v61, v61
    v_cvt_pk_bf16_f32 v76, v56, v57
    v_exp_f32 v62, v62
    v_exp_f32 v63, v63
    v_cvt_pk_bf16_f32 v77, v58, v59
    v_cvt_pk_bf16_f32 v78, v60, v61
    v_cvt_pk_bf16_f32 v79, v62, v63
    s_add_u32 s59, s34, 0
    buffer_load_dwordx4 a[20:23], v254, s[8:11], s59 offen offset:0 sc1
    buffer_load_dwordx4 a[24:27], v254, s[8:11], s59 offen offset:1024 sc1
    v_mfma_f32_32x32x16_bf16 v[48:63], a[224:227], v[12:15], 0
    v_exp_f32 v32, v32
    v_exp_f32 v33, v33
    v_exp_f32 v34, v34
    v_exp_f32 v35, v35
    v_mfma_f32_32x32x8bf16_1k v[48:63], a[228:229], v[22:23], v[48:63]
    v_exp_f32 v36, v36
    v_exp_f32 v37, v37
    v_cvt_pk_bf16_f32 v64, v32, v33
    v_exp_f32 v38, v38
    v_exp_f32 v39, v39
    v_cvt_pk_bf16_f32 v65, v34, v35
    buffer_load_dwordx4 a[216:219], v25, s[8:11], 0 offen offset:3456 sc1
    buffer_load_dwordx4 a[220:223], v25, s[8:11], 0 offen offset:4032 sc1
    v_mfma_f32_32x32x16_bf16 a[112:127], a[232:235], v[72:75], a[112:127]
    v_exp_f32 v40, v40
    v_exp_f32 v41, v41
    v_cvt_pk_bf16_f32 v66, v36, v37
    v_exp_f32 v42, v42
    v_exp_f32 v43, v43
    v_cvt_pk_bf16_f32 v67, v38, v39
    v_mfma_f32_32x32x16_bf16 a[112:127], a[236:239], v[76:79], a[112:127]
    v_exp_f32 v44, v44
    v_exp_f32 v45, v45
    v_cvt_pk_bf16_f32 v68, v40, v41
    v_exp_f32 v46, v46
    v_exp_f32 v47, v47
    v_cvt_pk_bf16_f32 v69, v42, v43
    v_cvt_pk_bf16_f32 v70, v44, v45
    v_cvt_pk_bf16_f32 v71, v46, v47
    buffer_load_dwordx4 a[28:31], v254, s[8:11], s59 offen offset:2048 sc1
    s_waitcnt vmcnt(39)
    v_mfma_f32_32x32x16_bf16 v[32:47], a[240:243], v[0:3], 0
    v_exp_f32 v48, v48
    v_exp_f32 v49, v49
    v_exp_f32 v50, v50
    v_exp_f32 v51, v51
    v_mfma_f32_32x32x8bf16_1k v[32:47], a[244:245], v[16:17], v[32:47]
    v_exp_f32 v52, v52
    v_exp_f32 v53, v53
    v_cvt_pk_bf16_f32 v72, v48, v49
    v_exp_f32 v54, v54
    v_exp_f32 v55, v55
    v_cvt_pk_bf16_f32 v73, v50, v51
    v_mfma_f32_32x32x16_bf16 a[128:143], a[232:235], v[64:67], a[128:143]
    v_exp_f32 v56, v56
    v_exp_f32 v57, v57
    v_cvt_pk_bf16_f32 v74, v52, v53
    v_exp_f32 v58, v58
    v_exp_f32 v59, v59
    v_cvt_pk_bf16_f32 v75, v54, v55
    v_mfma_f32_32x32x16_bf16 a[128:143], a[236:239], v[68:71], a[128:143]
    v_exp_f32 v60, v60
    v_exp_f32 v61, v61
    v_cvt_pk_bf16_f32 v76, v56, v57
    v_exp_f32 v62, v62
    v_exp_f32 v63, v63
    v_cvt_pk_bf16_f32 v77, v58, v59
    v_cvt_pk_bf16_f32 v78, v60, v61
    v_cvt_pk_bf16_f32 v79, v62, v63
    v_mfma_f32_32x32x16_bf16 v[48:63], a[240:243], v[4:7], 0
    v_exp_f32 v32, v32
    v_exp_f32 v33, v33
    v_exp_f32 v34, v34
    v_exp_f32 v35, v35
    v_mfma_f32_32x32x8bf16_1k v[48:63], a[244:245], v[18:19], v[48:63]
    v_exp_f32 v36, v36
    v_exp_f32 v37, v37
    v_cvt_pk_bf16_f32 v64, v32, v33
    v_exp_f32 v38, v38
    v_exp_f32 v39, v39
    v_cvt_pk_bf16_f32 v65, v34, v35
    v_mfma_f32_32x32x16_bf16 a[144:159], a[232:235], v[72:75], a[144:159]
    v_exp_f32 v40, v40
    v_exp_f32 v41, v41
    v_cvt_pk_bf16_f32 v66, v36, v37
    v_exp_f32 v42, v42
    v_exp_f32 v43, v43
    v_cvt_pk_bf16_f32 v67, v38, v39
    v_mfma_f32_32x32x16_bf16 a[144:159], a[236:239], v[76:79], a[144:159]
    v_exp_f32 v44, v44
    v_exp_f32 v45, v45
    v_cvt_pk_bf16_f32 v68, v40, v41
    v_exp_f32 v46, v46
    v_exp_f32 v47, v47
    v_cvt_pk_bf16_f32 v69, v42, v43
    v_cvt_pk_bf16_f32 v70, v44, v45
    v_cvt_pk_bf16_f32 v71, v46, v47
    buffer_load_dwordx4 a[32:35], v254, s[8:11], s59 offen offset:3072 sc1
    s_add_u32 s59, s34, 36864
    buffer_load_dwordx4 a[36:39], v254, s[8:11], s59 offen offset:0 sc1
    v_mfma_f32_32x32x16_bf16 v[32:47], a[240:243], v[8:11], 0
    v_exp_f32 v48, v48
    v_exp_f32 v49, v49
    v_exp_f32 v50, v50
    v_exp_f32 v51, v51
    s_add_u32 s62, s62, 4096
    s_add_u32 s63, s63, 4096
    s_add_u32 s64, s64, 4096
    buffer_load_dwordx2 a[224:225], v26, s[8:11], s62 offen offset:0 sc1
    buffer_load_dwordx2 a[226:227], v26, s[8:11], s63 offen offset:0 sc1
    v_mfma_f32_32x32x8bf16_1k v[32:47], a[244:245], v[20:21], v[32:47]
    v_exp_f32 v52, v52
    v_exp_f32 v53, v53
    v_cvt_pk_bf16_f32 v72, v48, v49
    v_exp_f32 v54, v54
    v_exp_f32 v55, v55
    v_cvt_pk_bf16_f32 v73, v50, v51
    v_mfma_f32_32x32x16_bf16 a[96:111], a[248:251], v[64:67], a[96:111]
    v_exp_f32 v56, v56
    v_exp_f32 v57, v57
    v_cvt_pk_bf16_f32 v74, v52, v53
    v_exp_f32 v58, v58
    v_exp_f32 v59, v59
    v_cvt_pk_bf16_f32 v75, v54, v55
    buffer_load_dword a228, v24, s[8:11], s64 offen offset:0 sc1
    v_mfma_f32_32x32x16_bf16 a[96:111], a[252:255], v[68:71], a[96:111]
    v_exp_f32 v60, v60
    v_exp_f32 v61, v61
    v_cvt_pk_bf16_f32 v76, v56, v57
    v_exp_f32 v62, v62
    v_exp_f32 v63, v63
    v_cvt_pk_bf16_f32 v77, v58, v59
    v_cvt_pk_bf16_f32 v78, v60, v61
    v_cvt_pk_bf16_f32 v79, v62, v63
    buffer_load_dwordx4 a[40:43], v254, s[8:11], s59 offen offset:1024 sc1
    buffer_load_dwordx4 a[44:47], v254, s[8:11], s59 offen offset:2048 sc1
    v_mfma_f32_32x32x16_bf16 v[48:63], a[240:243], v[12:15], 0
    v_exp_f32 v32, v32
    v_exp_f32 v33, v33
    v_exp_f32 v34, v34
    v_exp_f32 v35, v35
    v_mfma_f32_32x32x8bf16_1k v[48:63], a[244:245], v[22:23], v[48:63]
    v_exp_f32 v36, v36
    v_exp_f32 v37, v37
    v_cvt_pk_bf16_f32 v64, v32, v33
    v_exp_f32 v38, v38
    v_exp_f32 v39, v39
    v_cvt_pk_bf16_f32 v65, v34, v35
    v_add_u32 v25, v28, v25
    buffer_load_dwordx4 a[232:235], v25, s[8:11], 0 offen offset:0 sc1
    buffer_load_dwordx4 a[236:239], v25, s[8:11], 0 offen offset:576 sc1
    v_mfma_f32_32x32x16_bf16 a[112:127], a[248:251], v[72:75], a[112:127]
    v_exp_f32 v40, v40
    v_exp_f32 v41, v41
    v_cvt_pk_bf16_f32 v66, v36, v37
    v_exp_f32 v42, v42
    v_exp_f32 v43, v43
    v_cvt_pk_bf16_f32 v67, v38, v39
    v_mfma_f32_32x32x16_bf16 a[112:127], a[252:255], v[76:79], a[112:127]
    v_exp_f32 v44, v44
    v_exp_f32 v45, v45
    v_cvt_pk_bf16_f32 v68, v40, v41
    v_exp_f32 v46, v46
    v_exp_f32 v47, v47
    v_cvt_pk_bf16_f32 v69, v42, v43
    v_cvt_pk_bf16_f32 v70, v44, v45
    v_cvt_pk_bf16_f32 v71, v46, v47
    buffer_load_dword v243, v252, s[8:11], 0 offen sc1
    s_waitcnt vmcnt(40)
    v_mfma_f32_32x32x16_bf16 v[32:47], a[160:163], v[0:3], 0
    v_exp_f32 v48, v48
    v_exp_f32 v49, v49
    v_exp_f32 v50, v50
    v_exp_f32 v51, v51
    v_mfma_f32_32x32x8bf16_1k v[32:47], a[164:165], v[16:17], v[32:47]
    v_exp_f32 v52, v52
    v_exp_f32 v53, v53
    v_cvt_pk_bf16_f32 v72, v48, v49
    v_exp_f32 v54, v54
    v_exp_f32 v55, v55
    v_cvt_pk_bf16_f32 v73, v50, v51
    v_mfma_f32_32x32x16_bf16 a[128:143], a[248:251], v[64:67], a[128:143]
    v_exp_f32 v56, v56
    v_exp_f32 v57, v57
    v_cvt_pk_bf16_f32 v74, v52, v53
    v_exp_f32 v58, v58
    v_exp_f32 v59, v59
    v_cvt_pk_bf16_f32 v75, v54, v55
    v_mfma_f32_32x32x16_bf16 a[128:143], a[252:255], v[68:71], a[128:143]
    v_exp_f32 v60, v60
    v_exp_f32 v61, v61
    v_cvt_pk_bf16_f32 v76, v56, v57
    v_exp_f32 v62, v62
    v_exp_f32 v63, v63
    v_cvt_pk_bf16_f32 v77, v58, v59
    v_cvt_pk_bf16_f32 v78, v60, v61
    v_cvt_pk_bf16_f32 v79, v62, v63
    v_mfma_f32_32x32x16_bf16 v[48:63], a[160:163], v[4:7], 0
    v_exp_f32 v32, v32
    v_exp_f32 v33, v33
    v_exp_f32 v34, v34
    v_exp_f32 v35, v35
    v_mfma_f32_32x32x8bf16_1k v[48:63], a[164:165], v[18:19], v[48:63]
    v_exp_f32 v36, v36
    v_exp_f32 v37, v37
    v_cvt_pk_bf16_f32 v64, v32, v33
    v_exp_f32 v38, v38
    v_exp_f32 v39, v39
    v_cvt_pk_bf16_f32 v65, v34, v35
    v_mfma_f32_32x32x16_bf16 a[144:159], a[248:251], v[72:75], a[144:159]
    v_exp_f32 v40, v40
    v_exp_f32 v41, v41
    v_cvt_pk_bf16_f32 v66, v36, v37
    v_exp_f32 v42, v42
    v_exp_f32 v43, v43
    v_cvt_pk_bf16_f32 v67, v38, v39
    v_mfma_f32_32x32x16_bf16 a[144:159], a[252:255], v[76:79], a[144:159]
    v_exp_f32 v44, v44
    v_exp_f32 v45, v45
    v_cvt_pk_bf16_f32 v68, v40, v41
    v_exp_f32 v46, v46
    v_exp_f32 v47, v47
    v_cvt_pk_bf16_f32 v69, v42, v43
    v_cvt_pk_bf16_f32 v70, v44, v45
    v_cvt_pk_bf16_f32 v71, v46, v47
    buffer_load_dwordx4 a[48:51], v254, s[8:11], s59 offen offset:3072 sc1
    v_mfma_f32_32x32x16_bf16 v[32:47], a[160:163], v[8:11], 0
    v_exp_f32 v48, v48
    v_exp_f32 v49, v49
    v_exp_f32 v50, v50
    v_exp_f32 v51, v51
    buffer_load_dwordx2 a[240:241], v26, s[8:11], s62 offen offset:256 sc1
    buffer_load_dwordx2 a[242:243], v26, s[8:11], s63 offen offset:256 sc1
    v_mfma_f32_32x32x8bf16_1k v[32:47], a[164:165], v[20:21], v[32:47]
    v_exp_f32 v52, v52
    v_exp_f32 v53, v53
    v_cvt_pk_bf16_f32 v72, v48, v49
    v_exp_f32 v54, v54
    v_exp_f32 v55, v55
    v_cvt_pk_bf16_f32 v73, v50, v51
    v_mfma_f32_32x32x16_bf16 a[96:111], a[168:171], v[64:67], a[96:111]
    v_exp_f32 v56, v56
    v_exp_f32 v57, v57
    v_cvt_pk_bf16_f32 v74, v52, v53
    v_exp_f32 v58, v58
    v_exp_f32 v59, v59
    v_cvt_pk_bf16_f32 v75, v54, v55
    buffer_load_dword a244, v24, s[8:11], s64 offen offset:256 sc1
    v_mfma_f32_32x32x16_bf16 a[96:111], a[172:175], v[68:71], a[96:111]
    v_exp_f32 v60, v60
    v_exp_f32 v61, v61
    v_cvt_pk_bf16_f32 v76, v56, v57
    v_exp_f32 v62, v62
    v_exp_f32 v63, v63
    v_cvt_pk_bf16_f32 v77, v58, v59
    v_cvt_pk_bf16_f32 v78, v60, v61
    v_cvt_pk_bf16_f32 v79, v62, v63
    s_add_u32 s59, s34, 73728
    buffer_load_dwordx4 a[52:55], v254, s[8:11], s59 offen offset:0 sc1
    v_mfma_f32_32x32x16_bf16 v[48:63], a[160:163], v[12:15], 0
    v_exp_f32 v32, v32
    v_exp_f32 v33, v33
    v_exp_f32 v34, v34
    v_exp_f32 v35, v35
    v_mfma_f32_32x32x8bf16_1k v[48:63], a[164:165], v[22:23], v[48:63]
    v_exp_f32 v36, v36
    v_exp_f32 v37, v37
    v_cvt_pk_bf16_f32 v64, v32, v33
    v_exp_f32 v38, v38
    v_exp_f32 v39, v39
    v_cvt_pk_bf16_f32 v65, v34, v35
    buffer_load_dwordx4 a[248:251], v25, s[8:11], 0 offen offset:1152 sc1
    buffer_load_dwordx4 a[252:255], v25, s[8:11], 0 offen offset:1728 sc1
    v_mfma_f32_32x32x16_bf16 a[112:127], a[168:171], v[72:75], a[112:127]
    v_exp_f32 v40, v40
    v_exp_f32 v41, v41
    v_cvt_pk_bf16_f32 v66, v36, v37
    v_exp_f32 v42, v42
    v_exp_f32 v43, v43
    v_cvt_pk_bf16_f32 v67, v38, v39
    v_mfma_f32_32x32x16_bf16 a[112:127], a[172:175], v[76:79], a[112:127]
    v_exp_f32 v44, v44
    v_exp_f32 v45, v45
    v_cvt_pk_bf16_f32 v68, v40, v41
    v_exp_f32 v46, v46
    v_exp_f32 v47, v47
    v_cvt_pk_bf16_f32 v69, v42, v43
    v_cvt_pk_bf16_f32 v70, v44, v45
    v_cvt_pk_bf16_f32 v71, v46, v47
    buffer_load_dwordx4 a[56:59], v254, s[8:11], s59 offen offset:1024 sc1
    s_waitcnt vmcnt(39)
    v_mfma_f32_32x32x16_bf16 v[32:47], a[176:179], v[0:3], 0
    v_exp_f32 v48, v48
    v_exp_f32 v49, v49
    v_exp_f32 v50, v50
    v_exp_f32 v51, v51
    v_mfma_f32_32x32x8bf16_1k v[32:47], a[180:181], v[16:17], v[32:47]
    v_exp_f32 v52, v52
    v_exp_f32 v53, v53
    v_cvt_pk_bf16_f32 v72, v48, v49
    v_exp_f32 v54, v54
    v_exp_f32 v55, v55
    v_cvt_pk_bf16_f32 v73, v50, v51
    v_mfma_f32_32x32x16_bf16 a[128:143], a[168:171], v[64:67], a[128:143]
    v_exp_f32 v56, v56
    v_exp_f32 v57, v57
    v_cvt_pk_bf16_f32 v74, v52, v53
    v_exp_f32 v58, v58
    v_exp_f32 v59, v59
    v_cvt_pk_bf16_f32 v75, v54, v55
    v_mfma_f32_32x32x16_bf16 a[128:143], a[172:175], v[68:71], a[128:143]
    v_exp_f32 v60, v60
    v_exp_f32 v61, v61
    v_cvt_pk_bf16_f32 v76, v56, v57
    v_exp_f32 v62, v62
    v_exp_f32 v63, v63
    v_cvt_pk_bf16_f32 v77, v58, v59
    v_cvt_pk_bf16_f32 v78, v60, v61
    v_cvt_pk_bf16_f32 v79, v62, v63
    buffer_load_dwordx4 a[60:63], v254, s[8:11], s59 offen offset:2048 sc1
    v_mfma_f32_32x32x16_bf16 v[48:63], a[176:179], v[4:7], 0
    v_exp_f32 v32, v32
    v_exp_f32 v33, v33
    v_exp_f32 v34, v34
    v_exp_f32 v35, v35
    v_mfma_f32_32x32x8bf16_1k v[48:63], a[180:181], v[18:19], v[48:63]
    v_exp_f32 v36, v36
    v_exp_f32 v37, v37
    v_cvt_pk_bf16_f32 v64, v32, v33
    v_exp_f32 v38, v38
    v_exp_f32 v39, v39
    v_cvt_pk_bf16_f32 v65, v34, v35
    v_mfma_f32_32x32x16_bf16 a[144:159], a[168:171], v[72:75], a[144:159]
    v_exp_f32 v40, v40
    v_exp_f32 v41, v41
    v_cvt_pk_bf16_f32 v66, v36, v37
    v_exp_f32 v42, v42
    v_exp_f32 v43, v43
    v_cvt_pk_bf16_f32 v67, v38, v39
    v_mfma_f32_32x32x16_bf16 a[144:159], a[172:175], v[76:79], a[144:159]
    v_exp_f32 v44, v44
    v_exp_f32 v45, v45
    v_cvt_pk_bf16_f32 v68, v40, v41
    v_exp_f32 v46, v46
    v_exp_f32 v47, v47
    v_cvt_pk_bf16_f32 v69, v42, v43
    v_cvt_pk_bf16_f32 v70, v44, v45
    v_cvt_pk_bf16_f32 v71, v46, v47
    buffer_load_dwordx4 a[64:67], v254, s[8:11], s59 offen offset:3072 sc1
    s_add_u32 s59, s34, 110592
    buffer_load_dwordx4 a[68:71], v254, s[8:11], s59 offen offset:0 sc1
    v_mfma_f32_32x32x16_bf16 v[32:47], a[176:179], v[8:11], 0
    v_exp_f32 v48, v48
    v_exp_f32 v49, v49
    v_exp_f32 v50, v50
    v_exp_f32 v51, v51
    buffer_load_dwordx2 a[160:161], v26, s[8:11], s62 offen offset:512 sc1
    buffer_load_dwordx2 a[162:163], v26, s[8:11], s63 offen offset:512 sc1
    v_mfma_f32_32x32x8bf16_1k v[32:47], a[180:181], v[20:21], v[32:47]
    v_exp_f32 v52, v52
    v_exp_f32 v53, v53
    v_cvt_pk_bf16_f32 v72, v48, v49
    v_exp_f32 v54, v54
    v_exp_f32 v55, v55
    v_cvt_pk_bf16_f32 v73, v50, v51
    v_mfma_f32_32x32x16_bf16 a[96:111], a[184:187], v[64:67], a[96:111]
    v_exp_f32 v56, v56
    v_exp_f32 v57, v57
    v_cvt_pk_bf16_f32 v74, v52, v53
    v_exp_f32 v58, v58
    v_exp_f32 v59, v59
    v_cvt_pk_bf16_f32 v75, v54, v55
    buffer_load_dword a164, v24, s[8:11], s64 offen offset:512 sc1
    v_mfma_f32_32x32x16_bf16 a[96:111], a[188:191], v[68:71], a[96:111]
    v_exp_f32 v60, v60
    v_exp_f32 v61, v61
    v_cvt_pk_bf16_f32 v76, v56, v57
    v_exp_f32 v62, v62
    v_exp_f32 v63, v63
    v_cvt_pk_bf16_f32 v77, v58, v59
    v_cvt_pk_bf16_f32 v78, v60, v61
    v_cvt_pk_bf16_f32 v79, v62, v63
    buffer_load_dwordx4 a[72:75], v254, s[8:11], s59 offen offset:1024 sc1
    buffer_load_dwordx4 a[76:79], v254, s[8:11], s59 offen offset:2048 sc1
    v_mfma_f32_32x32x16_bf16 v[48:63], a[176:179], v[12:15], 0
    v_exp_f32 v32, v32
    v_exp_f32 v33, v33
    v_exp_f32 v34, v34
    v_exp_f32 v35, v35
    v_mfma_f32_32x32x8bf16_1k v[48:63], a[180:181], v[22:23], v[48:63]
    v_exp_f32 v36, v36
    v_exp_f32 v37, v37
    v_cvt_pk_bf16_f32 v64, v32, v33
    v_exp_f32 v38, v38
    v_exp_f32 v39, v39
    v_cvt_pk_bf16_f32 v65, v34, v35
    buffer_load_dwordx4 a[168:171], v25, s[8:11], 0 offen offset:2304 sc1
    buffer_load_dwordx4 a[172:175], v25, s[8:11], 0 offen offset:2880 sc1
    v_mfma_f32_32x32x16_bf16 a[112:127], a[184:187], v[72:75], a[112:127]
    v_exp_f32 v40, v40
    v_exp_f32 v41, v41
    v_cvt_pk_bf16_f32 v66, v36, v37
    v_exp_f32 v42, v42
    v_exp_f32 v43, v43
    v_cvt_pk_bf16_f32 v67, v38, v39
    v_mfma_f32_32x32x16_bf16 a[112:127], a[188:191], v[76:79], a[112:127]
    v_exp_f32 v44, v44
    v_exp_f32 v45, v45
    v_cvt_pk_bf16_f32 v68, v40, v41
    v_exp_f32 v46, v46
    v_exp_f32 v47, v47
    v_cvt_pk_bf16_f32 v69, v42, v43
    v_cvt_pk_bf16_f32 v70, v44, v45
    v_cvt_pk_bf16_f32 v71, v46, v47
    s_waitcnt vmcnt(18)
    v_cmp_eq_u32 vcc, s78, v243
    s_cmp_eq_u64 vcc, -1
    s_cbranch_scc0 parallel_sum__softmax_full_mha__dense_activation_relu__prompt_kernel_spin_pf
parallel_sum__softmax_full_mha__dense_activation_relu__prompt_kernel_spin_pf_ret:
    v_mfma_f32_32x32x16_bf16 v[32:47], a[192:195], v[0:3], 0
    v_exp_f32 v48, v48
    v_exp_f32 v49, v49
    v_exp_f32 v50, v50
    v_exp_f32 v51, v51
    v_mfma_f32_32x32x8bf16_1k v[32:47], a[196:197], v[16:17], v[32:47]
    v_exp_f32 v52, v52
    v_exp_f32 v53, v53
    v_cvt_pk_bf16_f32 v72, v48, v49
    v_exp_f32 v54, v54
    v_exp_f32 v55, v55
    v_cvt_pk_bf16_f32 v73, v50, v51
    v_mfma_f32_32x32x16_bf16 a[128:143], a[184:187], v[64:67], a[128:143]
    v_exp_f32 v56, v56
    v_exp_f32 v57, v57
    v_cvt_pk_bf16_f32 v74, v52, v53
    v_exp_f32 v58, v58
    v_exp_f32 v59, v59
    v_cvt_pk_bf16_f32 v75, v54, v55
    v_mfma_f32_32x32x16_bf16 a[128:143], a[188:191], v[68:71], a[128:143]
    v_exp_f32 v60, v60
    v_exp_f32 v61, v61
    v_cvt_pk_bf16_f32 v76, v56, v57
    v_exp_f32 v62, v62
    v_exp_f32 v63, v63
    v_cvt_pk_bf16_f32 v77, v58, v59
    v_cvt_pk_bf16_f32 v78, v60, v61
    v_cvt_pk_bf16_f32 v79, v62, v63
    v_mfma_f32_32x32x16_bf16 v[48:63], a[192:195], v[4:7], 0
    v_exp_f32 v32, v32
    v_exp_f32 v33, v33
    v_exp_f32 v34, v34
    v_exp_f32 v35, v35
    v_mfma_f32_32x32x8bf16_1k v[48:63], a[196:197], v[18:19], v[48:63]
    v_exp_f32 v36, v36
    v_exp_f32 v37, v37
    v_cvt_pk_bf16_f32 v64, v32, v33
    v_exp_f32 v38, v38
    v_exp_f32 v39, v39
    v_cvt_pk_bf16_f32 v65, v34, v35
    v_mfma_f32_32x32x16_bf16 a[144:159], a[184:187], v[72:75], a[144:159]
    v_exp_f32 v40, v40
    v_exp_f32 v41, v41
    v_cvt_pk_bf16_f32 v66, v36, v37
    v_exp_f32 v42, v42
    v_exp_f32 v43, v43
    v_cvt_pk_bf16_f32 v67, v38, v39
    v_mfma_f32_32x32x16_bf16 a[144:159], a[188:191], v[76:79], a[144:159]
    v_exp_f32 v44, v44
    v_exp_f32 v45, v45
    v_cvt_pk_bf16_f32 v68, v40, v41
    v_exp_f32 v46, v46
    v_exp_f32 v47, v47
    v_cvt_pk_bf16_f32 v69, v42, v43
    v_cvt_pk_bf16_f32 v70, v44, v45
    v_cvt_pk_bf16_f32 v71, v46, v47
    buffer_load_dwordx4 a[80:83], v254, s[8:11], s59 offen offset:3072 sc1
    s_add_u32 s59, s34, 147456
    buffer_load_dwordx4 a[84:87], v254, s[8:11], s59 offen offset:0 sc1
    v_mfma_f32_32x32x16_bf16 v[32:47], a[192:195], v[8:11], 0
    v_exp_f32 v48, v48
    v_exp_f32 v49, v49
    v_exp_f32 v50, v50
    v_exp_f32 v51, v51
    buffer_load_dwordx2 a[176:177], v26, s[8:11], s62 offen offset:768 sc1
    buffer_load_dwordx2 a[178:179], v26, s[8:11], s63 offen offset:768 sc1
    v_mfma_f32_32x32x8bf16_1k v[32:47], a[196:197], v[20:21], v[32:47]
    v_exp_f32 v52, v52
    v_exp_f32 v53, v53
    v_cvt_pk_bf16_f32 v72, v48, v49
    v_exp_f32 v54, v54
    v_exp_f32 v55, v55
    v_cvt_pk_bf16_f32 v73, v50, v51
    v_mfma_f32_32x32x16_bf16 a[96:111], a[200:203], v[64:67], a[96:111]
    v_exp_f32 v56, v56
    v_exp_f32 v57, v57
    v_cvt_pk_bf16_f32 v74, v52, v53
    v_exp_f32 v58, v58
    v_exp_f32 v59, v59
    v_cvt_pk_bf16_f32 v75, v54, v55
    buffer_load_dword a180, v24, s[8:11], s64 offen offset:768 sc1
    v_mfma_f32_32x32x16_bf16 a[96:111], a[204:207], v[68:71], a[96:111]
    v_exp_f32 v60, v60
    v_exp_f32 v61, v61
    v_cvt_pk_bf16_f32 v76, v56, v57
    v_exp_f32 v62, v62
    v_exp_f32 v63, v63
    v_cvt_pk_bf16_f32 v77, v58, v59
    v_cvt_pk_bf16_f32 v78, v60, v61
    v_cvt_pk_bf16_f32 v79, v62, v63
    buffer_load_dwordx4 a[88:91], v254, s[8:11], s59 offen offset:1024 sc1
    buffer_load_dwordx4 a[92:95], v254, s[8:11], s59 offen offset:2048 sc1
    v_mfma_f32_32x32x16_bf16 v[48:63], a[192:195], v[12:15], 0
    v_exp_f32 v32, v32
    v_exp_f32 v33, v33
    v_exp_f32 v34, v34
    v_exp_f32 v35, v35
    v_mfma_f32_32x32x8bf16_1k v[48:63], a[196:197], v[22:23], v[48:63]
    v_exp_f32 v36, v36
    v_exp_f32 v37, v37
    v_cvt_pk_bf16_f32 v64, v32, v33
    v_exp_f32 v38, v38
    v_exp_f32 v39, v39
    v_cvt_pk_bf16_f32 v65, v34, v35
    buffer_load_dwordx4 a[184:187], v25, s[8:11], 0 offen offset:3456 sc1
    buffer_load_dwordx4 a[188:191], v25, s[8:11], 0 offen offset:4032 sc1
    v_mfma_f32_32x32x16_bf16 a[112:127], a[200:203], v[72:75], a[112:127]
    v_exp_f32 v40, v40
    v_exp_f32 v41, v41
    v_cvt_pk_bf16_f32 v66, v36, v37
    v_exp_f32 v42, v42
    v_exp_f32 v43, v43
    v_cvt_pk_bf16_f32 v67, v38, v39
    v_mfma_f32_32x32x16_bf16 a[112:127], a[204:207], v[76:79], a[112:127]
    v_exp_f32 v44, v44
    v_exp_f32 v45, v45
    v_cvt_pk_bf16_f32 v68, v40, v41
    v_exp_f32 v46, v46
    v_exp_f32 v47, v47
    v_cvt_pk_bf16_f32 v69, v42, v43
    v_cvt_pk_bf16_f32 v70, v44, v45
    v_cvt_pk_bf16_f32 v71, v46, v47
    s_add_u32 s37, s35, 0
    buffer_load_dwordx4 v[208:211], v254, s[8:11], s37 offen offset:0 sc1
    buffer_load_dwordx4 v[212:215], v254, s[8:11], s37 offen offset:1024 sc1
    v_mfma_f32_32x32x16_bf16 v[32:47], a[208:211], v[0:3], 0
    v_exp_f32 v48, v48
    v_exp_f32 v49, v49
    v_exp_f32 v50, v50
    v_exp_f32 v51, v51
    v_mfma_f32_32x32x8bf16_1k v[32:47], a[212:213], v[16:17], v[32:47]
    v_exp_f32 v52, v52
    v_exp_f32 v53, v53
    v_cvt_pk_bf16_f32 v72, v48, v49
    v_exp_f32 v54, v54
    v_exp_f32 v55, v55
    v_cvt_pk_bf16_f32 v73, v50, v51
    v_mfma_f32_32x32x16_bf16 a[128:143], a[200:203], v[64:67], a[128:143]
    v_exp_f32 v56, v56
    v_exp_f32 v57, v57
    v_cvt_pk_bf16_f32 v74, v52, v53
    v_exp_f32 v58, v58
    v_exp_f32 v59, v59
    v_cvt_pk_bf16_f32 v75, v54, v55
    v_mfma_f32_32x32x16_bf16 a[128:143], a[204:207], v[68:71], a[128:143]
    v_exp_f32 v60, v60
    v_exp_f32 v61, v61
    v_cvt_pk_bf16_f32 v76, v56, v57
    v_exp_f32 v62, v62
    v_exp_f32 v63, v63
    v_cvt_pk_bf16_f32 v77, v58, v59
    v_cvt_pk_bf16_f32 v78, v60, v61
    v_cvt_pk_bf16_f32 v79, v62, v63
    buffer_load_dwordx4 v[216:219], v254, s[8:11], s37 offen offset:2048 sc1
    v_mfma_f32_32x32x16_bf16 v[48:63], a[208:211], v[4:7], 0
    v_exp_f32 v32, v32
    v_exp_f32 v33, v33
    v_exp_f32 v34, v34
    v_exp_f32 v35, v35
    v_mfma_f32_32x32x8bf16_1k v[48:63], a[212:213], v[18:19], v[48:63]
    v_exp_f32 v36, v36
    v_exp_f32 v37, v37
    v_cvt_pk_bf16_f32 v64, v32, v33
    v_exp_f32 v38, v38
    v_exp_f32 v39, v39
    v_cvt_pk_bf16_f32 v65, v34, v35
    v_mfma_f32_32x32x16_bf16 a[144:159], a[200:203], v[72:75], a[144:159]
    v_exp_f32 v40, v40
    v_exp_f32 v41, v41
    v_cvt_pk_bf16_f32 v66, v36, v37
    v_exp_f32 v42, v42
    v_exp_f32 v43, v43
    v_cvt_pk_bf16_f32 v67, v38, v39
    v_mfma_f32_32x32x16_bf16 a[144:159], a[204:207], v[76:79], a[144:159]
    v_exp_f32 v44, v44
    v_exp_f32 v45, v45
    v_cvt_pk_bf16_f32 v68, v40, v41
    v_exp_f32 v46, v46
    v_exp_f32 v47, v47
    v_cvt_pk_bf16_f32 v69, v42, v43
    v_cvt_pk_bf16_f32 v70, v44, v45
    v_cvt_pk_bf16_f32 v71, v46, v47
    s_add_u32 s59, s34, 45056
    buffer_load_dwordx4 a[4:7], v254, s[8:11], s59 offen sc1
    v_mfma_f32_32x32x16_bf16 v[32:47], a[208:211], v[8:11], 0
    v_exp_f32 v48, v48
    v_exp_f32 v49, v49
    v_exp_f32 v50, v50
    v_exp_f32 v51, v51
    buffer_load_dwordx2 a[192:193], v26, s[8:11], s62 offen offset:1024 sc1
    buffer_load_dwordx2 a[194:195], v26, s[8:11], s63 offen offset:1024 sc1
    v_mfma_f32_32x32x8bf16_1k v[32:47], a[212:213], v[20:21], v[32:47]
    v_exp_f32 v52, v52
    v_exp_f32 v53, v53
    v_cvt_pk_bf16_f32 v72, v48, v49
    v_exp_f32 v54, v54
    v_exp_f32 v55, v55
    v_cvt_pk_bf16_f32 v73, v50, v51
    v_mfma_f32_32x32x16_bf16 a[96:111], a[216:219], v[64:67], a[96:111]
    v_exp_f32 v56, v56
    v_exp_f32 v57, v57
    v_cvt_pk_bf16_f32 v74, v52, v53
    v_exp_f32 v58, v58
    v_exp_f32 v59, v59
    v_cvt_pk_bf16_f32 v75, v54, v55
    buffer_load_dword a196, v24, s[8:11], s64 offen offset:1024 sc1
    v_mfma_f32_32x32x16_bf16 a[96:111], a[220:223], v[68:71], a[96:111]
    v_exp_f32 v60, v60
    v_exp_f32 v61, v61
    v_cvt_pk_bf16_f32 v76, v56, v57
    v_exp_f32 v62, v62
    v_exp_f32 v63, v63
    v_cvt_pk_bf16_f32 v77, v58, v59
    v_cvt_pk_bf16_f32 v78, v60, v61
    v_cvt_pk_bf16_f32 v79, v62, v63
    s_add_u32 s59, s34, 8192
    buffer_load_dwordx4 a[0:3], v254, s[8:11], s59 offen sc1
    v_mfma_f32_32x32x16_bf16 v[48:63], a[208:211], v[12:15], 0
    v_exp_f32 v32, v32
    v_exp_f32 v33, v33
    v_exp_f32 v34, v34
    v_exp_f32 v35, v35
    v_mfma_f32_32x32x8bf16_1k v[48:63], a[212:213], v[22:23], v[48:63]
    v_exp_f32 v36, v36
    v_exp_f32 v37, v37
    v_cvt_pk_bf16_f32 v64, v32, v33
    v_exp_f32 v38, v38
    v_exp_f32 v39, v39
    v_cvt_pk_bf16_f32 v65, v34, v35
    v_add_u32 v25, v28, v25
    buffer_load_dwordx4 a[200:203], v25, s[8:11], 0 offen offset:0 sc1
    buffer_load_dwordx4 a[204:207], v25, s[8:11], 0 offen offset:576 sc1
    v_mfma_f32_32x32x16_bf16 a[112:127], a[216:219], v[72:75], a[112:127]
    v_exp_f32 v40, v40
    v_exp_f32 v41, v41
    v_cvt_pk_bf16_f32 v66, v36, v37
    v_exp_f32 v42, v42
    v_exp_f32 v43, v43
    v_cvt_pk_bf16_f32 v67, v38, v39
    v_mfma_f32_32x32x16_bf16 a[112:127], a[220:223], v[76:79], a[112:127]
    v_exp_f32 v44, v44
    v_exp_f32 v45, v45
    v_cvt_pk_bf16_f32 v68, v40, v41
    v_exp_f32 v46, v46
    v_exp_f32 v47, v47
    v_cvt_pk_bf16_f32 v69, v42, v43
    v_cvt_pk_bf16_f32 v70, v44, v45
    v_cvt_pk_bf16_f32 v71, v46, v47
    buffer_load_dwordx4 v[220:223], v254, s[8:11], s37 offen offset:3072 sc1
    v_mfma_f32_32x32x16_bf16 v[32:47], a[224:227], v[0:3], 0
    v_exp_f32 v48, v48
    v_exp_f32 v49, v49
    v_exp_f32 v50, v50
    v_exp_f32 v51, v51
    v_mfma_f32_32x32x8bf16_1k v[32:47], a[228:229], v[16:17], v[32:47]
    v_exp_f32 v52, v52
    v_exp_f32 v53, v53
    v_cvt_pk_bf16_f32 v72, v48, v49
    v_exp_f32 v54, v54
    v_exp_f32 v55, v55
    v_cvt_pk_bf16_f32 v73, v50, v51
    v_mfma_f32_32x32x16_bf16 a[128:143], a[216:219], v[64:67], a[128:143]
    v_exp_f32 v56, v56
    v_exp_f32 v57, v57
    v_cvt_pk_bf16_f32 v74, v52, v53
    v_exp_f32 v58, v58
    v_exp_f32 v59, v59
    v_cvt_pk_bf16_f32 v75, v54, v55
    v_mfma_f32_32x32x16_bf16 a[128:143], a[220:223], v[68:71], a[128:143]
    v_exp_f32 v60, v60
    v_exp_f32 v61, v61
    v_cvt_pk_bf16_f32 v76, v56, v57
    v_exp_f32 v62, v62
    v_exp_f32 v63, v63
    v_cvt_pk_bf16_f32 v77, v58, v59
    v_cvt_pk_bf16_f32 v78, v60, v61
    v_cvt_pk_bf16_f32 v79, v62, v63
    s_add_u32 s37, s35, 1048576
    buffer_load_dwordx4 v[224:227], v254, s[8:11], s37 offen offset:0 sc1
    v_mfma_f32_32x32x16_bf16 v[48:63], a[224:227], v[4:7], 0
    v_exp_f32 v32, v32
    v_exp_f32 v33, v33
    v_exp_f32 v34, v34
    v_exp_f32 v35, v35
    v_mfma_f32_32x32x8bf16_1k v[48:63], a[228:229], v[18:19], v[48:63]
    v_exp_f32 v36, v36
    v_exp_f32 v37, v37
    v_cvt_pk_bf16_f32 v64, v32, v33
    v_exp_f32 v38, v38
    v_exp_f32 v39, v39
    v_cvt_pk_bf16_f32 v65, v34, v35
    v_mfma_f32_32x32x16_bf16 a[144:159], a[216:219], v[72:75], a[144:159]
    v_exp_f32 v40, v40
    v_exp_f32 v41, v41
    v_cvt_pk_bf16_f32 v66, v36, v37
    v_exp_f32 v42, v42
    v_exp_f32 v43, v43
    v_cvt_pk_bf16_f32 v67, v38, v39
    v_mfma_f32_32x32x16_bf16 a[144:159], a[220:223], v[76:79], a[144:159]
    v_exp_f32 v44, v44
    v_exp_f32 v45, v45
    v_cvt_pk_bf16_f32 v68, v40, v41
    v_exp_f32 v46, v46
    v_exp_f32 v47, v47
    v_cvt_pk_bf16_f32 v69, v42, v43
    v_cvt_pk_bf16_f32 v70, v44, v45
    v_cvt_pk_bf16_f32 v71, v46, v47
    s_add_u32 s59, s34, 118784
    buffer_load_dwordx4 a[12:15], v254, s[8:11], s59 offen sc1
    s_add_u32 s59, s34, 81920
    buffer_load_dwordx4 a[8:11], v254, s[8:11], s59 offen sc1
    v_mfma_f32_32x32x16_bf16 v[32:47], a[224:227], v[8:11], 0
    v_exp_f32 v48, v48
    v_exp_f32 v49, v49
    v_exp_f32 v50, v50
    v_exp_f32 v51, v51
    buffer_load_dwordx2 a[208:209], v26, s[8:11], s62 offen offset:1280 sc1
    buffer_load_dwordx2 a[210:211], v26, s[8:11], s63 offen offset:1280 sc1
    v_mfma_f32_32x32x8bf16_1k v[32:47], a[228:229], v[20:21], v[32:47]
    v_exp_f32 v52, v52
    v_exp_f32 v53, v53
    v_cvt_pk_bf16_f32 v72, v48, v49
    v_exp_f32 v54, v54
    v_exp_f32 v55, v55
    v_cvt_pk_bf16_f32 v73, v50, v51
    v_mfma_f32_32x32x16_bf16 a[96:111], a[232:235], v[64:67], a[96:111]
    v_exp_f32 v56, v56
    v_exp_f32 v57, v57
    v_cvt_pk_bf16_f32 v74, v52, v53
    v_exp_f32 v58, v58
    v_exp_f32 v59, v59
    v_cvt_pk_bf16_f32 v75, v54, v55
    buffer_load_dword a212, v24, s[8:11], s64 offen offset:1280 sc1
    v_mfma_f32_32x32x16_bf16 a[96:111], a[236:239], v[68:71], a[96:111]
    v_exp_f32 v60, v60
    v_exp_f32 v61, v61
    v_cvt_pk_bf16_f32 v76, v56, v57
    v_exp_f32 v62, v62
    v_exp_f32 v63, v63
    v_cvt_pk_bf16_f32 v77, v58, v59
    v_cvt_pk_bf16_f32 v78, v60, v61
    v_cvt_pk_bf16_f32 v79, v62, v63
    buffer_load_dwordx4 v[228:231], v254, s[8:11], s37 offen offset:1024 sc1
    buffer_load_dwordx4 v[232:235], v254, s[8:11], s37 offen offset:2048 sc1
    v_mfma_f32_32x32x16_bf16 v[48:63], a[224:227], v[12:15], 0
    v_exp_f32 v32, v32
    v_exp_f32 v33, v33
    v_exp_f32 v34, v34
    v_exp_f32 v35, v35
    v_mfma_f32_32x32x8bf16_1k v[48:63], a[228:229], v[22:23], v[48:63]
    v_exp_f32 v36, v36
    v_exp_f32 v37, v37
    v_cvt_pk_bf16_f32 v64, v32, v33
    v_exp_f32 v38, v38
    v_exp_f32 v39, v39
    v_cvt_pk_bf16_f32 v65, v34, v35
    buffer_load_dwordx4 a[216:219], v25, s[8:11], 0 offen offset:1152 sc1
    buffer_load_dwordx4 a[220:223], v25, s[8:11], 0 offen offset:1728 sc1
    v_mfma_f32_32x32x16_bf16 a[112:127], a[232:235], v[72:75], a[112:127]
    v_exp_f32 v40, v40
    v_exp_f32 v41, v41
    v_cvt_pk_bf16_f32 v66, v36, v37
    v_exp_f32 v42, v42
    v_exp_f32 v43, v43
    v_cvt_pk_bf16_f32 v67, v38, v39
    v_mfma_f32_32x32x16_bf16 a[112:127], a[236:239], v[76:79], a[112:127]
    v_exp_f32 v44, v44
    v_exp_f32 v45, v45
    v_cvt_pk_bf16_f32 v68, v40, v41
    v_exp_f32 v46, v46
    v_exp_f32 v47, v47
    v_cvt_pk_bf16_f32 v69, v42, v43
    v_cvt_pk_bf16_f32 v70, v44, v45
    v_cvt_pk_bf16_f32 v71, v46, v47
    buffer_load_dwordx4 v[236:239], v254, s[8:11], s37 offen offset:3072 sc1
    s_waitcnt vmcnt(42)
    v_mfma_f32_32x32x16_bf16 v[32:47], a[240:243], v[0:3], 0
    v_exp_f32 v48, v48
    v_exp_f32 v49, v49
    v_exp_f32 v50, v50
    v_exp_f32 v51, v51
    v_mfma_f32_32x32x8bf16_1k v[32:47], a[244:245], v[16:17], v[32:47]
    v_exp_f32 v52, v52
    v_exp_f32 v53, v53
    v_cvt_pk_bf16_f32 v72, v48, v49
    v_exp_f32 v54, v54
    v_exp_f32 v55, v55
    v_cvt_pk_bf16_f32 v73, v50, v51
    v_mfma_f32_32x32x16_bf16 a[128:143], a[232:235], v[64:67], a[128:143]
    v_exp_f32 v56, v56
    v_exp_f32 v57, v57
    v_cvt_pk_bf16_f32 v74, v52, v53
    v_exp_f32 v58, v58
    v_exp_f32 v59, v59
    v_cvt_pk_bf16_f32 v75, v54, v55
    v_mfma_f32_32x32x16_bf16 a[128:143], a[236:239], v[68:71], a[128:143]
    v_exp_f32 v60, v60
    v_exp_f32 v61, v61
    v_cvt_pk_bf16_f32 v76, v56, v57
    v_exp_f32 v62, v62
    v_exp_f32 v63, v63
    v_cvt_pk_bf16_f32 v77, v58, v59
    v_cvt_pk_bf16_f32 v78, v60, v61
    v_cvt_pk_bf16_f32 v79, v62, v63
    v_mfma_f32_32x32x16_bf16 v[48:63], a[240:243], v[4:7], 0
    v_exp_f32 v32, v32
    v_exp_f32 v33, v33
    v_exp_f32 v34, v34
    v_exp_f32 v35, v35
    v_mfma_f32_32x32x8bf16_1k v[48:63], a[244:245], v[18:19], v[48:63]
    v_exp_f32 v36, v36
    v_exp_f32 v37, v37
    v_cvt_pk_bf16_f32 v64, v32, v33
    v_exp_f32 v38, v38
    v_cvt_pk_bf16_f32 v65, v34, v35
    s_waitcnt vmcnt(21)
    v_mfma_f32_32x32x16_bf16 v[128:143], v[244:247], v[208:211], 0
    v_exp_f32 v39, v39
    v_exp_f32 v40, v40
    v_cvt_pk_bf16_f32 v66, v36, v37
    v_exp_f32 v41, v41
    v_cvt_pk_bf16_f32 v67, v38, v39
    v_mfma_f32_32x32x16_bf16 a[144:159], a[232:235], v[72:75], a[144:159]
    v_exp_f32 v42, v42
    v_exp_f32 v43, v43
    v_cvt_pk_bf16_f32 v68, v40, v41
    v_exp_f32 v44, v44
    v_mfma_f32_32x32x16_bf16 a[144:159], a[236:239], v[76:79], a[144:159]
    v_exp_f32 v45, v45
    v_exp_f32 v46, v46
    v_cvt_pk_bf16_f32 v69, v42, v43
    v_exp_f32 v47, v47
    v_cvt_pk_bf16_f32 v70, v44, v45
    v_cvt_pk_bf16_f32 v71, v46, v47
    v_mfma_f32_32x32x16_bf16 v[32:47], a[240:243], v[8:11], 0
    v_exp_f32 v48, v48
    v_exp_f32 v49, v49
    v_exp_f32 v50, v50
    v_exp_f32 v51, v51
    buffer_load_dwordx2 a[224:225], v26, s[8:11], s62 offen offset:1536 sc1
    buffer_load_dwordx2 a[226:227], v26, s[8:11], s63 offen offset:1536 sc1
    v_mfma_f32_32x32x8bf16_1k v[32:47], a[244:245], v[20:21], v[32:47]
    v_exp_f32 v52, v52
    v_exp_f32 v53, v53
    v_cvt_pk_bf16_f32 v72, v48, v49
    v_exp_f32 v54, v54
    v_cvt_pk_bf16_f32 v73, v50, v51
    s_waitcnt vmcnt(22)
    v_mfma_f32_32x32x16_bf16 v[128:143], v[244:247], v[212:215], v[128:143]
    v_exp_f32 v55, v55
    v_exp_f32 v56, v56
    v_cvt_pk_bf16_f32 v74, v52, v53
    v_exp_f32 v57, v57
    v_cvt_pk_bf16_f32 v75, v54, v55
    v_mfma_f32_32x32x16_bf16 a[96:111], a[248:251], v[64:67], a[96:111]
    v_exp_f32 v58, v58
    v_exp_f32 v59, v59
    v_cvt_pk_bf16_f32 v76, v56, v57
    v_exp_f32 v60, v60
    buffer_load_dword a228, v24, s[8:11], s64 offen offset:1536 sc1
    v_mfma_f32_32x32x16_bf16 a[96:111], a[252:255], v[68:71], a[96:111]
    v_exp_f32 v61, v61
    v_exp_f32 v62, v62
    v_cvt_pk_bf16_f32 v77, v58, v59
    v_exp_f32 v63, v63
    v_cvt_pk_bf16_f32 v78, v60, v61
    v_cvt_pk_bf16_f32 v79, v62, v63
    v_mfma_f32_32x32x16_bf16 v[48:63], a[240:243], v[12:15], 0
    v_exp_f32 v32, v32
    v_exp_f32 v33, v33
    v_exp_f32 v34, v34
    v_exp_f32 v35, v35
    v_mfma_f32_32x32x8bf16_1k v[48:63], a[244:245], v[22:23], v[48:63]
    v_exp_f32 v36, v36
    v_exp_f32 v37, v37
    v_cvt_pk_bf16_f32 v64, v32, v33
    v_exp_f32 v38, v38
    v_cvt_pk_bf16_f32 v65, v34, v35
    buffer_load_dwordx4 a[232:235], v25, s[8:11], 0 offen offset:2304 sc1
    buffer_load_dwordx4 a[236:239], v25, s[8:11], 0 offen offset:2880 sc1
    s_waitcnt vmcnt(24)
    v_mfma_f32_32x32x16_bf16 v[128:143], v[244:247], v[216:219], v[128:143]
    v_exp_f32 v39, v39
    v_exp_f32 v40, v40
    v_cvt_pk_bf16_f32 v66, v36, v37
    v_exp_f32 v41, v41
    v_cvt_pk_bf16_f32 v67, v38, v39
    v_mfma_f32_32x32x16_bf16 a[112:127], a[248:251], v[72:75], a[112:127]
    v_exp_f32 v42, v42
    v_exp_f32 v43, v43
    v_cvt_pk_bf16_f32 v68, v40, v41
    v_exp_f32 v44, v44
    v_mfma_f32_32x32x16_bf16 a[112:127], a[252:255], v[76:79], a[112:127]
    v_exp_f32 v45, v45
    v_exp_f32 v46, v46
    v_cvt_pk_bf16_f32 v69, v42, v43
    v_exp_f32 v47, v47
    v_cvt_pk_bf16_f32 v70, v44, v45
    v_cvt_pk_bf16_f32 v71, v46, v47
    v_mfma_f32_32x32x16_bf16 v[32:47], a[160:163], v[0:3], 0
    v_exp_f32 v48, v48
    v_exp_f32 v49, v49
    v_exp_f32 v50, v50
    v_exp_f32 v51, v51
    v_mfma_f32_32x32x8bf16_1k v[32:47], a[164:165], v[16:17], v[32:47]
    v_exp_f32 v52, v52
    v_exp_f32 v53, v53
    v_cvt_pk_bf16_f32 v72, v48, v49
    v_exp_f32 v54, v54
    v_exp_f32 v55, v55
    v_cvt_pk_bf16_f32 v73, v50, v51
    v_mfma_f32_32x32x16_bf16 a[128:143], a[248:251], v[64:67], a[128:143]
    v_exp_f32 v56, v56
    v_exp_f32 v57, v57
    v_cvt_pk_bf16_f32 v74, v52, v53
    v_exp_f32 v58, v58
    v_exp_f32 v59, v59
    v_cvt_pk_bf16_f32 v75, v54, v55
    v_mfma_f32_32x32x16_bf16 a[128:143], a[252:255], v[68:71], a[128:143]
    v_exp_f32 v60, v60
    v_exp_f32 v61, v61
    v_cvt_pk_bf16_f32 v76, v56, v57
    v_exp_f32 v62, v62
    v_exp_f32 v63, v63
    v_cvt_pk_bf16_f32 v77, v58, v59
    v_cvt_pk_bf16_f32 v78, v60, v61
    v_cvt_pk_bf16_f32 v79, v62, v63
    s_add_u32 s59, s34, 155648
    buffer_load_dwordx4 a[16:19], v254, s[8:11], s59 offen sc1
    s_add_u32 s37, s35, 2097152
    buffer_load_dwordx4 v[240:243], v254, s[8:11], s37 offen offset:0 sc1
    buffer_load_dwordx4 v[208:211], v254, s[8:11], s37 offen offset:1024 sc1
    v_mfma_f32_32x32x16_bf16 v[48:63], a[160:163], v[4:7], 0
    v_exp_f32 v32, v32
    v_exp_f32 v33, v33
    v_exp_f32 v34, v34
    v_exp_f32 v35, v35
    v_mfma_f32_32x32x8bf16_1k v[48:63], a[164:165], v[18:19], v[48:63]
    v_exp_f32 v36, v36
    v_exp_f32 v37, v37
    v_cvt_pk_bf16_f32 v64, v32, v33
    v_exp_f32 v38, v38
    v_cvt_pk_bf16_f32 v65, v34, v35
    s_waitcnt vmcnt(19)
    v_mfma_f32_32x32x16_bf16 v[128:143], v[244:247], v[220:223], v[128:143]
    v_exp_f32 v39, v39
    v_exp_f32 v40, v40
    v_cvt_pk_bf16_f32 v66, v36, v37
    v_exp_f32 v41, v41
    v_cvt_pk_bf16_f32 v67, v38, v39
    v_mfma_f32_32x32x16_bf16 a[144:159], a[248:251], v[72:75], a[144:159]
    v_exp_f32 v42, v42
    v_exp_f32 v43, v43
    v_cvt_pk_bf16_f32 v68, v40, v41
    v_exp_f32 v44, v44
    v_mfma_f32_32x32x16_bf16 a[144:159], a[252:255], v[76:79], a[144:159]
    v_exp_f32 v45, v45
    v_exp_f32 v46, v46
    v_cvt_pk_bf16_f32 v69, v42, v43
    v_exp_f32 v47, v47
    v_cvt_pk_bf16_f32 v70, v44, v45
    v_cvt_pk_bf16_f32 v71, v46, v47
    v_mfma_f32_32x32x16_bf16 v[32:47], a[160:163], v[8:11], 0
    v_exp_f32 v48, v48
    v_exp_f32 v49, v49
    v_exp_f32 v50, v50
    v_exp_f32 v51, v51
    buffer_load_dwordx2 a[240:241], v26, s[8:11], s62 offen offset:1792 sc1
    buffer_load_dwordx2 a[242:243], v26, s[8:11], s63 offen offset:1792 sc1
    v_mfma_f32_32x32x8bf16_1k v[32:47], a[164:165], v[20:21], v[32:47]
    v_exp_f32 v52, v52
    v_exp_f32 v53, v53
    v_cvt_pk_bf16_f32 v72, v48, v49
    v_exp_f32 v54, v54
    v_cvt_pk_bf16_f32 v73, v50, v51
    s_waitcnt vmcnt(20)
    v_mfma_f32_32x32x16_bf16 v[128:143], v[248:251], v[224:227], v[128:143]
    v_exp_f32 v55, v55
    v_exp_f32 v56, v56
    v_cvt_pk_bf16_f32 v74, v52, v53
    v_exp_f32 v57, v57
    v_cvt_pk_bf16_f32 v75, v54, v55
    v_mfma_f32_32x32x16_bf16 a[96:111], a[168:171], v[64:67], a[96:111]
    v_exp_f32 v58, v58
    v_exp_f32 v59, v59
    v_cvt_pk_bf16_f32 v76, v56, v57
    v_exp_f32 v60, v60
    buffer_load_dword a244, v24, s[8:11], s64 offen offset:1792 sc1
    v_mfma_f32_32x32x16_bf16 a[96:111], a[172:175], v[68:71], a[96:111]
    v_exp_f32 v61, v61
    v_exp_f32 v62, v62
    v_cvt_pk_bf16_f32 v77, v58, v59
    v_exp_f32 v63, v63
    v_cvt_pk_bf16_f32 v78, v60, v61
    v_cvt_pk_bf16_f32 v79, v62, v63
    v_mfma_f32_32x32x16_bf16 v[48:63], a[160:163], v[12:15], 0
    v_exp_f32 v32, v32
    v_exp_f32 v33, v33
    v_exp_f32 v34, v34
    v_exp_f32 v35, v35
    v_mfma_f32_32x32x8bf16_1k v[48:63], a[164:165], v[22:23], v[48:63]
    v_exp_f32 v36, v36
    v_exp_f32 v37, v37
    v_cvt_pk_bf16_f32 v64, v32, v33
    v_exp_f32 v38, v38
    v_exp_f32 v39, v39
    v_cvt_pk_bf16_f32 v65, v34, v35
    buffer_load_dwordx4 a[248:251], v25, s[8:11], 0 offen offset:3456 sc1
    buffer_load_dwordx4 a[252:255], v25, s[8:11], 0 offen offset:4032 sc1
    v_mfma_f32_32x32x16_bf16 a[112:127], a[168:171], v[72:75], a[112:127]
    v_exp_f32 v40, v40
    v_exp_f32 v41, v41
    v_cvt_pk_bf16_f32 v66, v36, v37
    v_exp_f32 v42, v42
    v_exp_f32 v43, v43
    v_cvt_pk_bf16_f32 v67, v38, v39
    v_mfma_f32_32x32x16_bf16 a[112:127], a[172:175], v[76:79], a[112:127]
    v_exp_f32 v44, v44
    v_exp_f32 v45, v45
    v_cvt_pk_bf16_f32 v68, v40, v41
    v_exp_f32 v46, v46
    v_exp_f32 v47, v47
    v_cvt_pk_bf16_f32 v69, v42, v43
    v_cvt_pk_bf16_f32 v70, v44, v45
    v_cvt_pk_bf16_f32 v71, v46, v47
    v_mfma_f32_32x32x16_bf16 v[32:47], a[176:179], v[0:3], 0
    v_exp_f32 v48, v48
    v_exp_f32 v49, v49
    v_exp_f32 v50, v50
    v_exp_f32 v51, v51
    v_mfma_f32_32x32x8bf16_1k v[32:47], a[180:181], v[16:17], v[32:47]
    v_exp_f32 v52, v52
    v_exp_f32 v53, v53
    v_cvt_pk_bf16_f32 v72, v48, v49
    v_exp_f32 v54, v54
    v_exp_f32 v55, v55
    v_cvt_pk_bf16_f32 v73, v50, v51
    v_mfma_f32_32x32x16_bf16 a[128:143], a[168:171], v[64:67], a[128:143]
    v_exp_f32 v56, v56
    v_exp_f32 v57, v57
    v_cvt_pk_bf16_f32 v74, v52, v53
    v_exp_f32 v58, v58
    v_exp_f32 v59, v59
    v_cvt_pk_bf16_f32 v75, v54, v55
    v_mfma_f32_32x32x16_bf16 a[128:143], a[172:175], v[68:71], a[128:143]
    v_exp_f32 v60, v60
    v_exp_f32 v61, v61
    v_cvt_pk_bf16_f32 v76, v56, v57
    v_exp_f32 v62, v62
    v_exp_f32 v63, v63
    v_cvt_pk_bf16_f32 v77, v58, v59
    v_cvt_pk_bf16_f32 v78, v60, v61
    v_cvt_pk_bf16_f32 v79, v62, v63
    buffer_load_dwordx4 v[212:215], v254, s[8:11], s37 offen offset:2048 sc1
    buffer_load_dwordx4 v[216:219], v254, s[8:11], s37 offen offset:3072 sc1
    v_mfma_f32_32x32x16_bf16 v[48:63], a[176:179], v[4:7], 0
    v_exp_f32 v32, v32
    v_exp_f32 v33, v33
    v_exp_f32 v34, v34
    v_exp_f32 v35, v35
    v_mfma_f32_32x32x8bf16_1k v[48:63], a[180:181], v[18:19], v[48:63]
    v_exp_f32 v36, v36
    v_exp_f32 v37, v37
    v_cvt_pk_bf16_f32 v64, v32, v33
    v_exp_f32 v38, v38
    v_cvt_pk_bf16_f32 v65, v34, v35
    s_waitcnt vmcnt(19)
    v_mfma_f32_32x32x16_bf16 v[128:143], v[248:251], v[228:231], v[128:143]
    v_exp_f32 v39, v39
    v_exp_f32 v40, v40
    v_cvt_pk_bf16_f32 v66, v36, v37
    v_exp_f32 v41, v41
    v_cvt_pk_bf16_f32 v67, v38, v39
    v_mfma_f32_32x32x16_bf16 a[144:159], a[168:171], v[72:75], a[144:159]
    v_exp_f32 v42, v42
    v_exp_f32 v43, v43
    v_cvt_pk_bf16_f32 v68, v40, v41
    v_exp_f32 v44, v44
    v_mfma_f32_32x32x16_bf16 a[144:159], a[172:175], v[76:79], a[144:159]
    v_exp_f32 v45, v45
    v_exp_f32 v46, v46
    v_cvt_pk_bf16_f32 v69, v42, v43
    v_exp_f32 v47, v47
    v_cvt_pk_bf16_f32 v70, v44, v45
    v_cvt_pk_bf16_f32 v71, v46, v47
    v_mfma_f32_32x32x16_bf16 v[32:47], a[176:179], v[8:11], 0
    v_exp_f32 v48, v48
    v_exp_f32 v49, v49
    v_exp_f32 v50, v50
    v_exp_f32 v51, v51
    buffer_load_dwordx2 a[160:161], v26, s[8:11], s62 offen offset:2048 sc1
    buffer_load_dwordx2 a[162:163], v26, s[8:11], s63 offen offset:2048 sc1
    v_mfma_f32_32x32x8bf16_1k v[32:47], a[180:181], v[20:21], v[32:47]
    v_exp_f32 v52, v52
    v_exp_f32 v53, v53
    v_cvt_pk_bf16_f32 v72, v48, v49
    v_exp_f32 v54, v54
    v_cvt_pk_bf16_f32 v73, v50, v51
    s_waitcnt vmcnt(20)
    v_mfma_f32_32x32x16_bf16 v[128:143], v[248:251], v[232:235], v[128:143]
    v_exp_f32 v55, v55
    v_exp_f32 v56, v56
    v_cvt_pk_bf16_f32 v74, v52, v53
    v_exp_f32 v57, v57
    v_cvt_pk_bf16_f32 v75, v54, v55
    v_mfma_f32_32x32x16_bf16 a[96:111], a[184:187], v[64:67], a[96:111]
    v_exp_f32 v58, v58
    v_exp_f32 v59, v59
    v_cvt_pk_bf16_f32 v76, v56, v57
    v_exp_f32 v60, v60
    buffer_load_dword a164, v24, s[8:11], s64 offen offset:2048 sc1
    v_mfma_f32_32x32x16_bf16 a[96:111], a[188:191], v[68:71], a[96:111]
    v_exp_f32 v61, v61
    v_exp_f32 v62, v62
    v_cvt_pk_bf16_f32 v77, v58, v59
    v_exp_f32 v63, v63
    v_cvt_pk_bf16_f32 v78, v60, v61
    v_cvt_pk_bf16_f32 v79, v62, v63
    v_mfma_f32_32x32x16_bf16 v[48:63], a[176:179], v[12:15], 0
    v_exp_f32 v32, v32
    v_exp_f32 v33, v33
    v_exp_f32 v34, v34
    v_exp_f32 v35, v35
    v_mfma_f32_32x32x8bf16_1k v[48:63], a[180:181], v[22:23], v[48:63]
    v_exp_f32 v36, v36
    v_exp_f32 v37, v37
    v_cvt_pk_bf16_f32 v64, v32, v33
    v_exp_f32 v38, v38
    v_cvt_pk_bf16_f32 v65, v34, v35
    v_add_u32 v25, v28, v25
    buffer_load_dwordx4 a[168:171], v25, s[8:11], 0 offen offset:0 sc1
    buffer_load_dwordx4 a[172:175], v25, s[8:11], 0 offen offset:576 sc1
    s_waitcnt vmcnt(20)
    v_mfma_f32_32x32x16_bf16 v[128:143], v[248:251], v[236:239], v[128:143]
    v_exp_f32 v39, v39
    v_exp_f32 v40, v40
    v_cvt_pk_bf16_f32 v66, v36, v37
    v_exp_f32 v41, v41
    v_cvt_pk_bf16_f32 v67, v38, v39
    v_mfma_f32_32x32x16_bf16 a[112:127], a[184:187], v[72:75], a[112:127]
    v_exp_f32 v42, v42
    v_exp_f32 v43, v43
    v_cvt_pk_bf16_f32 v68, v40, v41
    v_exp_f32 v44, v44
    v_mfma_f32_32x32x16_bf16 a[112:127], a[188:191], v[76:79], a[112:127]
    v_exp_f32 v45, v45
    v_exp_f32 v46, v46
    v_cvt_pk_bf16_f32 v69, v42, v43
    v_exp_f32 v47, v47
    v_cvt_pk_bf16_f32 v70, v44, v45
    v_cvt_pk_bf16_f32 v71, v46, v47
    v_mfma_f32_32x32x16_bf16 v[32:47], a[192:195], v[0:3], 0
    v_exp_f32 v48, v48
    v_exp_f32 v49, v49
    v_exp_f32 v50, v50
    v_exp_f32 v51, v51
    v_mfma_f32_32x32x8bf16_1k v[32:47], a[196:197], v[16:17], v[32:47]
    v_exp_f32 v52, v52
    v_exp_f32 v53, v53
    v_cvt_pk_bf16_f32 v72, v48, v49
    v_exp_f32 v54, v54
    v_exp_f32 v55, v55
    v_cvt_pk_bf16_f32 v73, v50, v51
    v_mfma_f32_32x32x16_bf16 a[128:143], a[184:187], v[64:67], a[128:143]
    v_exp_f32 v56, v56
    v_exp_f32 v57, v57
    v_cvt_pk_bf16_f32 v74, v52, v53
    v_exp_f32 v58, v58
    v_exp_f32 v59, v59
    v_cvt_pk_bf16_f32 v75, v54, v55
    v_mfma_f32_32x32x16_bf16 a[128:143], a[188:191], v[68:71], a[128:143]
    v_exp_f32 v60, v60
    v_exp_f32 v61, v61
    v_cvt_pk_bf16_f32 v76, v56, v57
    v_exp_f32 v62, v62
    v_exp_f32 v63, v63
    v_cvt_pk_bf16_f32 v77, v58, v59
    v_cvt_pk_bf16_f32 v78, v60, v61
    v_cvt_pk_bf16_f32 v79, v62, v63
    s_add_u32 s37, s35, 3145728
    buffer_load_dwordx4 v[220:223], v254, s[8:11], s37 offen offset:0 sc1
    buffer_load_dwordx4 v[224:227], v254, s[8:11], s37 offen offset:1024 sc1
    buffer_load_dwordx4 v[228:231], v254, s[8:11], s37 offen offset:2048 sc1
    v_mfma_f32_32x32x16_bf16 v[48:63], a[192:195], v[4:7], 0
    v_exp_f32 v32, v32
    v_exp_f32 v33, v33
    v_exp_f32 v34, v34
    v_exp_f32 v35, v35
    v_mfma_f32_32x32x8bf16_1k v[48:63], a[196:197], v[18:19], v[48:63]
    v_exp_f32 v36, v36
    v_exp_f32 v37, v37
    v_cvt_pk_bf16_f32 v64, v32, v33
    v_exp_f32 v38, v38
    v_cvt_pk_bf16_f32 v65, v34, v35
    s_waitcnt vmcnt(16)
    v_mfma_f32_32x32x16_bf16 v[144:159], v[244:247], v[240:243], 0
    v_exp_f32 v39, v39
    v_exp_f32 v40, v40
    v_cvt_pk_bf16_f32 v66, v36, v37
    v_exp_f32 v41, v41
    v_cvt_pk_bf16_f32 v67, v38, v39
    v_mfma_f32_32x32x16_bf16 a[144:159], a[184:187], v[72:75], a[144:159]
    v_exp_f32 v42, v42
    v_exp_f32 v43, v43
    v_cvt_pk_bf16_f32 v68, v40, v41
    v_exp_f32 v44, v44
    v_mfma_f32_32x32x16_bf16 a[144:159], a[188:191], v[76:79], a[144:159]
    v_exp_f32 v45, v45
    v_exp_f32 v46, v46
    v_cvt_pk_bf16_f32 v69, v42, v43
    v_exp_f32 v47, v47
    v_cvt_pk_bf16_f32 v70, v44, v45
    v_cvt_pk_bf16_f32 v71, v46, v47
    v_mfma_f32_32x32x16_bf16 v[32:47], a[192:195], v[8:11], 0
    v_exp_f32 v48, v48
    v_exp_f32 v49, v49
    v_exp_f32 v50, v50
    v_exp_f32 v51, v51
    buffer_load_dwordx2 a[176:177], v26, s[8:11], s62 offen offset:2304 sc1
    buffer_load_dwordx2 a[178:179], v26, s[8:11], s63 offen offset:2304 sc1
    v_mfma_f32_32x32x8bf16_1k v[32:47], a[196:197], v[20:21], v[32:47]
    v_exp_f32 v52, v52
    v_exp_f32 v53, v53
    v_cvt_pk_bf16_f32 v72, v48, v49
    v_exp_f32 v54, v54
    v_cvt_pk_bf16_f32 v73, v50, v51
    s_waitcnt vmcnt(17)
    v_mfma_f32_32x32x16_bf16 v[144:159], v[244:247], v[208:211], v[144:159]
    v_exp_f32 v55, v55
    v_exp_f32 v56, v56
    v_cvt_pk_bf16_f32 v74, v52, v53
    v_exp_f32 v57, v57
    v_cvt_pk_bf16_f32 v75, v54, v55
    v_mfma_f32_32x32x16_bf16 a[96:111], a[200:203], v[64:67], a[96:111]
    v_exp_f32 v58, v58
    v_exp_f32 v59, v59
    v_cvt_pk_bf16_f32 v76, v56, v57
    v_exp_f32 v60, v60
    buffer_load_dword a180, v24, s[8:11], s64 offen offset:2304 sc1
    v_mfma_f32_32x32x16_bf16 a[96:111], a[204:207], v[68:71], a[96:111]
    v_exp_f32 v61, v61
    v_exp_f32 v62, v62
    v_cvt_pk_bf16_f32 v77, v58, v59
    v_exp_f32 v63, v63
    v_cvt_pk_bf16_f32 v78, v60, v61
    v_cvt_pk_bf16_f32 v79, v62, v63
    v_mfma_f32_32x32x16_bf16 v[48:63], a[192:195], v[12:15], 0
    v_exp_f32 v32, v32
    v_exp_f32 v33, v33
    v_exp_f32 v34, v34
    v_exp_f32 v35, v35
    v_mfma_f32_32x32x8bf16_1k v[48:63], a[196:197], v[22:23], v[48:63]
    v_exp_f32 v36, v36
    v_exp_f32 v37, v37
    v_cvt_pk_bf16_f32 v64, v32, v33
    v_exp_f32 v38, v38
    v_exp_f32 v39, v39
    v_cvt_pk_bf16_f32 v65, v34, v35
    buffer_load_dwordx4 a[184:187], v25, s[8:11], 0 offen offset:1152 sc1
    buffer_load_dwordx4 a[188:191], v25, s[8:11], 0 offen offset:1728 sc1
    v_mfma_f32_32x32x16_bf16 a[112:127], a[200:203], v[72:75], a[112:127]
    v_exp_f32 v40, v40
    v_exp_f32 v41, v41
    v_cvt_pk_bf16_f32 v66, v36, v37
    v_exp_f32 v42, v42
    v_exp_f32 v43, v43
    v_cvt_pk_bf16_f32 v67, v38, v39
    v_mfma_f32_32x32x16_bf16 a[112:127], a[204:207], v[76:79], a[112:127]
    v_exp_f32 v44, v44
    v_exp_f32 v45, v45
    v_cvt_pk_bf16_f32 v68, v40, v41
    v_exp_f32 v46, v46
    v_exp_f32 v47, v47
    v_cvt_pk_bf16_f32 v69, v42, v43
    v_cvt_pk_bf16_f32 v70, v44, v45
    v_cvt_pk_bf16_f32 v71, v46, v47
    v_mfma_f32_32x32x16_bf16 v[32:47], a[208:211], v[0:3], 0
    v_exp_f32 v48, v48
    v_exp_f32 v49, v49
    v_exp_f32 v50, v50
    v_exp_f32 v51, v51
    v_mfma_f32_32x32x8bf16_1k v[32:47], a[212:213], v[16:17], v[32:47]
    v_exp_f32 v52, v52
    v_exp_f32 v53, v53
    v_cvt_pk_bf16_f32 v72, v48, v49
    v_exp_f32 v54, v54
    v_exp_f32 v55, v55
    v_cvt_pk_bf16_f32 v73, v50, v51
    v_mfma_f32_32x32x16_bf16 a[128:143], a[200:203], v[64:67], a[128:143]
    v_exp_f32 v56, v56
    v_exp_f32 v57, v57
    v_cvt_pk_bf16_f32 v74, v52, v53
    v_exp_f32 v58, v58
    v_exp_f32 v59, v59
    v_cvt_pk_bf16_f32 v75, v54, v55
    v_mfma_f32_32x32x16_bf16 a[128:143], a[204:207], v[68:71], a[128:143]
    v_exp_f32 v60, v60
    v_exp_f32 v61, v61
    v_cvt_pk_bf16_f32 v76, v56, v57
    v_exp_f32 v62, v62
    v_exp_f32 v63, v63
    v_cvt_pk_bf16_f32 v77, v58, v59
    v_cvt_pk_bf16_f32 v78, v60, v61
    v_cvt_pk_bf16_f32 v79, v62, v63
    buffer_load_dwordx4 v[232:235], v254, s[8:11], s37 offen offset:3072 sc1
    s_add_u32 s37, s35, 4194304
    buffer_load_dwordx4 v[236:239], v254, s[8:11], s37 offen offset:0 sc1
    v_mfma_f32_32x32x16_bf16 v[48:63], a[208:211], v[4:7], 0
    v_exp_f32 v32, v32
    v_exp_f32 v33, v33
    v_exp_f32 v34, v34
    v_exp_f32 v35, v35
    v_mfma_f32_32x32x8bf16_1k v[48:63], a[212:213], v[18:19], v[48:63]
    v_exp_f32 v36, v36
    v_exp_f32 v37, v37
    v_cvt_pk_bf16_f32 v64, v32, v33
    v_exp_f32 v38, v38
    v_cvt_pk_bf16_f32 v65, v34, v35
    s_waitcnt vmcnt(16)
    v_mfma_f32_32x32x16_bf16 v[144:159], v[244:247], v[212:215], v[144:159]
    v_exp_f32 v39, v39
    v_exp_f32 v40, v40
    v_cvt_pk_bf16_f32 v66, v36, v37
    v_exp_f32 v41, v41
    v_cvt_pk_bf16_f32 v67, v38, v39
    v_mfma_f32_32x32x16_bf16 a[144:159], a[200:203], v[72:75], a[144:159]
    v_exp_f32 v42, v42
    v_exp_f32 v43, v43
    v_cvt_pk_bf16_f32 v68, v40, v41
    v_exp_f32 v44, v44
    v_mfma_f32_32x32x16_bf16 a[144:159], a[204:207], v[76:79], a[144:159]
    v_exp_f32 v45, v45
    v_exp_f32 v46, v46
    v_cvt_pk_bf16_f32 v69, v42, v43
    v_exp_f32 v47, v47
    v_cvt_pk_bf16_f32 v70, v44, v45
    v_cvt_pk_bf16_f32 v71, v46, v47
    v_mfma_f32_32x32x16_bf16 v[32:47], a[208:211], v[8:11], 0
    v_exp_f32 v48, v48
    v_exp_f32 v49, v49
    v_exp_f32 v50, v50
    v_exp_f32 v51, v51
    buffer_load_dwordx2 a[192:193], v26, s[8:11], s62 offen offset:2560 sc1
    buffer_load_dwordx2 a[194:195], v26, s[8:11], s63 offen offset:2560 sc1
    v_mfma_f32_32x32x8bf16_1k v[32:47], a[212:213], v[20:21], v[32:47]
    v_exp_f32 v52, v52
    v_exp_f32 v53, v53
    v_cvt_pk_bf16_f32 v72, v48, v49
    v_exp_f32 v54, v54
    v_cvt_pk_bf16_f32 v73, v50, v51
    s_waitcnt vmcnt(17)
    v_mfma_f32_32x32x16_bf16 v[144:159], v[244:247], v[216:219], v[144:159]
    v_exp_f32 v55, v55
    v_exp_f32 v56, v56
    v_cvt_pk_bf16_f32 v74, v52, v53
    v_exp_f32 v57, v57
    v_cvt_pk_bf16_f32 v75, v54, v55
    v_mfma_f32_32x32x16_bf16 a[96:111], a[216:219], v[64:67], a[96:111]
    v_exp_f32 v58, v58
    v_exp_f32 v59, v59
    v_cvt_pk_bf16_f32 v76, v56, v57
    v_exp_f32 v60, v60
    buffer_load_dword a196, v24, s[8:11], s64 offen offset:2560 sc1
    v_mfma_f32_32x32x16_bf16 a[96:111], a[220:223], v[68:71], a[96:111]
    v_exp_f32 v61, v61
    v_exp_f32 v62, v62
    v_cvt_pk_bf16_f32 v77, v58, v59
    v_exp_f32 v63, v63
    v_cvt_pk_bf16_f32 v78, v60, v61
    v_cvt_pk_bf16_f32 v79, v62, v63
    v_mfma_f32_32x32x16_bf16 v[48:63], a[208:211], v[12:15], 0
    v_exp_f32 v32, v32
    v_exp_f32 v33, v33
    v_exp_f32 v34, v34
    v_exp_f32 v35, v35
    v_mfma_f32_32x32x8bf16_1k v[48:63], a[212:213], v[22:23], v[48:63]
    v_exp_f32 v36, v36
    v_exp_f32 v37, v37
    v_cvt_pk_bf16_f32 v64, v32, v33
    v_exp_f32 v38, v38
    v_exp_f32 v39, v39
    v_cvt_pk_bf16_f32 v65, v34, v35
    buffer_load_dwordx4 a[200:203], v25, s[8:11], 0 offen offset:2304 sc1
    buffer_load_dwordx4 a[204:207], v25, s[8:11], 0 offen offset:2880 sc1
    v_mfma_f32_32x32x16_bf16 a[112:127], a[216:219], v[72:75], a[112:127]
    v_exp_f32 v40, v40
    v_exp_f32 v41, v41
    v_cvt_pk_bf16_f32 v66, v36, v37
    v_exp_f32 v42, v42
    v_exp_f32 v43, v43
    v_cvt_pk_bf16_f32 v67, v38, v39
    v_mfma_f32_32x32x16_bf16 a[112:127], a[220:223], v[76:79], a[112:127]
    v_exp_f32 v44, v44
    v_exp_f32 v45, v45
    v_cvt_pk_bf16_f32 v68, v40, v41
    v_exp_f32 v46, v46
    v_exp_f32 v47, v47
    v_cvt_pk_bf16_f32 v69, v42, v43
    v_cvt_pk_bf16_f32 v70, v44, v45
    v_cvt_pk_bf16_f32 v71, v46, v47
    v_mfma_f32_32x32x16_bf16 v[32:47], a[224:227], v[0:3], 0
    v_exp_f32 v48, v48
    v_exp_f32 v49, v49
    v_exp_f32 v50, v50
    v_exp_f32 v51, v51
    v_mfma_f32_32x32x8bf16_1k v[32:47], a[228:229], v[16:17], v[32:47]
    v_exp_f32 v52, v52
    v_exp_f32 v53, v53
    v_cvt_pk_bf16_f32 v72, v48, v49
    v_exp_f32 v54, v54
    v_exp_f32 v55, v55
    v_cvt_pk_bf16_f32 v73, v50, v51
    v_mfma_f32_32x32x16_bf16 a[128:143], a[216:219], v[64:67], a[128:143]
    v_exp_f32 v56, v56
    v_exp_f32 v57, v57
    v_cvt_pk_bf16_f32 v74, v52, v53
    v_exp_f32 v58, v58
    v_exp_f32 v59, v59
    v_cvt_pk_bf16_f32 v75, v54, v55
    v_mfma_f32_32x32x16_bf16 a[128:143], a[220:223], v[68:71], a[128:143]
    v_exp_f32 v60, v60
    v_exp_f32 v61, v61
    v_cvt_pk_bf16_f32 v76, v56, v57
    v_exp_f32 v62, v62
    v_exp_f32 v63, v63
    v_cvt_pk_bf16_f32 v77, v58, v59
    v_cvt_pk_bf16_f32 v78, v60, v61
    v_cvt_pk_bf16_f32 v79, v62, v63
    buffer_load_dwordx4 v[240:243], v254, s[8:11], s37 offen offset:1024 sc1
    buffer_load_dwordx4 v[208:211], v254, s[8:11], s37 offen offset:2048 sc1
    buffer_load_dwordx4 v[212:215], v254, s[8:11], s37 offen offset:3072 sc1
    v_mfma_f32_32x32x16_bf16 v[48:63], a[224:227], v[4:7], 0
    v_exp_f32 v32, v32
    v_exp_f32 v33, v33
    v_exp_f32 v34, v34
    v_exp_f32 v35, v35
    v_mfma_f32_32x32x8bf16_1k v[48:63], a[228:229], v[18:19], v[48:63]
    v_exp_f32 v36, v36
    v_exp_f32 v37, v37
    v_cvt_pk_bf16_f32 v64, v32, v33
    v_exp_f32 v38, v38
    v_cvt_pk_bf16_f32 v65, v34, v35
    s_waitcnt vmcnt(17)
    v_mfma_f32_32x32x16_bf16 v[144:159], v[248:251], v[220:223], v[144:159]
    v_exp_f32 v39, v39
    v_exp_f32 v40, v40
    v_cvt_pk_bf16_f32 v66, v36, v37
    v_exp_f32 v41, v41
    v_cvt_pk_bf16_f32 v67, v38, v39
    v_mfma_f32_32x32x16_bf16 a[144:159], a[216:219], v[72:75], a[144:159]
    v_exp_f32 v42, v42
    v_exp_f32 v43, v43
    v_cvt_pk_bf16_f32 v68, v40, v41
    v_exp_f32 v44, v44
    v_mfma_f32_32x32x16_bf16 a[144:159], a[220:223], v[76:79], a[144:159]
    v_exp_f32 v45, v45
    v_exp_f32 v46, v46
    v_cvt_pk_bf16_f32 v69, v42, v43
    v_exp_f32 v47, v47
    v_cvt_pk_bf16_f32 v70, v44, v45
    v_cvt_pk_bf16_f32 v71, v46, v47
    v_mfma_f32_32x32x16_bf16 v[32:47], a[224:227], v[8:11], 0
    v_exp_f32 v48, v48
    v_exp_f32 v49, v49
    v_exp_f32 v50, v50
    v_exp_f32 v51, v51
    buffer_load_dwordx2 a[208:209], v26, s[8:11], s62 offen offset:2816 sc1
    buffer_load_dwordx2 a[210:211], v26, s[8:11], s63 offen offset:2816 sc1
    v_mfma_f32_32x32x8bf16_1k v[32:47], a[228:229], v[20:21], v[32:47]
    v_exp_f32 v52, v52
    v_exp_f32 v53, v53
    v_cvt_pk_bf16_f32 v72, v48, v49
    v_exp_f32 v54, v54
    v_cvt_pk_bf16_f32 v73, v50, v51
    s_waitcnt vmcnt(18)
    v_mfma_f32_32x32x16_bf16 v[144:159], v[248:251], v[224:227], v[144:159]
    v_exp_f32 v55, v55
    v_exp_f32 v56, v56
    v_cvt_pk_bf16_f32 v74, v52, v53
    v_exp_f32 v57, v57
    v_cvt_pk_bf16_f32 v75, v54, v55
    v_mfma_f32_32x32x16_bf16 a[96:111], a[232:235], v[64:67], a[96:111]
    v_exp_f32 v58, v58
    v_exp_f32 v59, v59
    v_cvt_pk_bf16_f32 v76, v56, v57
    v_exp_f32 v60, v60
    buffer_load_dword a212, v24, s[8:11], s64 offen offset:2816 sc1
    v_mfma_f32_32x32x16_bf16 a[96:111], a[236:239], v[68:71], a[96:111]
    v_exp_f32 v61, v61
    v_exp_f32 v62, v62
    v_cvt_pk_bf16_f32 v77, v58, v59
    v_exp_f32 v63, v63
    v_cvt_pk_bf16_f32 v78, v60, v61
    v_cvt_pk_bf16_f32 v79, v62, v63
    v_mfma_f32_32x32x16_bf16 v[48:63], a[224:227], v[12:15], 0
    v_exp_f32 v32, v32
    v_exp_f32 v33, v33
    v_exp_f32 v34, v34
    v_exp_f32 v35, v35
    v_mfma_f32_32x32x8bf16_1k v[48:63], a[228:229], v[22:23], v[48:63]
    v_exp_f32 v36, v36
    v_exp_f32 v37, v37
    v_cvt_pk_bf16_f32 v64, v32, v33
    v_exp_f32 v38, v38
    v_cvt_pk_bf16_f32 v65, v34, v35
    buffer_load_dwordx4 a[216:219], v25, s[8:11], 0 offen offset:3456 sc1
    buffer_load_dwordx4 a[220:223], v25, s[8:11], 0 offen offset:4032 sc1
    s_waitcnt vmcnt(20)
    v_mfma_f32_32x32x16_bf16 v[144:159], v[248:251], v[228:231], v[144:159]
    v_exp_f32 v39, v39
    v_exp_f32 v40, v40
    v_cvt_pk_bf16_f32 v66, v36, v37
    v_exp_f32 v41, v41
    v_cvt_pk_bf16_f32 v67, v38, v39
    v_mfma_f32_32x32x16_bf16 a[112:127], a[232:235], v[72:75], a[112:127]
    v_exp_f32 v42, v42
    v_exp_f32 v43, v43
    v_cvt_pk_bf16_f32 v68, v40, v41
    v_exp_f32 v44, v44
    v_mfma_f32_32x32x16_bf16 a[112:127], a[236:239], v[76:79], a[112:127]
    v_exp_f32 v45, v45
    v_exp_f32 v46, v46
    v_cvt_pk_bf16_f32 v69, v42, v43
    v_exp_f32 v47, v47
    v_cvt_pk_bf16_f32 v70, v44, v45
    v_cvt_pk_bf16_f32 v71, v46, v47
    v_mfma_f32_32x32x16_bf16 v[32:47], a[240:243], v[0:3], 0
    v_exp_f32 v48, v48
    v_exp_f32 v49, v49
    v_exp_f32 v50, v50
    v_exp_f32 v51, v51
    v_mfma_f32_32x32x8bf16_1k v[32:47], a[244:245], v[16:17], v[32:47]
    v_exp_f32 v52, v52
    v_exp_f32 v53, v53
    v_cvt_pk_bf16_f32 v72, v48, v49
    v_exp_f32 v54, v54
    v_exp_f32 v55, v55
    v_cvt_pk_bf16_f32 v73, v50, v51
    v_mfma_f32_32x32x16_bf16 a[128:143], a[232:235], v[64:67], a[128:143]
    v_exp_f32 v56, v56
    v_exp_f32 v57, v57
    v_cvt_pk_bf16_f32 v74, v52, v53
    v_exp_f32 v58, v58
    v_exp_f32 v59, v59
    v_cvt_pk_bf16_f32 v75, v54, v55
    v_mfma_f32_32x32x16_bf16 a[128:143], a[236:239], v[68:71], a[128:143]
    v_exp_f32 v60, v60
    v_exp_f32 v61, v61
    v_cvt_pk_bf16_f32 v76, v56, v57
    v_exp_f32 v62, v62
    v_exp_f32 v63, v63
    v_cvt_pk_bf16_f32 v77, v58, v59
    v_cvt_pk_bf16_f32 v78, v60, v61
    v_cvt_pk_bf16_f32 v79, v62, v63
    s_add_u32 s37, s35, 5242880
    buffer_load_dwordx4 v[216:219], v254, s[8:11], s37 offen offset:0 sc1
    buffer_load_dwordx4 v[220:223], v254, s[8:11], s37 offen offset:1024 sc1
    v_mfma_f32_32x32x16_bf16 v[48:63], a[240:243], v[4:7], 0
    v_exp_f32 v32, v32
    v_exp_f32 v33, v33
    v_exp_f32 v34, v34
    v_exp_f32 v35, v35
    v_mfma_f32_32x32x8bf16_1k v[48:63], a[244:245], v[18:19], v[48:63]
    v_exp_f32 v36, v36
    v_exp_f32 v37, v37
    v_cvt_pk_bf16_f32 v64, v32, v33
    v_exp_f32 v38, v38
    v_cvt_pk_bf16_f32 v65, v34, v35
    s_waitcnt vmcnt(16)
    v_mfma_f32_32x32x16_bf16 v[144:159], v[248:251], v[232:235], v[144:159]
    v_exp_f32 v39, v39
    v_exp_f32 v40, v40
    v_cvt_pk_bf16_f32 v66, v36, v37
    v_exp_f32 v41, v41
    v_cvt_pk_bf16_f32 v67, v38, v39
    v_mfma_f32_32x32x16_bf16 a[144:159], a[232:235], v[72:75], a[144:159]
    v_exp_f32 v42, v42
    v_exp_f32 v43, v43
    v_cvt_pk_bf16_f32 v68, v40, v41
    v_exp_f32 v44, v44
    v_mfma_f32_32x32x16_bf16 a[144:159], a[236:239], v[76:79], a[144:159]
    v_exp_f32 v45, v45
    v_exp_f32 v46, v46
    v_cvt_pk_bf16_f32 v69, v42, v43
    v_exp_f32 v47, v47
    v_cvt_pk_bf16_f32 v70, v44, v45
    v_cvt_pk_bf16_f32 v71, v46, v47
    v_mfma_f32_32x32x16_bf16 v[32:47], a[240:243], v[8:11], 0
    v_exp_f32 v48, v48
    v_exp_f32 v49, v49
    v_exp_f32 v50, v50
    v_exp_f32 v51, v51
    buffer_load_dwordx2 a[224:225], v26, s[8:11], s62 offen offset:3072 sc1
    buffer_load_dwordx2 a[226:227], v26, s[8:11], s63 offen offset:3072 sc1
    v_mfma_f32_32x32x8bf16_1k v[32:47], a[244:245], v[20:21], v[32:47]
    v_exp_f32 v52, v52
    v_exp_f32 v53, v53
    v_cvt_pk_bf16_f32 v72, v48, v49
    v_exp_f32 v54, v54
    v_cvt_pk_bf16_f32 v73, v50, v51
    s_waitcnt vmcnt(17)
    v_mfma_f32_32x32x16_bf16 v[160:175], v[244:247], v[236:239], 0
    v_exp_f32 v55, v55
    v_exp_f32 v56, v56
    v_cvt_pk_bf16_f32 v74, v52, v53
    v_exp_f32 v57, v57
    v_cvt_pk_bf16_f32 v75, v54, v55
    v_mfma_f32_32x32x16_bf16 a[96:111], a[248:251], v[64:67], a[96:111]
    v_exp_f32 v58, v58
    v_exp_f32 v59, v59
    v_cvt_pk_bf16_f32 v76, v56, v57
    v_exp_f32 v60, v60
    buffer_load_dword a228, v24, s[8:11], s64 offen offset:3072 sc1
    v_mfma_f32_32x32x16_bf16 a[96:111], a[252:255], v[68:71], a[96:111]
    v_exp_f32 v61, v61
    v_exp_f32 v62, v62
    v_cvt_pk_bf16_f32 v77, v58, v59
    v_exp_f32 v63, v63
    v_cvt_pk_bf16_f32 v78, v60, v61
    v_cvt_pk_bf16_f32 v79, v62, v63
    v_mfma_f32_32x32x16_bf16 v[48:63], a[240:243], v[12:15], 0
    v_exp_f32 v32, v32
    v_exp_f32 v33, v33
    v_exp_f32 v34, v34
    v_exp_f32 v35, v35
    v_mfma_f32_32x32x8bf16_1k v[48:63], a[244:245], v[22:23], v[48:63]
    v_exp_f32 v36, v36
    v_exp_f32 v37, v37
    v_cvt_pk_bf16_f32 v64, v32, v33
    v_exp_f32 v38, v38
    v_exp_f32 v39, v39
    v_cvt_pk_bf16_f32 v65, v34, v35
    v_add_u32 v25, v28, v25
    buffer_load_dwordx4 a[232:235], v25, s[8:11], 0 offen offset:0 sc1
    buffer_load_dwordx4 a[236:239], v25, s[8:11], 0 offen offset:576 sc1
    v_mfma_f32_32x32x16_bf16 a[112:127], a[248:251], v[72:75], a[112:127]
    v_exp_f32 v40, v40
    v_exp_f32 v41, v41
    v_cvt_pk_bf16_f32 v66, v36, v37
    v_exp_f32 v42, v42
    v_exp_f32 v43, v43
    v_cvt_pk_bf16_f32 v67, v38, v39
    v_mfma_f32_32x32x16_bf16 a[112:127], a[252:255], v[76:79], a[112:127]
    v_exp_f32 v44, v44
    v_exp_f32 v45, v45
    v_cvt_pk_bf16_f32 v68, v40, v41
    v_exp_f32 v46, v46
    v_exp_f32 v47, v47
    v_cvt_pk_bf16_f32 v69, v42, v43
    v_cvt_pk_bf16_f32 v70, v44, v45
    v_cvt_pk_bf16_f32 v71, v46, v47
    v_mfma_f32_32x32x16_bf16 v[32:47], a[160:163], v[0:3], 0
    v_exp_f32 v48, v48
    v_exp_f32 v49, v49
    v_exp_f32 v50, v50
    v_exp_f32 v51, v51
    v_mfma_f32_32x32x8bf16_1k v[32:47], a[164:165], v[16:17], v[32:47]
    v_exp_f32 v52, v52
    v_exp_f32 v53, v53
    v_cvt_pk_bf16_f32 v72, v48, v49
    v_exp_f32 v54, v54
    v_exp_f32 v55, v55
    v_cvt_pk_bf16_f32 v73, v50, v51
    v_mfma_f32_32x32x16_bf16 a[128:143], a[248:251], v[64:67], a[128:143]
    v_exp_f32 v56, v56
    v_exp_f32 v57, v57
    v_cvt_pk_bf16_f32 v74, v52, v53
    v_exp_f32 v58, v58
    v_exp_f32 v59, v59
    v_cvt_pk_bf16_f32 v75, v54, v55
    v_mfma_f32_32x32x16_bf16 a[128:143], a[252:255], v[68:71], a[128:143]
    v_exp_f32 v60, v60
    v_exp_f32 v61, v61
    v_cvt_pk_bf16_f32 v76, v56, v57
    v_exp_f32 v62, v62
    v_exp_f32 v63, v63
    v_cvt_pk_bf16_f32 v77, v58, v59
    v_cvt_pk_bf16_f32 v78, v60, v61
    v_cvt_pk_bf16_f32 v79, v62, v63
    buffer_load_dwordx4 v[224:227], v254, s[8:11], s37 offen offset:2048 sc1
    buffer_load_dwordx4 v[228:231], v254, s[8:11], s37 offen offset:3072 sc1
    v_mfma_f32_32x32x16_bf16 v[48:63], a[160:163], v[4:7], 0
    v_exp_f32 v32, v32
    v_exp_f32 v33, v33
    v_exp_f32 v34, v34
    v_exp_f32 v35, v35
    v_mfma_f32_32x32x8bf16_1k v[48:63], a[164:165], v[18:19], v[48:63]
    v_exp_f32 v36, v36
    v_exp_f32 v37, v37
    v_cvt_pk_bf16_f32 v64, v32, v33
    v_exp_f32 v38, v38
    v_cvt_pk_bf16_f32 v65, v34, v35
    s_waitcnt vmcnt(16)
    v_mfma_f32_32x32x16_bf16 v[160:175], v[244:247], v[240:243], v[160:175]
    v_exp_f32 v39, v39
    v_exp_f32 v40, v40
    v_cvt_pk_bf16_f32 v66, v36, v37
    v_exp_f32 v41, v41
    v_cvt_pk_bf16_f32 v67, v38, v39
    v_mfma_f32_32x32x16_bf16 a[144:159], a[248:251], v[72:75], a[144:159]
    v_exp_f32 v42, v42
    v_exp_f32 v43, v43
    v_cvt_pk_bf16_f32 v68, v40, v41
    v_exp_f32 v44, v44
    v_mfma_f32_32x32x16_bf16 a[144:159], a[252:255], v[76:79], a[144:159]
    v_exp_f32 v45, v45
    v_exp_f32 v46, v46
    v_cvt_pk_bf16_f32 v69, v42, v43
    v_exp_f32 v47, v47
    v_cvt_pk_bf16_f32 v70, v44, v45
    v_cvt_pk_bf16_f32 v71, v46, v47
    v_mfma_f32_32x32x16_bf16 v[32:47], a[160:163], v[8:11], 0
    v_exp_f32 v48, v48
    v_exp_f32 v49, v49
    v_exp_f32 v50, v50
    v_exp_f32 v51, v51
    buffer_load_dwordx2 a[240:241], v26, s[8:11], s62 offen offset:3328 sc1
    buffer_load_dwordx2 a[242:243], v26, s[8:11], s63 offen offset:3328 sc1
    v_mfma_f32_32x32x8bf16_1k v[32:47], a[164:165], v[20:21], v[32:47]
    v_exp_f32 v52, v52
    v_exp_f32 v53, v53
    v_cvt_pk_bf16_f32 v72, v48, v49
    v_exp_f32 v54, v54
    v_cvt_pk_bf16_f32 v73, v50, v51
    s_waitcnt vmcnt(17)
    v_mfma_f32_32x32x16_bf16 v[160:175], v[244:247], v[208:211], v[160:175]
    v_exp_f32 v55, v55
    v_exp_f32 v56, v56
    v_cvt_pk_bf16_f32 v74, v52, v53
    v_exp_f32 v57, v57
    v_cvt_pk_bf16_f32 v75, v54, v55
    v_mfma_f32_32x32x16_bf16 a[96:111], a[168:171], v[64:67], a[96:111]
    v_exp_f32 v58, v58
    v_exp_f32 v59, v59
    v_cvt_pk_bf16_f32 v76, v56, v57
    v_exp_f32 v60, v60
    buffer_load_dword a244, v24, s[8:11], s64 offen offset:3328 sc1
    v_mfma_f32_32x32x16_bf16 a[96:111], a[172:175], v[68:71], a[96:111]
    v_exp_f32 v61, v61
    v_exp_f32 v62, v62
    v_cvt_pk_bf16_f32 v77, v58, v59
    v_exp_f32 v63, v63
    v_cvt_pk_bf16_f32 v78, v60, v61
    v_cvt_pk_bf16_f32 v79, v62, v63
    v_mfma_f32_32x32x16_bf16 v[48:63], a[160:163], v[12:15], 0
    v_exp_f32 v32, v32
    v_exp_f32 v33, v33
    v_exp_f32 v34, v34
    v_exp_f32 v35, v35
    v_mfma_f32_32x32x8bf16_1k v[48:63], a[164:165], v[22:23], v[48:63]
    v_exp_f32 v36, v36
    v_exp_f32 v37, v37
    v_cvt_pk_bf16_f32 v64, v32, v33
    v_exp_f32 v38, v38
    v_cvt_pk_bf16_f32 v65, v34, v35
    buffer_load_dwordx4 a[248:251], v25, s[8:11], 0 offen offset:1152 sc1
    buffer_load_dwordx4 a[252:255], v25, s[8:11], 0 offen offset:1728 sc1
    s_waitcnt vmcnt(19)
    v_mfma_f32_32x32x16_bf16 v[160:175], v[244:247], v[212:215], v[160:175]
    v_exp_f32 v39, v39
    v_exp_f32 v40, v40
    v_cvt_pk_bf16_f32 v66, v36, v37
    v_exp_f32 v41, v41
    v_cvt_pk_bf16_f32 v67, v38, v39
    v_mfma_f32_32x32x16_bf16 a[112:127], a[168:171], v[72:75], a[112:127]
    v_exp_f32 v42, v42
    v_exp_f32 v43, v43
    v_cvt_pk_bf16_f32 v68, v40, v41
    v_exp_f32 v44, v44
    v_mfma_f32_32x32x16_bf16 a[112:127], a[172:175], v[76:79], a[112:127]
    v_exp_f32 v45, v45
    v_exp_f32 v46, v46
    v_cvt_pk_bf16_f32 v69, v42, v43
    v_exp_f32 v47, v47
    v_cvt_pk_bf16_f32 v70, v44, v45
    v_cvt_pk_bf16_f32 v71, v46, v47
    v_mfma_f32_32x32x16_bf16 v[32:47], a[176:179], v[0:3], 0
    v_exp_f32 v48, v48
    v_exp_f32 v49, v49
    v_exp_f32 v50, v50
    v_exp_f32 v51, v51
    v_mfma_f32_32x32x8bf16_1k v[32:47], a[180:181], v[16:17], v[32:47]
    v_exp_f32 v52, v52
    v_exp_f32 v53, v53
    v_cvt_pk_bf16_f32 v72, v48, v49
    v_exp_f32 v54, v54
    v_exp_f32 v55, v55
    v_cvt_pk_bf16_f32 v73, v50, v51
    v_mfma_f32_32x32x16_bf16 a[128:143], a[168:171], v[64:67], a[128:143]
    v_exp_f32 v56, v56
    v_exp_f32 v57, v57
    v_cvt_pk_bf16_f32 v74, v52, v53
    v_exp_f32 v58, v58
    v_exp_f32 v59, v59
    v_cvt_pk_bf16_f32 v75, v54, v55
    v_mfma_f32_32x32x16_bf16 a[128:143], a[172:175], v[68:71], a[128:143]
    v_exp_f32 v60, v60
    v_exp_f32 v61, v61
    v_cvt_pk_bf16_f32 v76, v56, v57
    v_exp_f32 v62, v62
    v_exp_f32 v63, v63
    v_cvt_pk_bf16_f32 v77, v58, v59
    v_cvt_pk_bf16_f32 v78, v60, v61
    v_cvt_pk_bf16_f32 v79, v62, v63
    s_add_u32 s37, s35, 6291456
    buffer_load_dwordx4 v[232:235], v254, s[8:11], s37 offen offset:0 sc1
    buffer_load_dwordx4 v[236:239], v254, s[8:11], s37 offen offset:1024 sc1
    buffer_load_dwordx4 v[240:243], v254, s[8:11], s37 offen offset:2048 sc1
    v_mfma_f32_32x32x16_bf16 v[48:63], a[176:179], v[4:7], 0
    v_exp_f32 v32, v32
    v_exp_f32 v33, v33
    v_exp_f32 v34, v34
    v_exp_f32 v35, v35
    v_mfma_f32_32x32x8bf16_1k v[48:63], a[180:181], v[18:19], v[48:63]
    v_exp_f32 v36, v36
    v_exp_f32 v37, v37
    v_cvt_pk_bf16_f32 v64, v32, v33
    v_exp_f32 v38, v38
    v_cvt_pk_bf16_f32 v65, v34, v35
    s_waitcnt vmcnt(16)
    v_mfma_f32_32x32x16_bf16 v[160:175], v[248:251], v[216:219], v[160:175]
    v_exp_f32 v39, v39
    v_exp_f32 v40, v40
    v_cvt_pk_bf16_f32 v66, v36, v37
    v_exp_f32 v41, v41
    v_cvt_pk_bf16_f32 v67, v38, v39
    v_mfma_f32_32x32x16_bf16 a[144:159], a[168:171], v[72:75], a[144:159]
    v_exp_f32 v42, v42
    v_exp_f32 v43, v43
    v_cvt_pk_bf16_f32 v68, v40, v41
    v_exp_f32 v44, v44
    v_mfma_f32_32x32x16_bf16 a[144:159], a[172:175], v[76:79], a[144:159]
    v_exp_f32 v45, v45
    v_exp_f32 v46, v46
    v_cvt_pk_bf16_f32 v69, v42, v43
    v_exp_f32 v47, v47
    v_cvt_pk_bf16_f32 v70, v44, v45
    v_cvt_pk_bf16_f32 v71, v46, v47
    v_mfma_f32_32x32x16_bf16 v[32:47], a[176:179], v[8:11], 0
    v_exp_f32 v48, v48
    v_exp_f32 v49, v49
    v_exp_f32 v50, v50
    v_exp_f32 v51, v51
    buffer_load_dwordx2 a[160:161], v26, s[8:11], s62 offen offset:3584 sc1
    buffer_load_dwordx2 a[162:163], v26, s[8:11], s63 offen offset:3584 sc1
    v_mfma_f32_32x32x8bf16_1k v[32:47], a[180:181], v[20:21], v[32:47]
    v_exp_f32 v52, v52
    v_exp_f32 v53, v53
    v_cvt_pk_bf16_f32 v72, v48, v49
    v_exp_f32 v54, v54
    v_cvt_pk_bf16_f32 v73, v50, v51
    s_waitcnt vmcnt(17)
    v_mfma_f32_32x32x16_bf16 v[160:175], v[248:251], v[220:223], v[160:175]
    v_exp_f32 v55, v55
    v_exp_f32 v56, v56
    v_cvt_pk_bf16_f32 v74, v52, v53
    v_exp_f32 v57, v57
    v_cvt_pk_bf16_f32 v75, v54, v55
    v_mfma_f32_32x32x16_bf16 a[96:111], a[184:187], v[64:67], a[96:111]
    v_exp_f32 v58, v58
    v_exp_f32 v59, v59
    v_cvt_pk_bf16_f32 v76, v56, v57
    v_exp_f32 v60, v60
    buffer_load_dword a164, v24, s[8:11], s64 offen offset:3584 sc1
    v_mfma_f32_32x32x16_bf16 a[96:111], a[188:191], v[68:71], a[96:111]
    v_exp_f32 v61, v61
    v_exp_f32 v62, v62
    v_cvt_pk_bf16_f32 v77, v58, v59
    v_exp_f32 v63, v63
    v_cvt_pk_bf16_f32 v78, v60, v61
    v_cvt_pk_bf16_f32 v79, v62, v63
    v_mfma_f32_32x32x16_bf16 v[48:63], a[176:179], v[12:15], 0
    v_exp_f32 v32, v32
    v_exp_f32 v33, v33
    v_exp_f32 v34, v34
    v_exp_f32 v35, v35
    v_mfma_f32_32x32x8bf16_1k v[48:63], a[180:181], v[22:23], v[48:63]
    v_exp_f32 v36, v36
    v_exp_f32 v37, v37
    v_cvt_pk_bf16_f32 v64, v32, v33
    v_exp_f32 v38, v38
    v_exp_f32 v39, v39
    v_cvt_pk_bf16_f32 v65, v34, v35
    buffer_load_dwordx4 a[168:171], v25, s[8:11], 0 offen offset:2304 sc1
    buffer_load_dwordx4 a[172:175], v25, s[8:11], 0 offen offset:2880 sc1
    v_mfma_f32_32x32x16_bf16 a[112:127], a[184:187], v[72:75], a[112:127]
    v_exp_f32 v40, v40
    v_exp_f32 v41, v41
    v_cvt_pk_bf16_f32 v66, v36, v37
    v_exp_f32 v42, v42
    v_exp_f32 v43, v43
    v_cvt_pk_bf16_f32 v67, v38, v39
    v_mfma_f32_32x32x16_bf16 a[112:127], a[188:191], v[76:79], a[112:127]
    v_exp_f32 v44, v44
    v_exp_f32 v45, v45
    v_cvt_pk_bf16_f32 v68, v40, v41
    v_exp_f32 v46, v46
    v_exp_f32 v47, v47
    v_cvt_pk_bf16_f32 v69, v42, v43
    v_cvt_pk_bf16_f32 v70, v44, v45
    v_cvt_pk_bf16_f32 v71, v46, v47
    v_mfma_f32_32x32x16_bf16 v[32:47], a[192:195], v[0:3], 0
    v_exp_f32 v48, v48
    v_exp_f32 v49, v49
    v_exp_f32 v50, v50
    v_exp_f32 v51, v51
    v_mfma_f32_32x32x8bf16_1k v[32:47], a[196:197], v[16:17], v[32:47]
    v_exp_f32 v52, v52
    v_exp_f32 v53, v53
    v_cvt_pk_bf16_f32 v72, v48, v49
    v_exp_f32 v54, v54
    v_exp_f32 v55, v55
    v_cvt_pk_bf16_f32 v73, v50, v51
    v_mfma_f32_32x32x16_bf16 a[128:143], a[184:187], v[64:67], a[128:143]
    v_exp_f32 v56, v56
    v_exp_f32 v57, v57
    v_cvt_pk_bf16_f32 v74, v52, v53
    v_exp_f32 v58, v58
    v_exp_f32 v59, v59
    v_cvt_pk_bf16_f32 v75, v54, v55
    v_mfma_f32_32x32x16_bf16 a[128:143], a[188:191], v[68:71], a[128:143]
    v_exp_f32 v60, v60
    v_exp_f32 v61, v61
    v_cvt_pk_bf16_f32 v76, v56, v57
    v_exp_f32 v62, v62
    v_exp_f32 v63, v63
    v_cvt_pk_bf16_f32 v77, v58, v59
    v_cvt_pk_bf16_f32 v78, v60, v61
    v_cvt_pk_bf16_f32 v79, v62, v63
    buffer_load_dwordx4 v[208:211], v254, s[8:11], s37 offen offset:3072 sc1
    s_add_u32 s37, s35, 7340032
    buffer_load_dwordx4 v[212:215], v254, s[8:11], s37 offen offset:0 sc1
    v_mfma_f32_32x32x16_bf16 v[48:63], a[192:195], v[4:7], 0
    v_exp_f32 v32, v32
    v_exp_f32 v33, v33
    v_exp_f32 v34, v34
    v_exp_f32 v35, v35
    v_mfma_f32_32x32x8bf16_1k v[48:63], a[196:197], v[18:19], v[48:63]
    v_exp_f32 v36, v36
    v_exp_f32 v37, v37
    v_cvt_pk_bf16_f32 v64, v32, v33
    v_exp_f32 v38, v38
    v_cvt_pk_bf16_f32 v65, v34, v35
    s_waitcnt vmcnt(16)
    v_mfma_f32_32x32x16_bf16 v[160:175], v[248:251], v[224:227], v[160:175]
    v_exp_f32 v39, v39
    v_exp_f32 v40, v40
    v_cvt_pk_bf16_f32 v66, v36, v37
    v_exp_f32 v41, v41
    v_cvt_pk_bf16_f32 v67, v38, v39
    v_mfma_f32_32x32x16_bf16 a[144:159], a[184:187], v[72:75], a[144:159]
    v_exp_f32 v42, v42
    v_exp_f32 v43, v43
    v_cvt_pk_bf16_f32 v68, v40, v41
    v_exp_f32 v44, v44
    v_mfma_f32_32x32x16_bf16 a[144:159], a[188:191], v[76:79], a[144:159]
    v_exp_f32 v45, v45
    v_exp_f32 v46, v46
    v_cvt_pk_bf16_f32 v69, v42, v43
    v_exp_f32 v47, v47
    v_cvt_pk_bf16_f32 v70, v44, v45
    v_cvt_pk_bf16_f32 v71, v46, v47
    v_mfma_f32_32x32x16_bf16 v[32:47], a[192:195], v[8:11], 0
    v_exp_f32 v48, v48
    v_exp_f32 v49, v49
    v_exp_f32 v50, v50
    v_exp_f32 v51, v51
    buffer_load_dwordx2 a[176:177], v26, s[8:11], s62 offen offset:3840 sc1
    buffer_load_dwordx2 a[178:179], v26, s[8:11], s63 offen offset:3840 sc1
    v_mfma_f32_32x32x8bf16_1k v[32:47], a[196:197], v[20:21], v[32:47]
    v_exp_f32 v52, v52
    v_exp_f32 v53, v53
    v_cvt_pk_bf16_f32 v72, v48, v49
    v_exp_f32 v54, v54
    v_cvt_pk_bf16_f32 v73, v50, v51
    s_waitcnt vmcnt(17)
    v_mfma_f32_32x32x16_bf16 v[160:175], v[248:251], v[228:231], v[160:175]
    v_exp_f32 v55, v55
    v_exp_f32 v56, v56
    v_cvt_pk_bf16_f32 v74, v52, v53
    v_exp_f32 v57, v57
    v_cvt_pk_bf16_f32 v75, v54, v55
    v_mfma_f32_32x32x16_bf16 a[96:111], a[200:203], v[64:67], a[96:111]
    v_exp_f32 v58, v58
    v_exp_f32 v59, v59
    v_cvt_pk_bf16_f32 v76, v56, v57
    v_exp_f32 v60, v60
    buffer_load_dword a180, v24, s[8:11], s64 offen offset:3840 sc1
    v_mfma_f32_32x32x16_bf16 a[96:111], a[204:207], v[68:71], a[96:111]
    v_exp_f32 v61, v61
    v_exp_f32 v62, v62
    v_cvt_pk_bf16_f32 v77, v58, v59
    v_exp_f32 v63, v63
    v_cvt_pk_bf16_f32 v78, v60, v61
    v_cvt_pk_bf16_f32 v79, v62, v63
    v_mfma_f32_32x32x16_bf16 v[48:63], a[192:195], v[12:15], 0
    v_exp_f32 v32, v32
    v_exp_f32 v33, v33
    v_exp_f32 v34, v34
    v_exp_f32 v35, v35
    v_mfma_f32_32x32x8bf16_1k v[48:63], a[196:197], v[22:23], v[48:63]
    v_exp_f32 v36, v36
    v_exp_f32 v37, v37
    v_cvt_pk_bf16_f32 v64, v32, v33
    v_exp_f32 v38, v38
    v_exp_f32 v39, v39
    v_cvt_pk_bf16_f32 v65, v34, v35
    buffer_load_dwordx4 a[184:187], v25, s[8:11], 0 offen offset:3456 sc1
    buffer_load_dwordx4 a[188:191], v25, s[8:11], 0 offen offset:4032 sc1
    v_mfma_f32_32x32x16_bf16 a[112:127], a[200:203], v[72:75], a[112:127]
    v_exp_f32 v40, v40
    v_exp_f32 v41, v41
    v_cvt_pk_bf16_f32 v66, v36, v37
    v_exp_f32 v42, v42
    v_exp_f32 v43, v43
    v_cvt_pk_bf16_f32 v67, v38, v39
    v_mfma_f32_32x32x16_bf16 a[112:127], a[204:207], v[76:79], a[112:127]
    v_exp_f32 v44, v44
    v_exp_f32 v45, v45
    v_cvt_pk_bf16_f32 v68, v40, v41
    v_exp_f32 v46, v46
    v_exp_f32 v47, v47
    v_cvt_pk_bf16_f32 v69, v42, v43
    v_cvt_pk_bf16_f32 v70, v44, v45
    v_cvt_pk_bf16_f32 v71, v46, v47
    v_mfma_f32_32x32x16_bf16 v[32:47], a[208:211], v[0:3], 0
    v_exp_f32 v48, v48
    v_exp_f32 v49, v49
    v_exp_f32 v50, v50
    v_exp_f32 v51, v51
    v_mfma_f32_32x32x8bf16_1k v[32:47], a[212:213], v[16:17], v[32:47]
    v_exp_f32 v52, v52
    v_exp_f32 v53, v53
    v_cvt_pk_bf16_f32 v72, v48, v49
    v_exp_f32 v54, v54
    v_exp_f32 v55, v55
    v_cvt_pk_bf16_f32 v73, v50, v51
    v_mfma_f32_32x32x16_bf16 a[128:143], a[200:203], v[64:67], a[128:143]
    v_exp_f32 v56, v56
    v_exp_f32 v57, v57
    v_cvt_pk_bf16_f32 v74, v52, v53
    v_exp_f32 v58, v58
    v_exp_f32 v59, v59
    v_cvt_pk_bf16_f32 v75, v54, v55
    v_mfma_f32_32x32x16_bf16 a[128:143], a[204:207], v[68:71], a[128:143]
    v_exp_f32 v60, v60
    v_exp_f32 v61, v61
    v_cvt_pk_bf16_f32 v76, v56, v57
    v_exp_f32 v62, v62
    v_exp_f32 v63, v63
    v_cvt_pk_bf16_f32 v77, v58, v59
    v_cvt_pk_bf16_f32 v78, v60, v61
    v_cvt_pk_bf16_f32 v79, v62, v63
    buffer_load_dwordx4 v[216:219], v254, s[8:11], s37 offen offset:1024 sc1
    buffer_load_dwordx4 v[220:223], v254, s[8:11], s37 offen offset:2048 sc1
    buffer_load_dwordx4 v[224:227], v254, s[8:11], s37 offen offset:3072 sc1
    v_mfma_f32_32x32x16_bf16 v[48:63], a[208:211], v[4:7], 0
    v_exp_f32 v32, v32
    v_exp_f32 v33, v33
    v_exp_f32 v34, v34
    v_exp_f32 v35, v35
    v_mfma_f32_32x32x8bf16_1k v[48:63], a[212:213], v[18:19], v[48:63]
    v_exp_f32 v36, v36
    v_exp_f32 v37, v37
    v_cvt_pk_bf16_f32 v64, v32, v33
    v_exp_f32 v38, v38
    v_cvt_pk_bf16_f32 v65, v34, v35
    s_waitcnt vmcnt(17)
    v_mfma_f32_32x32x16_bf16 v[176:191], v[244:247], v[232:235], 0
    v_exp_f32 v39, v39
    v_exp_f32 v40, v40
    v_cvt_pk_bf16_f32 v66, v36, v37
    v_exp_f32 v41, v41
    v_cvt_pk_bf16_f32 v67, v38, v39
    v_mfma_f32_32x32x16_bf16 a[144:159], a[200:203], v[72:75], a[144:159]
    v_exp_f32 v42, v42
    v_exp_f32 v43, v43
    v_cvt_pk_bf16_f32 v68, v40, v41
    v_exp_f32 v44, v44
    v_mfma_f32_32x32x16_bf16 a[144:159], a[204:207], v[76:79], a[144:159]
    v_exp_f32 v45, v45
    v_exp_f32 v46, v46
    v_cvt_pk_bf16_f32 v69, v42, v43
    v_exp_f32 v47, v47
    v_cvt_pk_bf16_f32 v70, v44, v45
    v_cvt_pk_bf16_f32 v71, v46, v47
    v_mfma_f32_32x32x16_bf16 v[32:47], a[208:211], v[8:11], 0
    v_exp_f32 v48, v48
    v_exp_f32 v49, v49
    v_exp_f32 v50, v50
    v_exp_f32 v51, v51
    v_mfma_f32_32x32x8bf16_1k v[32:47], a[212:213], v[20:21], v[32:47]
    v_exp_f32 v52, v52
    v_exp_f32 v53, v53
    v_cvt_pk_bf16_f32 v72, v48, v49
    v_exp_f32 v54, v54
    v_cvt_pk_bf16_f32 v73, v50, v51
    s_waitcnt vmcnt(16)
    v_mfma_f32_32x32x16_bf16 v[176:191], v[244:247], v[236:239], v[176:191]
    v_exp_f32 v55, v55
    v_exp_f32 v56, v56
    v_cvt_pk_bf16_f32 v74, v52, v53
    v_exp_f32 v57, v57
    v_cvt_pk_bf16_f32 v75, v54, v55
    v_mfma_f32_32x32x16_bf16 a[96:111], a[216:219], v[64:67], a[96:111]
    v_exp_f32 v58, v58
    v_exp_f32 v59, v59
    v_cvt_pk_bf16_f32 v76, v56, v57
    v_exp_f32 v60, v60
    v_mfma_f32_32x32x16_bf16 a[96:111], a[220:223], v[68:71], a[96:111]
    v_exp_f32 v61, v61
    v_exp_f32 v62, v62
    v_cvt_pk_bf16_f32 v77, v58, v59
    v_exp_f32 v63, v63
    v_cvt_pk_bf16_f32 v78, v60, v61
    v_cvt_pk_bf16_f32 v79, v62, v63
    v_mfma_f32_32x32x16_bf16 v[48:63], a[208:211], v[12:15], 0
    v_exp_f32 v32, v32
    v_exp_f32 v33, v33
    v_exp_f32 v34, v34
    v_exp_f32 v35, v35
    v_mfma_f32_32x32x8bf16_1k v[48:63], a[212:213], v[22:23], v[48:63]
    v_exp_f32 v36, v36
    v_exp_f32 v37, v37
    v_cvt_pk_bf16_f32 v64, v32, v33
    v_exp_f32 v38, v38
    v_cvt_pk_bf16_f32 v65, v34, v35
    s_waitcnt vmcnt(15)
    v_mfma_f32_32x32x16_bf16 v[176:191], v[244:247], v[240:243], v[176:191]
    v_exp_f32 v39, v39
    v_exp_f32 v40, v40
    v_cvt_pk_bf16_f32 v66, v36, v37
    v_exp_f32 v41, v41
    v_cvt_pk_bf16_f32 v67, v38, v39
    v_mfma_f32_32x32x16_bf16 a[112:127], a[216:219], v[72:75], a[112:127]
    v_exp_f32 v42, v42
    v_exp_f32 v43, v43
    v_cvt_pk_bf16_f32 v68, v40, v41
    v_exp_f32 v44, v44
    v_mfma_f32_32x32x16_bf16 a[112:127], a[220:223], v[76:79], a[112:127]
    v_exp_f32 v45, v45
    v_exp_f32 v46, v46
    v_cvt_pk_bf16_f32 v69, v42, v43
    v_exp_f32 v47, v47
    v_cvt_pk_bf16_f32 v70, v44, v45
    v_cvt_pk_bf16_f32 v71, v46, v47
    v_mfma_f32_32x32x16_bf16 v[32:47], a[224:227], v[0:3], 0
    v_exp_f32 v48, v48
    v_exp_f32 v49, v49
    v_exp_f32 v50, v50
    v_exp_f32 v51, v51
    v_mfma_f32_32x32x8bf16_1k v[32:47], a[228:229], v[16:17], v[32:47]
    v_exp_f32 v52, v52
    v_exp_f32 v53, v53
    v_cvt_pk_bf16_f32 v72, v48, v49
    v_exp_f32 v54, v54
    v_exp_f32 v55, v55
    v_cvt_pk_bf16_f32 v73, v50, v51
    v_mfma_f32_32x32x16_bf16 a[128:143], a[216:219], v[64:67], a[128:143]
    v_exp_f32 v56, v56
    v_exp_f32 v57, v57
    v_cvt_pk_bf16_f32 v74, v52, v53
    v_exp_f32 v58, v58
    v_exp_f32 v59, v59
    v_cvt_pk_bf16_f32 v75, v54, v55
    v_mfma_f32_32x32x16_bf16 a[128:143], a[220:223], v[68:71], a[128:143]
    v_exp_f32 v60, v60
    v_exp_f32 v61, v61
    v_cvt_pk_bf16_f32 v76, v56, v57
    v_exp_f32 v62, v62
    v_exp_f32 v63, v63
    v_cvt_pk_bf16_f32 v77, v58, v59
    v_cvt_pk_bf16_f32 v78, v60, v61
    v_cvt_pk_bf16_f32 v79, v62, v63
    s_add_u32 s37, s35, 8388608
    buffer_load_dwordx4 v[228:231], v254, s[8:11], s37 offen offset:0 sc1
    buffer_load_dwordx4 v[232:235], v254, s[8:11], s37 offen offset:1024 sc1
    v_mfma_f32_32x32x16_bf16 v[48:63], a[224:227], v[4:7], 0
    v_exp_f32 v32, v32
    v_exp_f32 v33, v33
    v_exp_f32 v34, v34
    v_exp_f32 v35, v35
    v_mfma_f32_32x32x8bf16_1k v[48:63], a[228:229], v[18:19], v[48:63]
    v_exp_f32 v36, v36
    v_exp_f32 v37, v37
    v_cvt_pk_bf16_f32 v64, v32, v33
    v_exp_f32 v38, v38
    v_cvt_pk_bf16_f32 v65, v34, v35
    s_waitcnt vmcnt(11)
    v_mfma_f32_32x32x16_bf16 v[176:191], v[244:247], v[208:211], v[176:191]
    v_exp_f32 v39, v39
    v_exp_f32 v40, v40
    v_cvt_pk_bf16_f32 v66, v36, v37
    v_exp_f32 v41, v41
    v_cvt_pk_bf16_f32 v67, v38, v39
    v_mfma_f32_32x32x16_bf16 a[144:159], a[216:219], v[72:75], a[144:159]
    v_exp_f32 v42, v42
    v_exp_f32 v43, v43
    v_cvt_pk_bf16_f32 v68, v40, v41
    v_exp_f32 v44, v44
    v_mfma_f32_32x32x16_bf16 a[144:159], a[220:223], v[76:79], a[144:159]
    v_exp_f32 v45, v45
    v_exp_f32 v46, v46
    v_cvt_pk_bf16_f32 v69, v42, v43
    v_exp_f32 v47, v47
    v_cvt_pk_bf16_f32 v70, v44, v45
    v_cvt_pk_bf16_f32 v71, v46, v47
    v_mfma_f32_32x32x16_bf16 v[32:47], a[224:227], v[8:11], 0
    v_exp_f32 v48, v48
    v_exp_f32 v49, v49
    v_exp_f32 v50, v50
    v_exp_f32 v51, v51
    v_mfma_f32_32x32x8bf16_1k v[32:47], a[228:229], v[20:21], v[32:47]
    v_exp_f32 v52, v52
    v_exp_f32 v53, v53
    v_cvt_pk_bf16_f32 v72, v48, v49
    v_exp_f32 v54, v54
    v_cvt_pk_bf16_f32 v73, v50, v51
    s_waitcnt vmcnt(10)
    v_mfma_f32_32x32x16_bf16 v[176:191], v[248:251], v[212:215], v[176:191]
    v_exp_f32 v55, v55
    v_exp_f32 v56, v56
    v_cvt_pk_bf16_f32 v74, v52, v53
    v_exp_f32 v57, v57
    v_cvt_pk_bf16_f32 v75, v54, v55
    v_mfma_f32_32x32x16_bf16 a[96:111], a[232:235], v[64:67], a[96:111]
    v_exp_f32 v58, v58
    v_exp_f32 v59, v59
    v_cvt_pk_bf16_f32 v76, v56, v57
    v_exp_f32 v60, v60
    v_mfma_f32_32x32x16_bf16 a[96:111], a[236:239], v[68:71], a[96:111]
    v_exp_f32 v61, v61
    v_exp_f32 v62, v62
    v_cvt_pk_bf16_f32 v77, v58, v59
    v_exp_f32 v63, v63
    v_cvt_pk_bf16_f32 v78, v60, v61
    v_cvt_pk_bf16_f32 v79, v62, v63
    v_mfma_f32_32x32x16_bf16 v[48:63], a[224:227], v[12:15], 0
    v_exp_f32 v32, v32
    v_exp_f32 v33, v33
    v_exp_f32 v34, v34
    v_exp_f32 v35, v35
    v_mfma_f32_32x32x8bf16_1k v[48:63], a[228:229], v[22:23], v[48:63]
    v_exp_f32 v36, v36
    v_exp_f32 v37, v37
    v_cvt_pk_bf16_f32 v64, v32, v33
    v_exp_f32 v38, v38
    v_exp_f32 v39, v39
    v_cvt_pk_bf16_f32 v65, v34, v35
    v_mfma_f32_32x32x16_bf16 a[112:127], a[232:235], v[72:75], a[112:127]
    v_exp_f32 v40, v40
    v_exp_f32 v41, v41
    v_cvt_pk_bf16_f32 v66, v36, v37
    v_exp_f32 v42, v42
    v_exp_f32 v43, v43
    v_cvt_pk_bf16_f32 v67, v38, v39
    v_mfma_f32_32x32x16_bf16 a[112:127], a[236:239], v[76:79], a[112:127]
    v_exp_f32 v44, v44
    v_exp_f32 v45, v45
    v_cvt_pk_bf16_f32 v68, v40, v41
    v_exp_f32 v46, v46
    v_exp_f32 v47, v47
    v_cvt_pk_bf16_f32 v69, v42, v43
    v_cvt_pk_bf16_f32 v70, v44, v45
    v_cvt_pk_bf16_f32 v71, v46, v47
    v_mfma_f32_32x32x16_bf16 v[32:47], a[240:243], v[0:3], 0
    v_exp_f32 v48, v48
    v_exp_f32 v49, v49
    v_exp_f32 v50, v50
    v_exp_f32 v51, v51
    v_mfma_f32_32x32x8bf16_1k v[32:47], a[244:245], v[16:17], v[32:47]
    v_exp_f32 v52, v52
    v_exp_f32 v53, v53
    v_cvt_pk_bf16_f32 v72, v48, v49
    v_exp_f32 v54, v54
    v_exp_f32 v55, v55
    v_cvt_pk_bf16_f32 v73, v50, v51
    v_mfma_f32_32x32x16_bf16 a[128:143], a[232:235], v[64:67], a[128:143]
    v_exp_f32 v56, v56
    v_exp_f32 v57, v57
    v_cvt_pk_bf16_f32 v74, v52, v53
    v_exp_f32 v58, v58
    v_exp_f32 v59, v59
    v_cvt_pk_bf16_f32 v75, v54, v55
    v_mfma_f32_32x32x16_bf16 a[128:143], a[236:239], v[68:71], a[128:143]
    v_exp_f32 v60, v60
    v_exp_f32 v61, v61
    v_cvt_pk_bf16_f32 v76, v56, v57
    v_exp_f32 v62, v62
    v_exp_f32 v63, v63
    v_cvt_pk_bf16_f32 v77, v58, v59
    v_cvt_pk_bf16_f32 v78, v60, v61
    v_cvt_pk_bf16_f32 v79, v62, v63
    buffer_load_dwordx4 v[236:239], v254, s[8:11], s37 offen offset:2048 sc1
    buffer_load_dwordx4 v[240:243], v254, s[8:11], s37 offen offset:3072 sc1
    v_mfma_f32_32x32x16_bf16 v[48:63], a[240:243], v[4:7], 0
    v_exp_f32 v32, v32
    v_exp_f32 v33, v33
    v_exp_f32 v34, v34
    v_exp_f32 v35, v35
    v_mfma_f32_32x32x8bf16_1k v[48:63], a[244:245], v[18:19], v[48:63]
    v_exp_f32 v36, v36
    v_exp_f32 v37, v37
    v_cvt_pk_bf16_f32 v64, v32, v33
    v_exp_f32 v38, v38
    v_cvt_pk_bf16_f32 v65, v34, v35
    s_waitcnt vmcnt(6)
    v_mfma_f32_32x32x16_bf16 v[176:191], v[248:251], v[216:219], v[176:191]
    v_exp_f32 v39, v39
    v_exp_f32 v40, v40
    v_cvt_pk_bf16_f32 v66, v36, v37
    v_exp_f32 v41, v41
    v_cvt_pk_bf16_f32 v67, v38, v39
    v_mfma_f32_32x32x16_bf16 a[144:159], a[232:235], v[72:75], a[144:159]
    v_exp_f32 v42, v42
    v_exp_f32 v43, v43
    v_cvt_pk_bf16_f32 v68, v40, v41
    v_exp_f32 v44, v44
    v_mfma_f32_32x32x16_bf16 a[144:159], a[236:239], v[76:79], a[144:159]
    v_exp_f32 v45, v45
    v_exp_f32 v46, v46
    v_cvt_pk_bf16_f32 v69, v42, v43
    v_exp_f32 v47, v47
    v_cvt_pk_bf16_f32 v70, v44, v45
    v_cvt_pk_bf16_f32 v71, v46, v47
    v_mfma_f32_32x32x16_bf16 v[32:47], a[240:243], v[8:11], 0
    v_exp_f32 v48, v48
    v_exp_f32 v49, v49
    v_exp_f32 v50, v50
    v_exp_f32 v51, v51
    v_mfma_f32_32x32x8bf16_1k v[32:47], a[244:245], v[20:21], v[32:47]
    v_exp_f32 v52, v52
    v_exp_f32 v53, v53
    v_cvt_pk_bf16_f32 v72, v48, v49
    v_exp_f32 v54, v54
    v_cvt_pk_bf16_f32 v73, v50, v51
    s_waitcnt vmcnt(5)
    v_mfma_f32_32x32x16_bf16 v[176:191], v[248:251], v[220:223], v[176:191]
    v_exp_f32 v55, v55
    v_exp_f32 v56, v56
    v_cvt_pk_bf16_f32 v74, v52, v53
    v_exp_f32 v57, v57
    v_cvt_pk_bf16_f32 v75, v54, v55
    v_mfma_f32_32x32x16_bf16 a[96:111], a[248:251], v[64:67], a[96:111]
    v_exp_f32 v58, v58
    v_exp_f32 v59, v59
    v_cvt_pk_bf16_f32 v76, v56, v57
    v_exp_f32 v60, v60
    v_mfma_f32_32x32x16_bf16 a[96:111], a[252:255], v[68:71], a[96:111]
    v_exp_f32 v61, v61
    v_exp_f32 v62, v62
    v_cvt_pk_bf16_f32 v77, v58, v59
    v_exp_f32 v63, v63
    v_cvt_pk_bf16_f32 v78, v60, v61
    v_cvt_pk_bf16_f32 v79, v62, v63
    v_mfma_f32_32x32x16_bf16 v[48:63], a[240:243], v[12:15], 0
    v_exp_f32 v32, v32
    v_exp_f32 v33, v33
    v_exp_f32 v34, v34
    v_exp_f32 v35, v35
    v_mfma_f32_32x32x8bf16_1k v[48:63], a[244:245], v[22:23], v[48:63]
    v_exp_f32 v36, v36
    v_exp_f32 v37, v37
    v_cvt_pk_bf16_f32 v64, v32, v33
    v_exp_f32 v38, v38
    v_cvt_pk_bf16_f32 v65, v34, v35
    s_waitcnt vmcnt(4)
    v_mfma_f32_32x32x16_bf16 v[176:191], v[248:251], v[224:227], v[176:191]
    v_exp_f32 v39, v39
    v_exp_f32 v40, v40
    v_cvt_pk_bf16_f32 v66, v36, v37
    v_exp_f32 v41, v41
    v_cvt_pk_bf16_f32 v67, v38, v39
    v_mfma_f32_32x32x16_bf16 a[112:127], a[248:251], v[72:75], a[112:127]
    v_exp_f32 v42, v42
    v_exp_f32 v43, v43
    v_cvt_pk_bf16_f32 v68, v40, v41
    v_exp_f32 v44, v44
    v_mfma_f32_32x32x16_bf16 a[112:127], a[252:255], v[76:79], a[112:127]
    v_exp_f32 v45, v45
    v_exp_f32 v46, v46
    v_cvt_pk_bf16_f32 v69, v42, v43
    v_exp_f32 v47, v47
    v_cvt_pk_bf16_f32 v70, v44, v45
    v_cvt_pk_bf16_f32 v71, v46, v47
    v_mfma_f32_32x32x16_bf16 v[32:47], a[160:163], v[0:3], 0
    v_exp_f32 v48, v48
    v_exp_f32 v49, v49
    v_exp_f32 v50, v50
    v_exp_f32 v51, v51
    v_mfma_f32_32x32x8bf16_1k v[32:47], a[164:165], v[16:17], v[32:47]
    v_exp_f32 v52, v52
    v_exp_f32 v53, v53
    v_cvt_pk_bf16_f32 v72, v48, v49
    v_exp_f32 v54, v54
    v_exp_f32 v55, v55
    v_cvt_pk_bf16_f32 v73, v50, v51
    v_mfma_f32_32x32x16_bf16 a[128:143], a[248:251], v[64:67], a[128:143]
    v_exp_f32 v56, v56
    v_exp_f32 v57, v57
    v_cvt_pk_bf16_f32 v74, v52, v53
    v_exp_f32 v58, v58
    v_exp_f32 v59, v59
    v_cvt_pk_bf16_f32 v75, v54, v55
    v_mfma_f32_32x32x16_bf16 a[128:143], a[252:255], v[68:71], a[128:143]
    v_exp_f32 v60, v60
    v_exp_f32 v61, v61
    v_cvt_pk_bf16_f32 v76, v56, v57
    v_exp_f32 v62, v62
    v_exp_f32 v63, v63
    v_cvt_pk_bf16_f32 v77, v58, v59
    v_cvt_pk_bf16_f32 v78, v60, v61
    v_cvt_pk_bf16_f32 v79, v62, v63
    v_mfma_f32_32x32x16_bf16 v[48:63], a[160:163], v[4:7], 0
    v_exp_f32 v32, v32
    v_exp_f32 v33, v33
    v_exp_f32 v34, v34
    v_exp_f32 v35, v35
    v_mfma_f32_32x32x8bf16_1k v[48:63], a[164:165], v[18:19], v[48:63]
    v_exp_f32 v36, v36
    v_exp_f32 v37, v37
    v_cvt_pk_bf16_f32 v64, v32, v33
    v_exp_f32 v38, v38
    v_cvt_pk_bf16_f32 v65, v34, v35
    s_waitcnt vmcnt(3)
    v_mfma_f32_32x32x16_bf16 v[192:207], v[244:247], v[228:231], 0
    v_exp_f32 v39, v39
    v_exp_f32 v40, v40
    v_cvt_pk_bf16_f32 v66, v36, v37
    v_exp_f32 v41, v41
    v_cvt_pk_bf16_f32 v67, v38, v39
    v_mfma_f32_32x32x16_bf16 a[144:159], a[248:251], v[72:75], a[144:159]
    v_exp_f32 v42, v42
    v_exp_f32 v43, v43
    v_cvt_pk_bf16_f32 v68, v40, v41
    v_exp_f32 v44, v44
    v_mfma_f32_32x32x16_bf16 a[144:159], a[252:255], v[76:79], a[144:159]
    v_exp_f32 v45, v45
    v_exp_f32 v46, v46
    v_cvt_pk_bf16_f32 v69, v42, v43
    v_exp_f32 v47, v47
    v_cvt_pk_bf16_f32 v70, v44, v45
    v_cvt_pk_bf16_f32 v71, v46, v47
    v_mfma_f32_32x32x16_bf16 v[32:47], a[160:163], v[8:11], 0
    v_exp_f32 v48, v48
    v_exp_f32 v49, v49
    v_exp_f32 v50, v50
    v_exp_f32 v51, v51
    v_mfma_f32_32x32x8bf16_1k v[32:47], a[164:165], v[20:21], v[32:47]
    v_exp_f32 v52, v52
    v_exp_f32 v53, v53
    v_cvt_pk_bf16_f32 v72, v48, v49
    v_exp_f32 v54, v54
    v_cvt_pk_bf16_f32 v73, v50, v51
    s_waitcnt vmcnt(2)
    v_mfma_f32_32x32x16_bf16 v[192:207], v[244:247], v[232:235], v[192:207]
    v_exp_f32 v55, v55
    v_exp_f32 v56, v56
    v_cvt_pk_bf16_f32 v74, v52, v53
    v_exp_f32 v57, v57
    v_cvt_pk_bf16_f32 v75, v54, v55
    v_mfma_f32_32x32x16_bf16 a[96:111], a[168:171], v[64:67], a[96:111]
    v_exp_f32 v58, v58
    v_exp_f32 v59, v59
    v_cvt_pk_bf16_f32 v76, v56, v57
    v_exp_f32 v60, v60
    v_mfma_f32_32x32x16_bf16 a[96:111], a[172:175], v[68:71], a[96:111]
    v_exp_f32 v61, v61
    v_exp_f32 v62, v62
    v_cvt_pk_bf16_f32 v77, v58, v59
    v_exp_f32 v63, v63
    v_cvt_pk_bf16_f32 v78, v60, v61
    v_cvt_pk_bf16_f32 v79, v62, v63
    v_mfma_f32_32x32x16_bf16 v[48:63], a[160:163], v[12:15], 0
    v_exp_f32 v32, v32
    v_exp_f32 v33, v33
    v_exp_f32 v34, v34
    v_exp_f32 v35, v35
    v_mfma_f32_32x32x8bf16_1k v[48:63], a[164:165], v[22:23], v[48:63]
    v_exp_f32 v36, v36
    v_exp_f32 v37, v37
    v_cvt_pk_bf16_f32 v64, v32, v33
    v_exp_f32 v38, v38
    v_exp_f32 v39, v39
    v_cvt_pk_bf16_f32 v65, v34, v35
    v_mfma_f32_32x32x16_bf16 a[112:127], a[168:171], v[72:75], a[112:127]
    v_exp_f32 v40, v40
    v_exp_f32 v41, v41
    v_cvt_pk_bf16_f32 v66, v36, v37
    v_exp_f32 v42, v42
    v_exp_f32 v43, v43
    v_cvt_pk_bf16_f32 v67, v38, v39
    v_mfma_f32_32x32x16_bf16 a[112:127], a[172:175], v[76:79], a[112:127]
    v_exp_f32 v44, v44
    v_exp_f32 v45, v45
    v_cvt_pk_bf16_f32 v68, v40, v41
    v_exp_f32 v46, v46
    v_exp_f32 v47, v47
    v_cvt_pk_bf16_f32 v69, v42, v43
    v_cvt_pk_bf16_f32 v70, v44, v45
    v_cvt_pk_bf16_f32 v71, v46, v47
    v_mfma_f32_32x32x16_bf16 v[32:47], a[176:179], v[0:3], 0
    v_exp_f32 v48, v48
    v_exp_f32 v49, v49
    v_exp_f32 v50, v50
    v_exp_f32 v51, v51
    v_mfma_f32_32x32x8bf16_1k v[32:47], a[180:181], v[16:17], v[32:47]
    v_exp_f32 v52, v52
    v_exp_f32 v53, v53
    v_cvt_pk_bf16_f32 v72, v48, v49
    v_exp_f32 v54, v54
    v_exp_f32 v55, v55
    v_cvt_pk_bf16_f32 v73, v50, v51
    v_mfma_f32_32x32x16_bf16 a[128:143], a[168:171], v[64:67], a[128:143]
    v_exp_f32 v56, v56
    v_exp_f32 v57, v57
    v_cvt_pk_bf16_f32 v74, v52, v53
    v_exp_f32 v58, v58
    v_exp_f32 v59, v59
    v_cvt_pk_bf16_f32 v75, v54, v55
    v_mfma_f32_32x32x16_bf16 a[128:143], a[172:175], v[68:71], a[128:143]
    v_exp_f32 v60, v60
    v_exp_f32 v61, v61
    v_cvt_pk_bf16_f32 v76, v56, v57
    v_exp_f32 v62, v62
    v_exp_f32 v63, v63
    v_cvt_pk_bf16_f32 v77, v58, v59
    v_cvt_pk_bf16_f32 v78, v60, v61
    v_cvt_pk_bf16_f32 v79, v62, v63
    v_mfma_f32_32x32x16_bf16 v[48:63], a[176:179], v[4:7], 0
    v_exp_f32 v32, v32
    v_exp_f32 v33, v33
    v_exp_f32 v34, v34
    v_exp_f32 v35, v35
    v_mfma_f32_32x32x8bf16_1k v[48:63], a[180:181], v[18:19], v[48:63]
    v_exp_f32 v36, v36
    v_exp_f32 v37, v37
    v_cvt_pk_bf16_f32 v64, v32, v33
    v_exp_f32 v38, v38
    v_cvt_pk_bf16_f32 v65, v34, v35
    s_waitcnt vmcnt(1)
    v_mfma_f32_32x32x16_bf16 v[192:207], v[244:247], v[236:239], v[192:207]
    v_exp_f32 v39, v39
    v_exp_f32 v40, v40
    v_cvt_pk_bf16_f32 v66, v36, v37
    v_exp_f32 v41, v41
    v_cvt_pk_bf16_f32 v67, v38, v39
    v_mfma_f32_32x32x16_bf16 a[144:159], a[168:171], v[72:75], a[144:159]
    v_exp_f32 v42, v42
    v_exp_f32 v43, v43
    v_cvt_pk_bf16_f32 v68, v40, v41
    v_exp_f32 v44, v44
    v_mfma_f32_32x32x16_bf16 a[144:159], a[172:175], v[76:79], a[144:159]
    v_exp_f32 v45, v45
    v_exp_f32 v46, v46
    v_cvt_pk_bf16_f32 v69, v42, v43
    v_exp_f32 v47, v47
    v_cvt_pk_bf16_f32 v70, v44, v45
    v_cvt_pk_bf16_f32 v71, v46, v47
    v_mfma_f32_32x32x16_bf16 v[32:47], a[176:179], v[8:11], 0
    v_exp_f32 v48, v48
    v_exp_f32 v49, v49
    v_exp_f32 v50, v50
    v_exp_f32 v51, v51
    v_mfma_f32_32x32x8bf16_1k v[32:47], a[180:181], v[20:21], v[32:47]
    v_exp_f32 v52, v52
    v_exp_f32 v53, v53
    v_cvt_pk_bf16_f32 v72, v48, v49
    v_exp_f32 v54, v54
    v_cvt_pk_bf16_f32 v73, v50, v51
    s_waitcnt vmcnt(0)
    v_mfma_f32_32x32x16_bf16 v[192:207], v[244:247], v[240:243], v[192:207]
    v_exp_f32 v55, v55
    v_exp_f32 v56, v56
    v_cvt_pk_bf16_f32 v74, v52, v53
    v_exp_f32 v57, v57
    v_cvt_pk_bf16_f32 v75, v54, v55
    v_mfma_f32_32x32x16_bf16 a[96:111], a[184:187], v[64:67], a[96:111]
    v_exp_f32 v58, v58
    v_exp_f32 v59, v59
    v_cvt_pk_bf16_f32 v76, v56, v57
    v_exp_f32 v60, v60
    v_mfma_f32_32x32x16_bf16 a[96:111], a[188:191], v[68:71], a[96:111]
    v_exp_f32 v61, v61
    v_exp_f32 v62, v62
    v_cvt_pk_bf16_f32 v77, v58, v59
    v_exp_f32 v63, v63
    v_cvt_pk_bf16_f32 v78, v60, v61
    v_cvt_pk_bf16_f32 v79, v62, v63
    v_mfma_f32_32x32x16_bf16 v[48:63], a[176:179], v[12:15], 0
    v_exp_f32 v32, v32
    v_exp_f32 v33, v33
    v_exp_f32 v34, v34
    v_exp_f32 v35, v35
    v_mfma_f32_32x32x8bf16_1k v[48:63], a[180:181], v[22:23], v[48:63]
    v_exp_f32 v36, v36
    v_exp_f32 v37, v37
    v_cvt_pk_bf16_f32 v64, v32, v33
    v_exp_f32 v38, v38
    v_exp_f32 v39, v39
    v_cvt_pk_bf16_f32 v65, v34, v35
    v_mfma_f32_32x32x16_bf16 a[112:127], a[184:187], v[72:75], a[112:127]
    v_exp_f32 v40, v40
    v_exp_f32 v41, v41
    v_cvt_pk_bf16_f32 v66, v36, v37
    v_exp_f32 v42, v42
    v_exp_f32 v43, v43
    v_cvt_pk_bf16_f32 v67, v38, v39
    v_mfma_f32_32x32x16_bf16 a[112:127], a[188:191], v[76:79], a[112:127]
    v_exp_f32 v44, v44
    v_exp_f32 v45, v45
    v_cvt_pk_bf16_f32 v68, v40, v41
    v_exp_f32 v46, v46
    v_exp_f32 v47, v47
    v_cvt_pk_bf16_f32 v69, v42, v43
    v_cvt_pk_bf16_f32 v70, v44, v45
    v_cvt_pk_bf16_f32 v71, v46, v47
    v_exp_f32 v48, v48
    v_exp_f32 v49, v49
    v_exp_f32 v50, v50
    v_exp_f32 v51, v51
    v_exp_f32 v52, v52
    v_exp_f32 v53, v53
    v_cvt_pk_bf16_f32 v72, v48, v49
    v_exp_f32 v54, v54
    v_exp_f32 v55, v55
    v_cvt_pk_bf16_f32 v73, v50, v51
    v_mfma_f32_32x32x16_bf16 a[128:143], a[184:187], v[64:67], a[128:143]
    v_exp_f32 v56, v56
    v_exp_f32 v57, v57
    v_cvt_pk_bf16_f32 v74, v52, v53
    v_exp_f32 v58, v58
    v_exp_f32 v59, v59
    v_cvt_pk_bf16_f32 v75, v54, v55
    v_mfma_f32_32x32x16_bf16 a[128:143], a[188:191], v[68:71], a[128:143]
    v_exp_f32 v60, v60
    v_exp_f32 v61, v61
    v_cvt_pk_bf16_f32 v76, v56, v57
    v_exp_f32 v62, v62
    v_exp_f32 v63, v63
    v_cvt_pk_bf16_f32 v77, v58, v59
    v_cvt_pk_bf16_f32 v78, v60, v61
    v_cvt_pk_bf16_f32 v79, v62, v63
    s_nop 1
    v_mfma_f32_32x32x16_bf16 a[144:159], a[184:187], v[72:75], a[144:159]
    v_mfma_f32_32x32x16_bf16 a[144:159], a[188:191], v[76:79], a[144:159]
    s_mul_i32 s76, s40, 6144
    s_add_u32 s76, s76, 98304
    v_add_u32 v100, s76, v254
    s_xor_b32 s77, s40, 1
    s_mul_i32 s77, s77, 6144
    s_add_u32 s77, s77, 98304
    v_add_u32 v101, s77, v254
    s_nop 8
    s_cmp_eq_u32 s68, 0
    s_cbranch_scc0 parallel_sum__softmax_full_mha__dense_activation_relu__prompt_kernel_mrg1
    ds_write_b128 v100, a[128:131] offset:0
    ds_write_b128 v100, a[132:135] offset:1024
    ds_write_b128 v100, a[136:139] offset:2048
    ds_write_b128 v100, a[144:147] offset:3072
    ds_write_b128 v100, a[148:151] offset:4096
    ds_write_b128 v100, a[152:155] offset:5120
    v_accvgpr_read_b32 v64, a96
    v_accvgpr_read_b32 v65, a97
    v_accvgpr_read_b32 v66, a98
    v_accvgpr_read_b32 v67, a99
    v_accvgpr_read_b32 v68, a100
    v_accvgpr_read_b32 v69, a101
    v_accvgpr_read_b32 v70, a102
    v_accvgpr_read_b32 v71, a103
    v_accvgpr_read_b32 v72, a104
    v_accvgpr_read_b32 v73, a105
    v_accvgpr_read_b32 v74, a106
    v_accvgpr_read_b32 v80, a112
    v_accvgpr_read_b32 v81, a113
    v_accvgpr_read_b32 v82, a114
    v_accvgpr_read_b32 v83, a115
    v_accvgpr_read_b32 v84, a116
    v_accvgpr_read_b32 v85, a117
    v_accvgpr_read_b32 v86, a118
    v_accvgpr_read_b32 v87, a119
    v_accvgpr_read_b32 v88, a120
    v_accvgpr_read_b32 v89, a121
    v_accvgpr_read_b32 v90, a122
    s_branch parallel_sum__softmax_full_mha__dense_activation_relu__prompt_kernel_mrg2
parallel_sum__softmax_full_mha__dense_activation_relu__prompt_kernel_mrg1:
    ds_write_b128 v100, a[96:99] offset:0
    ds_write_b128 v100, a[100:103] offset:1024
    ds_write_b128 v100, a[104:107] offset:2048
    ds_write_b128 v100, a[112:115] offset:3072
    ds_write_b128 v100, a[116:119] offset:4096
    ds_write_b128 v100, a[120:123] offset:5120
    v_accvgpr_read_b32 v64, a128
    v_accvgpr_read_b32 v65, a129
    v_accvgpr_read_b32 v66, a130
    v_accvgpr_read_b32 v67, a131
    v_accvgpr_read_b32 v68, a132
    v_accvgpr_read_b32 v69, a133
    v_accvgpr_read_b32 v70, a134
    v_accvgpr_read_b32 v71, a135
    v_accvgpr_read_b32 v72, a136
    v_accvgpr_read_b32 v73, a137
    v_accvgpr_read_b32 v74, a138
    v_accvgpr_read_b32 v80, a144
    v_accvgpr_read_b32 v81, a145
    v_accvgpr_read_b32 v82, a146
    v_accvgpr_read_b32 v83, a147
    v_accvgpr_read_b32 v84, a148
    v_accvgpr_read_b32 v85, a149
    v_accvgpr_read_b32 v86, a150
    v_accvgpr_read_b32 v87, a151
    v_accvgpr_read_b32 v88, a152
    v_accvgpr_read_b32 v89, a153
    v_accvgpr_read_b32 v90, a154
parallel_sum__softmax_full_mha__dense_activation_relu__prompt_kernel_mrg2:
    s_waitcnt lgkmcnt(0)
    s_barrier
    ds_read_b128 v[32:35], v101 offset:0
    ds_read_b128 v[36:39], v101 offset:1024
    ds_read_b128 v[40:43], v101 offset:2048
    ds_read_b128 v[44:47], v101 offset:3072
    ds_read_b128 v[48:51], v101 offset:4096
    ds_read_b128 v[52:55], v101 offset:5120
    s_waitcnt lgkmcnt(0)
    v_add_f32 v64, v64, v32
    v_add_f32 v65, v65, v33
    v_add_f32 v66, v66, v34
    v_add_f32 v67, v67, v35
    v_add_f32 v68, v68, v36
    v_add_f32 v69, v69, v37
    v_add_f32 v70, v70, v38
    v_add_f32 v71, v71, v39
    v_add_f32 v72, v72, v40
    v_add_f32 v73, v73, v41
    v_add_f32 v74, v74, v42
    v_add_f32 v80, v80, v44
    v_add_f32 v81, v81, v45
    v_add_f32 v82, v82, v46
    v_add_f32 v83, v83, v47
    v_add_f32 v84, v84, v48
    v_add_f32 v85, v85, v49
    v_add_f32 v86, v86, v50
    v_add_f32 v87, v87, v51
    v_add_f32 v88, v88, v52
    v_add_f32 v89, v89, v53
    v_add_f32 v90, v90, v54
    v_max3_f32 v115, |v64|, |v65|, |v66|
    v_max3_f32 v115, v115, |v67|, |v68|
    v_max3_f32 v115, v115, |v69|, |v70|
    v_max3_f32 v115, v115, |v71|, |v72|
    v_max_f32 v115, v115, |v73|
    v_max3_f32 v116, |v80|, |v81|, |v82|
    v_max3_f32 v116, v116, |v83|, |v84|
    v_max3_f32 v116, v116, |v85|, |v86|
    v_max3_f32 v116, v116, |v87|, |v88|
    v_max_f32 v116, v116, |v89|
    v_max_f32 v115, v115, v116
    v_mov_b32 v113, 0x7e800000
    v_mov_b32 v114, 0x71800000
    v_cmp_lt_f32 vcc, v115, v113
    v_cmp_lt_f32 s[76:77], v74, v114
    s_and_b64 vcc, vcc, s[76:77]
    v_cmp_lt_f32 s[76:77], v90, v114
    s_and_b64 vcc, vcc, s[76:77]
    s_cmp_eq_u64 vcc, -1
    s_cbranch_scc0 parallel_sum__softmax_full_mha__dense_activation_relu__prompt_kernel_fallback
parallel_sum__softmax_full_mha__dense_activation_relu__prompt_kernel_afinish:
    s_lshl_b32 s62, s70, 15
    s_lshl_b32 s64, s69, 10
    s_add_u32 s62, s62, s64
    s_add_u32 s62, s62, 7077888
    s_lshl_b32 s64, s70, 12
    s_lshr_b32 s63, s69, 2
    s_lshl_b32 s63, s63, 9
    s_add_u32 s64, s64, s63
    s_and_b32 s63, s69, 3
    s_lshl_b32 s63, s63, 2
    s_add_u32 s64, s64, s63
    s_add_u32 s64, s64, 9175040
    v_and_b32 v116, 31, v255
    v_lshlrev_b32 v116, 4, v116
    v_mov_b32 v113, v74
    v_mov_b32 v114, v74
    s_nop 1
    v_permlane32_swap_b32 v113, v114
    s_nop 1
    v_rcp_f32 v113, v113
    s_nop 0
    v_mul_f32 v64, v113, v64
    v_mul_f32 v65, v113, v65
    v_mul_f32 v66, v113, v66
    v_mul_f32 v67, v113, v67
    v_mul_f32 v68, v113, v68
    v_mul_f32 v69, v113, v69
    v_mul_f32 v70, v113, v70
    v_mul_f32 v71, v113, v71
    v_mul_f32 v72, v113, v72
    v_mul_f32 v73, v113, v73
    v_cvt_pk_bf16_f32 v48, v64, v65
    v_cvt_pk_bf16_f32 v49, v66, v67
    v_cvt_pk_bf16_f32 v50, v68, v69
    v_cvt_pk_bf16_f32 v51, v70, v71
    v_cvt_pk_bf16_f32 v52, v72, v73
    buffer_store_dwordx4 v[48:51], v254, s[8:11], s62 offen sc1
    s_mov_b64 exec, s[74:75]
    buffer_store_dword v52, v116, s[8:11], s64 offen sc1
    s_mov_b64 exec, -1
    s_add_u32 s62, s62, 32768
    s_add_u32 s64, s64, 4096
    v_mov_b32 v113, v90
    v_mov_b32 v114, v90
    s_nop 1
    v_permlane32_swap_b32 v113, v114
    s_nop 1
    v_rcp_f32 v113, v113
    s_nop 0
    v_mul_f32 v80, v113, v80
    v_mul_f32 v81, v113, v81
    v_mul_f32 v82, v113, v82
    v_mul_f32 v83, v113, v83
    v_mul_f32 v84, v113, v84
    v_mul_f32 v85, v113, v85
    v_mul_f32 v86, v113, v86
    v_mul_f32 v87, v113, v87
    v_mul_f32 v88, v113, v88
    v_mul_f32 v89, v113, v89
    v_cvt_pk_bf16_f32 v56, v80, v81
    v_cvt_pk_bf16_f32 v57, v82, v83
    v_cvt_pk_bf16_f32 v58, v84, v85
    v_cvt_pk_bf16_f32 v59, v86, v87
    v_cvt_pk_bf16_f32 v60, v88, v89
    buffer_store_dwordx4 v[56:59], v254, s[8:11], s62 offen sc1
    s_mov_b64 exec, s[74:75]
    buffer_store_dword v60, v116, s[8:11], s64 offen sc1
    s_mov_b64 exec, -1
    s_load_dwordx2 s[4:5], s[0:1], 48
    s_waitcnt lgkmcnt(0)
    s_mov_b32 s16, s4
    s_mov_b32 s17, s5
    s_mov_b32 s18, 2359296
    s_mov_b32 s19, 0x20000
    s_mul_i32 s35, s32, 36864
    s_mul_i32 s58, s33, 288
    s_add_u32 s35, s35, s58
    s_lshl_b32 s56, s40, 6
    v_add_u32 v16, s56, v255
    v_add_u32 v17, 0, v16
    v_min_u32 v17, 575, v17
    v_mul_u32_u24 v18, 3641, v17
    v_lshrrev_b32 v18, 16, v18
    v_mul_u32_u24 v19, 18, v18
    v_sub_u32 v19, v17, v19
    v_mul_u32_u24 v47, 592, v18
    v_lshl_add_u32 v47, v19, 5, v47
    v_mul_u32_u24 v44, 1152, v18
    v_lshl_add_u32 v44, v19, 4, v44
    buffer_load_dwordx4 v[32:35], v44, s[12:15], s35 offen
    v_add_u32 v17, 256, v16
    v_min_u32 v17, 575, v17
    v_mul_u32_u24 v18, 3641, v17
    v_lshrrev_b32 v18, 16, v18
    v_mul_u32_u24 v19, 18, v18
    v_sub_u32 v19, v17, v19
    v_mul_u32_u24 v48, 592, v18
    v_lshl_add_u32 v48, v19, 5, v48
    v_mul_u32_u24 v45, 1152, v18
    v_lshl_add_u32 v45, v19, 4, v45
    buffer_load_dwordx4 v[36:39], v45, s[12:15], s35 offen
    v_add_u32 v17, 512, v16
    v_min_u32 v17, 575, v17
    v_mul_u32_u24 v18, 3641, v17
    v_lshrrev_b32 v18, 16, v18
    v_mul_u32_u24 v19, 18, v18
    v_sub_u32 v19, v17, v19
    v_mul_u32_u24 v49, 592, v18
    v_lshl_add_u32 v49, v19, 5, v49
    v_mul_u32_u24 v46, 1152, v18
    v_lshl_add_u32 v46, v19, 4, v46
    buffer_load_dwordx4 v[40:43], v46, s[12:15], s35 offen
    s_waitcnt vmcnt(3)
    s_mov_b32 s3, 0
parallel_sum__softmax_full_mha__dense_activation_relu__prompt_kernel_poll_o:
    s_lshl_b32 s56, s32, 15
    s_lshl_b32 s57, s40, 13
    s_add_u32 s56, s56, s57
    s_add_u32 s56, s56, 7077888
    buffer_load_dwordx4 v[208:211], v254, s[8:11], s56 offen offset:0 sc1
    buffer_load_dwordx4 v[212:215], v254, s[8:11], s56 offen offset:1024 sc1
    buffer_load_dwordx4 v[216:219], v254, s[8:11], s56 offen offset:2048 sc1
    buffer_load_dwordx4 v[220:223], v254, s[8:11], s56 offen offset:3072 sc1
    s_add_u32 s56, s56, 4096
    buffer_load_dwordx4 v[224:227], v254, s[8:11], s56 offen offset:0 sc1
    buffer_load_dwordx4 v[228:231], v254, s[8:11], s56 offen offset:1024 sc1
    buffer_load_dwordx4 v[232:235], v254, s[8:11], s56 offen offset:2048 sc1
    buffer_load_dwordx4 v[236:239], v254, s[8:11], s56 offen offset:3072 sc1
    s_lshl_b32 s56, s32, 12
    s_lshl_b32 s57, s40, 10
    s_add_u32 s56, s56, s57
    s_add_u32 s56, s56, 9175040
    buffer_load_dwordx4 v[240:243], v254, s[8:11], s56 offen sc1
    s_waitcnt vmcnt(0)
    v_max3_u32 v16, v208, v209, v210
    v_max3_u32 v16, v16, v211, v212
    v_max3_u32 v16, v16, v213, v214
    v_max3_u32 v16, v16, v215, v216
    v_max3_u32 v16, v16, v217, v218
    v_max3_u32 v16, v16, v219, v220
    v_max3_u32 v16, v16, v221, v222
    v_max3_u32 v16, v16, v223, v224
    v_max3_u32 v16, v16, v225, v226
    v_max3_u32 v16, v16, v227, v228
    v_max3_u32 v16, v16, v229, v230
    v_max3_u32 v16, v16, v231, v232
    v_max3_u32 v16, v16, v233, v234
    v_max3_u32 v16, v16, v235, v236
    v_max3_u32 v16, v16, v237, v238
    v_max3_u32 v16, v16, v239, v240
    v_max3_u32 v16, v16, v241, v242
    v_max_u32 v16, v16, v243
    v_cmp_ne_u32 vcc, -1, v16
    s_add_u32 s3, s3, 1
    s_cmp_eq_u64 vcc, -1
    s_cbranch_scc1 parallel_sum__softmax_full_mha__dense_activation_relu__prompt_kernel_o_ready
    s_cmp_lt_u32 s3, 20000
    s_cbranch_scc1 parallel_sum__softmax_full_mha__dense_activation_relu__prompt_kernel_poll_o
parallel_sum__softmax_full_mha__dense_activation_relu__prompt_kernel_o_ready:
    s_mul_i32 s56, s40, 21504
    s_add_u32 s56, s56, 4096
    v_add_u32 v252, s56, v254
    ds_read_b128 v[52:55], v252 offset:0
    ds_read_b128 v[56:59], v252 offset:1024
    ds_read_b128 v[60:63], v252 offset:2048
    ds_read_b128 v[64:67], v252 offset:3072
    ds_read_b128 v[68:71], v252 offset:4096
    v_mfma_f32_32x32x16_bf16 v[128:143], a[20:23], v[208:211], v[128:143]
    v_mfma_f32_32x32x16_bf16 v[128:143], a[24:27], v[212:215], v[128:143]
    v_mfma_f32_32x32x16_bf16 v[128:143], a[28:31], v[216:219], v[128:143]
    v_mfma_f32_32x32x16_bf16 v[128:143], a[32:35], v[220:223], v[128:143]
    v_mfma_f32_32x32x16_bf16 v[144:159], a[36:39], v[208:211], v[144:159]
    v_mfma_f32_32x32x16_bf16 v[144:159], a[40:43], v[212:215], v[144:159]
    v_mfma_f32_32x32x16_bf16 v[144:159], a[44:47], v[216:219], v[144:159]
    v_mfma_f32_32x32x16_bf16 v[144:159], a[48:51], v[220:223], v[144:159]
    v_mfma_f32_32x32x16_bf16 v[160:175], a[52:55], v[208:211], v[160:175]
    v_mfma_f32_32x32x16_bf16 v[160:175], a[56:59], v[212:215], v[160:175]
    v_mfma_f32_32x32x16_bf16 v[160:175], a[60:63], v[216:219], v[160:175]
    v_mfma_f32_32x32x16_bf16 v[160:175], a[64:67], v[220:223], v[160:175]
    v_mfma_f32_32x32x16_bf16 v[176:191], a[68:71], v[208:211], v[176:191]
    v_mfma_f32_32x32x16_bf16 v[176:191], a[72:75], v[212:215], v[176:191]
    v_mfma_f32_32x32x16_bf16 v[176:191], a[76:79], v[216:219], v[176:191]
    v_mfma_f32_32x32x16_bf16 v[176:191], a[80:83], v[220:223], v[176:191]
    v_mfma_f32_32x32x16_bf16 v[192:207], a[84:87], v[208:211], v[192:207]
    v_mfma_f32_32x32x16_bf16 v[192:207], a[88:91], v[212:215], v[192:207]
    v_mfma_f32_32x32x16_bf16 v[192:207], a[92:95], v[216:219], v[192:207]
    ds_read_b128 v[72:75], v252 offset:5120
    s_waitcnt lgkmcnt(5)
    v_mfma_f32_32x32x16_bf16 v[192:207], v[52:55], v[220:223], v[192:207]
    ds_read_b128 v[52:55], v252 offset:6144
    s_waitcnt lgkmcnt(5)
    v_mfma_f32_32x32x16_bf16 v[128:143], v[56:59], v[224:227], v[128:143]
    ds_read_b128 v[56:59], v252 offset:7168
    s_waitcnt lgkmcnt(5)
    v_mfma_f32_32x32x16_bf16 v[128:143], v[60:63], v[228:231], v[128:143]
    ds_read_b128 v[60:63], v252 offset:8192
    s_waitcnt lgkmcnt(5)
    v_mfma_f32_32x32x16_bf16 v[128:143], v[64:67], v[232:235], v[128:143]
    ds_read_b128 v[64:67], v252 offset:9216
    s_waitcnt lgkmcnt(5)
    v_mfma_f32_32x32x16_bf16 v[128:143], v[68:71], v[236:239], v[128:143]
    ds_read_b128 v[68:71], v252 offset:10240
    s_waitcnt lgkmcnt(5)
    v_mfma_f32_32x32x16_bf16 v[144:159], v[72:75], v[224:227], v[144:159]
    ds_read_b128 v[72:75], v252 offset:11264
    s_waitcnt lgkmcnt(5)
    v_mfma_f32_32x32x16_bf16 v[144:159], v[52:55], v[228:231], v[144:159]
    ds_read_b128 v[52:55], v252 offset:12288
    s_waitcnt lgkmcnt(5)
    v_mfma_f32_32x32x16_bf16 v[144:159], v[56:59], v[232:235], v[144:159]
    ds_read_b128 v[56:59], v252 offset:13312
    s_waitcnt lgkmcnt(5)
    v_mfma_f32_32x32x16_bf16 v[144:159], v[60:63], v[236:239], v[144:159]
    ds_read_b128 v[60:63], v252 offset:14336
    s_waitcnt lgkmcnt(5)
    v_mfma_f32_32x32x16_bf16 v[160:175], v[64:67], v[224:227], v[160:175]
    ds_read_b128 v[64:67], v252 offset:15360
    s_waitcnt lgkmcnt(5)
    v_mfma_f32_32x32x16_bf16 v[160:175], v[68:71], v[228:231], v[160:175]
    ds_read_b128 v[68:71], v252 offset:16384
    s_waitcnt lgkmcnt(5)
    v_mfma_f32_32x32x16_bf16 v[160:175], v[72:75], v[232:235], v[160:175]
    ds_read_b128 v[72:75], v252 offset:17408
    s_waitcnt lgkmcnt(5)
    v_mfma_f32_32x32x16_bf16 v[160:175], v[52:55], v[236:239], v[160:175]
    ds_read_b128 v[52:55], v252 offset:18432
    s_waitcnt lgkmcnt(5)
    v_mfma_f32_32x32x16_bf16 v[176:191], v[56:59], v[224:227], v[176:191]
    ds_read_b128 v[56:59], v252 offset:19456
    s_waitcnt lgkmcnt(5)
    v_mfma_f32_32x32x16_bf16 v[176:191], v[60:63], v[228:231], v[176:191]
    ds_read_b128 v[60:63], v252 offset:20480
    s_waitcnt lgkmcnt(5)
    v_mfma_f32_32x32x16_bf16 v[176:191], v[64:67], v[232:235], v[176:191]
    s_waitcnt lgkmcnt(4)
    v_mfma_f32_32x32x16_bf16 v[176:191], v[68:71], v[236:239], v[176:191]
    s_waitcnt lgkmcnt(3)
    v_mfma_f32_32x32x16_bf16 v[192:207], v[72:75], v[224:227], v[192:207]
    s_waitcnt lgkmcnt(2)
    v_mfma_f32_32x32x16_bf16 v[192:207], v[52:55], v[228:231], v[192:207]
    s_waitcnt lgkmcnt(1)
    v_mfma_f32_32x32x16_bf16 v[192:207], v[56:59], v[232:235], v[192:207]
    s_waitcnt lgkmcnt(0)
    v_mfma_f32_32x32x16_bf16 v[192:207], v[60:63], v[236:239], v[192:207]
    s_waitcnt vmcnt(0)
    v_mfma_f32_32x32x16_bf16 v[128:143], a[0:3], v[240:243], v[128:143]
    v_mfma_f32_32x32x16_bf16 v[144:159], a[4:7], v[240:243], v[144:159]
    v_mfma_f32_32x32x16_bf16 v[160:175], a[8:11], v[240:243], v[160:175]
    v_mfma_f32_32x32x16_bf16 v[176:191], a[12:15], v[240:243], v[176:191]
    v_mfma_f32_32x32x16_bf16 v[192:207], a[16:19], v[240:243], v[192:207]
    v_and_b32 v16, 31, v255
    v_lshrrev_b32 v17, 5, v255
    v_mul_u32_u24 v18, 592, v16
    v_lshl_add_u32 v18, v17, 4, v18
    s_mul_i32 s56, s40, 18944
    v_add_u32 v18, s56, v18
    s_barrier
    s_nop 6
    ds_write_b128 v18, v[128:131] offset:0
    ds_write_b128 v18, v[132:135] offset:32
    ds_write_b128 v18, v[136:139] offset:64
    ds_write_b128 v18, v[140:143] offset:96
    ds_write_b128 v18, v[144:147] offset:128
    ds_write_b128 v18, v[148:151] offset:160
    ds_write_b128 v18, v[152:155] offset:192
    ds_write_b128 v18, v[156:159] offset:224
    ds_write_b128 v18, v[160:163] offset:256
    ds_write_b128 v18, v[164:167] offset:288
    ds_write_b128 v18, v[168:171] offset:320
    ds_write_b128 v18, v[172:175] offset:352
    ds_write_b128 v18, v[176:179] offset:384
    ds_write_b128 v18, v[180:183] offset:416
    ds_write_b128 v18, v[184:187] offset:448
    ds_write_b128 v18, v[188:191] offset:480
    ds_write_b128 v18, v[192:195] offset:512
    ds_write_b128 v18, v[196:199] offset:544
    s_waitcnt lgkmcnt(0)
    s_barrier
    ds_read_b128 v[128:131], v47 offset:0
    ds_read_b128 v[132:135], v47 offset:16
    ds_read_b128 v[136:139], v47 offset:18944
    ds_read_b128 v[140:143], v47 offset:18960
    ds_read_b128 v[144:147], v47 offset:37888
    ds_read_b128 v[148:151], v47 offset:37904
    ds_read_b128 v[152:155], v47 offset:56832
    ds_read_b128 v[156:159], v47 offset:56848
    ds_read_b128 v[160:163], v48 offset:0
    ds_read_b128 v[164:167], v48 offset:16
    ds_read_b128 v[168:171], v48 offset:18944
    ds_read_b128 v[172:175], v48 offset:18960
    ds_read_b128 v[176:179], v48 offset:37888
    ds_read_b128 v[180:183], v48 offset:37904
    ds_read_b128 v[184:187], v48 offset:56832
    ds_read_b128 v[188:191], v48 offset:56848
    s_waitcnt lgkmcnt(8)
    v_add_f32 v128, v128, v136
    v_add_f32 v144, v144, v152
    v_add_f32 v129, v129, v137
    v_add_f32 v145, v145, v153
    v_add_f32 v130, v130, v138
    v_add_f32 v146, v146, v154
    v_add_f32 v131, v131, v139
    v_add_f32 v147, v147, v155
    v_add_f32 v132, v132, v140
    v_add_f32 v148, v148, v156
    v_add_f32 v133, v133, v141
    v_add_f32 v149, v149, v157
    v_add_f32 v134, v134, v142
    v_add_f32 v150, v150, v158
    v_add_f32 v135, v135, v143
    v_add_f32 v151, v151, v159
    v_lshlrev_b32 v16, 16, v32
    v_and_b32 v17, 0xffff0000, v32
    v_add_f32 v144, v144, v16
    v_add_f32 v145, v145, v17
    v_lshlrev_b32 v16, 16, v33
    v_and_b32 v17, 0xffff0000, v33
    v_add_f32 v146, v146, v16
    v_add_f32 v147, v147, v17
    v_lshlrev_b32 v16, 16, v34
    v_and_b32 v17, 0xffff0000, v34
    v_add_f32 v148, v148, v16
    v_add_f32 v149, v149, v17
    v_lshlrev_b32 v16, 16, v35
    v_and_b32 v17, 0xffff0000, v35
    v_add_f32 v150, v150, v16
    v_add_f32 v151, v151, v17
    v_add_f32 v128, v128, v144
    v_add_f32 v129, v129, v145
    v_add_f32 v130, v130, v146
    v_add_f32 v131, v131, v147
    v_add_f32 v132, v132, v148
    v_add_f32 v133, v133, v149
    v_add_f32 v134, v134, v150
    v_add_f32 v135, v135, v151
    v_cvt_pk_bf16_f32 v20, v128, v129
    v_cvt_pk_bf16_f32 v21, v130, v131
    v_cvt_pk_bf16_f32 v22, v132, v133
    v_cvt_pk_bf16_f32 v23, v134, v135
    buffer_store_dwordx4 v[20:23], v44, s[16:19], s35 offen
    s_cmp_lg_u32 s40, 0
    s_cbranch_scc1 parallel_sum__softmax_full_mha__dense_activation_relu__prompt_kernel_last
    ds_read_b128 v[128:131], v49 offset:0
    ds_read_b128 v[132:135], v49 offset:16
    ds_read_b128 v[136:139], v49 offset:18944
    ds_read_b128 v[140:143], v49 offset:18960
    ds_read_b128 v[144:147], v49 offset:37888
    ds_read_b128 v[148:151], v49 offset:37904
    ds_read_b128 v[152:155], v49 offset:56832
    ds_read_b128 v[156:159], v49 offset:56848
    s_waitcnt lgkmcnt(8)
    v_add_f32 v160, v160, v168
    v_add_f32 v176, v176, v184
    v_add_f32 v161, v161, v169
    v_add_f32 v177, v177, v185
    v_add_f32 v162, v162, v170
    v_add_f32 v178, v178, v186
    v_add_f32 v163, v163, v171
    v_add_f32 v179, v179, v187
    v_add_f32 v164, v164, v172
    v_add_f32 v180, v180, v188
    v_add_f32 v165, v165, v173
    v_add_f32 v181, v181, v189
    v_add_f32 v166, v166, v174
    v_add_f32 v182, v182, v190
    v_add_f32 v167, v167, v175
    v_add_f32 v183, v183, v191
    v_lshlrev_b32 v16, 16, v36
    v_and_b32 v17, 0xffff0000, v36
    v_add_f32 v176, v176, v16
    v_add_f32 v177, v177, v17
    v_lshlrev_b32 v16, 16, v37
    v_and_b32 v17, 0xffff0000, v37
    v_add_f32 v178, v178, v16
    v_add_f32 v179, v179, v17
    v_lshlrev_b32 v16, 16, v38
    v_and_b32 v17, 0xffff0000, v38
    v_add_f32 v180, v180, v16
    v_add_f32 v181, v181, v17
    v_lshlrev_b32 v16, 16, v39
    v_and_b32 v17, 0xffff0000, v39
    v_add_f32 v182, v182, v16
    v_add_f32 v183, v183, v17
    v_add_f32 v160, v160, v176
    v_add_f32 v161, v161, v177
    v_add_f32 v162, v162, v178
    v_add_f32 v163, v163, v179
    v_add_f32 v164, v164, v180
    v_add_f32 v165, v165, v181
    v_add_f32 v166, v166, v182
    v_add_f32 v167, v167, v183
    v_cvt_pk_bf16_f32 v24, v160, v161
    v_cvt_pk_bf16_f32 v25, v162, v163
    v_cvt_pk_bf16_f32 v26, v164, v165
    v_cvt_pk_bf16_f32 v27, v166, v167
    buffer_store_dwordx4 v[24:27], v45, s[16:19], s35 offen
    s_waitcnt lgkmcnt(0)
    v_add_f32 v128, v128, v136
    v_add_f32 v144, v144, v152
    v_add_f32 v129, v129, v137
    v_add_f32 v145, v145, v153
    v_add_f32 v130, v130, v138
    v_add_f32 v146, v146, v154
    v_add_f32 v131, v131, v139
    v_add_f32 v147, v147, v155
    v_add_f32 v132, v132, v140
    v_add_f32 v148, v148, v156
    v_add_f32 v133, v133, v141
    v_add_f32 v149, v149, v157
    v_add_f32 v134, v134, v142
    v_add_f32 v150, v150, v158
    v_add_f32 v135, v135, v143
    v_add_f32 v151, v151, v159
    v_lshlrev_b32 v16, 16, v40
    v_and_b32 v17, 0xffff0000, v40
    v_add_f32 v144, v144, v16
    v_add_f32 v145, v145, v17
    v_lshlrev_b32 v16, 16, v41
    v_and_b32 v17, 0xffff0000, v41
    v_add_f32 v146, v146, v16
    v_add_f32 v147, v147, v17
    v_lshlrev_b32 v16, 16, v42
    v_and_b32 v17, 0xffff0000, v42
    v_add_f32 v148, v148, v16
    v_add_f32 v149, v149, v17
    v_lshlrev_b32 v16, 16, v43
    v_and_b32 v17, 0xffff0000, v43
    v_add_f32 v150, v150, v16
    v_add_f32 v151, v151, v17
    v_add_f32 v128, v128, v144
    v_add_f32 v129, v129, v145
    v_add_f32 v130, v130, v146
    v_add_f32 v131, v131, v147
    v_add_f32 v132, v132, v148
    v_add_f32 v133, v133, v149
    v_add_f32 v134, v134, v150
    v_add_f32 v135, v135, v151
    v_cvt_pk_bf16_f32 v28, v128, v129
    v_cvt_pk_bf16_f32 v29, v130, v131
    v_cvt_pk_bf16_f32 v30, v132, v133
    v_cvt_pk_bf16_f32 v31, v134, v135
    buffer_store_dwordx4 v[28:31], v46, s[16:19], s35 offen
    s_branch parallel_sum__softmax_full_mha__dense_activation_relu__prompt_kernel_done
parallel_sum__softmax_full_mha__dense_activation_relu__prompt_kernel_last:
    s_waitcnt lgkmcnt(0)
    v_add_f32 v160, v160, v168
    v_add_f32 v176, v176, v184
    v_add_f32 v161, v161, v169
    v_add_f32 v177, v177, v185
    v_add_f32 v162, v162, v170
    v_add_f32 v178, v178, v186
    v_add_f32 v163, v163, v171
    v_add_f32 v179, v179, v187
    v_add_f32 v164, v164, v172
    v_add_f32 v180, v180, v188
    v_add_f32 v165, v165, v173
    v_add_f32 v181, v181, v189
    v_add_f32 v166, v166, v174
    v_add_f32 v182, v182, v190
    v_add_f32 v167, v167, v175
    v_add_f32 v183, v183, v191
    v_lshlrev_b32 v16, 16, v36
    v_and_b32 v17, 0xffff0000, v36
    v_add_f32 v176, v176, v16
    v_add_f32 v177, v177, v17
    v_lshlrev_b32 v16, 16, v37
    v_and_b32 v17, 0xffff0000, v37
    v_add_f32 v178, v178, v16
    v_add_f32 v179, v179, v17
    v_lshlrev_b32 v16, 16, v38
    v_and_b32 v17, 0xffff0000, v38
    v_add_f32 v180, v180, v16
    v_add_f32 v181, v181, v17
    v_lshlrev_b32 v16, 16, v39
    v_and_b32 v17, 0xffff0000, v39
    v_add_f32 v182, v182, v16
    v_add_f32 v183, v183, v17
    v_add_f32 v160, v160, v176
    v_add_f32 v161, v161, v177
    v_add_f32 v162, v162, v178
    v_add_f32 v163, v163, v179
    v_add_f32 v164, v164, v180
    v_add_f32 v165, v165, v181
    v_add_f32 v166, v166, v182
    v_add_f32 v167, v167, v183
    v_cvt_pk_bf16_f32 v24, v160, v161
    v_cvt_pk_bf16_f32 v25, v162, v163
    v_cvt_pk_bf16_f32 v26, v164, v165
    v_cvt_pk_bf16_f32 v27, v166, v167
    buffer_store_dwordx4 v[24:27], v45, s[16:19], s35 offen
parallel_sum__softmax_full_mha__dense_activation_relu__prompt_kernel_done:
    s_mov_b64 exec, -1
parallel_sum__softmax_full_mha__dense_activation_relu__prompt_kernel_end:
    s_endpgm
parallel_sum__softmax_full_mha__dense_activation_relu__prompt_kernel_spin_n:
    s_mov_b32 s3, 0
parallel_sum__softmax_full_mha__dense_activation_relu__prompt_kernel_spin_n_l:
    v_mov_b32 v231, 0
    global_load_dword v232, v231, s[38:39] sc1
    s_waitcnt vmcnt(0)
    v_readfirstlane_b32 s78, v232
    s_nop 0
    s_cmp_lg_u32 s78, 0
    s_cbranch_scc1 parallel_sum__softmax_full_mha__dense_activation_relu__prompt_kernel_spin_n_ret
    s_add_u32 s3, s3, 1
    s_cmp_lt_u32 s3, 20000
    s_cbranch_scc0 parallel_sum__softmax_full_mha__dense_activation_relu__prompt_kernel_spin_n_ret
    s_sleep 2
    s_branch parallel_sum__softmax_full_mha__dense_activation_relu__prompt_kernel_spin_n_l
parallel_sum__softmax_full_mha__dense_activation_relu__prompt_kernel_spin_q:
    s_mov_b32 s3, 0
parallel_sum__softmax_full_mha__dense_activation_relu__prompt_kernel_spin_q_l:
    buffer_load_dword v233, v252, s[8:11], 0 offen offset:0 sc1
    buffer_load_dword v234, v252, s[8:11], 0 offen offset:256 sc1
    buffer_load_dword v235, v252, s[8:11], 0 offen offset:512 sc1
    buffer_load_dword v236, v252, s[8:11], 0 offen offset:768 sc1
    s_waitcnt vmcnt(0)
    v_cmp_eq_u32 vcc, s78, v233
    v_cmp_eq_u32 s[4:5], s78, v234
    s_and_b64 vcc, vcc, s[4:5]
    v_cmp_eq_u32 s[4:5], s78, v235
    s_and_b64 vcc, vcc, s[4:5]
    v_cmp_eq_u32 s[4:5], s78, v236
    s_and_b64 vcc, vcc, s[4:5]
    s_cmp_eq_u64 vcc, -1
    s_cbranch_scc1 parallel_sum__softmax_full_mha__dense_activation_relu__prompt_kernel_spin_q_ret
    s_add_u32 s3, s3, 1
    s_cmp_lt_u32 s3, 20000
    s_cbranch_scc0 parallel_sum__softmax_full_mha__dense_activation_relu__prompt_kernel_spin_q_ret
    s_sleep 2
    s_branch parallel_sum__softmax_full_mha__dense_activation_relu__prompt_kernel_spin_q_l
parallel_sum__softmax_full_mha__dense_activation_relu__prompt_kernel_spin_pf:
    s_mov_b32 s3, 0
parallel_sum__softmax_full_mha__dense_activation_relu__prompt_kernel_spin_pf_l:
    buffer_load_dword v243, v252, s[8:11], 0 offen sc1
    s_waitcnt vmcnt(0)
    v_cmp_eq_u32 vcc, s78, v243
    s_cmp_eq_u64 vcc, -1
    s_cbranch_scc1 parallel_sum__softmax_full_mha__dense_activation_relu__prompt_kernel_spin_pf_ret
    s_add_u32 s3, s3, 1
    s_cmp_lt_u32 s3, 20000
    s_cbranch_scc0 parallel_sum__softmax_full_mha__dense_activation_relu__prompt_kernel_spin_pf_ret
    s_sleep 2
    s_branch parallel_sum__softmax_full_mha__dense_activation_relu__prompt_kernel_spin_pf_l
parallel_sum__softmax_full_mha__dense_activation_relu__prompt_kernel_fallback:
    s_waitcnt vmcnt(0)
    v_and_b32 v113, 31, v255
    v_lshrrev_b32 v114, 5, v255
    s_lshl_b32 s77, s71, 2
    v_lshl_add_u32 v12, v113, 3, s77
    v_lshlrev_b32 v14, 15, v114
    v_lshl_add_u32 v14, v113, 3, v14
    s_mul_i32 s65, s42, 9
    s_mul_i32 s77, s71, 5
    s_add_u32 s65, s65, s77
    s_lshl_b32 s65, s65, 14
    s_add_u32 s65, s65, 2359296
    s_mul_i32 s77, s69, 73728
    s_add_u32 s77, s77, 4718592
    v_mul_u32_u24 v15, 288, v114
    v_lshl_add_u32 v15, v113, 4, v15
    v_add_u32 v15, s77, v15
    v_cmp_eq_u32 vcc, 18, v113
    v_mov_b32 v114, 47965184
    v_mov_b32 v108, 47961088
    v_cndmask_b32 v114, v114, v108, vcc
    v_cmp_gt_u32 vcc, 18, v113
    v_mov_b32 v113, 4608
    s_nop 0
    v_cndmask_b32 v15, v114, v15, vcc
    v_cndmask_b32 v108, 0, v113, vcc
    v_cmp_gt_u32 s[74:75], 32, v255
    s_lshl_b32 s64, s70, 8
    s_add_u32 s62, s65, s64
    s_sub_u32 s62, s62, 2359296
    s_add_u32 s63, s62, 16384
    buffer_load_dwordx2 v[0:1], v14, s[8:11], s62 offen offset:0 sc1
    buffer_load_dwordx2 v[2:3], v14, s[8:11], s63 offen offset:0 sc1
    buffer_load_dwordx2 v[4:5], v14, s[8:11], s62 offen offset:256 sc1
    buffer_load_dwordx2 v[6:7], v14, s[8:11], s63 offen offset:256 sc1
    s_mul_i32 s62, s42, 147456
    s_add_u32 s62, s62, s64
    s_add_u32 s62, s62, 65536
    buffer_load_dword v8, v12, s[8:11], s62 offen sc1
    buffer_load_dword v10, v12, s[8:11], s62 offen offset:256 sc1
    v_mov_b32 v114, 0x3f803f80
    v_accvgpr_write_b32 a133, v114
    v_accvgpr_write_b32 a149, v114
    v_accvgpr_write_b32 a165, v114
    v_accvgpr_write_b32 a181, v114
    v_accvgpr_write_b32 a197, v114
    v_accvgpr_write_b32 a213, v114
    v_accvgpr_write_b32 a229, v114
    v_accvgpr_write_b32 a245, v114
    v_accvgpr_write_b32 a248, v114
    v_accvgpr_write_b32 a249, v114
    v_accvgpr_write_b32 a250, v114
    v_accvgpr_write_b32 a251, v114
    v_accvgpr_write_b32 a252, v114
    v_accvgpr_write_b32 a253, v114
    v_accvgpr_write_b32 a254, v114
    v_accvgpr_write_b32 a255, v114
    s_waitcnt vmcnt(0)
    v_cndmask_b32 v8, 0, v8, s[74:75]
    v_cndmask_b32 v10, 0, v10, s[74:75]
    s_mov_b32 s67, 0
    s_mov_b32 s62, s65
    s_add_u32 s63, s65, 16384
    s_mul_i32 s64, s42, 147456
    s_add_u32 s64, s64, 2424832
    v_mov_b32 v13, v15
    s_mov_b32 s68, 64
    v_mov_b32 v9, 0
    v_mov_b32 v11, 0
    v_mov_b32 v111, 0xff800000
    v_mov_b32 v112, 0xff800000
parallel_sum__softmax_full_mha__dense_activation_relu__prompt_kernel_fbloop:
    buffer_load_dwordx2 a[128:129], v14, s[8:11], s62 offen sc1
    buffer_load_dwordx2 a[130:131], v14, s[8:11], s63 offen sc1
    buffer_load_dword a132, v12, s[8:11], s64 offen sc1
    s_add_u32 s62, s62, 256
    s_add_u32 s63, s63, 256
    s_add_u32 s64, s64, 256
    s_waitcnt vmcnt(0)
    v_mfma_f32_32x32x16_bf16 v[16:31], a[128:131], v[0:3], 0
    v_mfma_f32_32x32x16_bf16 v[32:47], a[128:131], v[4:7], 0
    v_mfma_f32_32x32x8bf16_1k v[16:31], a[132:133], v[8:9], v[16:31]
    v_mfma_f32_32x32x8bf16_1k v[32:47], a[132:133], v[10:11], v[32:47]
    s_nop 10
    v_max3_f32 v111, v111, v16, v17
    v_max3_f32 v111, v111, v18, v19
    v_max3_f32 v111, v111, v20, v21
    v_max3_f32 v111, v111, v22, v23
    v_max3_f32 v111, v111, v24, v25
    v_max3_f32 v111, v111, v26, v27
    v_max3_f32 v111, v111, v28, v29
    v_max3_f32 v111, v111, v30, v31
    v_max3_f32 v112, v112, v32, v33
    v_max3_f32 v112, v112, v34, v35
    v_max3_f32 v112, v112, v36, v37
    v_max3_f32 v112, v112, v38, v39
    v_max3_f32 v112, v112, v40, v41
    v_max3_f32 v112, v112, v42, v43
    v_max3_f32 v112, v112, v44, v45
    v_max3_f32 v112, v112, v46, v47
    s_sub_u32 s68, s68, 1
    s_cmp_lg_u32 s68, 0
    s_cbranch_scc1 parallel_sum__softmax_full_mha__dense_activation_relu__prompt_kernel_fbloop
    v_mov_b32 v113, v111
    v_mov_b32 v114, v111
    s_nop 1
    v_permlane32_swap_b32 v113, v114
    s_nop 1
    v_max_f32 v111, v113, v114
    v_mov_b32 v113, v112
    v_mov_b32 v114, v112
    s_nop 1
    v_permlane32_swap_b32 v113, v114
    s_nop 1
    v_max_f32 v112, v113, v114
    s_mov_b32 s62, s65
    s_add_u32 s63, s65, 16384
    s_mul_i32 s64, s42, 147456
    s_add_u32 s64, s64, 2424832
    v_mov_b32 v13, v15
    buffer_load_dwordx2 a[128:129], v14, s[8:11], s62 offen offset:0 sc1
    buffer_load_dwordx2 a[130:131], v14, s[8:11], s63 offen offset:0 sc1
    buffer_load_dword a132, v12, s[8:11], s64 offen offset:0 sc1
    buffer_load_dwordx4 a[136:139], v13, s[8:11], 0 offen offset:0 sc1
    buffer_load_dwordx4 a[140:143], v13, s[8:11], 0 offen offset:576 sc1
    buffer_load_dwordx2 a[144:145], v14, s[8:11], s62 offen offset:256 sc1
    buffer_load_dwordx2 a[146:147], v14, s[8:11], s63 offen offset:256 sc1
    buffer_load_dword a148, v12, s[8:11], s64 offen offset:256 sc1
    buffer_load_dwordx4 a[152:155], v13, s[8:11], 0 offen offset:1152 sc1
    buffer_load_dwordx4 a[156:159], v13, s[8:11], 0 offen offset:1728 sc1
    buffer_load_dwordx2 a[160:161], v14, s[8:11], s62 offen offset:512 sc1
    buffer_load_dwordx2 a[162:163], v14, s[8:11], s63 offen offset:512 sc1
    buffer_load_dword a164, v12, s[8:11], s64 offen offset:512 sc1
    buffer_load_dwordx4 a[168:171], v13, s[8:11], 0 offen offset:2304 sc1
    buffer_load_dwordx4 a[172:175], v13, s[8:11], 0 offen offset:2880 sc1
    buffer_load_dwordx2 a[176:177], v14, s[8:11], s62 offen offset:768 sc1
    buffer_load_dwordx2 a[178:179], v14, s[8:11], s63 offen offset:768 sc1
    buffer_load_dword a180, v12, s[8:11], s64 offen offset:768 sc1
    buffer_load_dwordx4 a[184:187], v13, s[8:11], 0 offen offset:3456 sc1
    buffer_load_dwordx4 a[188:191], v13, s[8:11], 0 offen offset:4032 sc1
    buffer_load_dwordx2 a[192:193], v14, s[8:11], s62 offen offset:1024 sc1
    buffer_load_dwordx2 a[194:195], v14, s[8:11], s63 offen offset:1024 sc1
    buffer_load_dword a196, v12, s[8:11], s64 offen offset:1024 sc1
    v_add_u32 v13, v108, v13
    buffer_load_dwordx4 a[200:203], v13, s[8:11], 0 offen offset:0 sc1
    buffer_load_dwordx4 a[204:207], v13, s[8:11], 0 offen offset:576 sc1
    buffer_load_dwordx2 a[208:209], v14, s[8:11], s62 offen offset:1280 sc1
    buffer_load_dwordx2 a[210:211], v14, s[8:11], s63 offen offset:1280 sc1
    buffer_load_dword a212, v12, s[8:11], s64 offen offset:1280 sc1
    buffer_load_dwordx4 a[216:219], v13, s[8:11], 0 offen offset:1152 sc1
    buffer_load_dwordx4 a[220:223], v13, s[8:11], 0 offen offset:1728 sc1
    buffer_load_dwordx2 a[224:225], v14, s[8:11], s62 offen offset:1536 sc1
    buffer_load_dwordx2 a[226:227], v14, s[8:11], s63 offen offset:1536 sc1
    buffer_load_dword a228, v12, s[8:11], s64 offen offset:1536 sc1
    buffer_load_dwordx4 a[232:235], v13, s[8:11], 0 offen offset:2304 sc1
    buffer_load_dwordx4 a[236:239], v13, s[8:11], 0 offen offset:2880 sc1
    s_waitcnt vmcnt(25)
    v_add_f32 v113, s67, v111
    v_sub_f32 v113, 0, v113
    v_cvt_pk_bf16_f32 v114, v113, v113
    v_lshlrev_b32 v114, 16, v114
    v_sub_f32 v115, v113, v114
    v_cvt_pk_bf16_f32 v113, v114, v115
    v_cndmask_b32 v9, 0, v113, s[74:75]
    v_add_f32 v113, s67, v112
    v_sub_f32 v113, 0, v113
    v_cvt_pk_bf16_f32 v114, v113, v113
    v_lshlrev_b32 v114, 16, v114
    v_sub_f32 v115, v113, v114
    v_cvt_pk_bf16_f32 v113, v114, v115
    v_cndmask_b32 v11, 0, v113, s[74:75]
    v_mov_b32 v64, 0
    v_mov_b32 v80, 0
    v_mov_b32 v65, 0
    v_mov_b32 v81, 0
    v_mov_b32 v66, 0
    v_mov_b32 v82, 0
    v_mov_b32 v67, 0
    v_mov_b32 v83, 0
    v_mov_b32 v68, 0
    v_mov_b32 v84, 0
    v_mov_b32 v69, 0
    v_mov_b32 v85, 0
    v_mov_b32 v70, 0
    v_mov_b32 v86, 0
    v_mov_b32 v71, 0
    v_mov_b32 v87, 0
    v_mov_b32 v72, 0
    v_mov_b32 v88, 0
    v_mov_b32 v73, 0
    v_mov_b32 v89, 0
    v_mov_b32 v74, 0
    v_mov_b32 v90, 0
    v_mov_b32 v75, 0
    v_mov_b32 v91, 0
    v_mov_b32 v76, 0
    v_mov_b32 v92, 0
    v_mov_b32 v77, 0
    v_mov_b32 v93, 0
    v_mov_b32 v78, 0
    v_mov_b32 v94, 0
    v_mov_b32 v79, 0
    v_mov_b32 v95, 0
    v_mov_b32 v56, 0
    v_mov_b32 v57, 0
    v_mov_b32 v58, 0
    v_mov_b32 v59, 0
    v_mov_b32 v60, 0
    v_mov_b32 v61, 0
    v_mov_b32 v62, 0
    v_mov_b32 v63, 0
    v_mfma_f32_32x32x16_bf16 v[16:31], a[128:131], v[0:3], 0
    v_mfma_f32_32x32x8bf16_1k v[16:31], a[132:133], v[8:9], v[16:31]
    s_mov_b32 s68, 4
    s_nop 10
parallel_sum__softmax_full_mha__dense_activation_relu__prompt_kernel_fb2loop:
    v_mfma_f32_32x32x16_bf16 v[32:47], a[128:131], v[4:7], 0
    v_exp_f32 v16, v16
    v_exp_f32 v17, v17
    v_exp_f32 v18, v18
    v_exp_f32 v19, v19
    v_mfma_f32_32x32x8bf16_1k v[32:47], a[132:133], v[10:11], v[32:47]
    v_exp_f32 v20, v20
    v_exp_f32 v21, v21
    v_cvt_pk_bf16_f32 v48, v16, v17
    v_exp_f32 v22, v22
    v_exp_f32 v23, v23
    v_cvt_pk_bf16_f32 v49, v18, v19
    v_mfma_f32_32x32x16_bf16 v[80:95], a[248:251], v[56:59], v[80:95]
    v_exp_f32 v24, v24
    v_exp_f32 v25, v25
    v_cvt_pk_bf16_f32 v50, v20, v21
    v_exp_f32 v26, v26
    v_exp_f32 v27, v27
    v_cvt_pk_bf16_f32 v51, v22, v23
    v_mfma_f32_32x32x16_bf16 v[80:95], a[252:255], v[60:63], v[80:95]
    v_exp_f32 v28, v28
    v_exp_f32 v29, v29
    v_cvt_pk_bf16_f32 v52, v24, v25
    v_exp_f32 v30, v30
    v_exp_f32 v31, v31
    v_cvt_pk_bf16_f32 v53, v26, v27
    v_cvt_pk_bf16_f32 v54, v28, v29
    v_cvt_pk_bf16_f32 v55, v30, v31
    s_waitcnt vmcnt(25)
    v_mfma_f32_32x32x16_bf16 v[16:31], a[144:147], v[0:3], 0
    v_exp_f32 v32, v32
    v_exp_f32 v33, v33
    v_exp_f32 v34, v34
    v_exp_f32 v35, v35
    buffer_load_dwordx2 a[240:241], v14, s[8:11], s62 offen offset:1792 sc1
    buffer_load_dwordx2 a[242:243], v14, s[8:11], s63 offen offset:1792 sc1
    v_mfma_f32_32x32x8bf16_1k v[16:31], a[148:149], v[8:9], v[16:31]
    v_exp_f32 v36, v36
    v_exp_f32 v37, v37
    v_cvt_pk_bf16_f32 v56, v32, v33
    v_exp_f32 v38, v38
    v_exp_f32 v39, v39
    v_cvt_pk_bf16_f32 v57, v34, v35
    buffer_load_dword a244, v12, s[8:11], s64 offen offset:1792 sc1
    v_mfma_f32_32x32x16_bf16 v[64:79], a[136:139], v[48:51], v[64:79]
    v_exp_f32 v40, v40
    v_exp_f32 v41, v41
    v_cvt_pk_bf16_f32 v58, v36, v37
    v_exp_f32 v42, v42
    v_exp_f32 v43, v43
    v_cvt_pk_bf16_f32 v59, v38, v39
    buffer_load_dwordx4 a[248:251], v13, s[8:11], 0 offen offset:3456 sc1
    buffer_load_dwordx4 a[252:255], v13, s[8:11], 0 offen offset:4032 sc1
    v_mfma_f32_32x32x16_bf16 v[64:79], a[140:143], v[52:55], v[64:79]
    v_exp_f32 v44, v44
    v_exp_f32 v45, v45
    v_cvt_pk_bf16_f32 v60, v40, v41
    v_exp_f32 v46, v46
    v_exp_f32 v47, v47
    v_cvt_pk_bf16_f32 v61, v42, v43
    v_cvt_pk_bf16_f32 v62, v44, v45
    v_cvt_pk_bf16_f32 v63, v46, v47
    v_mfma_f32_32x32x16_bf16 v[32:47], a[144:147], v[4:7], 0
    v_exp_f32 v16, v16
    v_exp_f32 v17, v17
    v_exp_f32 v18, v18
    v_exp_f32 v19, v19
    v_mfma_f32_32x32x8bf16_1k v[32:47], a[148:149], v[10:11], v[32:47]
    v_exp_f32 v20, v20
    v_exp_f32 v21, v21
    v_cvt_pk_bf16_f32 v48, v16, v17
    v_exp_f32 v22, v22
    v_exp_f32 v23, v23
    v_cvt_pk_bf16_f32 v49, v18, v19
    v_mfma_f32_32x32x16_bf16 v[80:95], a[136:139], v[56:59], v[80:95]
    v_exp_f32 v24, v24
    v_exp_f32 v25, v25
    v_cvt_pk_bf16_f32 v50, v20, v21
    v_exp_f32 v26, v26
    v_exp_f32 v27, v27
    v_cvt_pk_bf16_f32 v51, v22, v23
    v_mfma_f32_32x32x16_bf16 v[80:95], a[140:143], v[60:63], v[80:95]
    v_exp_f32 v28, v28
    v_exp_f32 v29, v29
    v_cvt_pk_bf16_f32 v52, v24, v25
    v_exp_f32 v30, v30
    v_exp_f32 v31, v31
    v_cvt_pk_bf16_f32 v53, v26, v27
    v_cvt_pk_bf16_f32 v54, v28, v29
    v_cvt_pk_bf16_f32 v55, v30, v31
    s_waitcnt vmcnt(25)
    v_mfma_f32_32x32x16_bf16 v[16:31], a[160:163], v[0:3], 0
    v_exp_f32 v32, v32
    v_exp_f32 v33, v33
    v_exp_f32 v34, v34
    v_exp_f32 v35, v35
    buffer_load_dwordx2 a[128:129], v14, s[8:11], s62 offen offset:2048 sc1
    buffer_load_dwordx2 a[130:131], v14, s[8:11], s63 offen offset:2048 sc1
    v_mfma_f32_32x32x8bf16_1k v[16:31], a[164:165], v[8:9], v[16:31]
    v_exp_f32 v36, v36
    v_exp_f32 v37, v37
    v_cvt_pk_bf16_f32 v56, v32, v33
    v_exp_f32 v38, v38
    v_exp_f32 v39, v39
    v_cvt_pk_bf16_f32 v57, v34, v35
    buffer_load_dword a132, v12, s[8:11], s64 offen offset:2048 sc1
    v_mfma_f32_32x32x16_bf16 v[64:79], a[152:155], v[48:51], v[64:79]
    v_exp_f32 v40, v40
    v_exp_f32 v41, v41
    v_cvt_pk_bf16_f32 v58, v36, v37
    v_exp_f32 v42, v42
    v_exp_f32 v43, v43
    v_cvt_pk_bf16_f32 v59, v38, v39
    v_add_u32 v13, v108, v13
    buffer_load_dwordx4 a[136:139], v13, s[8:11], 0 offen offset:0 sc1
    buffer_load_dwordx4 a[140:143], v13, s[8:11], 0 offen offset:576 sc1
    v_mfma_f32_32x32x16_bf16 v[64:79], a[156:159], v[52:55], v[64:79]
    v_exp_f32 v44, v44
    v_exp_f32 v45, v45
    v_cvt_pk_bf16_f32 v60, v40, v41
    v_exp_f32 v46, v46
    v_exp_f32 v47, v47
    v_cvt_pk_bf16_f32 v61, v42, v43
    v_cvt_pk_bf16_f32 v62, v44, v45
    v_cvt_pk_bf16_f32 v63, v46, v47
    v_mfma_f32_32x32x16_bf16 v[32:47], a[160:163], v[4:7], 0
    v_exp_f32 v16, v16
    v_exp_f32 v17, v17
    v_exp_f32 v18, v18
    v_exp_f32 v19, v19
    v_mfma_f32_32x32x8bf16_1k v[32:47], a[164:165], v[10:11], v[32:47]
    v_exp_f32 v20, v20
    v_exp_f32 v21, v21
    v_cvt_pk_bf16_f32 v48, v16, v17
    v_exp_f32 v22, v22
    v_exp_f32 v23, v23
    v_cvt_pk_bf16_f32 v49, v18, v19
    v_mfma_f32_32x32x16_bf16 v[80:95], a[152:155], v[56:59], v[80:95]
    v_exp_f32 v24, v24
    v_exp_f32 v25, v25
    v_cvt_pk_bf16_f32 v50, v20, v21
    v_exp_f32 v26, v26
    v_exp_f32 v27, v27
    v_cvt_pk_bf16_f32 v51, v22, v23
    v_mfma_f32_32x32x16_bf16 v[80:95], a[156:159], v[60:63], v[80:95]
    v_exp_f32 v28, v28
    v_exp_f32 v29, v29
    v_cvt_pk_bf16_f32 v52, v24, v25
    v_exp_f32 v30, v30
    v_exp_f32 v31, v31
    v_cvt_pk_bf16_f32 v53, v26, v27
    v_cvt_pk_bf16_f32 v54, v28, v29
    v_cvt_pk_bf16_f32 v55, v30, v31
    s_waitcnt vmcnt(25)
    v_mfma_f32_32x32x16_bf16 v[16:31], a[176:179], v[0:3], 0
    v_exp_f32 v32, v32
    v_exp_f32 v33, v33
    v_exp_f32 v34, v34
    v_exp_f32 v35, v35
    buffer_load_dwordx2 a[144:145], v14, s[8:11], s62 offen offset:2304 sc1
    buffer_load_dwordx2 a[146:147], v14, s[8:11], s63 offen offset:2304 sc1
    v_mfma_f32_32x32x8bf16_1k v[16:31], a[180:181], v[8:9], v[16:31]
    v_exp_f32 v36, v36
    v_exp_f32 v37, v37
    v_cvt_pk_bf16_f32 v56, v32, v33
    v_exp_f32 v38, v38
    v_exp_f32 v39, v39
    v_cvt_pk_bf16_f32 v57, v34, v35
    buffer_load_dword a148, v12, s[8:11], s64 offen offset:2304 sc1
    v_mfma_f32_32x32x16_bf16 v[64:79], a[168:171], v[48:51], v[64:79]
    v_exp_f32 v40, v40
    v_exp_f32 v41, v41
    v_cvt_pk_bf16_f32 v58, v36, v37
    v_exp_f32 v42, v42
    v_exp_f32 v43, v43
    v_cvt_pk_bf16_f32 v59, v38, v39
    buffer_load_dwordx4 a[152:155], v13, s[8:11], 0 offen offset:1152 sc1
    buffer_load_dwordx4 a[156:159], v13, s[8:11], 0 offen offset:1728 sc1
    v_mfma_f32_32x32x16_bf16 v[64:79], a[172:175], v[52:55], v[64:79]
    v_exp_f32 v44, v44
    v_exp_f32 v45, v45
    v_cvt_pk_bf16_f32 v60, v40, v41
    v_exp_f32 v46, v46
    v_exp_f32 v47, v47
    v_cvt_pk_bf16_f32 v61, v42, v43
    v_cvt_pk_bf16_f32 v62, v44, v45
    v_cvt_pk_bf16_f32 v63, v46, v47
    v_mfma_f32_32x32x16_bf16 v[32:47], a[176:179], v[4:7], 0
    v_exp_f32 v16, v16
    v_exp_f32 v17, v17
    v_exp_f32 v18, v18
    v_exp_f32 v19, v19
    v_mfma_f32_32x32x8bf16_1k v[32:47], a[180:181], v[10:11], v[32:47]
    v_exp_f32 v20, v20
    v_exp_f32 v21, v21
    v_cvt_pk_bf16_f32 v48, v16, v17
    v_exp_f32 v22, v22
    v_exp_f32 v23, v23
    v_cvt_pk_bf16_f32 v49, v18, v19
    v_mfma_f32_32x32x16_bf16 v[80:95], a[168:171], v[56:59], v[80:95]
    v_exp_f32 v24, v24
    v_exp_f32 v25, v25
    v_cvt_pk_bf16_f32 v50, v20, v21
    v_exp_f32 v26, v26
    v_exp_f32 v27, v27
    v_cvt_pk_bf16_f32 v51, v22, v23
    v_mfma_f32_32x32x16_bf16 v[80:95], a[172:175], v[60:63], v[80:95]
    v_exp_f32 v28, v28
    v_exp_f32 v29, v29
    v_cvt_pk_bf16_f32 v52, v24, v25
    v_exp_f32 v30, v30
    v_exp_f32 v31, v31
    v_cvt_pk_bf16_f32 v53, v26, v27
    v_cvt_pk_bf16_f32 v54, v28, v29
    v_cvt_pk_bf16_f32 v55, v30, v31
    s_waitcnt vmcnt(25)
    v_mfma_f32_32x32x16_bf16 v[16:31], a[192:195], v[0:3], 0
    v_exp_f32 v32, v32
    v_exp_f32 v33, v33
    v_exp_f32 v34, v34
    v_exp_f32 v35, v35
    buffer_load_dwordx2 a[160:161], v14, s[8:11], s62 offen offset:2560 sc1
    buffer_load_dwordx2 a[162:163], v14, s[8:11], s63 offen offset:2560 sc1
    v_mfma_f32_32x32x8bf16_1k v[16:31], a[196:197], v[8:9], v[16:31]
    v_exp_f32 v36, v36
    v_exp_f32 v37, v37
    v_cvt_pk_bf16_f32 v56, v32, v33
    v_exp_f32 v38, v38
    v_exp_f32 v39, v39
    v_cvt_pk_bf16_f32 v57, v34, v35
    buffer_load_dword a164, v12, s[8:11], s64 offen offset:2560 sc1
    v_mfma_f32_32x32x16_bf16 v[64:79], a[184:187], v[48:51], v[64:79]
    v_exp_f32 v40, v40
    v_exp_f32 v41, v41
    v_cvt_pk_bf16_f32 v58, v36, v37
    v_exp_f32 v42, v42
    v_exp_f32 v43, v43
    v_cvt_pk_bf16_f32 v59, v38, v39
    buffer_load_dwordx4 a[168:171], v13, s[8:11], 0 offen offset:2304 sc1
    buffer_load_dwordx4 a[172:175], v13, s[8:11], 0 offen offset:2880 sc1
    v_mfma_f32_32x32x16_bf16 v[64:79], a[188:191], v[52:55], v[64:79]
    v_exp_f32 v44, v44
    v_exp_f32 v45, v45
    v_cvt_pk_bf16_f32 v60, v40, v41
    v_exp_f32 v46, v46
    v_exp_f32 v47, v47
    v_cvt_pk_bf16_f32 v61, v42, v43
    v_cvt_pk_bf16_f32 v62, v44, v45
    v_cvt_pk_bf16_f32 v63, v46, v47
    v_mfma_f32_32x32x16_bf16 v[32:47], a[192:195], v[4:7], 0
    v_exp_f32 v16, v16
    v_exp_f32 v17, v17
    v_exp_f32 v18, v18
    v_exp_f32 v19, v19
    v_mfma_f32_32x32x8bf16_1k v[32:47], a[196:197], v[10:11], v[32:47]
    v_exp_f32 v20, v20
    v_exp_f32 v21, v21
    v_cvt_pk_bf16_f32 v48, v16, v17
    v_exp_f32 v22, v22
    v_exp_f32 v23, v23
    v_cvt_pk_bf16_f32 v49, v18, v19
    v_mfma_f32_32x32x16_bf16 v[80:95], a[184:187], v[56:59], v[80:95]
    v_exp_f32 v24, v24
    v_exp_f32 v25, v25
    v_cvt_pk_bf16_f32 v50, v20, v21
    v_exp_f32 v26, v26
    v_exp_f32 v27, v27
    v_cvt_pk_bf16_f32 v51, v22, v23
    v_mfma_f32_32x32x16_bf16 v[80:95], a[188:191], v[60:63], v[80:95]
    v_exp_f32 v28, v28
    v_exp_f32 v29, v29
    v_cvt_pk_bf16_f32 v52, v24, v25
    v_exp_f32 v30, v30
    v_exp_f32 v31, v31
    v_cvt_pk_bf16_f32 v53, v26, v27
    v_cvt_pk_bf16_f32 v54, v28, v29
    v_cvt_pk_bf16_f32 v55, v30, v31
    s_waitcnt vmcnt(25)
    v_mfma_f32_32x32x16_bf16 v[16:31], a[208:211], v[0:3], 0
    v_exp_f32 v32, v32
    v_exp_f32 v33, v33
    v_exp_f32 v34, v34
    v_exp_f32 v35, v35
    buffer_load_dwordx2 a[176:177], v14, s[8:11], s62 offen offset:2816 sc1
    buffer_load_dwordx2 a[178:179], v14, s[8:11], s63 offen offset:2816 sc1
    v_mfma_f32_32x32x8bf16_1k v[16:31], a[212:213], v[8:9], v[16:31]
    v_exp_f32 v36, v36
    v_exp_f32 v37, v37
    v_cvt_pk_bf16_f32 v56, v32, v33
    v_exp_f32 v38, v38
    v_exp_f32 v39, v39
    v_cvt_pk_bf16_f32 v57, v34, v35
    buffer_load_dword a180, v12, s[8:11], s64 offen offset:2816 sc1
    v_mfma_f32_32x32x16_bf16 v[64:79], a[200:203], v[48:51], v[64:79]
    v_exp_f32 v40, v40
    v_exp_f32 v41, v41
    v_cvt_pk_bf16_f32 v58, v36, v37
    v_exp_f32 v42, v42
    v_exp_f32 v43, v43
    v_cvt_pk_bf16_f32 v59, v38, v39
    buffer_load_dwordx4 a[184:187], v13, s[8:11], 0 offen offset:3456 sc1
    buffer_load_dwordx4 a[188:191], v13, s[8:11], 0 offen offset:4032 sc1
    v_mfma_f32_32x32x16_bf16 v[64:79], a[204:207], v[52:55], v[64:79]
    v_exp_f32 v44, v44
    v_exp_f32 v45, v45
    v_cvt_pk_bf16_f32 v60, v40, v41
    v_exp_f32 v46, v46
    v_exp_f32 v47, v47
    v_cvt_pk_bf16_f32 v61, v42, v43
    v_cvt_pk_bf16_f32 v62, v44, v45
    v_cvt_pk_bf16_f32 v63, v46, v47
    v_mfma_f32_32x32x16_bf16 v[32:47], a[208:211], v[4:7], 0
    v_exp_f32 v16, v16
    v_exp_f32 v17, v17
    v_exp_f32 v18, v18
    v_exp_f32 v19, v19
    v_mfma_f32_32x32x8bf16_1k v[32:47], a[212:213], v[10:11], v[32:47]
    v_exp_f32 v20, v20
    v_exp_f32 v21, v21
    v_cvt_pk_bf16_f32 v48, v16, v17
    v_exp_f32 v22, v22
    v_exp_f32 v23, v23
    v_cvt_pk_bf16_f32 v49, v18, v19
    v_mfma_f32_32x32x16_bf16 v[80:95], a[200:203], v[56:59], v[80:95]
    v_exp_f32 v24, v24
    v_exp_f32 v25, v25
    v_cvt_pk_bf16_f32 v50, v20, v21
    v_exp_f32 v26, v26
    v_exp_f32 v27, v27
    v_cvt_pk_bf16_f32 v51, v22, v23
    v_mfma_f32_32x32x16_bf16 v[80:95], a[204:207], v[60:63], v[80:95]
    v_exp_f32 v28, v28
    v_exp_f32 v29, v29
    v_cvt_pk_bf16_f32 v52, v24, v25
    v_exp_f32 v30, v30
    v_exp_f32 v31, v31
    v_cvt_pk_bf16_f32 v53, v26, v27
    v_cvt_pk_bf16_f32 v54, v28, v29
    v_cvt_pk_bf16_f32 v55, v30, v31
    s_waitcnt vmcnt(25)
    v_mfma_f32_32x32x16_bf16 v[16:31], a[224:227], v[0:3], 0
    v_exp_f32 v32, v32
    v_exp_f32 v33, v33
    v_exp_f32 v34, v34
    v_exp_f32 v35, v35
    buffer_load_dwordx2 a[192:193], v14, s[8:11], s62 offen offset:3072 sc1
    buffer_load_dwordx2 a[194:195], v14, s[8:11], s63 offen offset:3072 sc1
    v_mfma_f32_32x32x8bf16_1k v[16:31], a[228:229], v[8:9], v[16:31]
    v_exp_f32 v36, v36
    v_exp_f32 v37, v37
    v_cvt_pk_bf16_f32 v56, v32, v33
    v_exp_f32 v38, v38
    v_exp_f32 v39, v39
    v_cvt_pk_bf16_f32 v57, v34, v35
    buffer_load_dword a196, v12, s[8:11], s64 offen offset:3072 sc1
    v_mfma_f32_32x32x16_bf16 v[64:79], a[216:219], v[48:51], v[64:79]
    v_exp_f32 v40, v40
    v_exp_f32 v41, v41
    v_cvt_pk_bf16_f32 v58, v36, v37
    v_exp_f32 v42, v42
    v_exp_f32 v43, v43
    v_cvt_pk_bf16_f32 v59, v38, v39
    v_add_u32 v13, v108, v13
    buffer_load_dwordx4 a[200:203], v13, s[8:11], 0 offen offset:0 sc1
    buffer_load_dwordx4 a[204:207], v13, s[8:11], 0 offen offset:576 sc1
    v_mfma_f32_32x32x16_bf16 v[64:79], a[220:223], v[52:55], v[64:79]
    v_exp_f32 v44, v44
    v_exp_f32 v45, v45
    v_cvt_pk_bf16_f32 v60, v40, v41
    v_exp_f32 v46, v46
    v_exp_f32 v47, v47
    v_cvt_pk_bf16_f32 v61, v42, v43
    v_cvt_pk_bf16_f32 v62, v44, v45
    v_cvt_pk_bf16_f32 v63, v46, v47
    v_mfma_f32_32x32x16_bf16 v[32:47], a[224:227], v[4:7], 0
    v_exp_f32 v16, v16
    v_exp_f32 v17, v17
    v_exp_f32 v18, v18
    v_exp_f32 v19, v19
    v_mfma_f32_32x32x8bf16_1k v[32:47], a[228:229], v[10:11], v[32:47]
    v_exp_f32 v20, v20
    v_exp_f32 v21, v21
    v_cvt_pk_bf16_f32 v48, v16, v17
    v_exp_f32 v22, v22
    v_exp_f32 v23, v23
    v_cvt_pk_bf16_f32 v49, v18, v19
    v_mfma_f32_32x32x16_bf16 v[80:95], a[216:219], v[56:59], v[80:95]
    v_exp_f32 v24, v24
    v_exp_f32 v25, v25
    v_cvt_pk_bf16_f32 v50, v20, v21
    v_exp_f32 v26, v26
    v_exp_f32 v27, v27
    v_cvt_pk_bf16_f32 v51, v22, v23
    v_mfma_f32_32x32x16_bf16 v[80:95], a[220:223], v[60:63], v[80:95]
    v_exp_f32 v28, v28
    v_exp_f32 v29, v29
    v_cvt_pk_bf16_f32 v52, v24, v25
    v_exp_f32 v30, v30
    v_exp_f32 v31, v31
    v_cvt_pk_bf16_f32 v53, v26, v27
    v_cvt_pk_bf16_f32 v54, v28, v29
    v_cvt_pk_bf16_f32 v55, v30, v31
    s_waitcnt vmcnt(25)
    v_mfma_f32_32x32x16_bf16 v[16:31], a[240:243], v[0:3], 0
    v_exp_f32 v32, v32
    v_exp_f32 v33, v33
    v_exp_f32 v34, v34
    v_exp_f32 v35, v35
    buffer_load_dwordx2 a[208:209], v14, s[8:11], s62 offen offset:3328 sc1
    buffer_load_dwordx2 a[210:211], v14, s[8:11], s63 offen offset:3328 sc1
    v_mfma_f32_32x32x8bf16_1k v[16:31], a[244:245], v[8:9], v[16:31]
    v_exp_f32 v36, v36
    v_exp_f32 v37, v37
    v_cvt_pk_bf16_f32 v56, v32, v33
    v_exp_f32 v38, v38
    v_exp_f32 v39, v39
    v_cvt_pk_bf16_f32 v57, v34, v35
    buffer_load_dword a212, v12, s[8:11], s64 offen offset:3328 sc1
    v_mfma_f32_32x32x16_bf16 v[64:79], a[232:235], v[48:51], v[64:79]
    v_exp_f32 v40, v40
    v_exp_f32 v41, v41
    v_cvt_pk_bf16_f32 v58, v36, v37
    v_exp_f32 v42, v42
    v_exp_f32 v43, v43
    v_cvt_pk_bf16_f32 v59, v38, v39
    buffer_load_dwordx4 a[216:219], v13, s[8:11], 0 offen offset:1152 sc1
    buffer_load_dwordx4 a[220:223], v13, s[8:11], 0 offen offset:1728 sc1
    v_mfma_f32_32x32x16_bf16 v[64:79], a[236:239], v[52:55], v[64:79]
    v_exp_f32 v44, v44
    v_exp_f32 v45, v45
    v_cvt_pk_bf16_f32 v60, v40, v41
    v_exp_f32 v46, v46
    v_exp_f32 v47, v47
    v_cvt_pk_bf16_f32 v61, v42, v43
    v_cvt_pk_bf16_f32 v62, v44, v45
    v_cvt_pk_bf16_f32 v63, v46, v47
    v_mfma_f32_32x32x16_bf16 v[32:47], a[240:243], v[4:7], 0
    v_exp_f32 v16, v16
    v_exp_f32 v17, v17
    v_exp_f32 v18, v18
    v_exp_f32 v19, v19
    v_mfma_f32_32x32x8bf16_1k v[32:47], a[244:245], v[10:11], v[32:47]
    v_exp_f32 v20, v20
    v_exp_f32 v21, v21
    v_cvt_pk_bf16_f32 v48, v16, v17
    v_exp_f32 v22, v22
    v_exp_f32 v23, v23
    v_cvt_pk_bf16_f32 v49, v18, v19
    v_mfma_f32_32x32x16_bf16 v[80:95], a[232:235], v[56:59], v[80:95]
    v_exp_f32 v24, v24
    v_exp_f32 v25, v25
    v_cvt_pk_bf16_f32 v50, v20, v21
    v_exp_f32 v26, v26
    v_exp_f32 v27, v27
    v_cvt_pk_bf16_f32 v51, v22, v23
    v_mfma_f32_32x32x16_bf16 v[80:95], a[236:239], v[60:63], v[80:95]
    v_exp_f32 v28, v28
    v_exp_f32 v29, v29
    v_cvt_pk_bf16_f32 v52, v24, v25
    v_exp_f32 v30, v30
    v_exp_f32 v31, v31
    v_cvt_pk_bf16_f32 v53, v26, v27
    v_cvt_pk_bf16_f32 v54, v28, v29
    v_cvt_pk_bf16_f32 v55, v30, v31
    s_waitcnt vmcnt(25)
    v_mfma_f32_32x32x16_bf16 v[16:31], a[128:131], v[0:3], 0
    v_exp_f32 v32, v32
    v_exp_f32 v33, v33
    v_exp_f32 v34, v34
    v_exp_f32 v35, v35
    buffer_load_dwordx2 a[224:225], v14, s[8:11], s62 offen offset:3584 sc1
    buffer_load_dwordx2 a[226:227], v14, s[8:11], s63 offen offset:3584 sc1
    v_mfma_f32_32x32x8bf16_1k v[16:31], a[132:133], v[8:9], v[16:31]
    v_exp_f32 v36, v36
    v_exp_f32 v37, v37
    v_cvt_pk_bf16_f32 v56, v32, v33
    v_exp_f32 v38, v38
    v_exp_f32 v39, v39
    v_cvt_pk_bf16_f32 v57, v34, v35
    buffer_load_dword a228, v12, s[8:11], s64 offen offset:3584 sc1
    v_mfma_f32_32x32x16_bf16 v[64:79], a[248:251], v[48:51], v[64:79]
    v_exp_f32 v40, v40
    v_exp_f32 v41, v41
    v_cvt_pk_bf16_f32 v58, v36, v37
    v_exp_f32 v42, v42
    v_exp_f32 v43, v43
    v_cvt_pk_bf16_f32 v59, v38, v39
    buffer_load_dwordx4 a[232:235], v13, s[8:11], 0 offen offset:2304 sc1
    buffer_load_dwordx4 a[236:239], v13, s[8:11], 0 offen offset:2880 sc1
    v_mfma_f32_32x32x16_bf16 v[64:79], a[252:255], v[52:55], v[64:79]
    v_exp_f32 v44, v44
    v_exp_f32 v45, v45
    v_cvt_pk_bf16_f32 v60, v40, v41
    v_exp_f32 v46, v46
    v_exp_f32 v47, v47
    v_cvt_pk_bf16_f32 v61, v42, v43
    v_cvt_pk_bf16_f32 v62, v44, v45
    v_cvt_pk_bf16_f32 v63, v46, v47
    v_mfma_f32_32x32x16_bf16 v[32:47], a[128:131], v[4:7], 0
    v_exp_f32 v16, v16
    v_exp_f32 v17, v17
    v_exp_f32 v18, v18
    v_exp_f32 v19, v19
    v_mfma_f32_32x32x8bf16_1k v[32:47], a[132:133], v[10:11], v[32:47]
    v_exp_f32 v20, v20
    v_exp_f32 v21, v21
    v_cvt_pk_bf16_f32 v48, v16, v17
    v_exp_f32 v22, v22
    v_exp_f32 v23, v23
    v_cvt_pk_bf16_f32 v49, v18, v19
    v_mfma_f32_32x32x16_bf16 v[80:95], a[248:251], v[56:59], v[80:95]
    v_exp_f32 v24, v24
    v_exp_f32 v25, v25
    v_cvt_pk_bf16_f32 v50, v20, v21
    v_exp_f32 v26, v26
    v_exp_f32 v27, v27
    v_cvt_pk_bf16_f32 v51, v22, v23
    v_mfma_f32_32x32x16_bf16 v[80:95], a[252:255], v[60:63], v[80:95]
    v_exp_f32 v28, v28
    v_exp_f32 v29, v29
    v_cvt_pk_bf16_f32 v52, v24, v25
    v_exp_f32 v30, v30
    v_exp_f32 v31, v31
    v_cvt_pk_bf16_f32 v53, v26, v27
    v_cvt_pk_bf16_f32 v54, v28, v29
    v_cvt_pk_bf16_f32 v55, v30, v31
    s_waitcnt vmcnt(25)
    v_mfma_f32_32x32x16_bf16 v[16:31], a[144:147], v[0:3], 0
    v_exp_f32 v32, v32
    v_exp_f32 v33, v33
    v_exp_f32 v34, v34
    v_exp_f32 v35, v35
    buffer_load_dwordx2 a[240:241], v14, s[8:11], s62 offen offset:3840 sc1
    buffer_load_dwordx2 a[242:243], v14, s[8:11], s63 offen offset:3840 sc1
    v_mfma_f32_32x32x8bf16_1k v[16:31], a[148:149], v[8:9], v[16:31]
    v_exp_f32 v36, v36
    v_exp_f32 v37, v37
    v_cvt_pk_bf16_f32 v56, v32, v33
    v_exp_f32 v38, v38
    v_exp_f32 v39, v39
    v_cvt_pk_bf16_f32 v57, v34, v35
    buffer_load_dword a244, v12, s[8:11], s64 offen offset:3840 sc1
    v_mfma_f32_32x32x16_bf16 v[64:79], a[136:139], v[48:51], v[64:79]
    v_exp_f32 v40, v40
    v_exp_f32 v41, v41
    v_cvt_pk_bf16_f32 v58, v36, v37
    v_exp_f32 v42, v42
    v_exp_f32 v43, v43
    v_cvt_pk_bf16_f32 v59, v38, v39
    buffer_load_dwordx4 a[248:251], v13, s[8:11], 0 offen offset:3456 sc1
    buffer_load_dwordx4 a[252:255], v13, s[8:11], 0 offen offset:4032 sc1
    v_mfma_f32_32x32x16_bf16 v[64:79], a[140:143], v[52:55], v[64:79]
    v_exp_f32 v44, v44
    v_exp_f32 v45, v45
    v_cvt_pk_bf16_f32 v60, v40, v41
    v_exp_f32 v46, v46
    v_exp_f32 v47, v47
    v_cvt_pk_bf16_f32 v61, v42, v43
    v_cvt_pk_bf16_f32 v62, v44, v45
    v_cvt_pk_bf16_f32 v63, v46, v47
    v_mfma_f32_32x32x16_bf16 v[32:47], a[144:147], v[4:7], 0
    v_exp_f32 v16, v16
    v_exp_f32 v17, v17
    v_exp_f32 v18, v18
    v_exp_f32 v19, v19
    v_mfma_f32_32x32x8bf16_1k v[32:47], a[148:149], v[10:11], v[32:47]
    v_exp_f32 v20, v20
    v_exp_f32 v21, v21
    v_cvt_pk_bf16_f32 v48, v16, v17
    v_exp_f32 v22, v22
    v_exp_f32 v23, v23
    v_cvt_pk_bf16_f32 v49, v18, v19
    v_mfma_f32_32x32x16_bf16 v[80:95], a[136:139], v[56:59], v[80:95]
    v_exp_f32 v24, v24
    v_exp_f32 v25, v25
    v_cvt_pk_bf16_f32 v50, v20, v21
    v_exp_f32 v26, v26
    v_exp_f32 v27, v27
    v_cvt_pk_bf16_f32 v51, v22, v23
    v_mfma_f32_32x32x16_bf16 v[80:95], a[140:143], v[60:63], v[80:95]
    v_exp_f32 v28, v28
    v_exp_f32 v29, v29
    v_cvt_pk_bf16_f32 v52, v24, v25
    v_exp_f32 v30, v30
    v_exp_f32 v31, v31
    v_cvt_pk_bf16_f32 v53, v26, v27
    v_cvt_pk_bf16_f32 v54, v28, v29
    v_cvt_pk_bf16_f32 v55, v30, v31
    s_waitcnt vmcnt(25)
    v_mfma_f32_32x32x16_bf16 v[16:31], a[160:163], v[0:3], 0
    v_exp_f32 v32, v32
    v_exp_f32 v33, v33
    v_exp_f32 v34, v34
    v_exp_f32 v35, v35
    s_add_u32 s62, s62, 4096
    s_add_u32 s63, s63, 4096
    s_add_u32 s64, s64, 4096
    buffer_load_dwordx2 a[128:129], v14, s[8:11], s62 offen offset:0 sc1
    buffer_load_dwordx2 a[130:131], v14, s[8:11], s63 offen offset:0 sc1
    v_mfma_f32_32x32x8bf16_1k v[16:31], a[164:165], v[8:9], v[16:31]
    v_exp_f32 v36, v36
    v_exp_f32 v37, v37
    v_cvt_pk_bf16_f32 v56, v32, v33
    v_exp_f32 v38, v38
    v_exp_f32 v39, v39
    v_cvt_pk_bf16_f32 v57, v34, v35
    buffer_load_dword a132, v12, s[8:11], s64 offen offset:0 sc1
    v_mfma_f32_32x32x16_bf16 v[64:79], a[152:155], v[48:51], v[64:79]
    v_exp_f32 v40, v40
    v_exp_f32 v41, v41
    v_cvt_pk_bf16_f32 v58, v36, v37
    v_exp_f32 v42, v42
    v_exp_f32 v43, v43
    v_cvt_pk_bf16_f32 v59, v38, v39
    v_add_u32 v13, v108, v13
    buffer_load_dwordx4 a[136:139], v13, s[8:11], 0 offen offset:0 sc1
    buffer_load_dwordx4 a[140:143], v13, s[8:11], 0 offen offset:576 sc1
    v_mfma_f32_32x32x16_bf16 v[64:79], a[156:159], v[52:55], v[64:79]
    v_exp_f32 v44, v44
    v_exp_f32 v45, v45
    v_cvt_pk_bf16_f32 v60, v40, v41
    v_exp_f32 v46, v46
    v_exp_f32 v47, v47
    v_cvt_pk_bf16_f32 v61, v42, v43
    v_cvt_pk_bf16_f32 v62, v44, v45
    v_cvt_pk_bf16_f32 v63, v46, v47
    v_mfma_f32_32x32x16_bf16 v[32:47], a[160:163], v[4:7], 0
    v_exp_f32 v16, v16
    v_exp_f32 v17, v17
    v_exp_f32 v18, v18
    v_exp_f32 v19, v19
    v_mfma_f32_32x32x8bf16_1k v[32:47], a[164:165], v[10:11], v[32:47]
    v_exp_f32 v20, v20
    v_exp_f32 v21, v21
    v_cvt_pk_bf16_f32 v48, v16, v17
    v_exp_f32 v22, v22
    v_exp_f32 v23, v23
    v_cvt_pk_bf16_f32 v49, v18, v19
    v_mfma_f32_32x32x16_bf16 v[80:95], a[152:155], v[56:59], v[80:95]
    v_exp_f32 v24, v24
    v_exp_f32 v25, v25
    v_cvt_pk_bf16_f32 v50, v20, v21
    v_exp_f32 v26, v26
    v_exp_f32 v27, v27
    v_cvt_pk_bf16_f32 v51, v22, v23
    v_mfma_f32_32x32x16_bf16 v[80:95], a[156:159], v[60:63], v[80:95]
    v_exp_f32 v28, v28
    v_exp_f32 v29, v29
    v_cvt_pk_bf16_f32 v52, v24, v25
    v_exp_f32 v30, v30
    v_exp_f32 v31, v31
    v_cvt_pk_bf16_f32 v53, v26, v27
    v_cvt_pk_bf16_f32 v54, v28, v29
    v_cvt_pk_bf16_f32 v55, v30, v31
    s_waitcnt vmcnt(25)
    v_mfma_f32_32x32x16_bf16 v[16:31], a[176:179], v[0:3], 0
    v_exp_f32 v32, v32
    v_exp_f32 v33, v33
    v_exp_f32 v34, v34
    v_exp_f32 v35, v35
    buffer_load_dwordx2 a[144:145], v14, s[8:11], s62 offen offset:256 sc1
    buffer_load_dwordx2 a[146:147], v14, s[8:11], s63 offen offset:256 sc1
    v_mfma_f32_32x32x8bf16_1k v[16:31], a[180:181], v[8:9], v[16:31]
    v_exp_f32 v36, v36
    v_exp_f32 v37, v37
    v_cvt_pk_bf16_f32 v56, v32, v33
    v_exp_f32 v38, v38
    v_exp_f32 v39, v39
    v_cvt_pk_bf16_f32 v57, v34, v35
    buffer_load_dword a148, v12, s[8:11], s64 offen offset:256 sc1
    v_mfma_f32_32x32x16_bf16 v[64:79], a[168:171], v[48:51], v[64:79]
    v_exp_f32 v40, v40
    v_exp_f32 v41, v41
    v_cvt_pk_bf16_f32 v58, v36, v37
    v_exp_f32 v42, v42
    v_exp_f32 v43, v43
    v_cvt_pk_bf16_f32 v59, v38, v39
    buffer_load_dwordx4 a[152:155], v13, s[8:11], 0 offen offset:1152 sc1
    buffer_load_dwordx4 a[156:159], v13, s[8:11], 0 offen offset:1728 sc1
    v_mfma_f32_32x32x16_bf16 v[64:79], a[172:175], v[52:55], v[64:79]
    v_exp_f32 v44, v44
    v_exp_f32 v45, v45
    v_cvt_pk_bf16_f32 v60, v40, v41
    v_exp_f32 v46, v46
    v_exp_f32 v47, v47
    v_cvt_pk_bf16_f32 v61, v42, v43
    v_cvt_pk_bf16_f32 v62, v44, v45
    v_cvt_pk_bf16_f32 v63, v46, v47
    v_mfma_f32_32x32x16_bf16 v[32:47], a[176:179], v[4:7], 0
    v_exp_f32 v16, v16
    v_exp_f32 v17, v17
    v_exp_f32 v18, v18
    v_exp_f32 v19, v19
    v_mfma_f32_32x32x8bf16_1k v[32:47], a[180:181], v[10:11], v[32:47]
    v_exp_f32 v20, v20
    v_exp_f32 v21, v21
    v_cvt_pk_bf16_f32 v48, v16, v17
    v_exp_f32 v22, v22
    v_exp_f32 v23, v23
    v_cvt_pk_bf16_f32 v49, v18, v19
    v_mfma_f32_32x32x16_bf16 v[80:95], a[168:171], v[56:59], v[80:95]
    v_exp_f32 v24, v24
    v_exp_f32 v25, v25
    v_cvt_pk_bf16_f32 v50, v20, v21
    v_exp_f32 v26, v26
    v_exp_f32 v27, v27
    v_cvt_pk_bf16_f32 v51, v22, v23
    v_mfma_f32_32x32x16_bf16 v[80:95], a[172:175], v[60:63], v[80:95]
    v_exp_f32 v28, v28
    v_exp_f32 v29, v29
    v_cvt_pk_bf16_f32 v52, v24, v25
    v_exp_f32 v30, v30
    v_exp_f32 v31, v31
    v_cvt_pk_bf16_f32 v53, v26, v27
    v_cvt_pk_bf16_f32 v54, v28, v29
    v_cvt_pk_bf16_f32 v55, v30, v31
    s_waitcnt vmcnt(25)
    v_mfma_f32_32x32x16_bf16 v[16:31], a[192:195], v[0:3], 0
    v_exp_f32 v32, v32
    v_exp_f32 v33, v33
    v_exp_f32 v34, v34
    v_exp_f32 v35, v35
    buffer_load_dwordx2 a[160:161], v14, s[8:11], s62 offen offset:512 sc1
    buffer_load_dwordx2 a[162:163], v14, s[8:11], s63 offen offset:512 sc1
    v_mfma_f32_32x32x8bf16_1k v[16:31], a[196:197], v[8:9], v[16:31]
    v_exp_f32 v36, v36
    v_exp_f32 v37, v37
    v_cvt_pk_bf16_f32 v56, v32, v33
    v_exp_f32 v38, v38
    v_exp_f32 v39, v39
    v_cvt_pk_bf16_f32 v57, v34, v35
    buffer_load_dword a164, v12, s[8:11], s64 offen offset:512 sc1
    v_mfma_f32_32x32x16_bf16 v[64:79], a[184:187], v[48:51], v[64:79]
    v_exp_f32 v40, v40
    v_exp_f32 v41, v41
    v_cvt_pk_bf16_f32 v58, v36, v37
    v_exp_f32 v42, v42
    v_exp_f32 v43, v43
    v_cvt_pk_bf16_f32 v59, v38, v39
    buffer_load_dwordx4 a[168:171], v13, s[8:11], 0 offen offset:2304 sc1
    buffer_load_dwordx4 a[172:175], v13, s[8:11], 0 offen offset:2880 sc1
    v_mfma_f32_32x32x16_bf16 v[64:79], a[188:191], v[52:55], v[64:79]
    v_exp_f32 v44, v44
    v_exp_f32 v45, v45
    v_cvt_pk_bf16_f32 v60, v40, v41
    v_exp_f32 v46, v46
    v_exp_f32 v47, v47
    v_cvt_pk_bf16_f32 v61, v42, v43
    v_cvt_pk_bf16_f32 v62, v44, v45
    v_cvt_pk_bf16_f32 v63, v46, v47
    v_mfma_f32_32x32x16_bf16 v[32:47], a[192:195], v[4:7], 0
    v_exp_f32 v16, v16
    v_exp_f32 v17, v17
    v_exp_f32 v18, v18
    v_exp_f32 v19, v19
    v_mfma_f32_32x32x8bf16_1k v[32:47], a[196:197], v[10:11], v[32:47]
    v_exp_f32 v20, v20
    v_exp_f32 v21, v21
    v_cvt_pk_bf16_f32 v48, v16, v17
    v_exp_f32 v22, v22
    v_exp_f32 v23, v23
    v_cvt_pk_bf16_f32 v49, v18, v19
    v_mfma_f32_32x32x16_bf16 v[80:95], a[184:187], v[56:59], v[80:95]
    v_exp_f32 v24, v24
    v_exp_f32 v25, v25
    v_cvt_pk_bf16_f32 v50, v20, v21
    v_exp_f32 v26, v26
    v_exp_f32 v27, v27
    v_cvt_pk_bf16_f32 v51, v22, v23
    v_mfma_f32_32x32x16_bf16 v[80:95], a[188:191], v[60:63], v[80:95]
    v_exp_f32 v28, v28
    v_exp_f32 v29, v29
    v_cvt_pk_bf16_f32 v52, v24, v25
    v_exp_f32 v30, v30
    v_exp_f32 v31, v31
    v_cvt_pk_bf16_f32 v53, v26, v27
    v_cvt_pk_bf16_f32 v54, v28, v29
    v_cvt_pk_bf16_f32 v55, v30, v31
    s_waitcnt vmcnt(25)
    v_mfma_f32_32x32x16_bf16 v[16:31], a[208:211], v[0:3], 0
    v_exp_f32 v32, v32
    v_exp_f32 v33, v33
    v_exp_f32 v34, v34
    v_exp_f32 v35, v35
    buffer_load_dwordx2 a[176:177], v14, s[8:11], s62 offen offset:768 sc1
    buffer_load_dwordx2 a[178:179], v14, s[8:11], s63 offen offset:768 sc1
    v_mfma_f32_32x32x8bf16_1k v[16:31], a[212:213], v[8:9], v[16:31]
    v_exp_f32 v36, v36
    v_exp_f32 v37, v37
    v_cvt_pk_bf16_f32 v56, v32, v33
    v_exp_f32 v38, v38
    v_exp_f32 v39, v39
    v_cvt_pk_bf16_f32 v57, v34, v35
    buffer_load_dword a180, v12, s[8:11], s64 offen offset:768 sc1
    v_mfma_f32_32x32x16_bf16 v[64:79], a[200:203], v[48:51], v[64:79]
    v_exp_f32 v40, v40
    v_exp_f32 v41, v41
    v_cvt_pk_bf16_f32 v58, v36, v37
    v_exp_f32 v42, v42
    v_exp_f32 v43, v43
    v_cvt_pk_bf16_f32 v59, v38, v39
    buffer_load_dwordx4 a[184:187], v13, s[8:11], 0 offen offset:3456 sc1
    buffer_load_dwordx4 a[188:191], v13, s[8:11], 0 offen offset:4032 sc1
    v_mfma_f32_32x32x16_bf16 v[64:79], a[204:207], v[52:55], v[64:79]
    v_exp_f32 v44, v44
    v_exp_f32 v45, v45
    v_cvt_pk_bf16_f32 v60, v40, v41
    v_exp_f32 v46, v46
    v_exp_f32 v47, v47
    v_cvt_pk_bf16_f32 v61, v42, v43
    v_cvt_pk_bf16_f32 v62, v44, v45
    v_cvt_pk_bf16_f32 v63, v46, v47
    v_mfma_f32_32x32x16_bf16 v[32:47], a[208:211], v[4:7], 0
    v_exp_f32 v16, v16
    v_exp_f32 v17, v17
    v_exp_f32 v18, v18
    v_exp_f32 v19, v19
    v_mfma_f32_32x32x8bf16_1k v[32:47], a[212:213], v[10:11], v[32:47]
    v_exp_f32 v20, v20
    v_exp_f32 v21, v21
    v_cvt_pk_bf16_f32 v48, v16, v17
    v_exp_f32 v22, v22
    v_exp_f32 v23, v23
    v_cvt_pk_bf16_f32 v49, v18, v19
    v_mfma_f32_32x32x16_bf16 v[80:95], a[200:203], v[56:59], v[80:95]
    v_exp_f32 v24, v24
    v_exp_f32 v25, v25
    v_cvt_pk_bf16_f32 v50, v20, v21
    v_exp_f32 v26, v26
    v_exp_f32 v27, v27
    v_cvt_pk_bf16_f32 v51, v22, v23
    v_mfma_f32_32x32x16_bf16 v[80:95], a[204:207], v[60:63], v[80:95]
    v_exp_f32 v28, v28
    v_exp_f32 v29, v29
    v_cvt_pk_bf16_f32 v52, v24, v25
    v_exp_f32 v30, v30
    v_exp_f32 v31, v31
    v_cvt_pk_bf16_f32 v53, v26, v27
    v_cvt_pk_bf16_f32 v54, v28, v29
    v_cvt_pk_bf16_f32 v55, v30, v31
    s_waitcnt vmcnt(25)
    v_mfma_f32_32x32x16_bf16 v[16:31], a[224:227], v[0:3], 0
    v_exp_f32 v32, v32
    v_exp_f32 v33, v33
    v_exp_f32 v34, v34
    v_exp_f32 v35, v35
    buffer_load_dwordx2 a[192:193], v14, s[8:11], s62 offen offset:1024 sc1
    buffer_load_dwordx2 a[194:195], v14, s[8:11], s63 offen offset:1024 sc1
    v_mfma_f32_32x32x8bf16_1k v[16:31], a[228:229], v[8:9], v[16:31]
    v_exp_f32 v36, v36
    v_exp_f32 v37, v37
    v_cvt_pk_bf16_f32 v56, v32, v33
    v_exp_f32 v38, v38
    v_exp_f32 v39, v39
    v_cvt_pk_bf16_f32 v57, v34, v35
    buffer_load_dword a196, v12, s[8:11], s64 offen offset:1024 sc1
    v_mfma_f32_32x32x16_bf16 v[64:79], a[216:219], v[48:51], v[64:79]
    v_exp_f32 v40, v40
    v_exp_f32 v41, v41
    v_cvt_pk_bf16_f32 v58, v36, v37
    v_exp_f32 v42, v42
    v_exp_f32 v43, v43
    v_cvt_pk_bf16_f32 v59, v38, v39
    v_add_u32 v13, v108, v13
    buffer_load_dwordx4 a[200:203], v13, s[8:11], 0 offen offset:0 sc1
    buffer_load_dwordx4 a[204:207], v13, s[8:11], 0 offen offset:576 sc1
    v_mfma_f32_32x32x16_bf16 v[64:79], a[220:223], v[52:55], v[64:79]
    v_exp_f32 v44, v44
    v_exp_f32 v45, v45
    v_cvt_pk_bf16_f32 v60, v40, v41
    v_exp_f32 v46, v46
    v_exp_f32 v47, v47
    v_cvt_pk_bf16_f32 v61, v42, v43
    v_cvt_pk_bf16_f32 v62, v44, v45
    v_cvt_pk_bf16_f32 v63, v46, v47
    v_mfma_f32_32x32x16_bf16 v[32:47], a[224:227], v[4:7], 0
    v_exp_f32 v16, v16
    v_exp_f32 v17, v17
    v_exp_f32 v18, v18
    v_exp_f32 v19, v19
    v_mfma_f32_32x32x8bf16_1k v[32:47], a[228:229], v[10:11], v[32:47]
    v_exp_f32 v20, v20
    v_exp_f32 v21, v21
    v_cvt_pk_bf16_f32 v48, v16, v17
    v_exp_f32 v22, v22
    v_exp_f32 v23, v23
    v_cvt_pk_bf16_f32 v49, v18, v19
    v_mfma_f32_32x32x16_bf16 v[80:95], a[216:219], v[56:59], v[80:95]
    v_exp_f32 v24, v24
    v_exp_f32 v25, v25
    v_cvt_pk_bf16_f32 v50, v20, v21
    v_exp_f32 v26, v26
    v_exp_f32 v27, v27
    v_cvt_pk_bf16_f32 v51, v22, v23
    v_mfma_f32_32x32x16_bf16 v[80:95], a[220:223], v[60:63], v[80:95]
    v_exp_f32 v28, v28
    v_exp_f32 v29, v29
    v_cvt_pk_bf16_f32 v52, v24, v25
    v_exp_f32 v30, v30
    v_exp_f32 v31, v31
    v_cvt_pk_bf16_f32 v53, v26, v27
    v_cvt_pk_bf16_f32 v54, v28, v29
    v_cvt_pk_bf16_f32 v55, v30, v31
    s_waitcnt vmcnt(25)
    v_mfma_f32_32x32x16_bf16 v[16:31], a[240:243], v[0:3], 0
    v_exp_f32 v32, v32
    v_exp_f32 v33, v33
    v_exp_f32 v34, v34
    v_exp_f32 v35, v35
    buffer_load_dwordx2 a[208:209], v14, s[8:11], s62 offen offset:1280 sc1
    buffer_load_dwordx2 a[210:211], v14, s[8:11], s63 offen offset:1280 sc1
    v_mfma_f32_32x32x8bf16_1k v[16:31], a[244:245], v[8:9], v[16:31]
    v_exp_f32 v36, v36
    v_exp_f32 v37, v37
    v_cvt_pk_bf16_f32 v56, v32, v33
    v_exp_f32 v38, v38
    v_exp_f32 v39, v39
    v_cvt_pk_bf16_f32 v57, v34, v35
    buffer_load_dword a212, v12, s[8:11], s64 offen offset:1280 sc1
    v_mfma_f32_32x32x16_bf16 v[64:79], a[232:235], v[48:51], v[64:79]
    v_exp_f32 v40, v40
    v_exp_f32 v41, v41
    v_cvt_pk_bf16_f32 v58, v36, v37
    v_exp_f32 v42, v42
    v_exp_f32 v43, v43
    v_cvt_pk_bf16_f32 v59, v38, v39
    buffer_load_dwordx4 a[216:219], v13, s[8:11], 0 offen offset:1152 sc1
    buffer_load_dwordx4 a[220:223], v13, s[8:11], 0 offen offset:1728 sc1
    v_mfma_f32_32x32x16_bf16 v[64:79], a[236:239], v[52:55], v[64:79]
    v_exp_f32 v44, v44
    v_exp_f32 v45, v45
    v_cvt_pk_bf16_f32 v60, v40, v41
    v_exp_f32 v46, v46
    v_exp_f32 v47, v47
    v_cvt_pk_bf16_f32 v61, v42, v43
    v_cvt_pk_bf16_f32 v62, v44, v45
    v_cvt_pk_bf16_f32 v63, v46, v47
    v_mfma_f32_32x32x16_bf16 v[32:47], a[240:243], v[4:7], 0
    v_exp_f32 v16, v16
    v_exp_f32 v17, v17
    v_exp_f32 v18, v18
    v_exp_f32 v19, v19
    v_mfma_f32_32x32x8bf16_1k v[32:47], a[244:245], v[10:11], v[32:47]
    v_exp_f32 v20, v20
    v_exp_f32 v21, v21
    v_cvt_pk_bf16_f32 v48, v16, v17
    v_exp_f32 v22, v22
    v_exp_f32 v23, v23
    v_cvt_pk_bf16_f32 v49, v18, v19
    v_mfma_f32_32x32x16_bf16 v[80:95], a[232:235], v[56:59], v[80:95]
    v_exp_f32 v24, v24
    v_exp_f32 v25, v25
    v_cvt_pk_bf16_f32 v50, v20, v21
    v_exp_f32 v26, v26
    v_exp_f32 v27, v27
    v_cvt_pk_bf16_f32 v51, v22, v23
    v_mfma_f32_32x32x16_bf16 v[80:95], a[236:239], v[60:63], v[80:95]
    v_exp_f32 v28, v28
    v_exp_f32 v29, v29
    v_cvt_pk_bf16_f32 v52, v24, v25
    v_exp_f32 v30, v30
    v_exp_f32 v31, v31
    v_cvt_pk_bf16_f32 v53, v26, v27
    v_cvt_pk_bf16_f32 v54, v28, v29
    v_cvt_pk_bf16_f32 v55, v30, v31
    s_waitcnt vmcnt(25)
    v_mfma_f32_32x32x16_bf16 v[16:31], a[128:131], v[0:3], 0
    v_exp_f32 v32, v32
    v_exp_f32 v33, v33
    v_exp_f32 v34, v34
    v_exp_f32 v35, v35
    buffer_load_dwordx2 a[224:225], v14, s[8:11], s62 offen offset:1536 sc1
    buffer_load_dwordx2 a[226:227], v14, s[8:11], s63 offen offset:1536 sc1
    v_mfma_f32_32x32x8bf16_1k v[16:31], a[132:133], v[8:9], v[16:31]
    v_exp_f32 v36, v36
    v_exp_f32 v37, v37
    v_cvt_pk_bf16_f32 v56, v32, v33
    v_exp_f32 v38, v38
    v_exp_f32 v39, v39
    v_cvt_pk_bf16_f32 v57, v34, v35
    buffer_load_dword a228, v12, s[8:11], s64 offen offset:1536 sc1
    v_mfma_f32_32x32x16_bf16 v[64:79], a[248:251], v[48:51], v[64:79]
    v_exp_f32 v40, v40
    v_exp_f32 v41, v41
    v_cvt_pk_bf16_f32 v58, v36, v37
    v_exp_f32 v42, v42
    v_exp_f32 v43, v43
    v_cvt_pk_bf16_f32 v59, v38, v39
    buffer_load_dwordx4 a[232:235], v13, s[8:11], 0 offen offset:2304 sc1
    buffer_load_dwordx4 a[236:239], v13, s[8:11], 0 offen offset:2880 sc1
    v_mfma_f32_32x32x16_bf16 v[64:79], a[252:255], v[52:55], v[64:79]
    v_exp_f32 v44, v44
    v_exp_f32 v45, v45
    v_cvt_pk_bf16_f32 v60, v40, v41
    v_exp_f32 v46, v46
    v_exp_f32 v47, v47
    v_cvt_pk_bf16_f32 v61, v42, v43
    v_cvt_pk_bf16_f32 v62, v44, v45
    v_cvt_pk_bf16_f32 v63, v46, v47
    s_sub_u32 s68, s68, 1
    s_cmp_lg_u32 s68, 0
    s_cbranch_scc1 parallel_sum__softmax_full_mha__dense_activation_relu__prompt_kernel_fb2loop
    v_mfma_f32_32x32x16_bf16 v[80:95], a[248:251], v[56:59], v[80:95]
    v_mfma_f32_32x32x16_bf16 v[80:95], a[252:255], v[60:63], v[80:95]
    s_waitcnt vmcnt(0)
    s_nop 11
    s_branch parallel_sum__softmax_full_mha__dense_activation_relu__prompt_kernel_afinish
parallel_sum__softmax_full_mha__dense_activation_relu__prompt_kernel_codeend:
    s_endpgm
.section .rodata,"a"
.p2align 6
.amdhsa_kernel parallel_sum__softmax_full_mha__dense_activation_relu__prompt_kernel
  .amdhsa_next_free_vgpr 512
  .amdhsa_next_free_sgpr 102
  .amdhsa_accum_offset 256
  .amdhsa_group_segment_fixed_size 0
  .amdhsa_kernarg_size 72
  .amdhsa_user_sgpr_count 2
  .amdhsa_user_sgpr_kernarg_segment_ptr 1
  .amdhsa_system_sgpr_workgroup_id_x 1
.end_amdhsa_kernel
.text
```
